```python
import torch

def _softmax(x, axis=-1):
    return torch.softmax(x, dim=axis)
def _gelu(x):
    return torch.nn.functional.gelu(x, approximate="tanh")
def _silu(x):
    return torch.nn.functional.silu(x)
def _sigmoid(x):
    return torch.sigmoid(x)
def _layernorm(x, axis=-1, eps=1e-5):
    m = x.mean(dim=axis, keepdim=True)
    v = x.var(dim=axis, keepdim=True, unbiased=False)
    return (x - m) / torch.sqrt(v + eps)
def _scatter_add(tgt, idx, src, axis=0):
    return tgt.clone().index_add_(axis, idx, src)
def _segment_sum(src, seg, n):
    out = torch.zeros((n,) + src.shape[1:], dtype=src.dtype)
    return out.index_add_(0, seg, src)
def _pad(x, pw):
    flat = tuple(v for pair in reversed(pw) for v in pair)
    return torch.nn.functional.pad(x, flat)

kernel_name = 'gated_mix__compressed_kv_cla__dense_activation_relu__prompt'

def setup_inputs():

    _w = (lambda a: (lambda t: t.to(torch.bfloat16) if t.is_floating_point() else t)(torch.as_tensor(a)))
    def _A_setup():
        B, H, Sq, Sk, D, M = 1, 32, 2048, 2048, 128, 512
        Dc = 4 * D
        return {
            "x": _w((lambda *s: torch.randn(*s, dtype=torch.bfloat16) * 0.05)(B, Sq, M)),
            "c_kv": _w((lambda *s: torch.randn(*s, dtype=torch.bfloat16) * 0.8)(B, Sk, Dc)),
            "w_q": _w((lambda *s: torch.randn(*s, dtype=torch.bfloat16) * 6.4)(M, H, D) * (M ** -0.5)),
            "w_uk": _w((lambda *s: torch.randn(*s, dtype=torch.bfloat16) * 6.4)(Dc, H, D) * (Dc ** -0.5)),
            "w_uv": _w((lambda *s: torch.randn(*s, dtype=torch.bfloat16) * 0.8)(Dc, H, D) * (Dc ** -0.5)),
            "w_o": _w((lambda *s: torch.randn(*s, dtype=torch.bfloat16) * 0.8)(H, D, M) * ((H * D) ** -0.5)),
        }
    _A_in = _A_setup()

    def _B_setup():
        B, S, D, Dff = 1, 2048, 512, 1792
        return {
            "x": _w((lambda *s: torch.randn(*s, dtype=torch.bfloat16) * 0.05)(B, S, D)),
            "w1": _w((lambda *s: torch.randn(*s, dtype=torch.bfloat16) * 0.05)(D, Dff)),
            "w2": _w((lambda *s: torch.randn(*s, dtype=torch.bfloat16) * 0.05)(Dff, D)),
        }
    _B_in = _B_setup()

    return {
        "A_x": _A_in["x"],
        "A_c_kv": _A_in["c_kv"],
        "A_w_q": _A_in["w_q"],
        "A_w_uk": _A_in["w_uk"],
        "A_w_uv": _A_in["w_uv"],
        "A_w_o": _A_in["w_o"],
        "B_x": _B_in["x"],
        "B_w1": _B_in["w1"],
        "B_w2": _B_in["w2"],
        "gate_w": _w((lambda *s: torch.randn(*s, dtype=torch.bfloat16) * 0.05)(512) * 16.0),
    }

def reference(A_x, A_c_kv, A_w_q, A_w_uk, A_w_uv, A_w_o, B_x, B_w1, B_w2, gate_w):
    def _A_ref(x, c_kv, w_q, w_uk, w_uv, w_o):
        B, Sq, M = x.shape[0], x.shape[1], x.shape[2]
        Sk = c_kv.shape[1]
        H, D = w_q.shape[1], w_q.shape[2]
        q = torch.einsum("bqm,mhd->bhqd", x, w_q)
        k = torch.einsum("bkc,chd->bhkd", c_kv, w_uk)
        v = torch.einsum("bkc,chd->bhkd", c_kv, w_uv)
        scores = torch.einsum("bhqd,bhkd->bhqk", q, k) * (D ** -0.5)
        off = Sk - Sq
        qi = torch.arange(Sq)[:, None]
        kj = torch.arange(Sk)[None, :]
        cmask = kj <= (qi + off)
        scores = torch.where(cmask[None, None], scores, -1e9)
        p = _softmax(scores, axis=-1)
        ctx = torch.einsum("bhqk,bhkd->bhqd", p, v)
        return torch.einsum("bhqd,hdm->bqm", ctx, w_o)

    def _B_ref(x, w1, w2):
        h = torch.einsum("bsd,df->bsf", x, w1)
        zero = torch.zeros_like(h)
        h = torch.maximum(h, zero)
        return torch.einsum("bsf,fd->bsd", h, w2)

    x = A_x
    g = _sigmoid((x * gate_w).sum(-1, keepdims=True))
    a = _A_ref(x, A_c_kv, A_w_q, A_w_uk, A_w_uv, A_w_o)
    b = _B_ref(x, B_w1, B_w2)
    return g * a + (1 - g) * b
```

```asm
; @launch grid=(256,1,1) block=(256,1,1) lds=163840
.amdgcn_target "amdgcn-amd-amdhsa--gfx950"
.text
.globl gated_mix__compressed_kv_cla__dense_activation_relu__prompt_kernel
.p2align 12
.p2align 8
.type gated_mix__compressed_kv_cla__dense_activation_relu__prompt_kernel,@function
gated_mix__compressed_kv_cla__dense_activation_relu__prompt_kernel:
s_cmp_ge_u32 s2, 256
s_cbranch_scc1 L_exit
s_load_dwordx8 s[52:59], s[0:1], 16
s_load_dwordx2 s[8:9], s[0:1], 8
s_load_dwordx2 s[48:49], s[0:1], 0
s_load_dwordx2 s[62:63], s[0:1], 56
s_load_dwordx8 s[64:71], s[0:1], 64
s_load_dwordx2 s[72:73], s[0:1], 96
v_lshrrev_b32 v4, 6, v0
v_and_b32 v0, 63, v0
v_readfirstlane_b32 s3, v4
s_getpc_b64 s[76:77]
L_pc:
s_lshr_b32 s6, s2, 3
v_lshl_add_u32 v6, s6, 2, v4
v_min_u32 v7, 5, v0
v_lshl_add_u32 v6, v7, 7, v6
v_lshlrev_b32 v6, 7, v6
v_min_u32 v6, L_last-L_pc, v6
global_load_dword v8, v6, s[76:77]
v_lshlrev_b32 v1, 4, v0
s_and_b32 s6, s2, 7
s_lshl_b32 s4, s6, 2
s_lshr_b32 s7, s2, 6
s_add_u32 s4, s4, s7
s_bfe_u32 s5, s2, 0x30003
s_lshl_b32 s82, s3, 12
s_lshl_b32 s83, s3, 11
s_lshl_b32 s84, s3, 13
s_mov_b32 s85, 0x3e0293ee
s_lshr_b32 s6, s3, 1
s_and_b32 s7, s3, 1
s_mul_i32 s101, s6, 7
s_xor_b32 s93, s101, 0
s_lshl_b32 s93, s93, 3
s_add_u32 s93, s93, s5
s_xor_b32 s94, s101, 1
s_lshl_b32 s94, s94, 3
s_add_u32 s94, s94, s5
s_xor_b32 s95, s101, 2
s_lshl_b32 s95, s95, 3
s_add_u32 s95, s95, s5
s_xor_b32 s96, s101, 3
s_lshl_b32 s96, s96, 3
s_add_u32 s96, s96, s5
s_cmp_eq_u32 s7, 0
s_cselect_b32 s86, s93, s94
s_cselect_b32 s87, s95, s96
s_lshl_b32 s86, s86, 15
s_lshl_b32 s87, s87, 15
s_mul_i32 s101, s4, 1119232
s_lshl_b32 s80, s7, 13
s_add_u32 s101, s101, s80
s_mul_i32 s93, s93, 17408
s_add_u32 s93, s93, s101
s_mul_i32 s94, s94, 17408
s_add_u32 s94, s94, s101
s_mul_i32 s95, s95, 17408
s_add_u32 s95, s95, s101
s_mul_i32 s96, s96, 17408
s_add_u32 s96, s96, s101
s_lshl_b32 s88, s4, 8
s_lshl_b32 s101, s7, 7
s_add_u32 s88, s88, s101
v_lshrrev_b32 v4, 3, v0
v_and_b32 v6, 7, v0
v_lshrrev_b32 v7, 4, v0
v_xor_b32 v12, v6, v7
v_lshlrev_b32 v12, 4, v12
v_lshl_add_u32 v80, v4, 10, v12
v_xor_b32 v81, 64, v80
v_and_b32 v12, 1, v7
v_lshlrev_b32 v12, 1, v12
v_xor_b32 v12, v6, v12
v_lshlrev_b32 v12, 4, v12
v_lshl_add_u32 v82, v4, 13, v12
v_xor_b32 v83, 64, v82
v_mul_u32_u24 v4, 3584, v4
v_add_u32 v84, v4, v12
v_xor_b32 v12, 64, v12
v_add_u32 v85, v4, v12
s_mov_b32 s10, 2097152
s_mov_b32 s11, 0x20000
s_mov_b32 s14, 4194304
s_mov_b32 s15, 0x20000
s_xor_b32 s60, s2, s5
s_and_b32 s60, s60, 4
v_lshrrev_b32 v4, 4, v0
v_bfe_u32 v6, v0, 2, 2
v_lshlrev_b32 v6, 7, v6
v_lshl_add_u32 v6, v4, 10, v6
v_and_b32 v7, 3, v0
v_lshl_add_u32 v6, v7, 3, v6
v_bfe_u32 v7, v0, 3, 2
v_lshl_add_u32 v88, v7, 5, v6
v_xor_b32 v89, 32, v88
v_xor_b32 v90, 64, v88
v_xor_b32 v91, 96, v88
s_and_b32 s6, s82, 4096
v_add_u32 v16, s6, v88
v_add_u32 v17, s6, v89
v_add_u32 v18, s6, v90
v_add_u32 v19, s6, v91
v_add_u32 v32, 65536, v16
v_add_u32 v33, 65536, v17
v_add_u32 v34, 65536, v18
v_add_u32 v35, 65536, v19
v_and_b32 v6, 15, v0
v_lshrrev_b32 v7, 1, v6
v_xor_b32 v7, v4, v7
v_lshlrev_b32 v7, 4, v7
v_lshl_add_u32 v7, v6, 7, v7
v_xor_b32 v12, 64, v7
s_and_b32 s6, s82, 8192
s_add_u32 s7, s6, 131072
s_add_u32 s6, s6, 65536
v_add_u32 v48, s6, v7
v_add_u32 v49, s6, v12
v_add_u32 v50, s7, v7
v_add_u32 v51, s7, v12
s_add_u32 s7, s84, 131072
s_add_u32 s6, s84, 65536
v_add_u32 v92, s6, v7
v_add_u32 v93, s6, v12
v_add_u32 v94, s7, v7
v_add_u32 v95, s7, v12
v_lshlrev_b32 v7, 4, v6
v_lshlrev_b32 v12, 6, v4
v_xor_b32 v7, v7, v12
v_lshl_add_u32 v86, v4, 10, v7
v_lshrrev_b32 v6, 2, v0
v_and_b32 v7, 3, v0
v_lshlrev_b32 v7, 4, v7
v_and_b32 v12, 3, v6
v_lshl_add_u32 v7, v12, 6, v7
v_lshl_add_u32 v6, v6, 8, v7
s_add_u32 s6, s84, 98304
v_add_u32 v87, s6, v6
s_add_u32 s61, s60, 0
s_and_b32 s61, s61, 7
s_mul_i32 s61, s61, 524288
s_add_u32 s61, s61, s88
s_add_u32 m0, s82, 65536
s_add_u32 s80, s61, 0
s_cmp_lt_u32 s3, 2
s_waitcnt lgkmcnt(0)
s_cselect_b64 s[12:13], s[54:55], s[56:57]
buffer_load_dwordx4 v82, s[12:15], s80 offen lds
s_add_u32 m0, s82, 66560
s_add_u32 s80, s61, 65536
buffer_load_dwordx4 v83, s[12:15], s80 offen lds
s_add_u32 m0, s82, 67584
s_add_u32 s80, s61, 131072
buffer_load_dwordx4 v82, s[12:15], s80 offen lds
s_add_u32 m0, s82, 68608
s_add_u32 s80, s61, 196608
buffer_load_dwordx4 v83, s[12:15], s80 offen lds
s_add_u32 s61, s60, 0
s_and_b32 s61, s61, 7
s_mul_i32 s61, s61, 128
s_add_u32 s61, s61, s86
s_add_u32 m0, s82, 98304
s_add_u32 s80, s61, 0
buffer_load_dwordx4 v80, s[8:11], s80 offen lds
s_add_u32 m0, s82, 99328
s_add_u32 s80, s61, 8192
buffer_load_dwordx4 v81, s[8:11], s80 offen lds
s_add_u32 m0, s82, 100352
s_add_u32 s80, s61, 16384
buffer_load_dwordx4 v80, s[8:11], s80 offen lds
s_add_u32 m0, s82, 101376
s_add_u32 s80, s61, 24576
buffer_load_dwordx4 v81, s[8:11], s80 offen lds
s_add_u32 s61, s60, 0
s_and_b32 s61, s61, 7
s_mul_i32 s61, s61, 524288
s_add_u32 s61, s61, s88
s_add_u32 m0, s82, 81920
s_add_u32 s80, s61, 262144
buffer_load_dwordx4 v82, s[12:15], s80 offen lds
s_add_u32 m0, s82, 82944
s_add_u32 s80, s61, 327680
buffer_load_dwordx4 v83, s[12:15], s80 offen lds
s_add_u32 m0, s82, 83968
s_add_u32 s80, s61, 393216
buffer_load_dwordx4 v82, s[12:15], s80 offen lds
s_add_u32 m0, s82, 84992
s_add_u32 s80, s61, 458752
buffer_load_dwordx4 v83, s[12:15], s80 offen lds
s_add_u32 s61, s60, 0
s_and_b32 s61, s61, 7
s_mul_i32 s61, s61, 128
s_add_u32 s61, s61, s87
s_add_u32 m0, s82, 114688
s_add_u32 s80, s61, 0
v_mov_b32 v5, 1073741824
v_mov_b32 v2, 1073741824
v_writelane_b32 v2, 0, 0
s_lshl_b32 s6, s4, 3
s_add_u32 s6, s6, s5
s_lshl_b32 s7, s6, 2
s_add_u32 s7, s7, s3
s_lshl_b32 s7, s7, 2
s_add_u32 s99, s7, 79691776
v_writelane_b32 v5, s99, 0
s_add_u32 s7, s99, 4096
v_writelane_b32 v5, s7, 7
s_lshl_b32 s7, s3, 10
s_lshl2_add_u32 s7, s2, s7
s_add_u32 s7, s7, 79716352
v_writelane_b32 v5, s7, 8
s_lshl_b32 s6, s5, 1
s_lshr_b32 s7, s3, 1
s_add_u32 s6, s6, s7
s_lshl_b32 s6, s6, 2
s_lshr_b32 s7, s4, 3
s_add_u32 s6, s6, s7
s_lshl_b32 s6, s6, 7
s_and_b32 s7, s4, 7
s_lshl_b32 s7, s7, 1
s_and_b32 s101, s3, 1
s_add_u32 s7, s7, s101
s_lshl_b32 s7, s7, 2
s_add_u32 s6, s6, s7
s_add_u32 s7, s6, 79708160
v_writelane_b32 v5, s7, 2
s_add_u32 s7, s6, 79724544
v_writelane_b32 v5, s7, 3
s_lshl_b32 s6, s5, 1
s_lshr_b32 s7, s3, 1
s_add_u32 s6, s6, s7
s_lshl_b32 s6, s6, 9
s_mul_i32 s7, s4, 37
s_lshr_b32 s7, s7, 8
s_mul_i32 s7, s7, 72
s_add_u32 s6, s6, s7
s_lshl_b32 s7, s4, 1
s_add_u32 s7, s7, s101
s_lshl_b32 s7, s7, 2
s_add_u32 s6, s6, s7
s_add_u32 s6, s6, 79699968
s_cmp_lt_u32 s4, 28
s_cselect_b32 s6, s6, 1073741824
v_writelane_b32 v5, s6, 1
s_lshl_b32 s6, s5, 1
s_lshr_b32 s7, s3, 1
s_add_u32 s6, s6, s7
s_and_b32 s7, s4, 7
s_lshl3_add_u32 s6, s6, s7
s_lshr_b32 s7, s4, 4
s_lshl2_add_u32 s6, s6, s7
s_lshl2_add_u32 s6, s6, s101
s_bfe_u32 s7, s4, 0x10003
s_lshl1_add_u32 s6, s6, s7
s_lshl2_add_u32 s6, s6, 69206016
v_writelane_b32 v5, s6, 15
s_add_u32 s6, s6, 16
v_writelane_b32 v5, s6, 31
s_add_u32 s6, s6, 48
v_writelane_b32 v5, s6, 47
s_add_u32 s6, s6, 16
v_writelane_b32 v5, s6, 63
s_and_b32 s6, s2, 1
s_lshl1_add_u32 s6, s5, s6
s_lshr_b32 s7, s2, 6
s_lshl2_add_u32 s6, s6, s7
s_lshl_b32 s6, s6, 9
s_lshl_b32 s7, s3, 4
s_add_u32 s6, s6, s7
s_bfe_u32 s7, s2, 0x20001
s_add_u32 s7, s7, 1
s_and_b32 s7, s7, 3
s_lshl_b32 s7, s7, 7
s_add_u32 s7, s7, s6
s_add_u32 s7, s7, 79740928
v_writelane_b32 v5, s7, 4
s_bfe_u32 s7, s2, 0x20001
s_add_u32 s7, s7, 2
s_and_b32 s7, s7, 3
s_lshl_b32 s7, s7, 7
s_add_u32 s7, s7, s6
s_add_u32 s7, s7, 79740932
v_writelane_b32 v5, s7, 5
s_bfe_u32 s7, s2, 0x20001
s_add_u32 s7, s7, 3
s_and_b32 s7, s7, 3
s_lshl_b32 s7, s7, 7
s_add_u32 s7, s7, s6
s_add_u32 s7, s7, 79740936
v_writelane_b32 v5, s7, 6
v_mov_b32 v13, 0
s_mov_b32 s28, s72
s_mov_b32 s29, s73
s_mov_b32 s30, 268435456
s_mov_b32 s31, 0x20000
s_mov_b32 s16, s48
s_mov_b32 s17, s49
s_mov_b32 s18, 2097152
s_mov_b32 s19, 0x20000
s_mov_b32 s20, s52
s_mov_b32 s21, s53
s_mov_b32 s22, 4194304
s_mov_b32 s23, 0x20000
s_mov_b32 s24, s62
s_mov_b32 s25, s63
s_mov_b32 s26, 1835008
s_mov_b32 s27, 0x20000
s_cmp_lt_u32 s4, 28
s_cselect_b32 s26, s26, 0
s_mov_b32 s36, s70
s_mov_b32 s37, s71
s_mov_b32 s38, 256
s_mov_b32 s39, 0x20000
s_mov_b32 s44, s66
s_mov_b32 s45, s67
s_mov_b32 s46, 1024
s_mov_b32 s47, 0x20000
s_mov_b32 s76, s68
s_mov_b32 s77, s69
s_mov_b32 s78, 2097152
s_mov_b32 s79, 0x20000
s_mov_b32 s40, s72
s_mov_b32 s41, s73
s_mov_b32 s42, 268435456
s_mov_b32 s43, 0x20000
s_cmp_lt_u32 s2, 128
s_cselect_b32 s32, s58, s64
s_cselect_b32 s33, s59, s65
s_mov_b32 s6, 1835008
s_cselect_b32 s34, 4194304, s6
s_mov_b32 s35, 0x20000
s_and_b32 s97, s2, 127
s_lshl_b32 s97, s97, 15
s_lshl_b32 s6, s3, 8
s_add_u32 s97, s97, s6
s_mul_i32 s98, s3, 1512448
s_lshl_b32 s6, s2, 11
s_add_u32 s98, s98, s6
s_add_u32 s98, s98, 62914560
s_cmp_lt_u32 s2, 184
s_cselect_b32 s98, s98, 1073741824
s_sub_u32 s6, 15, s5
s_lshl_b32 s6, s6, 2
s_add_u32 s6, s6, s3
s_lshl_b32 s89, s6, 15
s_lshl_b32 s6, s5, 2
s_add_u32 s6, s6, 3
s_sub_u32 s6, s6, s3
s_lshl_b32 s90, s6, 15
s_lshl_b32 s91, s3, 17
s_lshl_b32 s6, s4, 8
s_add_u32 s91, s91, s6
s_mul_i32 s92, s3, 57344
s_lshl_b32 s6, s4, 7
s_add_u32 s92, s92, s6
s_lshr_b32 s72, s4, 3
s_lshl_b32 s6, s5, 1
s_lshr_b32 s7, s3, 1
s_add_u32 s6, s6, s7
s_lshl_b32 s6, s6, 2
s_add_u32 s6, s6, s72
s_mul_i32 s73, s6, 275456
s_and_b32 s7, s4, 7
s_lshl_b32 s7, s7, 12
s_add_u32 s73, s73, s7
s_add_u32 s73, s73, 36700160
s_and_b32 s7, s3, 1
s_lshl_b32 s7, s7, 1
s_add_u32 s7, s7, 7
s_sub_u32 s7, s7, s72
s_and_b32 s7, s7, 3
s_add_u32 s101, s7, 4
s_mul_i32 s7, s7, 33792
s_mul_i32 s101, s101, 33792
s_add_u32 s52, s73, s101
s_add_u32 s54, s73, s7
s_and_b32 s7, s3, 1
s_lshl_b32 s7, s7, 1
s_add_u32 s7, s7, 8
s_sub_u32 s7, s7, s72
s_and_b32 s7, s7, 3
s_add_u32 s101, s7, 4
s_mul_i32 s7, s7, 33792
s_mul_i32 s101, s101, 33792
s_add_u32 s53, s73, s101
s_add_u32 s55, s73, s7
s_mul_i32 s72, s4, 37
s_lshr_b32 s72, s72, 8
s_lshl_b32 s6, s5, 1
s_lshr_b32 s7, s3, 1
s_add_u32 s6, s6, s7
s_lshl_b32 s6, s6, 2
s_add_u32 s6, s6, s72
s_mul_i32 s73, s6, 115712
s_mul_i32 s7, s72, 7
s_sub_u32 s7, s4, s7
s_lshl_b32 s7, s7, 11
s_add_u32 s73, s73, s7
s_add_u32 s73, s73, 54525952
s_cmp_lt_u32 s4, 28
s_cselect_b32 s73, s73, 1073741824
s_and_b32 s7, s3, 1
s_lshl_b32 s7, s7, 1
s_add_u32 s7, s7, 7
s_sub_u32 s7, s7, s72
s_and_b32 s7, s7, 3
s_add_u32 s101, s7, 3
s_cmp_eq_u32 s7, 3
s_cselect_b32 s7, 6, s7
s_cselect_b32 s101, 7, s101
s_mul_i32 s7, s7, 14336
s_mul_i32 s101, s101, 14336
s_add_u32 s48, s73, s101
s_add_u32 s50, s73, s7
s_and_b32 s7, s3, 1
s_lshl_b32 s7, s7, 1
s_add_u32 s7, s7, 8
s_sub_u32 s7, s7, s72
s_and_b32 s7, s7, 3
s_add_u32 s101, s7, 3
s_cmp_eq_u32 s7, 3
s_cselect_b32 s7, 6, s7
s_cselect_b32 s101, 7, s101
s_mul_i32 s7, s7, 14336
s_mul_i32 s101, s101, 14336
s_add_u32 s49, s73, s101
s_add_u32 s51, s73, s7
s_bfe_u32 s70, s2, 0x20001
s_and_b32 s6, s2, 1
s_lshl1_add_u32 s69, s5, s6
s_lshr_b32 s71, s2, 6
s_lshl_b32 s6, s69, 2
s_add_u32 s6, s6, s70
s_mul_i32 s68, s6, 115712
s_add_u32 s68, s68, 54525952
s_add_u32 s68, s68, s82
s_mul_i32 s56, s4, 1119232
s_add_u32 s56, s56, s82
s_add_u32 s63, s82, 32768
s_lshl_b32 s66, s5, 2
s_sub_u32 s66, s66, 1
s_lshl_b32 s59, s5, 2
s_add_u32 s59, s59, 4
s_sub_u32 s59, s59, s3
s_mov_b32 s67, 0
s_cmp_eq_u32 s5, 0
s_cselect_b32 s42, 4096, 0
buffer_store_dword v13, v5, s[28:31], 0 offen sc1
buffer_load_dwordx4 v80, s[8:11], s80 offen lds
s_add_u32 m0, s82, 115712
s_add_u32 s80, s61, 8192
buffer_load_dwordx4 v81, s[8:11], s80 offen lds
s_add_u32 m0, s82, 116736
s_add_u32 s80, s61, 16384
buffer_load_dwordx4 v80, s[8:11], s80 offen lds
s_add_u32 m0, s82, 117760
s_add_u32 s80, s61, 24576
buffer_load_dwordx4 v81, s[8:11], s80 offen lds
s_add_u32 s61, s60, 1
s_and_b32 s61, s61, 7
s_mul_i32 s61, s61, 524288
s_add_u32 s61, s61, s88
s_add_u32 m0, s82, 0
s_add_u32 s80, s61, 0
buffer_load_dwordx4 v82, s[12:15], s80 offen lds
s_add_u32 m0, s82, 1024
s_add_u32 s80, s61, 65536
buffer_load_dwordx4 v83, s[12:15], s80 offen lds
s_add_u32 m0, s82, 2048
s_add_u32 s80, s61, 131072
buffer_load_dwordx4 v82, s[12:15], s80 offen lds
s_add_u32 m0, s82, 3072
s_add_u32 s80, s61, 196608
buffer_load_dwordx4 v83, s[12:15], s80 offen lds
s_add_u32 s61, s60, 1
s_and_b32 s61, s61, 7
s_mul_i32 s61, s61, 524288
s_add_u32 s61, s61, s88
s_add_u32 m0, s82, 16384
s_add_u32 s80, s61, 262144
s_mov_b64 exec, 0
s_cmp_eq_u32 s3, 1
s_cbranch_scc1 L_pad1
s_cmp_eq_u32 s3, 2
s_cbranch_scc1 L_pad2
s_cmp_eq_u32 s3, 3
s_cbranch_scc1 L_pad3
s_branch L_pad0
L_padret0:
s_mov_b64 exec, -1
s_waitcnt vmcnt(13)
s_barrier
ds_read_b64_tr_b16 a[136:137], v32 offset:0
buffer_load_dwordx4 v82, s[12:15], s80 offen lds
s_add_u32 m0, s82, 17408
s_add_u32 s80, s61, 327680
ds_read_b64_tr_b16 a[138:139], v32 offset:512
ds_read_b128 v[64:67], v48 offset:32768
ds_read_b128 v[20:23], v48 offset:34816
ds_read_b128 v[36:39], v48 offset:36864
ds_read_b64_tr_b16 a[252:253], v33 offset:0
ds_read_b64_tr_b16 a[254:255], v33 offset:512
buffer_load_dwordx4 v83, s[12:15], s80 offen lds
s_add_u32 m0, s82, 18432
s_add_u32 s80, s61, 393216
ds_read_b128 v[52:55], v48 offset:38912
s_waitcnt lgkmcnt(5)
ds_read_b64_tr_b16 a[132:133], v34 offset:0
v_mfma_f32_16x16x32_bf16 a[140:143], a[136:139], v[64:67], 0
s_waitcnt lgkmcnt(5)
ds_read_b64_tr_b16 a[134:135], v34 offset:512
v_mfma_f32_16x16x32_bf16 a[144:147], a[136:139], v[20:23], 0
s_waitcnt lgkmcnt(5)
ds_read_b64_tr_b16 a[148:149], v35 offset:0
v_mfma_f32_16x16x32_bf16 a[152:155], a[136:139], v[36:39], 0
s_waitcnt lgkmcnt(3)
ds_read_b64_tr_b16 a[150:151], v35 offset:512
v_mfma_f32_16x16x32_bf16 a[0:3], a[136:139], v[52:55], 0
buffer_load_dwordx4 v82, s[12:15], s80 offen lds
v_mfma_f32_16x16x32_bf16 a[4:7], a[252:255], v[64:67], 0
s_add_u32 m0, s82, 19456
s_add_u32 s80, s61, 458752
ds_read_b64_tr_b16 a[8:9], v32 offset:8192
v_mfma_f32_16x16x32_bf16 a[156:159], a[252:255], v[20:23], 0
ds_read_b64_tr_b16 a[10:11], v32 offset:8704
v_mfma_f32_16x16x32_bf16 a[12:15], a[252:255], v[36:39], 0
v_mfma_f32_16x16x32_bf16 a[16:19], a[252:255], v[52:55], 0
s_waitcnt lgkmcnt(4)
v_mfma_f32_16x16x32_bf16 a[20:23], a[132:135], v[64:67], 0
ds_read_b64_tr_b16 a[24:25], v33 offset:8192
v_mfma_f32_16x16x32_bf16 a[28:31], a[132:135], v[20:23], 0
ds_read_b64_tr_b16 a[26:27], v33 offset:8704
v_mfma_f32_16x16x32_bf16 a[160:163], a[132:135], v[36:39], 0
buffer_load_dwordx4 v83, s[12:15], s80 offen lds
v_mfma_f32_16x16x32_bf16 a[64:67], a[132:135], v[52:55], 0
s_waitcnt lgkmcnt(4)
s_add_u32 s61, s60, 1
ds_read_b128 v[68:71], v49 offset:32768
v_mfma_f32_16x16x32_bf16 a[68:71], a[148:151], v[64:67], 0
s_and_b32 s61, s61, 7
s_mul_i32 s61, s61, 128
ds_read_b64_tr_b16 a[72:73], v34 offset:8192
v_mfma_f32_16x16x32_bf16 a[76:79], a[148:151], v[20:23], 0
s_add_u32 s61, s61, s86
s_add_u32 m0, s82, 131072
ds_read_b64_tr_b16 a[74:75], v34 offset:8704
v_mfma_f32_16x16x32_bf16 a[80:83], a[148:151], v[36:39], 0
s_add_u32 s80, s61, 0
ds_read_b128 v[24:27], v49 offset:34816
v_mfma_f32_16x16x32_bf16 a[84:87], a[148:151], v[52:55], 0
s_waitcnt lgkmcnt(6)
ds_read_b128 v[40:43], v49 offset:36864
v_mfma_f32_16x16x32_bf16 v[56:59], v[64:67], a[8:11], 0
buffer_load_dwordx4 v80, s[8:11], s80 offen lds
v_mfma_f32_16x16x32_bf16 v[72:75], v[20:23], a[8:11], 0
s_add_u32 m0, s82, 132096
s_add_u32 s80, s61, 8192
ds_read_b64_tr_b16 a[88:89], v35 offset:8192
v_mfma_f32_16x16x32_bf16 v[232:235], v[36:39], a[8:11], 0
s_waitcnt vmcnt(14)
ds_read_b64_tr_b16 a[90:91], v35 offset:8704
v_mfma_f32_16x16x32_bf16 v[28:31], v[52:55], a[8:11], 0
s_waitcnt lgkmcnt(7)
s_barrier
v_mfma_f32_16x16x32_bf16 v[44:47], v[64:67], a[24:27], 0
ds_read_b128 v[60:63], v49 offset:38912
v_mfma_f32_16x16x32_bf16 v[76:79], v[20:23], a[24:27], 0
ds_read_b64_tr_b16 a[92:93], v32 offset:16384
v_mfma_f32_16x16x32_bf16 v[236:239], v[36:39], a[24:27], 0
ds_read_b64_tr_b16 a[94:95], v32 offset:16896
v_mfma_f32_16x16x32_bf16 v[240:243], v[52:55], a[24:27], 0
s_waitcnt lgkmcnt(6)
buffer_load_dwordx4 v81, s[8:11], s80 offen lds
v_mfma_f32_16x16x32_bf16 v[244:247], v[64:67], a[72:75], 0
s_add_u32 m0, s82, 133120
s_add_u32 s80, s61, 16384
ds_read_b64_tr_b16 a[32:33], v33 offset:16384
v_mfma_f32_16x16x32_bf16 v[248:251], v[20:23], a[72:75], 0
s_getreg_b32 s65, hwreg(HW_REG_XCC_ID, 0, 4)
s_lshl_b32 s65, 0x100, s65
ds_read_b64_tr_b16 a[34:35], v33 offset:16896
v_mfma_f32_16x16x32_bf16 v[252:255], v[36:39], a[72:75], 0
L_pad0:
s_cbranch_execz L_pad4
s_mov_b32 s81, s65
s_bitset1_b32 s81, s5
v_mov_b32 v13, s81
v_mfma_f32_16x16x32_bf16 v[112:115], v[52:55], a[72:75], 0
s_waitcnt lgkmcnt(5)
s_lshl_b32 s81, s4, 3
v_mfma_f32_16x16x32_bf16 v[116:119], v[64:67], a[88:91], 0
s_cmp_eq_u32 s3, 0
s_cselect_b32 s81, s81, 1073741824
ds_read_b64_tr_b16 a[36:37], v34 offset:16384
v_mfma_f32_16x16x32_bf16 v[120:123], v[20:23], a[88:91], 0
ds_read_b64_tr_b16 a[38:39], v34 offset:16896
v_mfma_f32_16x16x32_bf16 v[124:127], v[36:39], a[88:91], 0
buffer_load_dwordx4 v80, s[8:11], s80 offen lds
v_mfma_f32_16x16x32_bf16 v[128:131], v[52:55], a[88:91], 0
s_waitcnt lgkmcnt(4)
s_add_u32 m0, s82, 134144
s_add_u32 s80, s61, 24576
v_mfma_f32_16x16x32_bf16 a[140:143], a[92:95], v[68:71], a[140:143]
ds_read_b64_tr_b16 a[40:41], v35 offset:16384
v_mfma_f32_16x16x32_bf16 a[144:147], a[92:95], v[24:27], a[144:147]
ds_read_b64_tr_b16 a[42:43], v35 offset:16896
v_mfma_f32_16x16x32_bf16 a[152:155], a[92:95], v[40:43], a[152:155]
v_mfma_f32_16x16x32_bf16 a[0:3], a[92:95], v[60:63], a[0:3]
s_waitcnt lgkmcnt(4)
v_mfma_f32_16x16x32_bf16 a[4:7], a[32:35], v[68:71], a[4:7]
buffer_load_dwordx4 v81, s[8:11], s80 offen lds
v_mfma_f32_16x16x32_bf16 a[156:159], a[32:35], v[24:27], a[156:159]
s_add_u32 s61, s60, 2
s_and_b32 s61, s61, 7
ds_read_b64_tr_b16 a[44:45], v32 offset:24576
v_mfma_f32_16x16x32_bf16 a[12:15], a[32:35], v[40:43], a[12:15]
s_mul_i32 s61, s61, 524288
s_add_u32 s61, s61, s88
ds_read_b64_tr_b16 a[46:47], v32 offset:25088
v_mfma_f32_16x16x32_bf16 a[16:19], a[32:35], v[60:63], a[16:19]
s_waitcnt vmcnt(12) lgkmcnt(4)
s_add_u32 m0, s82, 32768
s_add_u32 s80, s61, 0
v_mfma_f32_16x16x32_bf16 a[20:23], a[36:39], v[68:71], a[20:23]
s_barrier
v_mfma_f32_16x16x32_bf16 a[28:31], a[36:39], v[24:27], a[28:31]
ds_read_b64_tr_b16 a[48:49], v33 offset:24576
v_mfma_f32_16x16x32_bf16 a[160:163], a[36:39], v[40:43], a[160:163]
ds_read_b64_tr_b16 a[50:51], v33 offset:25088
v_mfma_f32_16x16x32_bf16 a[64:67], a[36:39], v[60:63], a[64:67]
s_waitcnt lgkmcnt(4)
buffer_load_dwordx4 v82, s[12:15], s80 offen lds
v_mfma_f32_16x16x32_bf16 a[68:71], a[40:43], v[68:71], a[68:71]
s_add_u32 m0, s82, 33792
buffer_atomic_or v13, v2, s[36:39], s81 offen sc1
v_mfma_f32_16x16x32_bf16 a[76:79], a[40:43], v[24:27], a[76:79]
s_add_u32 s80, s61, 65536
ds_read_b64_tr_b16 a[52:53], v34 offset:24576
v_mfma_f32_16x16x32_bf16 a[80:83], a[40:43], v[40:43], a[80:83]
ds_read_b64_tr_b16 a[54:55], v34 offset:25088
v_mov_b32 v13, 1
v_mfma_f32_16x16x32_bf16 a[84:87], a[40:43], v[60:63], a[84:87]
s_waitcnt lgkmcnt(4)
s_add_u32 s81, s98, 0
ds_read_b128 v[64:67], v48 offset:49152
v_mfma_f32_16x16x32_bf16 v[56:59], v[68:71], a[44:47], v[56:59]
ds_read_b64_tr_b16 a[56:57], v35 offset:24576
v_mfma_f32_16x16x32_bf16 v[72:75], v[24:27], a[44:47], v[72:75]
ds_read_b64_tr_b16 a[58:59], v35 offset:25088
v_mfma_f32_16x16x32_bf16 v[232:235], v[40:43], a[44:47], v[232:235]
ds_read_b128 v[20:23], v49 offset:49152
v_mfma_f32_16x16x32_bf16 v[28:31], v[60:63], a[44:47], v[28:31]
s_waitcnt lgkmcnt(6)
buffer_load_dwordx4 v83, s[12:15], s80 offen lds
v_mfma_f32_16x16x32_bf16 v[44:47], v[68:71], a[48:51], v[44:47]
s_add_u32 m0, s82, 34816
s_add_u32 s80, s61, 131072
v_mfma_f32_16x16x32_bf16 v[76:79], v[24:27], a[48:51], v[76:79]
v_mfma_f32_16x16x32_bf16 v[236:239], v[40:43], a[48:51], v[236:239]
v_mfma_f32_16x16x32_bf16 v[240:243], v[60:63], a[48:51], v[240:243]
s_waitcnt lgkmcnt(4)
v_mfma_f32_16x16x32_bf16 v[244:247], v[68:71], a[52:55], v[244:247]
v_mfma_f32_16x16x32_bf16 v[248:251], v[24:27], a[52:55], v[248:251]
buffer_load_dwordx4 v82, s[12:15], s80 offen lds
v_mfma_f32_16x16x32_bf16 v[252:255], v[40:43], a[52:55], v[252:255]
s_add_u32 m0, s82, 35840
s_add_u32 s80, s61, 196608
ds_read_b128 v[32:35], v48 offset:51200
v_mfma_f32_16x16x32_bf16 v[112:115], v[60:63], a[52:55], v[112:115]
s_waitcnt lgkmcnt(1)
ds_read_b128 v[36:39], v49 offset:51200
v_mfma_f32_16x16x32_bf16 v[116:119], v[68:71], a[56:59], v[116:119]
v_mfma_f32_16x16x32_bf16 v[120:123], v[24:27], a[56:59], v[120:123]
v_mfma_f32_16x16x32_bf16 v[124:127], v[40:43], a[56:59], v[124:127]
v_mfma_f32_16x16x32_bf16 v[128:131], v[60:63], a[56:59], v[128:131]
buffer_load_dwordx4 v83, s[12:15], s80 offen lds
v_mfma_f32_16x16x32_bf16 a[60:63], a[136:139], v[64:67], 0
s_add_u32 s61, s60, 1
s_and_b32 s61, s61, 7
s_mul_i32 s61, s61, 128
v_mfma_f32_16x16x32_bf16 a[60:63], a[92:95], v[20:23], a[60:63]
s_waitcnt vmcnt(13)
s_add_u32 s61, s61, s87
s_add_u32 m0, s82, 147456
v_mfma_f32_16x16x32_bf16 a[96:99], a[32:35], v[20:23], 0
s_barrier
v_mfma_f32_16x16x32_bf16 a[96:99], a[252:255], v[64:67], a[96:99]
s_add_u32 s80, s61, 0
ds_read_b64_tr_b16 a[100:101], v16 offset:0
v_mfma_f32_16x16x32_bf16 a[104:107], a[132:135], v[64:67], 0
ds_read_b64_tr_b16 a[102:103], v16 offset:512
v_mfma_f32_16x16x32_bf16 a[104:107], a[36:39], v[20:23], a[104:107]
buffer_load_dwordx4 v80, s[8:11], s80 offen lds
v_mfma_f32_16x16x32_bf16 a[108:111], a[40:43], v[20:23], 0
s_add_u32 m0, s82, 148480
s_add_u32 s80, s61, 8192
ds_read_b64_tr_b16 a[112:113], v17 offset:0
v_mfma_f32_16x16x32_bf16 a[108:111], a[148:151], v[64:67], a[108:111]
ds_read_b64_tr_b16 a[114:115], v17 offset:512
v_mfma_f32_16x16x32_bf16 v[132:135], v[64:67], a[8:11], 0
ds_read_b64_tr_b16 a[116:117], v18 offset:0
v_mfma_f32_16x16x32_bf16 v[132:135], v[20:23], a[44:47], v[132:135]
ds_read_b64_tr_b16 a[118:119], v18 offset:512
v_mfma_f32_16x16x32_bf16 v[136:139], v[20:23], a[48:51], 0
ds_read_b128 v[52:55], v48 offset:53248
v_mfma_f32_16x16x32_bf16 v[136:139], v[64:67], a[24:27], v[136:139]
buffer_load_dwordx4 v81, s[8:11], s80 offen lds
v_mfma_f32_16x16x32_bf16 v[140:143], v[64:67], a[72:75], 0
s_add_u32 m0, s82, 149504
s_add_u32 s80, s61, 16384
ds_read_b128 v[68:71], v49 offset:53248
v_mfma_f32_16x16x32_bf16 v[140:143], v[20:23], a[52:55], v[140:143]
ds_read_b64_tr_b16 a[120:121], v19 offset:0
v_mfma_f32_16x16x32_bf16 v[96:99], v[20:23], a[56:59], 0
ds_read_b64_tr_b16 a[122:123], v19 offset:512
v_mfma_f32_16x16x32_bf16 v[96:99], v[64:67], a[88:91], v[96:99]
s_waitcnt lgkmcnt(7)
ds_read_b64_tr_b16 a[124:125], v16 offset:8192
v_mfma_f32_16x16x32_bf16 v[24:27], v[32:35], a[88:91], 0
ds_read_b64_tr_b16 a[126:127], v16 offset:8704
v_mfma_f32_16x16x32_bf16 v[24:27], v[36:39], a[56:59], v[24:27]
buffer_load_dwordx4 v80, s[8:11], s80 offen lds
v_mfma_f32_16x16x32_bf16 v[40:43], v[36:39], a[52:55], 0
s_add_u32 m0, s82, 150528
s_add_u32 s80, s61, 24576
ds_read_b64_tr_b16 a[128:129], v17 offset:8192
v_mfma_f32_16x16x32_bf16 v[40:43], v[32:35], a[72:75], v[40:43]
ds_read_b64_tr_b16 a[130:131], v17 offset:8704
v_mfma_f32_16x16x32_bf16 v[64:67], v[32:35], a[24:27], 0
ds_read_b64_tr_b16 a[164:165], v18 offset:8192
v_mfma_f32_16x16x32_bf16 v[64:67], v[36:39], a[48:51], v[64:67]
ds_read_b64_tr_b16 a[166:167], v18 offset:8704
v_mfma_f32_16x16x32_bf16 v[20:23], v[36:39], a[44:47], 0
ds_read_b64_tr_b16 a[168:169], v19 offset:8192
v_mfma_f32_16x16x32_bf16 v[20:23], v[32:35], a[8:11], v[20:23]
s_waitcnt vmcnt(12)
buffer_load_dwordx4 v81, s[8:11], s80 offen lds
v_mfma_f32_16x16x32_bf16 a[172:175], a[148:151], v[32:35], 0
s_barrier
v_mfma_f32_16x16x32_bf16 a[172:175], a[40:43], v[36:39], a[172:175]
s_add_u32 s61, s60, 2
s_and_b32 s61, s61, 7
ds_read_b64_tr_b16 a[170:171], v19 offset:8704
v_mfma_f32_16x16x32_bf16 a[176:179], a[36:39], v[36:39], 0
s_mul_i32 s61, s61, 524288
s_add_u32 s61, s61, s88
ds_read_b128 v[60:63], v48 offset:55296
v_mfma_f32_16x16x32_bf16 a[176:179], a[132:135], v[32:35], a[176:179]
s_add_u32 m0, s82, 49152
s_add_u32 s80, s61, 262144
ds_read_b128 v[100:103], v49 offset:55296
v_mfma_f32_16x16x32_bf16 a[180:183], a[252:255], v[32:35], 0
ds_read_b64_tr_b16 a[184:185], v16 offset:16384
v_mfma_f32_16x16x32_bf16 a[180:183], a[32:35], v[36:39], a[180:183]
buffer_load_dwordx4 v82, s[12:15], s80 offen lds
v_mfma_f32_16x16x32_bf16 a[188:191], a[92:95], v[36:39], 0
s_add_u32 m0, s82, 50176
s_add_u32 s80, s61, 327680
ds_read_b64_tr_b16 a[186:187], v16 offset:16896
v_mfma_f32_16x16x32_bf16 a[188:191], a[136:139], v[32:35], a[188:191]
s_waitcnt lgkmcnt(5)
ds_read_b64_tr_b16 a[192:193], v17 offset:16384
v_mfma_f32_16x16x32_bf16 a[196:199], a[136:139], v[52:55], 0
ds_read_b64_tr_b16 a[194:195], v17 offset:16896
v_mfma_f32_16x16x32_bf16 a[196:199], a[92:95], v[68:71], a[196:199]
ds_read_b64_tr_b16 a[200:201], v18 offset:16384
v_mfma_f32_16x16x32_bf16 a[204:207], a[32:35], v[68:71], 0
ds_read_b64_tr_b16 a[202:203], v18 offset:16896
v_mfma_f32_16x16x32_bf16 a[204:207], a[252:255], v[52:55], a[204:207]
buffer_load_dwordx4 v83, s[12:15], s80 offen lds
v_mfma_f32_16x16x32_bf16 a[208:211], a[132:135], v[52:55], 0
s_add_u32 m0, s82, 51200
s_add_u32 s80, s61, 393216
ds_read_b64_tr_b16 a[212:213], v19 offset:16384
v_mfma_f32_16x16x32_bf16 a[208:211], a[36:39], v[68:71], a[208:211]
s_lshl_b32 s62, s3, 10
s_lshl2_add_u32 s62, s2, s62
ds_read_b64_tr_b16 a[214:215], v19 offset:16896
v_mfma_f32_16x16x32_bf16 a[216:219], a[40:43], v[68:71], 0
s_add_u32 s62, s62, 79716352
ds_read_b64_tr_b16 a[220:221], v16 offset:24576
v_mfma_f32_16x16x32_bf16 a[216:219], a[148:151], v[52:55], a[216:219]
s_waitcnt vmcnt(6)
ds_read_b64_tr_b16 a[222:223], v16 offset:25088
v_mfma_f32_16x16x32_bf16 v[104:107], v[52:55], a[8:11], 0
s_barrier
v_mfma_f32_16x16x32_bf16 v[104:107], v[68:71], a[44:47], v[104:107]
buffer_load_dwordx4 v82, s[12:15], s80 offen lds
v_mfma_f32_16x16x32_bf16 v[108:111], v[68:71], a[48:51], 0
s_add_u32 m0, s82, 52224
s_add_u32 s80, s61, 458752
ds_read_b128 v[32:35], v50 offset:0
v_mfma_f32_16x16x32_bf16 v[108:111], v[52:55], a[24:27], v[108:111]
ds_read_b128 v[36:39], v51 offset:0
v_mfma_f32_16x16x32_bf16 v[144:147], v[52:55], a[72:75], 0
ds_read_b64_tr_b16 a[224:225], v17 offset:24576
v_mfma_f32_16x16x32_bf16 v[144:147], v[68:71], a[52:55], v[144:147]
ds_read_b64_tr_b16 a[226:227], v17 offset:25088
v_mfma_f32_16x16x32_bf16 v[148:151], v[68:71], a[56:59], 0
ds_read_b64_tr_b16 a[228:229], v18 offset:24576
v_mfma_f32_16x16x32_bf16 v[148:151], v[52:55], a[88:91], v[148:151]
s_waitcnt lgkmcnt(6)
buffer_load_dwordx4 v83, s[12:15], s80 offen lds
v_mfma_f32_16x16x32_bf16 v[152:155], v[60:63], a[88:91], 0
s_add_u32 s61, s60, 2
s_and_b32 s61, s61, 7
ds_read_b64_tr_b16 a[230:231], v18 offset:25088
v_mfma_f32_16x16x32_bf16 v[152:155], v[100:103], a[56:59], v[152:155]
s_mul_i32 s61, s61, 128
s_add_u32 s61, s61, s86
ds_read_b64_tr_b16 a[232:233], v19 offset:24576
v_mfma_f32_16x16x32_bf16 v[52:55], v[100:103], a[52:55], 0
s_add_u32 m0, s82, 65536
s_add_u32 s80, s61, 0
ds_read_b64_tr_b16 a[234:235], v19 offset:25088
v_mfma_f32_16x16x32_bf16 v[52:55], v[60:63], a[72:75], v[52:55]
v_mfma_f32_16x16x32_bf16 v[68:71], v[60:63], a[24:27], 0
v_mfma_f32_16x16x32_bf16 v[68:71], v[100:103], a[48:51], v[68:71]
buffer_load_dwordx4 v80, s[8:11], s80 offen lds
v_mfma_f32_16x16x32_bf16 v[156:159], v[100:103], a[44:47], 0
s_add_u32 m0, s82, 66560
s_add_u32 s80, s61, 8192
v_mfma_f32_16x16x32_bf16 v[156:159], v[60:63], a[8:11], v[156:159]
v_mfma_f32_16x16x32_bf16 a[88:91], a[148:151], v[60:63], 0
v_mfma_f32_16x16x32_bf16 a[88:91], a[40:43], v[100:103], a[88:91]
v_mfma_f32_16x16x32_bf16 a[52:55], a[36:39], v[100:103], 0
ds_read_b128 v[160:163], v50 offset:2048
v_mfma_f32_16x16x32_bf16 a[52:55], a[132:135], v[60:63], a[52:55]
buffer_load_dwordx4 v81, s[8:11], s80 offen lds
v_mfma_f32_16x16x32_bf16 a[24:27], a[252:255], v[60:63], 0
s_add_u32 m0, s82, 67584
s_add_u32 s80, s61, 16384
ds_read_b128 v[164:167], v51 offset:2048
v_mfma_f32_16x16x32_bf16 a[24:27], a[32:35], v[100:103], a[24:27]
v_mfma_f32_16x16x32_bf16 a[148:151], a[92:95], v[100:103], 0
v_mfma_f32_16x16x32_bf16 a[148:151], a[136:139], v[60:63], a[148:151]
s_waitcnt lgkmcnt(2)
v_mfma_f32_16x16x32_bf16 a[140:143], a[100:103], v[32:35], a[140:143]
ds_read_b64_tr_b16 a[132:133], v16 offset:32768
v_mfma_f32_16x16x32_bf16 a[140:143], a[184:187], v[36:39], a[140:143]
buffer_load_dwordx4 v80, s[8:11], s80 offen lds
v_mfma_f32_16x16x32_bf16 a[4:7], a[192:195], v[36:39], a[4:7]
s_add_u32 m0, s82, 68608
s_add_u32 s80, s61, 24576
ds_read_b64_tr_b16 a[134:135], v16 offset:33280
v_mfma_f32_16x16x32_bf16 a[4:7], a[112:115], v[32:35], a[4:7]
ds_read_b64_tr_b16 a[136:137], v17 offset:32768
v_mfma_f32_16x16x32_bf16 a[20:23], a[116:119], v[32:35], a[20:23]
ds_read_b64_tr_b16 a[138:139], v17 offset:33280
v_mfma_f32_16x16x32_bf16 a[20:23], a[200:203], v[36:39], a[20:23]
ds_read_b64_tr_b16 a[252:253], v18 offset:32768
v_mfma_f32_16x16x32_bf16 a[68:71], a[212:215], v[36:39], a[68:71]
ds_read_b64_tr_b16 a[254:255], v18 offset:33280
v_mfma_f32_16x16x32_bf16 a[68:71], a[120:123], v[32:35], a[68:71]
buffer_load_dwordx4 v81, s[8:11], s80 offen lds
v_mfma_f32_16x16x32_bf16 v[56:59], v[32:35], a[124:127], v[56:59]
s_add_u32 s61, s60, 3
s_and_b32 s61, s61, 7
ds_read_b64_tr_b16 a[8:9], v19 offset:32768
v_mfma_f32_16x16x32_bf16 v[56:59], v[36:39], a[220:223], v[56:59]
s_mul_i32 s61, s61, 524288
s_add_u32 s61, s61, s88
ds_read_b64_tr_b16 a[10:11], v19 offset:33280
v_mfma_f32_16x16x32_bf16 v[44:47], v[36:39], a[224:227], v[44:47]
s_add_u32 m0, s82, 0
s_add_u32 s80, s61, 0
ds_read_b128 v[60:63], v50 offset:4096
v_mfma_f32_16x16x32_bf16 v[44:47], v[32:35], a[128:131], v[44:47]
ds_read_b128 v[100:103], v51 offset:4096
v_mfma_f32_16x16x32_bf16 v[244:247], v[32:35], a[164:167], v[244:247]
ds_read_b64_tr_b16 a[72:73], v16 offset:40960
v_mfma_f32_16x16x32_bf16 v[244:247], v[36:39], a[228:231], v[244:247]
ds_read_b64_tr_b16 a[74:75], v16 offset:41472
v_mfma_f32_16x16x32_bf16 v[116:119], v[36:39], a[232:235], v[116:119]
ds_read_b64_tr_b16 a[92:93], v17 offset:40960
v_mfma_f32_16x16x32_bf16 v[116:119], v[32:35], a[168:171], v[116:119]
s_waitcnt lgkmcnt(7)
ds_read_b64_tr_b16 a[94:95], v17 offset:41472
v_mfma_f32_16x16x32_bf16 v[120:123], v[160:163], a[168:171], v[120:123]
ds_read_b64_tr_b16 a[32:33], v18 offset:40960
v_mfma_f32_16x16x32_bf16 v[120:123], v[164:167], a[232:235], v[120:123]
ds_read_b64_tr_b16 a[34:35], v18 offset:41472
v_mfma_f32_16x16x32_bf16 v[248:251], v[164:167], a[228:231], v[248:251]
ds_read_b64_tr_b16 a[36:37], v19 offset:40960
v_mfma_f32_16x16x32_bf16 v[248:251], v[160:163], a[164:167], v[248:251]
ds_read_b64_tr_b16 a[38:39], v19 offset:41472
v_mfma_f32_16x16x32_bf16 v[76:79], v[160:163], a[128:131], v[76:79]
v_mfma_f32_16x16x32_bf16 v[76:79], v[164:167], a[224:227], v[76:79]
v_mfma_f32_16x16x32_bf16 v[72:75], v[164:167], a[220:223], v[72:75]
v_mfma_f32_16x16x32_bf16 v[72:75], v[160:163], a[124:127], v[72:75]
v_mfma_f32_16x16x32_bf16 a[76:79], a[120:123], v[160:163], a[76:79]
v_mfma_f32_16x16x32_bf16 a[76:79], a[212:215], v[164:167], a[76:79]
v_mfma_f32_16x16x32_bf16 a[28:31], a[200:203], v[164:167], a[28:31]
ds_read_b128 v[32:35], v50 offset:6144
v_mfma_f32_16x16x32_bf16 a[28:31], a[116:119], v[160:163], a[28:31]
ds_read_b128 v[36:39], v51 offset:6144
v_mfma_f32_16x16x32_bf16 a[156:159], a[112:115], v[160:163], a[156:159]
v_mfma_f32_16x16x32_bf16 a[156:159], a[192:195], v[164:167], a[156:159]
v_mfma_f32_16x16x32_bf16 a[144:147], a[184:187], v[164:167], a[144:147]
v_mfma_f32_16x16x32_bf16 a[144:147], a[100:103], v[160:163], a[144:147]
s_waitcnt lgkmcnt(2)
v_mfma_f32_16x16x32_bf16 a[152:155], a[100:103], v[60:63], a[152:155]
v_mfma_f32_16x16x32_bf16 a[152:155], a[184:187], v[100:103], a[152:155]
v_mfma_f32_16x16x32_bf16 a[12:15], a[192:195], v[100:103], a[12:15]
v_mfma_f32_16x16x32_bf16 a[12:15], a[112:115], v[60:63], a[12:15]
v_mfma_f32_16x16x32_bf16 a[160:163], a[116:119], v[60:63], a[160:163]
v_mfma_f32_16x16x32_bf16 a[160:163], a[200:203], v[100:103], a[160:163]
v_mfma_f32_16x16x32_bf16 a[80:83], a[212:215], v[100:103], a[80:83]
v_mfma_f32_16x16x32_bf16 a[80:83], a[120:123], v[60:63], a[80:83]
s_waitcnt vmcnt(4)
v_mfma_f32_16x16x32_bf16 v[232:235], v[60:63], a[124:127], v[232:235]
s_barrier
v_mfma_f32_16x16x32_bf16 v[232:235], v[100:103], a[220:223], v[232:235]
buffer_load_dwordx4 v82, s[12:15], s80 offen lds
v_mfma_f32_16x16x32_bf16 v[236:239], v[100:103], a[224:227], v[236:239]
s_add_u32 m0, s82, 1024
s_add_u32 s80, s61, 65536
ds_read_b128 v[160:163], v50 offset:16384
v_mfma_f32_16x16x32_bf16 v[236:239], v[60:63], a[128:131], v[236:239]
ds_read_b128 v[164:167], v51 offset:16384
v_mfma_f32_16x16x32_bf16 v[252:255], v[60:63], a[164:167], v[252:255]
ds_read_b64_tr_b16 a[40:41], v16 offset:49152
v_mfma_f32_16x16x32_bf16 v[252:255], v[100:103], a[228:231], v[252:255]
v_mfma_f32_16x16x32_bf16 v[124:127], v[100:103], a[232:235], v[124:127]
ds_read_b64_tr_b16 a[42:43], v16 offset:49664
v_mfma_f32_16x16x32_bf16 v[124:127], v[60:63], a[168:171], v[124:127]
s_waitcnt lgkmcnt(4)
buffer_load_dwordx4 v83, s[12:15], s80 offen lds
v_mfma_f32_16x16x32_bf16 v[128:131], v[32:35], a[168:171], v[128:131]
s_add_u32 m0, s82, 2048
s_add_u32 s80, s61, 131072
ds_read_b64_tr_b16 a[44:45], v17 offset:49152
v_mfma_f32_16x16x32_bf16 v[128:131], v[36:39], a[232:235], v[128:131]
v_mfma_f32_16x16x32_bf16 v[112:115], v[36:39], a[228:231], v[112:115]
ds_read_b64_tr_b16 a[46:47], v17 offset:49664
v_mfma_f32_16x16x32_bf16 v[112:115], v[32:35], a[164:167], v[112:115]
v_mfma_f32_16x16x32_bf16 v[240:243], v[32:35], a[128:131], v[240:243]
ds_read_b64_tr_b16 a[48:49], v18 offset:49152
v_mfma_f32_16x16x32_bf16 v[240:243], v[36:39], a[224:227], v[240:243]
buffer_load_dwordx4 v82, s[12:15], s80 offen lds
v_mfma_f32_16x16x32_bf16 v[28:31], v[36:39], a[220:223], v[28:31]
s_add_u32 m0, s82, 3072
s_add_u32 s80, s61, 196608
ds_read_b64_tr_b16 a[50:51], v18 offset:49664
v_mfma_f32_16x16x32_bf16 v[28:31], v[32:35], a[124:127], v[28:31]
v_mfma_f32_16x16x32_bf16 a[84:87], a[120:123], v[32:35], a[84:87]
ds_read_b64_tr_b16 a[56:57], v19 offset:49152
v_mfma_f32_16x16x32_bf16 a[84:87], a[212:215], v[36:39], a[84:87]
v_mfma_f32_16x16x32_bf16 a[64:67], a[200:203], v[36:39], a[64:67]
ds_read_b128 v[60:63], v50 offset:18432
v_mfma_f32_16x16x32_bf16 a[64:67], a[116:119], v[32:35], a[64:67]
buffer_load_dwordx4 v83, s[12:15], s80 offen lds
v_mfma_f32_16x16x32_bf16 a[16:19], a[112:115], v[32:35], a[16:19]
s_add_u32 s61, s60, 2
s_and_b32 s61, s61, 7
ds_read_b128 v[100:103], v51 offset:18432
v_mfma_f32_16x16x32_bf16 a[16:19], a[192:195], v[36:39], a[16:19]
s_mul_i32 s61, s61, 128
s_add_u32 s61, s61, s87
ds_read_b64_tr_b16 a[58:59], v19 offset:49664
v_mfma_f32_16x16x32_bf16 a[0:3], a[184:187], v[36:39], a[0:3]
s_add_u32 m0, s82, 81920
s_add_u32 s80, s61, 0
ds_read_b64_tr_b16 a[236:237], v16 offset:57344
v_mfma_f32_16x16x32_bf16 a[0:3], a[100:103], v[32:35], a[0:3]
s_waitcnt lgkmcnt(5)
ds_read_b64_tr_b16 a[238:239], v16 offset:57856
v_mfma_f32_16x16x32_bf16 a[60:63], a[100:103], v[160:163], a[60:63]
ds_read_b64_tr_b16 a[240:241], v17 offset:57344
v_mfma_f32_16x16x32_bf16 a[60:63], a[184:187], v[164:167], a[60:63]
buffer_load_dwordx4 v80, s[8:11], s80 offen lds
v_mfma_f32_16x16x32_bf16 a[96:99], a[192:195], v[164:167], a[96:99]
s_add_u32 m0, s82, 82944
s_add_u32 s80, s61, 8192
ds_read_b64_tr_b16 a[242:243], v17 offset:57856
v_mfma_f32_16x16x32_bf16 a[96:99], a[112:115], v[160:163], a[96:99]
v_mfma_f32_16x16x32_bf16 a[104:107], a[116:119], v[160:163], a[104:107]
ds_read_b64_tr_b16 a[244:245], v18 offset:57344
v_mfma_f32_16x16x32_bf16 a[104:107], a[200:203], v[164:167], a[104:107]
v_mfma_f32_16x16x32_bf16 a[108:111], a[212:215], v[164:167], a[108:111]
ds_read_b64_tr_b16 a[246:247], v18 offset:57856
v_mfma_f32_16x16x32_bf16 a[108:111], a[120:123], v[160:163], a[108:111]
buffer_load_dwordx4 v81, s[8:11], s80 offen lds
v_mfma_f32_16x16x32_bf16 v[132:135], v[160:163], a[124:127], v[132:135]
s_add_u32 m0, s82, 83968
s_add_u32 s80, s61, 16384
ds_read_b64_tr_b16 a[248:249], v19 offset:57344
v_mfma_f32_16x16x32_bf16 v[132:135], v[164:167], a[220:223], v[132:135]
v_mfma_f32_16x16x32_bf16 v[136:139], v[164:167], a[224:227], v[136:139]
ds_read_b128 v[32:35], v50 offset:20480
v_mfma_f32_16x16x32_bf16 v[136:139], v[160:163], a[128:131], v[136:139]
ds_read_b128 v[36:39], v51 offset:20480
v_mfma_f32_16x16x32_bf16 v[140:143], v[160:163], a[164:167], v[140:143]
ds_read_b64_tr_b16 a[250:251], v19 offset:57856
v_mfma_f32_16x16x32_bf16 v[140:143], v[164:167], a[228:231], v[140:143]
buffer_load_dwordx4 v80, s[8:11], s80 offen lds
v_mfma_f32_16x16x32_bf16 v[96:99], v[164:167], a[232:235], v[96:99]
s_add_u32 m0, s82, 84992
s_add_u32 s80, s61, 24576
v_mfma_f32_16x16x32_bf16 v[96:99], v[160:163], a[168:171], v[96:99]
s_waitcnt lgkmcnt(4)
v_mfma_f32_16x16x32_bf16 v[24:27], v[60:63], a[168:171], v[24:27]
v_mfma_f32_16x16x32_bf16 v[24:27], v[100:103], a[232:235], v[24:27]
v_mfma_f32_16x16x32_bf16 v[40:43], v[100:103], a[228:231], v[40:43]
v_mfma_f32_16x16x32_bf16 v[40:43], v[60:63], a[164:167], v[40:43]
buffer_load_dwordx4 v81, s[8:11], s80 offen lds
v_mfma_f32_16x16x32_bf16 v[64:67], v[60:63], a[128:131], v[64:67]
s_add_u32 s61, s60, 3
s_and_b32 s61, s61, 7
s_mul_i32 s61, s61, 524288
v_mfma_f32_16x16x32_bf16 v[64:67], v[100:103], a[224:227], v[64:67]
s_add_u32 s61, s61, s88
s_add_u32 m0, s82, 16384
s_add_u32 s80, s61, 262144
v_mfma_f32_16x16x32_bf16 v[20:23], v[100:103], a[220:223], v[20:23]
v_mfma_f32_16x16x32_bf16 v[20:23], v[60:63], a[124:127], v[20:23]
v_mfma_f32_16x16x32_bf16 a[172:175], a[120:123], v[60:63], a[172:175]
v_mfma_f32_16x16x32_bf16 a[172:175], a[212:215], v[100:103], a[172:175]
buffer_load_dwordx4 v82, s[12:15], s80 offen lds
v_mfma_f32_16x16x32_bf16 a[176:179], a[200:203], v[100:103], a[176:179]
s_add_u32 m0, s82, 17408
s_add_u32 s80, s61, 327680
ds_read_b128 v[160:163], v50 offset:22528
v_mfma_f32_16x16x32_bf16 a[176:179], a[116:119], v[60:63], a[176:179]
ds_read_b128 v[164:167], v51 offset:22528
v_mfma_f32_16x16x32_bf16 a[180:183], a[112:115], v[60:63], a[180:183]
s_bitcmp1_b32 s4, 4
s_cselect_b32 s57, s90, s89
s_and_b32 s101, s4, 15
v_mfma_f32_16x16x32_bf16 a[180:183], a[192:195], v[100:103], a[180:183]
s_lshl_b32 s101, s101, 11
s_add_u32 s57, s57, s101
v_mfma_f32_16x16x32_bf16 a[188:191], a[184:187], v[100:103], a[188:191]
v_mfma_f32_16x16x32_bf16 a[188:191], a[100:103], v[60:63], a[188:191]
s_waitcnt lgkmcnt(2)
buffer_load_dwordx4 v83, s[12:15], s80 offen lds
v_mfma_f32_16x16x32_bf16 a[196:199], a[100:103], v[32:35], a[196:199]
s_add_u32 m0, s82, 18432
s_add_u32 s80, s61, 393216
v_mfma_f32_16x16x32_bf16 a[196:199], a[184:187], v[36:39], a[196:199]
v_mfma_f32_16x16x32_bf16 a[204:207], a[192:195], v[36:39], a[204:207]
v_mfma_f32_16x16x32_bf16 a[204:207], a[112:115], v[32:35], a[204:207]
v_mfma_f32_16x16x32_bf16 a[208:211], a[116:119], v[32:35], a[208:211]
v_mfma_f32_16x16x32_bf16 a[208:211], a[200:203], v[36:39], a[208:211]
buffer_load_dwordx4 v82, s[12:15], s80 offen lds
v_mfma_f32_16x16x32_bf16 a[216:219], a[212:215], v[36:39], a[216:219]
s_add_u32 m0, s82, 19456
s_add_u32 s80, s61, 458752
v_mfma_f32_16x16x32_bf16 a[216:219], a[120:123], v[32:35], a[216:219]
s_waitcnt vmcnt(7)
v_mfma_f32_16x16x32_bf16 v[104:107], v[32:35], a[124:127], v[104:107]
s_barrier
v_mfma_f32_16x16x32_bf16 v[104:107], v[36:39], a[220:223], v[104:107]
v_mfma_f32_16x16x32_bf16 v[108:111], v[36:39], a[224:227], v[108:111]
ds_read_b128 v[60:63], v48 offset:0
v_mfma_f32_16x16x32_bf16 v[108:111], v[32:35], a[128:131], v[108:111]
buffer_load_dwordx4 v83, s[12:15], s80 offen lds
v_mfma_f32_16x16x32_bf16 v[144:147], v[32:35], a[164:167], v[144:147]
s_add_u32 s61, s60, 3
s_and_b32 s61, s61, 7
ds_read_b128 v[100:103], v49 offset:0
v_mfma_f32_16x16x32_bf16 v[144:147], v[36:39], a[228:231], v[144:147]
s_mul_i32 s61, s61, 128
s_add_u32 s61, s61, s86
s_add_u32 m0, s82, 98304
v_mfma_f32_16x16x32_bf16 v[148:151], v[36:39], a[232:235], v[148:151]
s_add_u32 s80, s61, 0
v_mfma_f32_16x16x32_bf16 v[148:151], v[32:35], a[168:171], v[148:151]
s_waitcnt lgkmcnt(2)
v_mfma_f32_16x16x32_bf16 v[152:155], v[160:163], a[168:171], v[152:155]
buffer_load_dwordx4 v[168:171], v1, s[44:47], 0 offen
v_mfma_f32_16x16x32_bf16 v[152:155], v[164:167], a[232:235], v[152:155]
v_mfma_f32_16x16x32_bf16 v[52:55], v[164:167], a[228:231], v[52:55]
buffer_load_dwordx4 v[172:175], v1, s[16:19], s57 offen
v_mfma_f32_16x16x32_bf16 v[52:55], v[160:163], a[164:167], v[52:55]
v_mfma_f32_16x16x32_bf16 v[68:71], v[160:163], a[128:131], v[68:71]
buffer_load_dword v10, v5, s[28:31], 0 offen sc1
v_mfma_f32_16x16x32_bf16 v[68:71], v[164:167], a[224:227], v[68:71]
buffer_load_dwordx4 v80, s[8:11], s80 offen lds
v_mfma_f32_16x16x32_bf16 v[156:159], v[164:167], a[220:223], v[156:159]
s_add_u32 m0, s82, 99328
buffer_load_dwordx4 v[32:35], v1, s[16:19], s57 offen offset:1024
v_mfma_f32_16x16x32_bf16 v[156:159], v[160:163], a[124:127], v[156:159]
s_add_u32 s80, s61, 8192
v_mfma_f32_16x16x32_bf16 a[88:91], a[120:123], v[160:163], a[88:91]
v_mfma_f32_16x16x32_bf16 a[88:91], a[212:215], v[164:167], a[88:91]
v_mfma_f32_16x16x32_bf16 a[52:55], a[200:203], v[164:167], a[52:55]
ds_read_b128 v[36:39], v48 offset:2048
v_mfma_f32_16x16x32_bf16 a[52:55], a[116:119], v[160:163], a[52:55]
ds_read_b128 v[176:179], v49 offset:2048
v_mfma_f32_16x16x32_bf16 a[24:27], a[112:115], v[160:163], a[24:27]
v_mfma_f32_16x16x32_bf16 a[24:27], a[192:195], v[164:167], a[24:27]
v_mfma_f32_16x16x32_bf16 a[148:151], a[184:187], v[164:167], a[148:151]
v_mfma_f32_16x16x32_bf16 a[148:151], a[100:103], v[160:163], a[148:151]
s_waitcnt lgkmcnt(2)
buffer_load_dwordx4 v81, s[8:11], s80 offen lds
v_mfma_f32_16x16x32_bf16 a[140:143], a[132:135], v[60:63], a[140:143]
s_add_u32 m0, s82, 100352
s_add_u32 s80, s61, 16384
ds_read_b64_tr_b16 a[116:117], v16 offset:0
v_mfma_f32_16x16x32_bf16 a[140:143], a[40:43], v[100:103], a[140:143]
ds_read_b64_tr_b16 a[118:119], v16 offset:512
v_mfma_f32_16x16x32_bf16 a[4:7], a[44:47], v[100:103], a[4:7]
ds_read_b64_tr_b16 a[112:113], v17 offset:0
v_mfma_f32_16x16x32_bf16 a[4:7], a[136:139], v[60:63], a[4:7]
ds_read_b64_tr_b16 a[114:115], v17 offset:512
v_mfma_f32_16x16x32_bf16 a[20:23], a[252:255], v[60:63], a[20:23]
ds_read_b64_tr_b16 a[100:101], v18 offset:0
v_mfma_f32_16x16x32_bf16 a[20:23], a[48:51], v[100:103], a[20:23]
ds_read_b64_tr_b16 a[102:103], v18 offset:512
v_mfma_f32_16x16x32_bf16 a[68:71], a[56:59], v[100:103], a[68:71]
ds_read_b64_tr_b16 a[120:121], v19 offset:0
v_mfma_f32_16x16x32_bf16 a[68:71], a[8:11], v[60:63], a[68:71]
ds_read_b64_tr_b16 a[122:123], v19 offset:512
v_mfma_f32_16x16x32_bf16 v[56:59], v[60:63], a[72:75], v[56:59]
ds_read_b64_tr_b16 a[124:125], v16 offset:8192
v_mfma_f32_16x16x32_bf16 v[56:59], v[100:103], a[236:239], v[56:59]
buffer_load_dwordx4 v80, s[8:11], s80 offen lds
v_mfma_f32_16x16x32_bf16 v[44:47], v[100:103], a[240:243], v[44:47]
s_add_u32 m0, s82, 101376
s_add_u32 s80, s61, 24576
ds_read_b128 v[160:163], v48 offset:4096
v_mfma_f32_16x16x32_bf16 v[44:47], v[60:63], a[92:95], v[44:47]
ds_read_b128 v[164:167], v49 offset:4096
v_mfma_f32_16x16x32_bf16 v[244:247], v[60:63], a[32:35], v[244:247]
ds_read_b64_tr_b16 a[126:127], v16 offset:8704
v_mfma_f32_16x16x32_bf16 v[244:247], v[100:103], a[244:247], v[244:247]
ds_read_b64_tr_b16 a[128:129], v17 offset:8192
v_mfma_f32_16x16x32_bf16 v[116:119], v[100:103], a[248:251], v[116:119]
ds_read_b64_tr_b16 a[130:131], v17 offset:8704
v_mfma_f32_16x16x32_bf16 v[116:119], v[60:63], a[36:39], v[116:119]
s_waitcnt lgkmcnt(7)
ds_read_b64_tr_b16 a[164:165], v18 offset:8192
v_mfma_f32_16x16x32_bf16 v[120:123], v[36:39], a[36:39], v[120:123]
L_pad1:
s_cbranch_execz L_pad5
ds_read_b64_tr_b16 a[166:167], v18 offset:8704
v_mfma_f32_16x16x32_bf16 v[120:123], v[176:179], a[248:251], v[120:123]
ds_read_b64_tr_b16 a[168:169], v19 offset:8192
v_mfma_f32_16x16x32_bf16 v[248:251], v[176:179], a[244:247], v[248:251]
ds_read_b64_tr_b16 a[170:171], v19 offset:8704
v_mfma_f32_16x16x32_bf16 v[248:251], v[36:39], a[32:35], v[248:251]
buffer_load_dwordx4 v81, s[8:11], s80 offen lds
v_mfma_f32_16x16x32_bf16 v[76:79], v[36:39], a[92:95], v[76:79]
s_add_u32 s61, s60, 4
s_and_b32 s61, s61, 7
s_mul_i32 s61, s61, 524288
v_mfma_f32_16x16x32_bf16 v[76:79], v[176:179], a[240:243], v[76:79]
s_add_u32 s61, s61, s88
s_add_u32 m0, s82, 32768
s_add_u32 s80, s61, 0
v_mfma_f32_16x16x32_bf16 v[72:75], v[176:179], a[236:239], v[72:75]
v_mfma_f32_16x16x32_bf16 v[72:75], v[36:39], a[72:75], v[72:75]
v_mfma_f32_16x16x32_bf16 a[76:79], a[8:11], v[36:39], a[76:79]
v_mfma_f32_16x16x32_bf16 a[76:79], a[56:59], v[176:179], a[76:79]
v_mfma_f32_16x16x32_bf16 a[28:31], a[48:51], v[176:179], a[28:31]
ds_read_b128 v[60:63], v48 offset:6144
v_mfma_f32_16x16x32_bf16 a[28:31], a[252:255], v[36:39], a[28:31]
ds_read_b128 v[100:103], v49 offset:6144
v_mfma_f32_16x16x32_bf16 a[156:159], a[136:139], v[36:39], a[156:159]
v_mfma_f32_16x16x32_bf16 a[156:159], a[44:47], v[176:179], a[156:159]
buffer_load_dwordx4 v82, s[12:15], s80 offen lds
v_mfma_f32_16x16x32_bf16 a[144:147], a[40:43], v[176:179], a[144:147]
s_add_u32 m0, s82, 33792
s_add_u32 s80, s61, 65536
v_mfma_f32_16x16x32_bf16 a[144:147], a[132:135], v[36:39], a[144:147]
s_waitcnt lgkmcnt(2)
v_mfma_f32_16x16x32_bf16 a[152:155], a[132:135], v[160:163], a[152:155]
v_mfma_f32_16x16x32_bf16 a[152:155], a[40:43], v[164:167], a[152:155]
v_mfma_f32_16x16x32_bf16 a[12:15], a[44:47], v[164:167], a[12:15]
v_mfma_f32_16x16x32_bf16 a[12:15], a[136:139], v[160:163], a[12:15]
v_mfma_f32_16x16x32_bf16 a[160:163], a[252:255], v[160:163], a[160:163]
v_mfma_f32_16x16x32_bf16 a[160:163], a[48:51], v[164:167], a[160:163]
v_mfma_f32_16x16x32_bf16 a[80:83], a[56:59], v[164:167], a[80:83]
v_mfma_f32_16x16x32_bf16 a[80:83], a[8:11], v[160:163], a[80:83]
s_waitcnt vmcnt(9)
buffer_load_dwordx4 v83, s[12:15], s80 offen lds
v_mfma_f32_16x16x32_bf16 v[232:235], v[160:163], a[72:75], v[232:235]
s_barrier
v_mfma_f32_16x16x32_bf16 v[232:235], v[164:167], a[236:239], v[232:235]
s_add_u32 m0, s82, 34816
s_add_u32 s80, s61, 131072
v_mfma_f32_16x16x32_bf16 v[236:239], v[164:167], a[240:243], v[236:239]
ds_read_b128 v[36:39], v48 offset:16384
v_mfma_f32_16x16x32_bf16 v[236:239], v[160:163], a[92:95], v[236:239]
ds_read_b128 v[176:179], v49 offset:16384
v_mfma_f32_16x16x32_bf16 v[252:255], v[160:163], a[32:35], v[252:255]
ds_read_b64_tr_b16 a[184:185], v16 offset:16384
v_mfma_f32_16x16x32_bf16 v[252:255], v[164:167], a[244:247], v[252:255]
v_mfma_f32_16x16x32_bf16 v[124:127], v[164:167], a[248:251], v[124:127]
ds_read_b64_tr_b16 a[186:187], v16 offset:16896
v_mfma_f32_16x16x32_bf16 v[124:127], v[160:163], a[36:39], v[124:127]
s_waitcnt lgkmcnt(4)
v_mfma_f32_16x16x32_bf16 v[128:131], v[60:63], a[36:39], v[128:131]
ds_read_b64_tr_b16 a[192:193], v17 offset:16384
v_mfma_f32_16x16x32_bf16 v[128:131], v[100:103], a[248:251], v[128:131]
buffer_load_dwordx4 v82, s[12:15], s80 offen lds
v_mfma_f32_16x16x32_bf16 v[112:115], v[100:103], a[244:247], v[112:115]
s_add_u32 m0, s82, 35840
s_add_u32 s80, s61, 196608
ds_read_b64_tr_b16 a[194:195], v17 offset:16896
v_mfma_f32_16x16x32_bf16 v[112:115], v[60:63], a[32:35], v[112:115]
v_mfma_f32_16x16x32_bf16 v[240:243], v[60:63], a[92:95], v[240:243]
ds_read_b64_tr_b16 a[200:201], v18 offset:16384
v_mfma_f32_16x16x32_bf16 v[240:243], v[100:103], a[240:243], v[240:243]
v_mfma_f32_16x16x32_bf16 v[28:31], v[100:103], a[236:239], v[28:31]
ds_read_b64_tr_b16 a[202:203], v18 offset:16896
v_mfma_f32_16x16x32_bf16 v[28:31], v[60:63], a[72:75], v[28:31]
buffer_load_dwordx4 v83, s[12:15], s80 offen lds
v_mfma_f32_16x16x32_bf16 a[84:87], a[8:11], v[60:63], a[84:87]
s_add_u32 s61, s60, 3
s_and_b32 s61, s61, 7
ds_read_b64_tr_b16 a[212:213], v19 offset:16384
v_mfma_f32_16x16x32_bf16 a[84:87], a[56:59], v[100:103], a[84:87]
s_mul_i32 s61, s61, 128
s_add_u32 s61, s61, s87
s_add_u32 m0, s82, 114688
v_mfma_f32_16x16x32_bf16 a[64:67], a[48:51], v[100:103], a[64:67]
s_add_u32 s80, s61, 0
ds_read_b128 v[160:163], v48 offset:18432
v_mfma_f32_16x16x32_bf16 a[64:67], a[252:255], v[60:63], a[64:67]
ds_read_b128 v[164:167], v49 offset:18432
v_mfma_f32_16x16x32_bf16 a[16:19], a[136:139], v[60:63], a[16:19]
ds_read_b64_tr_b16 a[214:215], v19 offset:16896
v_mfma_f32_16x16x32_bf16 a[16:19], a[44:47], v[100:103], a[16:19]
buffer_load_dwordx4 v80, s[8:11], s80 offen lds
v_mfma_f32_16x16x32_bf16 a[0:3], a[40:43], v[100:103], a[0:3]
s_add_u32 m0, s82, 115712
s_add_u32 s80, s61, 8192
ds_read_b64_tr_b16 a[220:221], v16 offset:24576
v_mfma_f32_16x16x32_bf16 a[0:3], a[132:135], v[60:63], a[0:3]
s_waitcnt lgkmcnt(5)
ds_read_b64_tr_b16 a[222:223], v16 offset:25088
v_mfma_f32_16x16x32_bf16 a[60:63], a[132:135], v[36:39], a[60:63]
ds_read_b64_tr_b16 a[224:225], v17 offset:24576
v_mfma_f32_16x16x32_bf16 a[60:63], a[40:43], v[176:179], a[60:63]
v_mfma_f32_16x16x32_bf16 a[96:99], a[44:47], v[176:179], a[96:99]
ds_read_b64_tr_b16 a[226:227], v17 offset:25088
v_mfma_f32_16x16x32_bf16 a[96:99], a[136:139], v[36:39], a[96:99]
buffer_load_dwordx4 v81, s[8:11], s80 offen lds
v_mfma_f32_16x16x32_bf16 a[104:107], a[252:255], v[36:39], a[104:107]
s_add_u32 m0, s82, 116736
s_add_u32 s80, s61, 16384
ds_read_b64_tr_b16 a[228:229], v18 offset:24576
v_mfma_f32_16x16x32_bf16 a[104:107], a[48:51], v[176:179], a[104:107]
v_mfma_f32_16x16x32_bf16 a[108:111], a[56:59], v[176:179], a[108:111]
ds_read_b64_tr_b16 a[230:231], v18 offset:25088
v_mfma_f32_16x16x32_bf16 a[108:111], a[8:11], v[36:39], a[108:111]
v_mfma_f32_16x16x32_bf16 v[132:135], v[36:39], a[72:75], v[132:135]
ds_read_b64_tr_b16 a[232:233], v19 offset:24576
v_mfma_f32_16x16x32_bf16 v[132:135], v[176:179], a[236:239], v[132:135]
buffer_load_dwordx4 v80, s[8:11], s80 offen lds
v_mfma_f32_16x16x32_bf16 v[136:139], v[176:179], a[240:243], v[136:139]
s_add_u32 m0, s82, 117760
ds_read_b128 v[60:63], v48 offset:20480
v_lshrrev_b32 v100, 1, v0
v_mfma_f32_16x16x32_bf16 v[136:139], v[36:39], a[92:95], v[136:139]
s_add_u32 s80, s61, 24576
ds_read_b128 v[180:183], v49 offset:20480
v_lshlrev_b32 v100, 13, v100
v_mfma_f32_16x16x32_bf16 v[140:143], v[36:39], a[32:35], v[140:143]
ds_read_b64_tr_b16 a[234:235], v19 offset:25088
v_and_b32 v101, 1, v0
v_mfma_f32_16x16x32_bf16 v[140:143], v[176:179], a[244:247], v[140:143]
v_lshl_add_u32 v100, v101, 7, v100
v_lshrrev_b32 v103, 5, v0
v_mfma_f32_16x16x32_bf16 v[96:99], v[176:179], a[248:251], v[96:99]
v_lshl_add_u32 v100, v103, 30, v100
v_lshrrev_b32 v103, 4, v0
v_mfma_f32_16x16x32_bf16 v[96:99], v[36:39], a[36:39], v[96:99]
s_waitcnt lgkmcnt(4)
buffer_load_dwordx4 v81, s[8:11], s80 offen lds
v_mfma_f32_16x16x32_bf16 v[24:27], v[160:163], a[36:39], v[24:27]
s_add_u32 s61, s60, 4
v_lshlrev_b32 v103, 28, v103
v_mul_u32_u24 v101, 3584, v0
v_mfma_f32_16x16x32_bf16 v[24:27], v[164:167], a[248:251], v[24:27]
s_and_b32 s61, s61, 7
v_add_u32 v101, v101, v103
v_and_b32 v102, 31, v0
v_mfma_f32_16x16x32_bf16 v[40:43], v[164:167], a[244:247], v[40:43]
s_mul_i32 s61, s61, 524288
v_lshlrev_b32 v102, 10, v102
v_lshrrev_b32 v103, 5, v0
v_mfma_f32_16x16x32_bf16 v[40:43], v[160:163], a[32:35], v[40:43]
s_add_u32 s61, s61, s88
s_add_u32 m0, s82, 49152
v_lshl_add_u32 v102, v103, 7, v102
v_mfma_f32_16x16x32_bf16 v[64:67], v[160:163], a[92:95], v[64:67]
s_add_u32 s80, s61, 262144
s_lshl_b32 s58, s5, 19
s_add_u32 s58, s58, s91
v_mfma_f32_16x16x32_bf16 v[64:67], v[164:167], a[240:243], v[64:67]
buffer_load_dwordx4 v82, s[12:15], s80 offen lds
v_mfma_f32_16x16x32_bf16 v[20:23], v[164:167], a[236:239], v[20:23]
s_add_u32 m0, s82, 50176
s_add_u32 s80, s61, 327680
v_mfma_f32_16x16x32_bf16 v[20:23], v[160:163], a[72:75], v[20:23]
v_mfma_f32_16x16x32_bf16 a[172:175], a[8:11], v[160:163], a[172:175]
v_mfma_f32_16x16x32_bf16 a[172:175], a[56:59], v[164:167], a[172:175]
v_mfma_f32_16x16x32_bf16 a[176:179], a[48:51], v[164:167], a[176:179]
ds_read_b128 v[36:39], v48 offset:22528
v_mfma_f32_16x16x32_bf16 a[176:179], a[252:255], v[160:163], a[176:179]
buffer_load_dwordx4 v83, s[12:15], s80 offen lds
v_mfma_f32_16x16x32_bf16 a[180:183], a[136:139], v[160:163], a[180:183]
s_add_u32 m0, s82, 51200
s_add_u32 s80, s61, 393216
ds_read_b128 v[176:179], v49 offset:22528
v_mfma_f32_16x16x32_bf16 a[180:183], a[44:47], v[164:167], a[180:183]
v_mfma_f32_16x16x32_bf16 a[188:191], a[40:43], v[164:167], a[188:191]
v_mfma_f32_16x16x32_bf16 a[188:191], a[132:135], v[160:163], a[188:191]
s_waitcnt lgkmcnt(2)
v_mfma_f32_16x16x32_bf16 a[196:199], a[132:135], v[60:63], a[196:199]
v_mfma_f32_16x16x32_bf16 a[196:199], a[40:43], v[180:183], a[196:199]
buffer_load_dwordx4 v82, s[12:15], s80 offen lds
v_mfma_f32_16x16x32_bf16 a[204:207], a[44:47], v[180:183], a[204:207]
s_add_u32 m0, s82, 52224
s_add_u32 s80, s61, 458752
v_mfma_f32_16x16x32_bf16 a[204:207], a[136:139], v[60:63], a[204:207]
v_mfma_f32_16x16x32_bf16 a[208:211], a[252:255], v[60:63], a[208:211]
v_mfma_f32_16x16x32_bf16 a[208:211], a[48:51], v[180:183], a[208:211]
v_mfma_f32_16x16x32_bf16 a[216:219], a[56:59], v[180:183], a[216:219]
v_mfma_f32_16x16x32_bf16 a[216:219], a[8:11], v[60:63], a[216:219]
s_waitcnt vmcnt(7)
buffer_load_dwordx4 v83, s[12:15], s80 offen lds
v_mfma_f32_16x16x32_bf16 v[104:107], v[60:63], a[72:75], v[104:107]
s_barrier
v_mfma_f32_16x16x32_bf16 v[104:107], v[180:183], a[236:239], v[104:107]
s_add_u32 s61, s60, 4
buffer_load_dword v160, v100, s[20:23], s58 offen
v_mfma_f32_16x16x32_bf16 v[108:111], v[180:183], a[240:243], v[108:111]
s_and_b32 s61, s61, 7
s_mul_i32 s61, s61, 128
ds_read_b128 v[164:167], v48 offset:32768
v_mfma_f32_16x16x32_bf16 v[108:111], v[60:63], a[92:95], v[108:111]
s_add_u32 s61, s61, s86
s_add_u32 m0, s82, 131072
ds_read_b128 v[184:187], v49 offset:32768
v_mfma_f32_16x16x32_bf16 v[144:147], v[60:63], a[32:35], v[144:147]
s_add_u32 s80, s61, 0
s_mul_i32 s58, s5, 229376
s_add_u32 s58, s58, s92
v_mfma_f32_16x16x32_bf16 v[144:147], v[180:183], a[244:247], v[144:147]
buffer_load_dword v161, v101, s[24:27], s58 offen
v_mfma_f32_16x16x32_bf16 v[148:151], v[180:183], a[248:251], v[148:151]
v_mfma_f32_16x16x32_bf16 v[148:151], v[60:63], a[36:39], v[148:151]
s_waitcnt lgkmcnt(2)
v_mfma_f32_16x16x32_bf16 v[152:155], v[36:39], a[36:39], v[152:155]
v_mfma_f32_16x16x32_bf16 v[152:155], v[176:179], a[248:251], v[152:155]
buffer_load_dwordx4 v80, s[8:11], s80 offen lds
v_mfma_f32_16x16x32_bf16 v[52:55], v[176:179], a[244:247], v[52:55]
s_add_u32 m0, s82, 132096
s_add_u32 s80, s61, 8192
v_mfma_f32_16x16x32_bf16 v[52:55], v[36:39], a[32:35], v[52:55]
v_mfma_f32_16x16x32_bf16 v[68:71], v[36:39], a[92:95], v[68:71]
v_mfma_f32_16x16x32_bf16 v[68:71], v[176:179], a[240:243], v[68:71]
v_mfma_f32_16x16x32_bf16 v[156:159], v[176:179], a[236:239], v[156:159]
v_mfma_f32_16x16x32_bf16 v[156:159], v[36:39], a[72:75], v[156:159]
v_mfma_f32_16x16x32_bf16 a[88:91], a[8:11], v[36:39], a[88:91]
v_mfma_f32_16x16x32_bf16 a[88:91], a[56:59], v[176:179], a[88:91]
v_mfma_f32_16x16x32_bf16 a[52:55], a[48:51], v[176:179], a[52:55]
ds_read_b128 v[60:63], v48 offset:34816
v_mfma_f32_16x16x32_bf16 a[52:55], a[252:255], v[36:39], a[52:55]
buffer_load_dwordx4 v81, s[8:11], s80 offen lds
v_mfma_f32_16x16x32_bf16 a[24:27], a[136:139], v[36:39], a[24:27]
s_add_u32 m0, s82, 133120
s_add_u32 s80, s61, 16384
ds_read_b128 v[100:103], v49 offset:34816
v_mfma_f32_16x16x32_bf16 a[24:27], a[44:47], v[176:179], a[24:27]
v_mfma_f32_16x16x32_bf16 a[148:151], a[40:43], v[176:179], a[148:151]
v_mfma_f32_16x16x32_bf16 a[148:151], a[132:135], v[36:39], a[148:151]
s_waitcnt lgkmcnt(2)
v_mfma_f32_16x16x32_bf16 a[140:143], a[116:119], v[164:167], a[140:143]
ds_read_b64_tr_b16 a[252:253], v16 offset:32768
v_mfma_f32_16x16x32_bf16 a[140:143], a[184:187], v[184:187], a[140:143]
ds_read_b64_tr_b16 a[254:255], v16 offset:33280
v_mfma_f32_16x16x32_bf16 a[4:7], a[192:195], v[184:187], a[4:7]
ds_read_b64_tr_b16 a[136:137], v17 offset:32768
v_mfma_f32_16x16x32_bf16 a[4:7], a[112:115], v[164:167], a[4:7]
ds_read_b64_tr_b16 a[138:139], v17 offset:33280
v_mfma_f32_16x16x32_bf16 a[20:23], a[100:103], v[164:167], a[20:23]
ds_read_b64_tr_b16 a[132:133], v18 offset:32768
v_mfma_f32_16x16x32_bf16 a[20:23], a[200:203], v[184:187], a[20:23]
buffer_load_dwordx4 v80, s[8:11], s80 offen lds
v_mfma_f32_16x16x32_bf16 a[68:71], a[212:215], v[184:187], a[68:71]
s_add_u32 m0, s82, 134144
s_add_u32 s80, s61, 24576
ds_read_b64_tr_b16 a[134:135], v18 offset:33280
v_mfma_f32_16x16x32_bf16 a[68:71], a[120:123], v[164:167], a[68:71]
ds_read_b64_tr_b16 a[8:9], v19 offset:32768
v_mfma_f32_16x16x32_bf16 v[56:59], v[164:167], a[124:127], v[56:59]
ds_read_b64_tr_b16 a[10:11], v19 offset:33280
v_mfma_f32_16x16x32_bf16 v[56:59], v[184:187], a[220:223], v[56:59]
ds_read_b64_tr_b16 a[72:73], v16 offset:40960
v_mfma_f32_16x16x32_bf16 v[44:47], v[184:187], a[224:227], v[44:47]
ds_read_b128 v[36:39], v48 offset:36864
v_mfma_f32_16x16x32_bf16 v[44:47], v[164:167], a[128:131], v[44:47]
ds_read_b128 v[176:179], v49 offset:36864
v_mfma_f32_16x16x32_bf16 v[244:247], v[164:167], a[164:167], v[244:247]
ds_read_b64_tr_b16 a[74:75], v16 offset:41472
v_mfma_f32_16x16x32_bf16 v[244:247], v[184:187], a[228:231], v[244:247]
ds_read_b64_tr_b16 a[92:93], v17 offset:40960
v_mfma_f32_16x16x32_bf16 v[116:119], v[184:187], a[232:235], v[116:119]
ds_read_b64_tr_b16 a[94:95], v17 offset:41472
v_mfma_f32_16x16x32_bf16 v[116:119], v[164:167], a[168:171], v[116:119]
s_waitcnt lgkmcnt(8)
buffer_load_dwordx4 v81, s[8:11], s80 offen lds
v_mfma_f32_16x16x32_bf16 v[120:123], v[60:63], a[168:171], v[120:123]
s_add_u32 s61, s60, 5
s_and_b32 s61, s61, 7
ds_read_b64_tr_b16 a[32:33], v18 offset:40960
v_mfma_f32_16x16x32_bf16 v[120:123], v[100:103], a[232:235], v[120:123]
s_mul_i32 s61, s61, 524288
s_add_u32 s61, s61, s88
ds_read_b64_tr_b16 a[34:35], v18 offset:41472
v_mfma_f32_16x16x32_bf16 v[248:251], v[100:103], a[228:231], v[248:251]
s_add_u32 m0, s82, 0
s_add_u32 s80, s61, 0
ds_read_b64_tr_b16 a[36:37], v19 offset:40960
v_mfma_f32_16x16x32_bf16 v[248:251], v[60:63], a[164:167], v[248:251]
ds_read_b64_tr_b16 a[38:39], v19 offset:41472
v_mfma_f32_16x16x32_bf16 v[76:79], v[60:63], a[128:131], v[76:79]
v_mfma_f32_16x16x32_bf16 v[76:79], v[100:103], a[224:227], v[76:79]
v_mfma_f32_16x16x32_bf16 v[72:75], v[100:103], a[220:223], v[72:75]
v_lshlrev_b32 v164, 16, v168
v_and_b32 v168, 0xffff0000, v168
v_mfma_f32_16x16x32_bf16 v[72:75], v[60:63], a[124:127], v[72:75]
v_lshlrev_b32 v165, 16, v169
v_and_b32 v169, 0xffff0000, v169
v_mfma_f32_16x16x32_bf16 a[76:79], a[120:123], v[60:63], a[76:79]
v_lshlrev_b32 v166, 16, v170
v_and_b32 v170, 0xffff0000, v170
v_mfma_f32_16x16x32_bf16 a[76:79], a[212:215], v[100:103], a[76:79]
buffer_load_dwordx4 v82, s[12:15], s80 offen lds
v_mfma_f32_16x16x32_bf16 a[28:31], a[200:203], v[100:103], a[28:31]
s_add_u32 m0, s82, 1024
ds_read_b128 v[180:183], v48 offset:38912
v_lshlrev_b32 v167, 16, v171
v_mfma_f32_16x16x32_bf16 a[28:31], a[100:103], v[60:63], a[28:31]
s_add_u32 s80, s61, 65536
ds_read_b128 v[184:187], v49 offset:38912
v_and_b32 v171, 0xffff0000, v171
v_mfma_f32_16x16x32_bf16 a[156:159], a[112:115], v[60:63], a[156:159]
v_lshlrev_b32 v188, 16, v172
v_and_b32 v172, 0xffff0000, v172
v_mfma_f32_16x16x32_bf16 a[156:159], a[192:195], v[100:103], a[156:159]
v_lshlrev_b32 v189, 16, v173
v_and_b32 v173, 0xffff0000, v173
v_mfma_f32_16x16x32_bf16 a[144:147], a[184:187], v[100:103], a[144:147]
v_lshlrev_b32 v190, 16, v174
v_and_b32 v174, 0xffff0000, v174
v_mfma_f32_16x16x32_bf16 a[144:147], a[116:119], v[60:63], a[144:147]
s_waitcnt lgkmcnt(2)
v_lshlrev_b32 v191, 16, v175
v_and_b32 v175, 0xffff0000, v175
v_mfma_f32_16x16x32_bf16 a[152:155], a[116:119], v[36:39], a[152:155]
v_mul_f32 v192, v188, v164
v_fma_f32 v192, v172, v168, v192
v_mfma_f32_16x16x32_bf16 a[152:155], a[184:187], v[176:179], a[152:155]
v_fma_f32 v192, v189, v165, v192
v_fma_f32 v192, v173, v169, v192
v_mfma_f32_16x16x32_bf16 a[12:15], a[192:195], v[176:179], a[12:15]
v_fma_f32 v192, v190, v166, v192
v_fma_f32 v192, v174, v170, v192
v_mfma_f32_16x16x32_bf16 a[12:15], a[112:115], v[36:39], a[12:15]
buffer_load_dwordx4 v83, s[12:15], s80 offen lds
v_mfma_f32_16x16x32_bf16 a[160:163], a[100:103], v[36:39], a[160:163]
s_add_u32 m0, s82, 2048
v_fma_f32 v192, v191, v167, v192
v_fma_f32 v192, v175, v171, v192
v_mfma_f32_16x16x32_bf16 a[160:163], a[200:203], v[176:179], a[160:163]
s_add_u32 s80, s61, 131072
v_lshlrev_b32 v188, 16, v32
v_and_b32 v32, 0xffff0000, v32
v_mfma_f32_16x16x32_bf16 a[80:83], a[212:215], v[176:179], a[80:83]
v_lshlrev_b32 v189, 16, v33
v_and_b32 v33, 0xffff0000, v33
v_mfma_f32_16x16x32_bf16 a[80:83], a[120:123], v[36:39], a[80:83]
s_waitcnt vmcnt(8)
v_lshlrev_b32 v190, 16, v34
v_and_b32 v34, 0xffff0000, v34
v_mfma_f32_16x16x32_bf16 v[232:235], v[36:39], a[124:127], v[232:235]
s_barrier
v_mfma_f32_16x16x32_bf16 v[232:235], v[176:179], a[220:223], v[232:235]
v_lshlrev_b32 v191, 16, v35
v_and_b32 v35, 0xffff0000, v35
v_mfma_f32_16x16x32_bf16 v[236:239], v[176:179], a[224:227], v[236:239]
ds_read_b128 v[60:63], v48 offset:49152
v_mul_f32 v193, v188, v164
v_mfma_f32_16x16x32_bf16 v[236:239], v[36:39], a[128:131], v[236:239]
ds_read_b128 v[100:103], v49 offset:49152
v_fma_f32 v193, v32, v168, v193
v_mfma_f32_16x16x32_bf16 v[252:255], v[36:39], a[164:167], v[252:255]
ds_read_b64_tr_b16 a[40:41], v16 offset:49152
v_fma_f32 v193, v189, v165, v193
v_mfma_f32_16x16x32_bf16 v[252:255], v[176:179], a[228:231], v[252:255]
buffer_load_dwordx4 v82, s[12:15], s80 offen lds
v_mfma_f32_16x16x32_bf16 v[124:127], v[176:179], a[232:235], v[124:127]
s_add_u32 m0, s82, 3072
ds_read_b64_tr_b16 a[42:43], v16 offset:49664
v_fma_f32 v193, v33, v169, v193
v_mfma_f32_16x16x32_bf16 v[124:127], v[36:39], a[168:171], v[124:127]
s_waitcnt lgkmcnt(4)
v_fma_f32 v193, v190, v166, v193
v_fma_f32 v193, v34, v170, v193
v_mfma_f32_16x16x32_bf16 v[128:131], v[180:183], a[168:171], v[128:131]
s_add_u32 s80, s61, 196608
ds_read_b64_tr_b16 a[44:45], v17 offset:49152
v_fma_f32 v193, v191, v167, v193
v_mfma_f32_16x16x32_bf16 v[128:131], v[184:187], a[232:235], v[128:131]
v_fma_f32 v193, v35, v171, v193
v_mfma_f32_16x16x32_bf16 v[112:115], v[184:187], a[228:231], v[112:115]
ds_read_b64_tr_b16 a[46:47], v17 offset:49664
v_mfma_f32_16x16x32_bf16 v[112:115], v[180:183], a[164:167], v[112:115]
buffer_load_dwordx4 v83, s[12:15], s80 offen lds
v_mfma_f32_16x16x32_bf16 v[240:243], v[180:183], a[128:131], v[240:243]
s_add_u32 s61, s60, 4
ds_read_b64_tr_b16 a[48:49], v18 offset:49152
v_permlane32_swap_b32 v192, v193
v_mfma_f32_16x16x32_bf16 v[240:243], v[184:187], a[224:227], v[240:243]
s_and_b32 s61, s61, 7
v_add_f32 v192, v192, v193
v_mov_b32 v193, v192
v_mfma_f32_16x16x32_bf16 v[28:31], v[184:187], a[220:223], v[28:31]
s_mul_i32 s61, s61, 128
s_add_u32 s61, s61, s87
ds_read_b64_tr_b16 a[50:51], v18 offset:49664
v_mfma_f32_16x16x32_bf16 v[28:31], v[180:183], a[124:127], v[28:31]
s_add_u32 m0, s82, 147456
v_permlane16_swap_b32 v192, v193
v_add_f32 v192, v192, v193
v_mfma_f32_16x16x32_bf16 a[84:87], a[120:123], v[180:183], a[84:87]
s_add_u32 s80, s61, 0
ds_read_b64_tr_b16 a[56:57], v19 offset:49152
v_mfma_f32_16x16x32_bf16 a[84:87], a[212:215], v[184:187], a[84:87]
buffer_load_dwordx4 v80, s[8:11], s80 offen lds
v_mfma_f32_16x16x32_bf16 a[64:67], a[200:203], v[184:187], a[64:67]
s_add_u32 m0, s82, 148480
ds_read_b128 v[32:35], v48 offset:51200
v_add_f32_dpp v192, v192, v192 row_shr:1 row_mask:0xf bank_mask:0xf bound_ctrl:1
v_mfma_f32_16x16x32_bf16 a[64:67], a[100:103], v[180:183], a[64:67]
s_add_u32 s80, s61, 8192
ds_read_b128 v[36:39], v49 offset:51200
v_mfma_f32_16x16x32_bf16 a[16:19], a[112:115], v[180:183], a[16:19]
ds_read_b64_tr_b16 a[58:59], v19 offset:49664
v_add_f32_dpp v192, v192, v192 row_shr:2 row_mask:0xf bank_mask:0xf bound_ctrl:1
v_mfma_f32_16x16x32_bf16 a[16:19], a[192:195], v[184:187], a[16:19]
ds_read_b64_tr_b16 a[236:237], v16 offset:57344
v_mfma_f32_16x16x32_bf16 a[0:3], a[184:187], v[184:187], a[0:3]
ds_read_b64_tr_b16 a[238:239], v16 offset:57856
v_add_f32_dpp v192, v192, v192 row_shr:4 row_mask:0xf bank_mask:0xf bound_ctrl:1
v_mfma_f32_16x16x32_bf16 a[0:3], a[116:119], v[180:183], a[0:3]
s_waitcnt lgkmcnt(6)
buffer_load_dwordx4 v81, s[8:11], s80 offen lds
v_mfma_f32_16x16x32_bf16 a[60:63], a[116:119], v[60:63], a[60:63]
s_add_u32 m0, s82, 149504
ds_read_b64_tr_b16 a[240:241], v17 offset:57344
v_add_f32_dpp v192, v192, v192 row_shr:8 row_mask:0xf bank_mask:0xf bound_ctrl:1
v_mfma_f32_16x16x32_bf16 a[60:63], a[184:187], v[100:103], a[60:63]
s_add_u32 s80, s61, 16384
v_mul_f32 v192, 0xbfb8aa3b, v192
v_mfma_f32_16x16x32_bf16 a[96:99], a[192:195], v[100:103], a[96:99]
ds_read_b64_tr_b16 a[242:243], v17 offset:57856
v_mfma_f32_16x16x32_bf16 a[96:99], a[112:115], v[60:63], a[96:99]
v_exp_f32 v192, v192
v_mfma_f32_16x16x32_bf16 a[104:107], a[100:103], v[60:63], a[104:107]
ds_read_b64_tr_b16 a[244:245], v18 offset:57344
v_add_f32 v192, 1.0, v192
v_mfma_f32_16x16x32_bf16 a[104:107], a[200:203], v[100:103], a[104:107]
buffer_load_dwordx4 v80, s[8:11], s80 offen lds
v_mfma_f32_16x16x32_bf16 a[108:111], a[212:215], v[100:103], a[108:111]
s_add_u32 m0, s82, 150528
s_add_u32 s80, s61, 24576
ds_read_b64_tr_b16 a[246:247], v18 offset:57856
v_mfma_f32_16x16x32_bf16 a[108:111], a[120:123], v[60:63], a[108:111]
v_rcp_f32 v192, v192
v_mfma_f32_16x16x32_bf16 v[132:135], v[60:63], a[124:127], v[132:135]
ds_read_b64_tr_b16 a[248:249], v19 offset:57344
v_mov_b32 v193, 1073741824
v_mfma_f32_16x16x32_bf16 v[132:135], v[100:103], a[220:223], v[132:135]
v_or_b32 v192, 0x80000000, v192
v_mfma_f32_16x16x32_bf16 v[136:139], v[100:103], a[224:227], v[136:139]
s_mov_b32 s72, 0x80008000
s_mov_b32 s73, 0x80008000
ds_read_b128 v[164:167], v48 offset:53248
v_mfma_f32_16x16x32_bf16 v[136:139], v[60:63], a[128:131], v[136:139]
buffer_load_dwordx4 v81, s[8:11], s80 offen lds
v_mfma_f32_16x16x32_bf16 v[140:143], v[60:63], a[164:167], v[140:143]
s_add_u32 s61, s60, 5
ds_read_b128 v[168:171], v49 offset:53248
v_cndmask_b32 v193, v193, v5, s[72:73]
v_mfma_f32_16x16x32_bf16 v[140:143], v[100:103], a[228:231], v[140:143]
s_and_b32 s61, s61, 7
ds_read_b64_tr_b16 a[250:251], v19 offset:57856
buffer_store_dword v192, v193, s[28:31], 0 offen sc1
v_mfma_f32_16x16x32_bf16 v[96:99], v[100:103], a[232:235], v[96:99]
s_mul_i32 s61, s61, 524288
s_add_u32 s61, s61, s88
s_add_u32 m0, s82, 16384
v_mfma_f32_16x16x32_bf16 v[96:99], v[60:63], a[168:171], v[96:99]
s_waitcnt lgkmcnt(4)
s_add_u32 s80, s61, 262144
v_mfma_f32_16x16x32_bf16 v[24:27], v[32:35], a[168:171], v[24:27]
v_mfma_f32_16x16x32_bf16 v[24:27], v[36:39], a[232:235], v[24:27]
buffer_load_dwordx4 v82, s[12:15], s80 offen lds
v_mfma_f32_16x16x32_bf16 v[40:43], v[36:39], a[228:231], v[40:43]
s_add_u32 m0, s82, 17408
s_add_u32 s80, s61, 327680
v_mfma_f32_16x16x32_bf16 v[40:43], v[32:35], a[164:167], v[40:43]
v_mfma_f32_16x16x32_bf16 v[64:67], v[32:35], a[128:131], v[64:67]
v_mfma_f32_16x16x32_bf16 v[64:67], v[36:39], a[224:227], v[64:67]
v_mfma_f32_16x16x32_bf16 v[20:23], v[36:39], a[220:223], v[20:23]
v_mfma_f32_16x16x32_bf16 v[20:23], v[32:35], a[124:127], v[20:23]
buffer_load_dwordx4 v83, s[12:15], s80 offen lds
v_mfma_f32_16x16x32_bf16 a[172:175], a[120:123], v[32:35], a[172:175]
s_add_u32 m0, s82, 18432
s_add_u32 s80, s61, 393216
v_mfma_f32_16x16x32_bf16 a[172:175], a[212:215], v[36:39], a[172:175]
v_mfma_f32_16x16x32_bf16 a[176:179], a[200:203], v[36:39], a[176:179]
ds_read_b128 v[60:63], v48 offset:55296
v_mfma_f32_16x16x32_bf16 a[176:179], a[100:103], v[32:35], a[176:179]
ds_read_b128 v[100:103], v49 offset:55296
v_mfma_f32_16x16x32_bf16 a[180:183], a[112:115], v[32:35], a[180:183]
v_mfma_f32_16x16x32_bf16 a[180:183], a[192:195], v[36:39], a[180:183]
buffer_load_dwordx4 v82, s[12:15], s80 offen lds
v_mfma_f32_16x16x32_bf16 a[188:191], a[184:187], v[36:39], a[188:191]
s_add_u32 m0, s82, 19456
s_add_u32 s80, s61, 458752
v_mfma_f32_16x16x32_bf16 a[188:191], a[116:119], v[32:35], a[188:191]
s_waitcnt lgkmcnt(2)
v_mfma_f32_16x16x32_bf16 a[196:199], a[116:119], v[164:167], a[196:199]
v_mfma_f32_16x16x32_bf16 a[196:199], a[184:187], v[168:171], a[196:199]
v_mfma_f32_16x16x32_bf16 a[204:207], a[192:195], v[168:171], a[204:207]
v_mfma_f32_16x16x32_bf16 a[204:207], a[112:115], v[164:167], a[204:207]
buffer_load_dwordx4 v83, s[12:15], s80 offen lds
v_mfma_f32_16x16x32_bf16 a[208:211], a[100:103], v[164:167], a[208:211]
s_add_u32 s61, s60, 5
s_and_b32 s61, s61, 7
s_mul_i32 s61, s61, 128
v_mfma_f32_16x16x32_bf16 a[208:211], a[200:203], v[168:171], a[208:211]
s_add_u32 s61, s61, s86
s_add_u32 m0, s82, 65536
s_add_u32 s80, s61, 0
v_mfma_f32_16x16x32_bf16 a[216:219], a[212:215], v[168:171], a[216:219]
v_mfma_f32_16x16x32_bf16 a[216:219], a[120:123], v[164:167], a[216:219]
s_waitcnt vmcnt(9)
v_mfma_f32_16x16x32_bf16 v[104:107], v[164:167], a[124:127], v[104:107]
s_barrier
v_mfma_f32_16x16x32_bf16 v[104:107], v[168:171], a[220:223], v[104:107]
buffer_load_dwordx4 v80, s[8:11], s80 offen lds
v_mfma_f32_16x16x32_bf16 v[108:111], v[168:171], a[224:227], v[108:111]
s_add_u32 m0, s82, 66560
s_add_u32 s80, s61, 8192
ds_read_b128 v[32:35], v50 offset:0
v_mfma_f32_16x16x32_bf16 v[108:111], v[164:167], a[128:131], v[108:111]
ds_read_b128 v[36:39], v51 offset:0
v_mfma_f32_16x16x32_bf16 v[144:147], v[164:167], a[164:167], v[144:147]
v_mfma_f32_16x16x32_bf16 v[144:147], v[168:171], a[228:231], v[144:147]
v_mfma_f32_16x16x32_bf16 v[148:151], v[168:171], a[232:235], v[148:151]
v_mfma_f32_16x16x32_bf16 v[148:151], v[164:167], a[168:171], v[148:151]
s_waitcnt lgkmcnt(2)
buffer_load_dwordx4 v81, s[8:11], s80 offen lds
v_mfma_f32_16x16x32_bf16 v[152:155], v[60:63], a[168:171], v[152:155]
s_add_u32 m0, s82, 67584
s_add_u32 s80, s61, 16384
v_mfma_f32_16x16x32_bf16 v[152:155], v[100:103], a[232:235], v[152:155]
v_mfma_f32_16x16x32_bf16 v[52:55], v[100:103], a[228:231], v[52:55]
v_mfma_f32_16x16x32_bf16 v[52:55], v[60:63], a[164:167], v[52:55]
v_mfma_f32_16x16x32_bf16 v[68:71], v[60:63], a[128:131], v[68:71]
v_mfma_f32_16x16x32_bf16 v[68:71], v[100:103], a[224:227], v[68:71]
buffer_load_dwordx4 v80, s[8:11], s80 offen lds
v_mfma_f32_16x16x32_bf16 v[156:159], v[100:103], a[220:223], v[156:159]
s_add_u32 m0, s82, 68608
s_add_u32 s80, s61, 24576
v_mfma_f32_16x16x32_bf16 v[156:159], v[60:63], a[124:127], v[156:159]
v_mfma_f32_16x16x32_bf16 a[88:91], a[120:123], v[60:63], a[88:91]
v_mfma_f32_16x16x32_bf16 a[88:91], a[212:215], v[100:103], a[88:91]
v_mfma_f32_16x16x32_bf16 a[52:55], a[200:203], v[100:103], a[52:55]
ds_read_b128 v[164:167], v50 offset:2048
v_mfma_f32_16x16x32_bf16 a[52:55], a[100:103], v[60:63], a[52:55]
buffer_load_dwordx4 v81, s[8:11], s80 offen lds
v_mfma_f32_16x16x32_bf16 a[24:27], a[112:115], v[60:63], a[24:27]
s_add_u32 s61, s60, 6
s_and_b32 s61, s61, 7
ds_read_b128 v[168:171], v51 offset:2048
v_mfma_f32_16x16x32_bf16 a[24:27], a[192:195], v[100:103], a[24:27]
s_mul_i32 s61, s61, 524288
s_add_u32 s61, s61, s88
s_add_u32 m0, s82, 32768
v_mfma_f32_16x16x32_bf16 a[148:151], a[184:187], v[100:103], a[148:151]
s_add_u32 s80, s61, 0
v_mfma_f32_16x16x32_bf16 a[148:151], a[116:119], v[60:63], a[148:151]
s_waitcnt lgkmcnt(2)
v_mfma_f32_16x16x32_bf16 a[140:143], a[252:255], v[32:35], a[140:143]
L_pad2:
s_cbranch_execz L_pad6
ds_read_b64_tr_b16 a[100:101], v16 offset:0
v_mfma_f32_16x16x32_bf16 a[140:143], a[40:43], v[36:39], a[140:143]
buffer_load_dwordx4 v82, s[12:15], s80 offen lds
v_mfma_f32_16x16x32_bf16 a[4:7], a[44:47], v[36:39], a[4:7]
s_add_u32 m0, s82, 33792
s_add_u32 s80, s61, 65536
ds_read_b64_tr_b16 a[102:103], v16 offset:512
v_mfma_f32_16x16x32_bf16 a[4:7], a[136:139], v[32:35], a[4:7]
ds_read_b64_tr_b16 a[112:113], v17 offset:0
v_mfma_f32_16x16x32_bf16 a[20:23], a[132:135], v[32:35], a[20:23]
ds_read_b64_tr_b16 a[114:115], v17 offset:512
v_mfma_f32_16x16x32_bf16 a[20:23], a[48:51], v[36:39], a[20:23]
ds_read_b64_tr_b16 a[116:117], v18 offset:0
v_mfma_f32_16x16x32_bf16 a[68:71], a[56:59], v[36:39], a[68:71]
ds_read_b64_tr_b16 a[118:119], v18 offset:512
v_mfma_f32_16x16x32_bf16 a[68:71], a[8:11], v[32:35], a[68:71]
buffer_load_dwordx4 v83, s[12:15], s80 offen lds
v_mfma_f32_16x16x32_bf16 v[56:59], v[32:35], a[72:75], v[56:59]
s_add_u32 m0, s82, 34816
s_add_u32 s80, s61, 131072
ds_read_b64_tr_b16 a[120:121], v19 offset:0
v_mfma_f32_16x16x32_bf16 v[56:59], v[36:39], a[236:239], v[56:59]
ds_read_b64_tr_b16 a[122:123], v19 offset:512
v_mfma_f32_16x16x32_bf16 v[44:47], v[36:39], a[240:243], v[44:47]
ds_read_b128 v[60:63], v50 offset:4096
v_mfma_f32_16x16x32_bf16 v[44:47], v[32:35], a[92:95], v[44:47]
ds_read_b128 v[100:103], v51 offset:4096
v_mfma_f32_16x16x32_bf16 v[244:247], v[32:35], a[32:35], v[244:247]
ds_read_b64_tr_b16 a[124:125], v16 offset:8192
v_mfma_f32_16x16x32_bf16 v[244:247], v[36:39], a[244:247], v[244:247]
buffer_load_dwordx4 v82, s[12:15], s80 offen lds
v_mfma_f32_16x16x32_bf16 v[116:119], v[36:39], a[248:251], v[116:119]
s_add_u32 m0, s82, 35840
s_add_u32 s80, s61, 196608
ds_read_b64_tr_b16 a[126:127], v16 offset:8704
v_mfma_f32_16x16x32_bf16 v[116:119], v[32:35], a[36:39], v[116:119]
s_waitcnt lgkmcnt(6)
ds_read_b64_tr_b16 a[128:129], v17 offset:8192
v_mfma_f32_16x16x32_bf16 v[120:123], v[164:167], a[36:39], v[120:123]
ds_read_b64_tr_b16 a[130:131], v17 offset:8704
v_mfma_f32_16x16x32_bf16 v[120:123], v[168:171], a[248:251], v[120:123]
ds_read_b64_tr_b16 a[164:165], v18 offset:8192
v_mfma_f32_16x16x32_bf16 v[248:251], v[168:171], a[244:247], v[248:251]
ds_read_b64_tr_b16 a[166:167], v18 offset:8704
v_mfma_f32_16x16x32_bf16 v[248:251], v[164:167], a[32:35], v[248:251]
buffer_load_dwordx4 v83, s[12:15], s80 offen lds
v_mfma_f32_16x16x32_bf16 v[76:79], v[164:167], a[92:95], v[76:79]
s_add_u32 s61, s60, 5
s_and_b32 s61, s61, 7
ds_read_b64_tr_b16 a[168:169], v19 offset:8192
v_mfma_f32_16x16x32_bf16 v[76:79], v[168:171], a[240:243], v[76:79]
s_mul_i32 s61, s61, 128
s_add_u32 s61, s61, s87
ds_read_b64_tr_b16 a[170:171], v19 offset:8704
v_mfma_f32_16x16x32_bf16 v[72:75], v[168:171], a[236:239], v[72:75]
s_add_u32 m0, s82, 81920
s_add_u32 s80, s61, 0
v_mfma_f32_16x16x32_bf16 v[72:75], v[164:167], a[72:75], v[72:75]
v_mfma_f32_16x16x32_bf16 a[76:79], a[8:11], v[164:167], a[76:79]
v_mfma_f32_16x16x32_bf16 a[76:79], a[56:59], v[168:171], a[76:79]
buffer_load_dwordx4 v80, s[8:11], s80 offen lds
v_mfma_f32_16x16x32_bf16 a[28:31], a[48:51], v[168:171], a[28:31]
s_add_u32 m0, s82, 82944
s_add_u32 s80, s61, 8192
ds_read_b128 v[32:35], v50 offset:6144
v_mfma_f32_16x16x32_bf16 a[28:31], a[132:135], v[164:167], a[28:31]
ds_read_b128 v[36:39], v51 offset:6144
v_mfma_f32_16x16x32_bf16 a[156:159], a[136:139], v[164:167], a[156:159]
v_mfma_f32_16x16x32_bf16 a[156:159], a[44:47], v[168:171], a[156:159]
v_mfma_f32_16x16x32_bf16 a[144:147], a[40:43], v[168:171], a[144:147]
v_mfma_f32_16x16x32_bf16 a[144:147], a[252:255], v[164:167], a[144:147]
s_waitcnt lgkmcnt(2)
buffer_load_dwordx4 v81, s[8:11], s80 offen lds
v_mfma_f32_16x16x32_bf16 a[152:155], a[252:255], v[60:63], a[152:155]
s_add_u32 m0, s82, 83968
s_add_u32 s80, s61, 16384
v_mfma_f32_16x16x32_bf16 a[152:155], a[40:43], v[100:103], a[152:155]
v_mfma_f32_16x16x32_bf16 a[12:15], a[44:47], v[100:103], a[12:15]
v_mfma_f32_16x16x32_bf16 a[12:15], a[136:139], v[60:63], a[12:15]
v_mfma_f32_16x16x32_bf16 a[160:163], a[132:135], v[60:63], a[160:163]
v_mfma_f32_16x16x32_bf16 a[160:163], a[48:51], v[100:103], a[160:163]
buffer_load_dwordx4 v80, s[8:11], s80 offen lds
v_mfma_f32_16x16x32_bf16 a[80:83], a[56:59], v[100:103], a[80:83]
s_add_u32 m0, s82, 84992
s_add_u32 s80, s61, 24576
v_mfma_f32_16x16x32_bf16 a[80:83], a[8:11], v[60:63], a[80:83]
s_waitcnt vmcnt(11)
v_mfma_f32_16x16x32_bf16 v[232:235], v[60:63], a[72:75], v[232:235]
s_barrier
v_mfma_f32_16x16x32_bf16 v[232:235], v[100:103], a[236:239], v[232:235]
v_mfma_f32_16x16x32_bf16 v[236:239], v[100:103], a[240:243], v[236:239]
ds_read_b128 v[160:163], v50 offset:16384
v_mfma_f32_16x16x32_bf16 v[236:239], v[60:63], a[92:95], v[236:239]
buffer_load_dwordx4 v81, s[8:11], s80 offen lds
v_mfma_f32_16x16x32_bf16 v[252:255], v[60:63], a[32:35], v[252:255]
s_add_u32 s61, s60, 6
s_and_b32 s61, s61, 7
ds_read_b128 v[164:167], v51 offset:16384
v_mfma_f32_16x16x32_bf16 v[252:255], v[100:103], a[244:247], v[252:255]
s_mul_i32 s61, s61, 524288
s_add_u32 s61, s61, s88
ds_read_b64_tr_b16 a[184:185], v16 offset:16384
v_mfma_f32_16x16x32_bf16 v[124:127], v[100:103], a[248:251], v[124:127]
s_add_u32 m0, s82, 49152
s_add_u32 s80, s61, 262144
ds_read_b64_tr_b16 a[186:187], v16 offset:16896
v_mfma_f32_16x16x32_bf16 v[124:127], v[60:63], a[36:39], v[124:127]
s_waitcnt lgkmcnt(4)
v_mfma_f32_16x16x32_bf16 v[128:131], v[32:35], a[36:39], v[128:131]
ds_read_b64_tr_b16 a[192:193], v17 offset:16384
v_mfma_f32_16x16x32_bf16 v[128:131], v[36:39], a[248:251], v[128:131]
buffer_load_dwordx4 v82, s[12:15], s80 offen lds
v_mfma_f32_16x16x32_bf16 v[112:115], v[36:39], a[244:247], v[112:115]
s_add_u32 m0, s82, 50176
s_add_u32 s80, s61, 327680
ds_read_b64_tr_b16 a[194:195], v17 offset:16896
v_mfma_f32_16x16x32_bf16 v[112:115], v[32:35], a[32:35], v[112:115]
v_mfma_f32_16x16x32_bf16 v[240:243], v[32:35], a[92:95], v[240:243]
ds_read_b64_tr_b16 a[200:201], v18 offset:16384
v_mfma_f32_16x16x32_bf16 v[240:243], v[36:39], a[240:243], v[240:243]
v_mfma_f32_16x16x32_bf16 v[28:31], v[36:39], a[236:239], v[28:31]
ds_read_b64_tr_b16 a[202:203], v18 offset:16896
v_mfma_f32_16x16x32_bf16 v[28:31], v[32:35], a[72:75], v[28:31]
buffer_load_dwordx4 v83, s[12:15], s80 offen lds
v_mfma_f32_16x16x32_bf16 a[84:87], a[8:11], v[32:35], a[84:87]
s_add_u32 m0, s82, 51200
s_add_u32 s80, s61, 393216
ds_read_b64_tr_b16 a[212:213], v19 offset:16384
v_mfma_f32_16x16x32_bf16 a[84:87], a[56:59], v[36:39], a[84:87]
v_mfma_f32_16x16x32_bf16 a[64:67], a[48:51], v[36:39], a[64:67]
ds_read_b128 v[60:63], v50 offset:18432
v_mfma_f32_16x16x32_bf16 a[64:67], a[132:135], v[32:35], a[64:67]
ds_read_b128 v[100:103], v51 offset:18432
v_mfma_f32_16x16x32_bf16 a[16:19], a[136:139], v[32:35], a[16:19]
ds_read_b64_tr_b16 a[214:215], v19 offset:16896
v_mfma_f32_16x16x32_bf16 a[16:19], a[44:47], v[36:39], a[16:19]
buffer_load_dwordx4 v82, s[12:15], s80 offen lds
v_mfma_f32_16x16x32_bf16 a[0:3], a[40:43], v[36:39], a[0:3]
s_add_u32 m0, s82, 52224
s_add_u32 s80, s61, 458752
ds_read_b64_tr_b16 a[220:221], v16 offset:24576
v_mfma_f32_16x16x32_bf16 a[0:3], a[252:255], v[32:35], a[0:3]
s_waitcnt lgkmcnt(5)
ds_read_b64_tr_b16 a[222:223], v16 offset:25088
v_mfma_f32_16x16x32_bf16 a[60:63], a[252:255], v[160:163], a[60:63]
ds_read_b64_tr_b16 a[224:225], v17 offset:24576
v_mfma_f32_16x16x32_bf16 a[60:63], a[40:43], v[164:167], a[60:63]
v_mfma_f32_16x16x32_bf16 a[96:99], a[44:47], v[164:167], a[96:99]
ds_read_b64_tr_b16 a[226:227], v17 offset:25088
v_mfma_f32_16x16x32_bf16 a[96:99], a[136:139], v[160:163], a[96:99]
buffer_load_dwordx4 v83, s[12:15], s80 offen lds
v_mfma_f32_16x16x32_bf16 a[104:107], a[132:135], v[160:163], a[104:107]
s_add_u32 m0, s84, 98304
s_add_u32 s80, s97, 0
ds_read_b64_tr_b16 a[228:229], v18 offset:24576
v_mfma_f32_16x16x32_bf16 a[104:107], a[48:51], v[164:167], a[104:107]
v_mfma_f32_16x16x32_bf16 a[108:111], a[56:59], v[164:167], a[108:111]
ds_read_b64_tr_b16 a[230:231], v18 offset:25088
v_mfma_f32_16x16x32_bf16 a[108:111], a[8:11], v[160:163], a[108:111]
buffer_load_dwordx4 v86, s[32:35], s80 offen lds
v_mfma_f32_16x16x32_bf16 v[132:135], v[160:163], a[72:75], v[132:135]
s_add_u32 m0, s84, 99328
s_add_u32 s80, s97, 4096
ds_read_b64_tr_b16 a[232:233], v19 offset:24576
v_mfma_f32_16x16x32_bf16 v[132:135], v[164:167], a[236:239], v[132:135]
v_mfma_f32_16x16x32_bf16 v[136:139], v[164:167], a[240:243], v[136:139]
ds_read_b128 v[32:35], v50 offset:20480
v_mfma_f32_16x16x32_bf16 v[136:139], v[160:163], a[92:95], v[136:139]
buffer_load_dwordx4 v86, s[32:35], s80 offen lds
v_mfma_f32_16x16x32_bf16 v[140:143], v[160:163], a[32:35], v[140:143]
s_add_u32 m0, s84, 100352
s_add_u32 s80, s97, 8192
ds_read_b128 v[36:39], v51 offset:20480
v_mfma_f32_16x16x32_bf16 v[140:143], v[164:167], a[244:247], v[140:143]
ds_read_b64_tr_b16 a[234:235], v19 offset:25088
v_mfma_f32_16x16x32_bf16 v[96:99], v[164:167], a[248:251], v[96:99]
v_mfma_f32_16x16x32_bf16 v[96:99], v[160:163], a[36:39], v[96:99]
s_waitcnt lgkmcnt(4)
buffer_load_dwordx4 v86, s[32:35], s80 offen lds
v_mfma_f32_16x16x32_bf16 v[24:27], v[60:63], a[36:39], v[24:27]
s_add_u32 m0, s84, 101376
s_add_u32 s80, s97, 12288
v_mfma_f32_16x16x32_bf16 v[24:27], v[100:103], a[248:251], v[24:27]
v_mfma_f32_16x16x32_bf16 v[40:43], v[100:103], a[244:247], v[40:43]
v_mfma_f32_16x16x32_bf16 v[40:43], v[60:63], a[32:35], v[40:43]
buffer_load_dwordx4 v86, s[32:35], s80 offen lds
v_mfma_f32_16x16x32_bf16 v[64:67], v[60:63], a[92:95], v[64:67]
s_add_u32 m0, s84, 102400
s_add_u32 s80, s97, 16384
v_mfma_f32_16x16x32_bf16 v[64:67], v[100:103], a[240:243], v[64:67]
v_mfma_f32_16x16x32_bf16 v[20:23], v[100:103], a[236:239], v[20:23]
v_mfma_f32_16x16x32_bf16 v[20:23], v[60:63], a[72:75], v[20:23]
buffer_load_dwordx4 v86, s[32:35], s80 offen lds
v_mfma_f32_16x16x32_bf16 a[172:175], a[8:11], v[60:63], a[172:175]
s_add_u32 m0, s84, 103424
s_add_u32 s80, s97, 20480
v_mfma_f32_16x16x32_bf16 a[172:175], a[56:59], v[100:103], a[172:175]
v_mfma_f32_16x16x32_bf16 a[176:179], a[48:51], v[100:103], a[176:179]
ds_read_b128 v[160:163], v50 offset:22528
v_mfma_f32_16x16x32_bf16 a[176:179], a[132:135], v[60:63], a[176:179]
buffer_load_dwordx4 v86, s[32:35], s80 offen lds
v_mfma_f32_16x16x32_bf16 a[180:183], a[136:139], v[60:63], a[180:183]
s_add_u32 m0, s84, 104448
s_add_u32 s80, s97, 24576
ds_read_b128 v[164:167], v51 offset:22528
v_mfma_f32_16x16x32_bf16 a[180:183], a[44:47], v[100:103], a[180:183]
v_mfma_f32_16x16x32_bf16 a[188:191], a[40:43], v[100:103], a[188:191]
v_mfma_f32_16x16x32_bf16 a[188:191], a[252:255], v[60:63], a[188:191]
s_waitcnt lgkmcnt(2)
buffer_load_dwordx4 v86, s[32:35], s80 offen lds
v_mfma_f32_16x16x32_bf16 a[196:199], a[252:255], v[32:35], a[196:199]
s_add_u32 m0, s84, 105472
s_add_u32 s80, s97, 28672
v_mfma_f32_16x16x32_bf16 a[196:199], a[40:43], v[36:39], a[196:199]
v_mfma_f32_16x16x32_bf16 a[204:207], a[44:47], v[36:39], a[204:207]
v_mfma_f32_16x16x32_bf16 a[204:207], a[136:139], v[32:35], a[204:207]
buffer_load_dwordx4 v86, s[32:35], s80 offen lds
v_mfma_f32_16x16x32_bf16 a[208:211], a[132:135], v[32:35], a[208:211]
s_add_u32 s61, s60, 6
s_and_b32 s61, s61, 7
s_mul_i32 s61, s61, 128
v_mfma_f32_16x16x32_bf16 a[208:211], a[48:51], v[36:39], a[208:211]
s_add_u32 s61, s61, s86
s_add_u32 m0, s82, 131072
s_add_u32 s80, s61, 0
v_mfma_f32_16x16x32_bf16 a[216:219], a[56:59], v[36:39], a[216:219]
v_mfma_f32_16x16x32_bf16 a[216:219], a[8:11], v[32:35], a[216:219]
s_waitcnt vmcnt(16)
v_mfma_f32_16x16x32_bf16 v[104:107], v[32:35], a[72:75], v[104:107]
s_barrier
v_mfma_f32_16x16x32_bf16 v[104:107], v[36:39], a[236:239], v[104:107]
buffer_load_dwordx4 v80, s[8:11], s80 offen lds
v_mfma_f32_16x16x32_bf16 v[108:111], v[36:39], a[240:243], v[108:111]
s_add_u32 m0, s82, 132096
s_add_u32 s80, s61, 8192
ds_read_b128 v[60:63], v48 offset:0
v_mfma_f32_16x16x32_bf16 v[108:111], v[32:35], a[92:95], v[108:111]
ds_read_b128 v[100:103], v49 offset:0
v_mfma_f32_16x16x32_bf16 v[144:147], v[32:35], a[32:35], v[144:147]
v_mfma_f32_16x16x32_bf16 v[144:147], v[36:39], a[244:247], v[144:147]
v_mfma_f32_16x16x32_bf16 v[148:151], v[36:39], a[248:251], v[148:151]
v_mfma_f32_16x16x32_bf16 v[148:151], v[32:35], a[36:39], v[148:151]
s_waitcnt lgkmcnt(2)
buffer_load_dwordx4 v81, s[8:11], s80 offen lds
v_mfma_f32_16x16x32_bf16 v[152:155], v[160:163], a[36:39], v[152:155]
s_add_u32 m0, s82, 133120
s_add_u32 s80, s61, 16384
v_mfma_f32_16x16x32_bf16 v[152:155], v[164:167], a[248:251], v[152:155]
v_mfma_f32_16x16x32_bf16 v[52:55], v[164:167], a[244:247], v[52:55]
v_mfma_f32_16x16x32_bf16 v[52:55], v[160:163], a[32:35], v[52:55]
v_mfma_f32_16x16x32_bf16 v[68:71], v[160:163], a[92:95], v[68:71]
v_mfma_f32_16x16x32_bf16 v[68:71], v[164:167], a[240:243], v[68:71]
buffer_load_dwordx4 v80, s[8:11], s80 offen lds
v_mfma_f32_16x16x32_bf16 v[156:159], v[164:167], a[236:239], v[156:159]
s_add_u32 m0, s82, 134144
s_add_u32 s80, s61, 24576
v_mfma_f32_16x16x32_bf16 v[156:159], v[160:163], a[72:75], v[156:159]
v_mfma_f32_16x16x32_bf16 a[88:91], a[8:11], v[160:163], a[88:91]
v_mfma_f32_16x16x32_bf16 a[88:91], a[56:59], v[164:167], a[88:91]
v_mfma_f32_16x16x32_bf16 a[52:55], a[48:51], v[164:167], a[52:55]
ds_read_b128 v[32:35], v48 offset:2048
v_mfma_f32_16x16x32_bf16 a[52:55], a[132:135], v[160:163], a[52:55]
buffer_load_dwordx4 v81, s[8:11], s80 offen lds
v_mfma_f32_16x16x32_bf16 a[24:27], a[136:139], v[160:163], a[24:27]
s_add_u32 s61, s60, 7
s_and_b32 s61, s61, 7
ds_read_b128 v[36:39], v49 offset:2048
v_mfma_f32_16x16x32_bf16 a[24:27], a[44:47], v[164:167], a[24:27]
s_mul_i32 s61, s61, 524288
s_add_u32 s61, s61, s88
s_add_u32 m0, s82, 0
v_mfma_f32_16x16x32_bf16 a[148:151], a[40:43], v[164:167], a[148:151]
s_add_u32 s80, s61, 0
v_mfma_f32_16x16x32_bf16 a[148:151], a[252:255], v[160:163], a[148:151]
s_waitcnt lgkmcnt(2)
v_mfma_f32_16x16x32_bf16 a[140:143], a[100:103], v[60:63], a[140:143]
ds_read_b64_tr_b16 a[136:137], v16 offset:32768
v_mfma_f32_16x16x32_bf16 a[140:143], a[184:187], v[100:103], a[140:143]
buffer_load_dwordx4 v82, s[12:15], s80 offen lds
v_mfma_f32_16x16x32_bf16 a[4:7], a[192:195], v[100:103], a[4:7]
s_add_u32 m0, s82, 1024
s_add_u32 s80, s61, 65536
ds_read_b64_tr_b16 a[138:139], v16 offset:33280
v_mfma_f32_16x16x32_bf16 a[4:7], a[112:115], v[60:63], a[4:7]
ds_read_b64_tr_b16 a[252:253], v17 offset:32768
v_mfma_f32_16x16x32_bf16 a[20:23], a[116:119], v[60:63], a[20:23]
ds_read_b64_tr_b16 a[254:255], v17 offset:33280
v_mfma_f32_16x16x32_bf16 a[20:23], a[200:203], v[100:103], a[20:23]
ds_read_b64_tr_b16 a[132:133], v18 offset:32768
v_mfma_f32_16x16x32_bf16 a[68:71], a[212:215], v[100:103], a[68:71]
ds_read_b64_tr_b16 a[134:135], v18 offset:33280
v_mfma_f32_16x16x32_bf16 a[68:71], a[120:123], v[60:63], a[68:71]
buffer_load_dwordx4 v83, s[12:15], s80 offen lds
v_mfma_f32_16x16x32_bf16 v[56:59], v[60:63], a[124:127], v[56:59]
s_add_u32 m0, s82, 2048
s_add_u32 s80, s61, 131072
ds_read_b64_tr_b16 a[8:9], v19 offset:32768
v_mfma_f32_16x16x32_bf16 v[56:59], v[100:103], a[220:223], v[56:59]
ds_read_b64_tr_b16 a[10:11], v19 offset:33280
v_mfma_f32_16x16x32_bf16 v[44:47], v[100:103], a[224:227], v[44:47]
ds_read_b128 v[160:163], v48 offset:4096
v_mfma_f32_16x16x32_bf16 v[44:47], v[60:63], a[128:131], v[44:47]
ds_read_b128 v[164:167], v49 offset:4096
v_mfma_f32_16x16x32_bf16 v[244:247], v[60:63], a[164:167], v[244:247]
ds_read_b64_tr_b16 a[72:73], v16 offset:40960
v_mfma_f32_16x16x32_bf16 v[244:247], v[100:103], a[228:231], v[244:247]
buffer_load_dwordx4 v82, s[12:15], s80 offen lds
v_mfma_f32_16x16x32_bf16 v[116:119], v[100:103], a[232:235], v[116:119]
s_add_u32 m0, s82, 3072
s_add_u32 s80, s61, 196608
ds_read_b64_tr_b16 a[74:75], v16 offset:41472
v_mfma_f32_16x16x32_bf16 v[116:119], v[60:63], a[168:171], v[116:119]
s_waitcnt lgkmcnt(6)
ds_read_b64_tr_b16 a[92:93], v17 offset:40960
v_mfma_f32_16x16x32_bf16 v[120:123], v[32:35], a[168:171], v[120:123]
ds_read_b64_tr_b16 a[94:95], v17 offset:41472
v_mfma_f32_16x16x32_bf16 v[120:123], v[36:39], a[232:235], v[120:123]
ds_read_b64_tr_b16 a[32:33], v18 offset:40960
v_mfma_f32_16x16x32_bf16 v[248:251], v[36:39], a[228:231], v[248:251]
ds_read_b64_tr_b16 a[34:35], v18 offset:41472
v_mfma_f32_16x16x32_bf16 v[248:251], v[32:35], a[164:167], v[248:251]
buffer_load_dwordx4 v83, s[12:15], s80 offen lds
v_mfma_f32_16x16x32_bf16 v[76:79], v[32:35], a[128:131], v[76:79]
s_add_u32 s61, s60, 6
s_and_b32 s61, s61, 7
ds_read_b64_tr_b16 a[36:37], v19 offset:40960
v_mfma_f32_16x16x32_bf16 v[76:79], v[36:39], a[224:227], v[76:79]
s_mul_i32 s61, s61, 128
s_add_u32 s61, s61, s87
ds_read_b64_tr_b16 a[38:39], v19 offset:41472
v_mfma_f32_16x16x32_bf16 v[72:75], v[36:39], a[220:223], v[72:75]
s_add_u32 m0, s82, 147456
s_add_u32 s80, s61, 0
v_mfma_f32_16x16x32_bf16 v[72:75], v[32:35], a[124:127], v[72:75]
v_mfma_f32_16x16x32_bf16 a[76:79], a[120:123], v[32:35], a[76:79]
v_mfma_f32_16x16x32_bf16 a[76:79], a[212:215], v[36:39], a[76:79]
v_mfma_f32_16x16x32_bf16 a[28:31], a[200:203], v[36:39], a[28:31]
ds_read_b128 v[60:63], v48 offset:6144
v_mfma_f32_16x16x32_bf16 a[28:31], a[116:119], v[32:35], a[28:31]
ds_read_b128 v[100:103], v49 offset:6144
v_mfma_f32_16x16x32_bf16 a[156:159], a[112:115], v[32:35], a[156:159]
v_mfma_f32_16x16x32_bf16 a[156:159], a[192:195], v[36:39], a[156:159]
v_mfma_f32_16x16x32_bf16 a[144:147], a[184:187], v[36:39], a[144:147]
v_mfma_f32_16x16x32_bf16 a[144:147], a[100:103], v[32:35], a[144:147]
s_waitcnt lgkmcnt(2)
v_mfma_f32_16x16x32_bf16 a[152:155], a[100:103], v[160:163], a[152:155]
v_mfma_f32_16x16x32_bf16 a[152:155], a[184:187], v[164:167], a[152:155]
v_mfma_f32_16x16x32_bf16 a[12:15], a[192:195], v[164:167], a[12:15]
v_mfma_f32_16x16x32_bf16 a[12:15], a[112:115], v[160:163], a[12:15]
v_mfma_f32_16x16x32_bf16 a[160:163], a[116:119], v[160:163], a[160:163]
v_mfma_f32_16x16x32_bf16 a[160:163], a[200:203], v[164:167], a[160:163]
v_mfma_f32_16x16x32_bf16 a[80:83], a[212:215], v[164:167], a[80:83]
v_mfma_f32_16x16x32_bf16 a[80:83], a[120:123], v[160:163], a[80:83]
s_waitcnt vmcnt(16)
v_mfma_f32_16x16x32_bf16 v[232:235], v[160:163], a[124:127], v[232:235]
s_barrier
v_mfma_f32_16x16x32_bf16 v[232:235], v[164:167], a[220:223], v[232:235]
buffer_load_dwordx4 v80, s[8:11], s80 offen lds
v_mfma_f32_16x16x32_bf16 v[236:239], v[164:167], a[224:227], v[236:239]
s_add_u32 m0, s82, 148480
s_add_u32 s80, s61, 8192
ds_read_b128 v[32:35], v48 offset:16384
v_mfma_f32_16x16x32_bf16 v[236:239], v[160:163], a[128:131], v[236:239]
ds_read_b128 v[36:39], v49 offset:16384
v_mfma_f32_16x16x32_bf16 v[252:255], v[160:163], a[164:167], v[252:255]
ds_read_b64_tr_b16 a[40:41], v16 offset:49152
v_mfma_f32_16x16x32_bf16 v[252:255], v[164:167], a[228:231], v[252:255]
v_mfma_f32_16x16x32_bf16 v[124:127], v[164:167], a[232:235], v[124:127]
ds_read_b64_tr_b16 a[42:43], v16 offset:49664
v_mfma_f32_16x16x32_bf16 v[124:127], v[160:163], a[168:171], v[124:127]
s_waitcnt lgkmcnt(4)
buffer_load_dwordx4 v81, s[8:11], s80 offen lds
v_mfma_f32_16x16x32_bf16 v[128:131], v[60:63], a[168:171], v[128:131]
s_add_u32 m0, s82, 149504
s_add_u32 s80, s61, 16384
ds_read_b64_tr_b16 a[44:45], v17 offset:49152
v_mfma_f32_16x16x32_bf16 v[128:131], v[100:103], a[232:235], v[128:131]
v_mfma_f32_16x16x32_bf16 v[112:115], v[100:103], a[228:231], v[112:115]
ds_read_b64_tr_b16 a[46:47], v17 offset:49664
v_mfma_f32_16x16x32_bf16 v[112:115], v[60:63], a[164:167], v[112:115]
v_mfma_f32_16x16x32_bf16 v[240:243], v[60:63], a[128:131], v[240:243]
ds_read_b64_tr_b16 a[48:49], v18 offset:49152
v_mfma_f32_16x16x32_bf16 v[240:243], v[100:103], a[224:227], v[240:243]
buffer_load_dwordx4 v80, s[8:11], s80 offen lds
v_mfma_f32_16x16x32_bf16 v[28:31], v[100:103], a[220:223], v[28:31]
s_add_u32 m0, s82, 150528
s_add_u32 s80, s61, 24576
ds_read_b64_tr_b16 a[50:51], v18 offset:49664
v_mfma_f32_16x16x32_bf16 v[28:31], v[60:63], a[124:127], v[28:31]
v_mfma_f32_16x16x32_bf16 a[84:87], a[120:123], v[60:63], a[84:87]
ds_read_b64_tr_b16 a[56:57], v19 offset:49152
v_mfma_f32_16x16x32_bf16 a[84:87], a[212:215], v[100:103], a[84:87]
v_mfma_f32_16x16x32_bf16 a[64:67], a[200:203], v[100:103], a[64:67]
ds_read_b128 v[160:163], v48 offset:18432
v_mfma_f32_16x16x32_bf16 a[64:67], a[116:119], v[60:63], a[64:67]
buffer_load_dwordx4 v81, s[8:11], s80 offen lds
v_mfma_f32_16x16x32_bf16 a[16:19], a[112:115], v[60:63], a[16:19]
s_add_u32 s61, s60, 7
s_and_b32 s61, s61, 7
ds_read_b128 v[164:167], v49 offset:18432
v_mfma_f32_16x16x32_bf16 a[16:19], a[192:195], v[100:103], a[16:19]
s_mul_i32 s61, s61, 524288
s_add_u32 s61, s61, s88
ds_read_b64_tr_b16 a[58:59], v19 offset:49664
v_mfma_f32_16x16x32_bf16 a[0:3], a[184:187], v[100:103], a[0:3]
s_add_u32 m0, s82, 16384
s_add_u32 s80, s61, 262144
ds_read_b64_tr_b16 a[236:237], v16 offset:57344
v_mfma_f32_16x16x32_bf16 a[0:3], a[100:103], v[60:63], a[0:3]
s_waitcnt lgkmcnt(5)
ds_read_b64_tr_b16 a[238:239], v16 offset:57856
v_mfma_f32_16x16x32_bf16 a[60:63], a[100:103], v[32:35], a[60:63]
ds_read_b64_tr_b16 a[240:241], v17 offset:57344
v_mfma_f32_16x16x32_bf16 a[60:63], a[184:187], v[36:39], a[60:63]
buffer_load_dwordx4 v82, s[12:15], s80 offen lds
v_mfma_f32_16x16x32_bf16 a[96:99], a[192:195], v[36:39], a[96:99]
s_add_u32 m0, s82, 17408
s_add_u32 s80, s61, 327680
ds_read_b64_tr_b16 a[242:243], v17 offset:57856
v_mfma_f32_16x16x32_bf16 a[96:99], a[112:115], v[32:35], a[96:99]
v_mfma_f32_16x16x32_bf16 a[104:107], a[116:119], v[32:35], a[104:107]
ds_read_b64_tr_b16 a[244:245], v18 offset:57344
v_mfma_f32_16x16x32_bf16 a[104:107], a[200:203], v[36:39], a[104:107]
v_mfma_f32_16x16x32_bf16 a[108:111], a[212:215], v[36:39], a[108:111]
ds_read_b64_tr_b16 a[246:247], v18 offset:57856
v_mfma_f32_16x16x32_bf16 a[108:111], a[120:123], v[32:35], a[108:111]
buffer_load_dwordx4 v83, s[12:15], s80 offen lds
v_mfma_f32_16x16x32_bf16 v[132:135], v[32:35], a[124:127], v[132:135]
s_add_u32 m0, s82, 18432
s_add_u32 s80, s61, 393216
ds_read_b64_tr_b16 a[248:249], v19 offset:57344
v_mfma_f32_16x16x32_bf16 v[132:135], v[36:39], a[220:223], v[132:135]
v_mfma_f32_16x16x32_bf16 v[136:139], v[36:39], a[224:227], v[136:139]
ds_read_b128 v[60:63], v48 offset:20480
v_mfma_f32_16x16x32_bf16 v[136:139], v[32:35], a[128:131], v[136:139]
ds_read_b128 v[100:103], v49 offset:20480
v_mfma_f32_16x16x32_bf16 v[140:143], v[32:35], a[164:167], v[140:143]
ds_read_b64_tr_b16 a[250:251], v19 offset:57856
v_mfma_f32_16x16x32_bf16 v[140:143], v[36:39], a[228:231], v[140:143]
buffer_load_dwordx4 v82, s[12:15], s80 offen lds
v_mfma_f32_16x16x32_bf16 v[96:99], v[36:39], a[232:235], v[96:99]
s_add_u32 m0, s82, 19456
s_add_u32 s80, s61, 458752
v_mfma_f32_16x16x32_bf16 v[96:99], v[32:35], a[168:171], v[96:99]
s_waitcnt lgkmcnt(4)
v_mfma_f32_16x16x32_bf16 v[24:27], v[160:163], a[168:171], v[24:27]
v_mfma_f32_16x16x32_bf16 v[24:27], v[164:167], a[232:235], v[24:27]
v_mfma_f32_16x16x32_bf16 v[40:43], v[164:167], a[228:231], v[40:43]
v_mfma_f32_16x16x32_bf16 v[40:43], v[160:163], a[164:167], v[40:43]
buffer_load_dwordx4 v83, s[12:15], s80 offen lds
v_mfma_f32_16x16x32_bf16 v[64:67], v[160:163], a[128:131], v[64:67]
s_add_u32 s61, s60, 7
s_and_b32 s61, s61, 7
s_mul_i32 s61, s61, 128
v_mfma_f32_16x16x32_bf16 v[64:67], v[164:167], a[224:227], v[64:67]
s_add_u32 s61, s61, s86
s_add_u32 m0, s82, 65536
s_add_u32 s80, s61, 0
v_mfma_f32_16x16x32_bf16 v[20:23], v[164:167], a[220:223], v[20:23]
v_mfma_f32_16x16x32_bf16 v[20:23], v[160:163], a[124:127], v[20:23]
v_mfma_f32_16x16x32_bf16 a[172:175], a[120:123], v[160:163], a[172:175]
s_waitcnt vmcnt(16)
ds_read_b64_tr_b16 v[32:33], v87 offset:0
v_mfma_f32_16x16x32_bf16 a[172:175], a[212:215], v[164:167], a[172:175]
v_mfma_f32_16x16x32_bf16 a[176:179], a[200:203], v[164:167], a[176:179]
ds_read_b128 v[36:39], v48 offset:22528
v_mfma_f32_16x16x32_bf16 a[176:179], a[116:119], v[160:163], a[176:179]
ds_read_b128 v[168:171], v49 offset:22528
v_mfma_f32_16x16x32_bf16 a[180:183], a[112:115], v[160:163], a[180:183]
ds_read_b64_tr_b16 v[34:35], v87 offset:4096
v_mfma_f32_16x16x32_bf16 a[180:183], a[192:195], v[164:167], a[180:183]
v_mfma_f32_16x16x32_bf16 a[188:191], a[184:187], v[164:167], a[188:191]
ds_read_b64_tr_b16 v[172:173], v87 offset:8
v_mfma_f32_16x16x32_bf16 a[188:191], a[100:103], v[160:163], a[188:191]
s_waitcnt lgkmcnt(5)
v_mfma_f32_16x16x32_bf16 a[196:199], a[100:103], v[60:63], a[196:199]
v_mfma_f32_16x16x32_bf16 a[196:199], a[184:187], v[100:103], a[196:199]
ds_read_b64_tr_b16 v[174:175], v87 offset:4104
v_xor_b32 v87, 64, v87
v_mfma_f32_16x16x32_bf16 a[204:207], a[192:195], v[100:103], a[204:207]
v_mfma_f32_16x16x32_bf16 a[204:207], a[112:115], v[60:63], a[204:207]
v_mfma_f32_16x16x32_bf16 a[208:211], a[116:119], v[60:63], a[208:211]
ds_read_b64_tr_b16 v[164:165], v87 offset:0
v_mfma_f32_16x16x32_bf16 a[208:211], a[200:203], v[100:103], a[208:211]
v_mfma_f32_16x16x32_bf16 a[216:219], a[212:215], v[100:103], a[216:219]
v_mfma_f32_16x16x32_bf16 a[216:219], a[120:123], v[60:63], a[216:219]
s_waitcnt vmcnt(8)
ds_read_b64_tr_b16 v[166:167], v87 offset:4096
v_mfma_f32_16x16x32_bf16 v[104:107], v[60:63], a[124:127], v[104:107]
s_barrier
v_mfma_f32_16x16x32_bf16 v[104:107], v[100:103], a[220:223], v[104:107]
buffer_load_dwordx4 v80, s[8:11], s80 offen lds
v_mfma_f32_16x16x32_bf16 v[108:111], v[100:103], a[224:227], v[108:111]
s_add_u32 m0, s82, 66560
s_add_u32 s80, s61, 8192
ds_read_b128 v[160:163], v50 offset:0
v_mfma_f32_16x16x32_bf16 v[108:111], v[60:63], a[128:131], v[108:111]
ds_read_b128 v[176:179], v51 offset:0
v_mfma_f32_16x16x32_bf16 v[144:147], v[60:63], a[164:167], v[144:147]
ds_read_b64_tr_b16 v[180:181], v87 offset:8
v_mfma_f32_16x16x32_bf16 v[144:147], v[100:103], a[228:231], v[144:147]
ds_read_b64_tr_b16 v[182:183], v87 offset:4104
v_xor_b32 v87, 192, v87
v_mfma_f32_16x16x32_bf16 v[148:151], v[100:103], a[232:235], v[148:151]
v_mfma_f32_16x16x32_bf16 v[148:151], v[60:63], a[168:171], v[148:151]
s_waitcnt lgkmcnt(5)
buffer_load_dwordx4 v81, s[8:11], s80 offen lds
v_mfma_f32_16x16x32_bf16 v[152:155], v[36:39], a[168:171], v[152:155]
s_add_u32 m0, s82, 67584
s_add_u32 s80, s61, 16384
ds_read_b64_tr_b16 v[184:185], v87 offset:0
v_mfma_f32_16x16x32_bf16 v[152:155], v[168:171], a[232:235], v[152:155]
v_mfma_f32_16x16x32_bf16 v[52:55], v[168:171], a[228:231], v[52:55]
v_mfma_f32_16x16x32_bf16 v[52:55], v[36:39], a[164:167], v[52:55]
ds_read_b64_tr_b16 v[186:187], v87 offset:4096
v_mfma_f32_16x16x32_bf16 v[68:71], v[36:39], a[128:131], v[68:71]
v_mfma_f32_16x16x32_bf16 v[68:71], v[168:171], a[224:227], v[68:71]
buffer_load_dwordx4 v80, s[8:11], s80 offen lds
v_mfma_f32_16x16x32_bf16 v[156:159], v[168:171], a[220:223], v[156:159]
s_add_u32 m0, s82, 68608
s_add_u32 s80, s61, 24576
ds_read_b64_tr_b16 v[60:61], v87 offset:8
v_mfma_f32_16x16x32_bf16 v[156:159], v[36:39], a[124:127], v[156:159]
v_mfma_f32_16x16x32_bf16 a[88:91], a[120:123], v[36:39], a[88:91]
v_mfma_f32_16x16x32_bf16 a[88:91], a[212:215], v[168:171], a[88:91]
ds_read_b64_tr_b16 v[62:63], v87 offset:4104
v_xor_b32 v87, 64, v87
v_mfma_f32_16x16x32_bf16 a[52:55], a[200:203], v[168:171], a[52:55]
ds_read_b128 v[100:103], v50 offset:2048
v_mfma_f32_16x16x32_bf16 a[52:55], a[116:119], v[36:39], a[52:55]
buffer_load_dwordx4 v81, s[8:11], s80 offen lds
v_mfma_f32_16x16x32_bf16 a[24:27], a[112:115], v[36:39], a[24:27]
s_add_u32 s61, s60, 7
s_and_b32 s61, s61, 7
ds_read_b128 v[188:191], v51 offset:2048
v_mfma_f32_16x16x32_bf16 a[24:27], a[192:195], v[168:171], a[24:27]
s_mul_i32 s61, s61, 128
s_add_u32 s61, s61, s87
ds_read_b64_tr_b16 v[192:193], v87 offset:0
v_mfma_f32_16x16x32_bf16 a[148:151], a[184:187], v[168:171], a[148:151]
s_add_u32 m0, s82, 81920
s_add_u32 s80, s61, 0
v_mfma_f32_16x16x32_bf16 a[148:151], a[100:103], v[36:39], a[148:151]
s_waitcnt lgkmcnt(4)
ds_read_b64_tr_b16 v[194:195], v87 offset:4096
v_mfma_f32_16x16x32_bf16 a[140:143], a[136:139], v[160:163], a[140:143]
L_pad3:
s_cbranch_execz L_pad7
buffer_store_dwordx4 v[32:35], v1, s[28:31], s81 offen sc1
ds_read_b64_tr_b16 a[112:113], v16 offset:0
v_mfma_f32_16x16x32_bf16 a[140:143], a[40:43], v[176:179], a[140:143]
ds_read_b64_tr_b16 a[114:115], v16 offset:512
v_mfma_f32_16x16x32_bf16 a[4:7], a[44:47], v[176:179], a[4:7]
ds_read_b64_tr_b16 a[116:117], v17 offset:0
v_mfma_f32_16x16x32_bf16 a[4:7], a[252:255], v[160:163], a[4:7]
ds_read_b64_tr_b16 a[118:119], v17 offset:512
v_mfma_f32_16x16x32_bf16 a[20:23], a[132:135], v[160:163], a[20:23]
ds_read_b64_tr_b16 a[100:101], v18 offset:0
v_mfma_f32_16x16x32_bf16 a[20:23], a[48:51], v[176:179], a[20:23]
ds_read_b64_tr_b16 a[102:103], v18 offset:512
v_mfma_f32_16x16x32_bf16 a[68:71], a[56:59], v[176:179], a[68:71]
ds_read_b64_tr_b16 a[120:121], v19 offset:0
v_mfma_f32_16x16x32_bf16 a[68:71], a[8:11], v[160:163], a[68:71]
ds_read_b64_tr_b16 a[122:123], v19 offset:512
v_mfma_f32_16x16x32_bf16 v[56:59], v[160:163], a[72:75], v[56:59]
ds_read_b64_tr_b16 a[124:125], v16 offset:8192
v_mfma_f32_16x16x32_bf16 v[56:59], v[176:179], a[236:239], v[56:59]
ds_read_b64_tr_b16 a[126:127], v16 offset:8704
v_mfma_f32_16x16x32_bf16 v[44:47], v[176:179], a[240:243], v[44:47]
ds_read_b128 v[32:35], v50 offset:4096
v_mfma_f32_16x16x32_bf16 v[44:47], v[160:163], a[92:95], v[44:47]
ds_read_b128 v[36:39], v51 offset:4096
v_mfma_f32_16x16x32_bf16 v[244:247], v[160:163], a[32:35], v[244:247]
ds_read_b64_tr_b16 a[128:129], v17 offset:8192
v_mfma_f32_16x16x32_bf16 v[244:247], v[176:179], a[244:247], v[244:247]
ds_read_b64_tr_b16 a[130:131], v17 offset:8704
v_mfma_f32_16x16x32_bf16 v[116:119], v[176:179], a[248:251], v[116:119]
ds_read_b64_tr_b16 a[164:165], v18 offset:8192
v_mfma_f32_16x16x32_bf16 v[116:119], v[160:163], a[36:39], v[116:119]
s_waitcnt lgkmcnt(8)
ds_read_b64_tr_b16 a[166:167], v18 offset:8704
v_mfma_f32_16x16x32_bf16 v[120:123], v[100:103], a[36:39], v[120:123]
ds_read_b64_tr_b16 a[168:169], v19 offset:8192
v_mfma_f32_16x16x32_bf16 v[120:123], v[188:191], a[248:251], v[120:123]
ds_read_b64_tr_b16 a[170:171], v19 offset:8704
v_mfma_f32_16x16x32_bf16 v[248:251], v[188:191], a[244:247], v[248:251]
ds_read_b64_tr_b16 v[168:169], v87 offset:8
v_mfma_f32_16x16x32_bf16 v[248:251], v[100:103], a[32:35], v[248:251]
ds_read_b64_tr_b16 v[170:171], v87 offset:4104
v_mfma_f32_16x16x32_bf16 v[76:79], v[100:103], a[92:95], v[76:79]
v_mfma_f32_16x16x32_bf16 v[76:79], v[188:191], a[240:243], v[76:79]
v_mfma_f32_16x16x32_bf16 v[72:75], v[188:191], a[236:239], v[72:75]
v_mfma_f32_16x16x32_bf16 v[72:75], v[100:103], a[72:75], v[72:75]
v_mfma_f32_16x16x32_bf16 a[76:79], a[8:11], v[100:103], a[76:79]
buffer_store_dwordx4 v[172:175], v1, s[28:31], s81 offen offset:1024 sc1
v_mfma_f32_16x16x32_bf16 a[76:79], a[56:59], v[188:191], a[76:79]
s_add_u32 s81, s98, 377856
v_mfma_f32_16x16x32_bf16 a[28:31], a[48:51], v[188:191], a[28:31]
ds_read_b128 v[160:163], v50 offset:6144
v_mfma_f32_16x16x32_bf16 a[28:31], a[132:135], v[100:103], a[28:31]
ds_read_b128 v[176:179], v51 offset:6144
v_mfma_f32_16x16x32_bf16 a[156:159], a[252:255], v[100:103], a[156:159]
v_mfma_f32_16x16x32_bf16 a[156:159], a[44:47], v[188:191], a[156:159]
v_mfma_f32_16x16x32_bf16 a[144:147], a[40:43], v[188:191], a[144:147]
v_mfma_f32_16x16x32_bf16 a[144:147], a[136:139], v[100:103], a[144:147]
s_waitcnt lgkmcnt(2)
v_mfma_f32_16x16x32_bf16 a[152:155], a[136:139], v[32:35], a[152:155]
v_mfma_f32_16x16x32_bf16 a[152:155], a[40:43], v[36:39], a[152:155]
v_mfma_f32_16x16x32_bf16 a[12:15], a[44:47], v[36:39], a[12:15]
v_mfma_f32_16x16x32_bf16 a[12:15], a[252:255], v[32:35], a[12:15]
v_mfma_f32_16x16x32_bf16 a[160:163], a[132:135], v[32:35], a[160:163]
v_mfma_f32_16x16x32_bf16 a[160:163], a[48:51], v[36:39], a[160:163]
v_mfma_f32_16x16x32_bf16 a[80:83], a[56:59], v[36:39], a[80:83]
v_mfma_f32_16x16x32_bf16 a[80:83], a[8:11], v[32:35], a[80:83]
s_waitcnt vmcnt(6)
v_mfma_f32_16x16x32_bf16 v[232:235], v[32:35], a[72:75], v[232:235]
s_barrier
v_mfma_f32_16x16x32_bf16 v[232:235], v[36:39], a[236:239], v[232:235]
buffer_load_dwordx4 v80, s[8:11], s80 offen lds
v_mfma_f32_16x16x32_bf16 v[236:239], v[36:39], a[240:243], v[236:239]
s_add_u32 m0, s82, 82944
s_add_u32 s80, s61, 8192
ds_read_b128 v[100:103], v50 offset:16384
v_mfma_f32_16x16x32_bf16 v[236:239], v[32:35], a[92:95], v[236:239]
ds_read_b128 v[172:175], v51 offset:16384
v_mfma_f32_16x16x32_bf16 v[252:255], v[32:35], a[32:35], v[252:255]
ds_read_b64_tr_b16 a[184:185], v16 offset:16384
v_mfma_f32_16x16x32_bf16 v[252:255], v[36:39], a[244:247], v[252:255]
v_mfma_f32_16x16x32_bf16 v[124:127], v[36:39], a[248:251], v[124:127]
ds_read_b64_tr_b16 a[186:187], v16 offset:16896
v_mfma_f32_16x16x32_bf16 v[124:127], v[32:35], a[36:39], v[124:127]
s_waitcnt lgkmcnt(4)
buffer_load_dwordx4 v81, s[8:11], s80 offen lds
v_mfma_f32_16x16x32_bf16 v[128:131], v[160:163], a[36:39], v[128:131]
s_add_u32 m0, s82, 83968
buffer_store_dwordx4 v[164:167], v1, s[28:31], s81 offen sc1
ds_read_b64_tr_b16 a[192:193], v17 offset:16384
v_mfma_f32_16x16x32_bf16 v[128:131], v[176:179], a[248:251], v[128:131]
s_add_u32 s80, s61, 16384
v_mfma_f32_16x16x32_bf16 v[112:115], v[176:179], a[244:247], v[112:115]
ds_read_b64_tr_b16 a[194:195], v17 offset:16896
v_mfma_f32_16x16x32_bf16 v[112:115], v[160:163], a[32:35], v[112:115]
v_mfma_f32_16x16x32_bf16 v[240:243], v[160:163], a[92:95], v[240:243]
ds_read_b64_tr_b16 a[200:201], v18 offset:16384
v_mfma_f32_16x16x32_bf16 v[240:243], v[176:179], a[240:243], v[240:243]
buffer_load_dwordx4 v80, s[8:11], s80 offen lds
v_mfma_f32_16x16x32_bf16 v[28:31], v[176:179], a[236:239], v[28:31]
s_add_u32 m0, s82, 84992
s_add_u32 s80, s61, 24576
ds_read_b64_tr_b16 a[202:203], v18 offset:16896
v_mfma_f32_16x16x32_bf16 v[28:31], v[160:163], a[72:75], v[28:31]
v_mfma_f32_16x16x32_bf16 a[84:87], a[8:11], v[160:163], a[84:87]
ds_read_b64_tr_b16 a[212:213], v19 offset:16384
v_add_u32 v3, 65536, v1
v_mfma_f32_16x16x32_bf16 a[84:87], a[56:59], v[176:179], a[84:87]
v_mfma_f32_16x16x32_bf16 a[64:67], a[48:51], v[176:179], a[64:67]
ds_read_b128 v[32:35], v50 offset:18432
v_mfma_f32_16x16x32_bf16 a[64:67], a[132:135], v[160:163], a[64:67]
buffer_load_dwordx4 v81, s[8:11], s80 offen lds
v_mfma_f32_16x16x32_bf16 a[16:19], a[252:255], v[160:163], a[16:19]
s_add_u32 m0, s84, 98304
s_add_u32 s80, s89, 0
ds_read_b128 v[36:39], v51 offset:18432
v_mfma_f32_16x16x32_bf16 a[16:19], a[44:47], v[176:179], a[16:19]
ds_read_b64_tr_b16 a[214:215], v19 offset:16896
v_mfma_f32_16x16x32_bf16 a[0:3], a[40:43], v[176:179], a[0:3]
ds_read_b64_tr_b16 a[220:221], v16 offset:24576
v_mfma_f32_16x16x32_bf16 a[0:3], a[136:139], v[160:163], a[0:3]
s_waitcnt lgkmcnt(5)
ds_read_b64_tr_b16 a[222:223], v16 offset:25088
v_mfma_f32_16x16x32_bf16 a[60:63], a[136:139], v[100:103], a[60:63]
ds_read_b64_tr_b16 a[224:225], v17 offset:24576
v_mfma_f32_16x16x32_bf16 a[60:63], a[40:43], v[172:175], a[60:63]
buffer_load_dwordx4 v80, s[16:19], s80 offen lds
v_mfma_f32_16x16x32_bf16 a[96:99], a[44:47], v[172:175], a[96:99]
s_add_u32 m0, s84, 99328
s_add_u32 s80, s89, 8192
ds_read_b64_tr_b16 a[226:227], v17 offset:25088
v_mfma_f32_16x16x32_bf16 a[96:99], a[252:255], v[100:103], a[96:99]
v_mfma_f32_16x16x32_bf16 a[104:107], a[132:135], v[100:103], a[104:107]
ds_read_b64_tr_b16 a[228:229], v18 offset:24576
v_mfma_f32_16x16x32_bf16 a[104:107], a[48:51], v[172:175], a[104:107]
v_mfma_f32_16x16x32_bf16 a[108:111], a[56:59], v[172:175], a[108:111]
ds_read_b64_tr_b16 a[230:231], v18 offset:25088
v_mfma_f32_16x16x32_bf16 a[108:111], a[8:11], v[100:103], a[108:111]
buffer_load_dwordx4 v81, s[16:19], s80 offen lds
v_mfma_f32_16x16x32_bf16 v[132:135], v[100:103], a[72:75], v[132:135]
s_add_u32 m0, s84, 100352
buffer_store_dwordx4 v[180:183], v1, s[28:31], s81 offen offset:1024 sc1
ds_read_b64_tr_b16 a[232:233], v19 offset:24576
v_mfma_f32_16x16x32_bf16 v[132:135], v[172:175], a[236:239], v[132:135]
s_add_u32 s80, s89, 16384
s_add_u32 s81, s98, 755712
v_mfma_f32_16x16x32_bf16 v[136:139], v[172:175], a[240:243], v[136:139]
ds_read_b128 v[160:163], v50 offset:20480
v_mfma_f32_16x16x32_bf16 v[136:139], v[100:103], a[92:95], v[136:139]
ds_read_b128 v[164:167], v51 offset:20480
v_mfma_f32_16x16x32_bf16 v[140:143], v[100:103], a[32:35], v[140:143]
ds_read_b64_tr_b16 a[234:235], v19 offset:25088
v_mfma_f32_16x16x32_bf16 v[140:143], v[172:175], a[244:247], v[140:143]
buffer_load_dwordx4 v80, s[16:19], s80 offen lds
v_mfma_f32_16x16x32_bf16 v[96:99], v[172:175], a[248:251], v[96:99]
s_add_u32 m0, s84, 101376
s_add_u32 s80, s89, 24576
v_mfma_f32_16x16x32_bf16 v[96:99], v[100:103], a[36:39], v[96:99]
s_waitcnt lgkmcnt(4)
v_mfma_f32_16x16x32_bf16 v[24:27], v[32:35], a[36:39], v[24:27]
v_mfma_f32_16x16x32_bf16 v[24:27], v[36:39], a[248:251], v[24:27]
v_mfma_f32_16x16x32_bf16 v[40:43], v[36:39], a[244:247], v[40:43]
v_mfma_f32_16x16x32_bf16 v[40:43], v[32:35], a[32:35], v[40:43]
buffer_load_dwordx4 v81, s[16:19], s80 offen lds
v_mfma_f32_16x16x32_bf16 v[64:67], v[32:35], a[92:95], v[64:67]
s_add_u32 m0, s84, 102400
s_add_u32 s80, s90, 0
v_mfma_f32_16x16x32_bf16 v[64:67], v[36:39], a[240:243], v[64:67]
v_mfma_f32_16x16x32_bf16 v[20:23], v[36:39], a[236:239], v[20:23]
v_mfma_f32_16x16x32_bf16 v[20:23], v[32:35], a[72:75], v[20:23]
v_mfma_f32_16x16x32_bf16 a[172:175], a[8:11], v[32:35], a[172:175]
v_mfma_f32_16x16x32_bf16 a[172:175], a[56:59], v[36:39], a[172:175]
buffer_load_dwordx4 v80, s[16:19], s80 offen lds
v_mfma_f32_16x16x32_bf16 a[176:179], a[48:51], v[36:39], a[176:179]
s_add_u32 m0, s84, 103424
s_add_u32 s80, s90, 8192
ds_read_b128 v[16:19], v50 offset:22528
v_mfma_f32_16x16x32_bf16 a[176:179], a[132:135], v[32:35], a[176:179]
ds_read_b128 v[100:103], v51 offset:22528
v_mfma_f32_16x16x32_bf16 a[180:183], a[252:255], v[32:35], a[180:183]
v_mfma_f32_16x16x32_bf16 a[180:183], a[44:47], v[36:39], a[180:183]
v_mfma_f32_16x16x32_bf16 a[188:191], a[40:43], v[36:39], a[188:191]
v_mfma_f32_16x16x32_bf16 a[188:191], a[136:139], v[32:35], a[188:191]
s_waitcnt lgkmcnt(2)
buffer_load_dwordx4 v81, s[16:19], s80 offen lds
v_mfma_f32_16x16x32_bf16 a[196:199], a[136:139], v[160:163], a[196:199]
s_add_u32 m0, s84, 104448
buffer_store_dwordx4 v[184:187], v1, s[28:31], s81 offen sc1
v_mfma_f32_16x16x32_bf16 a[196:199], a[40:43], v[164:167], a[196:199]
s_add_u32 s80, s90, 16384
v_mfma_f32_16x16x32_bf16 a[204:207], a[44:47], v[164:167], a[204:207]
v_mfma_f32_16x16x32_bf16 a[204:207], a[252:255], v[160:163], a[204:207]
v_mfma_f32_16x16x32_bf16 a[208:211], a[132:135], v[160:163], a[208:211]
v_mfma_f32_16x16x32_bf16 a[208:211], a[48:51], v[164:167], a[208:211]
buffer_load_dwordx4 v80, s[16:19], s80 offen lds
v_mfma_f32_16x16x32_bf16 a[216:219], a[56:59], v[164:167], a[216:219]
s_add_u32 m0, s84, 105472
s_add_u32 s80, s90, 24576
v_mfma_f32_16x16x32_bf16 a[216:219], a[8:11], v[160:163], a[216:219]
s_waitcnt vmcnt(16)
v_mfma_f32_16x16x32_bf16 v[104:107], v[160:163], a[72:75], v[104:107]
s_barrier
v_mfma_f32_16x16x32_bf16 v[104:107], v[164:167], a[236:239], v[104:107]
v_mfma_f32_16x16x32_bf16 v[108:111], v[164:167], a[240:243], v[108:111]
ds_read_b128 v[32:35], v48 offset:0
v_mfma_f32_16x16x32_bf16 v[108:111], v[160:163], a[92:95], v[108:111]
buffer_load_dwordx4 v81, s[16:19], s80 offen lds
v_mfma_f32_16x16x32_bf16 v[144:147], v[160:163], a[32:35], v[144:147]
s_add_u32 m0, s83, 32768
s_add_u32 s80, s92, 0
ds_read_b128 v[36:39], v49 offset:0
v_mfma_f32_16x16x32_bf16 v[144:147], v[164:167], a[244:247], v[144:147]
v_mfma_f32_16x16x32_bf16 v[148:151], v[164:167], a[248:251], v[148:151]
v_mfma_f32_16x16x32_bf16 v[148:151], v[160:163], a[36:39], v[148:151]
s_waitcnt lgkmcnt(2)
v_mfma_f32_16x16x32_bf16 v[152:155], v[16:19], a[36:39], v[152:155]
v_mfma_f32_16x16x32_bf16 v[152:155], v[100:103], a[248:251], v[152:155]
buffer_load_dwordx4 v84, s[24:27], s80 offen lds
v_mfma_f32_16x16x32_bf16 v[52:55], v[100:103], a[244:247], v[52:55]
s_add_u32 m0, s83, 33792
s_add_u32 s80, s92, 28672
v_mfma_f32_16x16x32_bf16 v[52:55], v[16:19], a[32:35], v[52:55]
v_mfma_f32_16x16x32_bf16 v[68:71], v[16:19], a[92:95], v[68:71]
v_mfma_f32_16x16x32_bf16 v[68:71], v[100:103], a[240:243], v[68:71]
v_mfma_f32_16x16x32_bf16 v[156:159], v[100:103], a[236:239], v[156:159]
v_mfma_f32_16x16x32_bf16 v[156:159], v[16:19], a[72:75], v[156:159]
buffer_load_dwordx4 v85, s[24:27], s80 offen lds
v_mfma_f32_16x16x32_bf16 a[88:91], a[8:11], v[16:19], a[88:91]
s_add_u32 m0, s83, 40960
buffer_store_dwordx4 v[60:63], v1, s[28:31], s81 offen offset:1024 sc1
v_mfma_f32_16x16x32_bf16 a[88:91], a[56:59], v[100:103], a[88:91]
s_add_u32 s80, s91, 0
s_add_u32 s81, s98, 1133568
v_mfma_f32_16x16x32_bf16 a[52:55], a[48:51], v[100:103], a[52:55]
ds_read_b128 v[160:163], v48 offset:2048
v_mfma_f32_16x16x32_bf16 a[52:55], a[132:135], v[16:19], a[52:55]
ds_read_b128 v[164:167], v49 offset:2048
v_mfma_f32_16x16x32_bf16 a[24:27], a[252:255], v[16:19], a[24:27]
v_mfma_f32_16x16x32_bf16 a[24:27], a[44:47], v[100:103], a[24:27]
buffer_load_dwordx4 v82, s[20:23], s80 offen lds
v_mfma_f32_16x16x32_bf16 a[148:151], a[40:43], v[100:103], a[148:151]
s_add_u32 m0, s83, 41984
s_add_u32 s80, s91, 65536
v_mfma_f32_16x16x32_bf16 a[148:151], a[136:139], v[16:19], a[148:151]
s_waitcnt lgkmcnt(2)
v_mfma_f32_16x16x32_bf16 a[140:143], a[112:115], v[32:35], a[140:143]
v_mfma_f32_16x16x32_bf16 a[140:143], a[184:187], v[36:39], a[140:143]
v_mfma_f32_16x16x32_bf16 a[4:7], a[192:195], v[36:39], a[4:7]
v_mfma_f32_16x16x32_bf16 a[4:7], a[116:119], v[32:35], a[4:7]
buffer_load_dwordx4 v83, s[20:23], s80 offen lds
v_mfma_f32_16x16x32_bf16 a[20:23], a[100:103], v[32:35], a[20:23]
s_add_u32 m0, s83, 49152
s_add_u32 s80, s91, 128
v_mfma_f32_16x16x32_bf16 a[20:23], a[200:203], v[36:39], a[20:23]
v_mfma_f32_16x16x32_bf16 a[68:71], a[212:215], v[36:39], a[68:71]
v_mfma_f32_16x16x32_bf16 a[68:71], a[120:123], v[32:35], a[68:71]
v_mfma_f32_16x16x32_bf16 v[56:59], v[32:35], a[124:127], v[56:59]
v_mfma_f32_16x16x32_bf16 v[56:59], v[36:39], a[220:223], v[56:59]
buffer_load_dwordx4 v82, s[20:23], s80 offen lds
v_mfma_f32_16x16x32_bf16 v[44:47], v[36:39], a[224:227], v[44:47]
s_add_u32 m0, s83, 50176
s_add_u32 s80, s91, 65664
ds_read_b128 v[16:19], v48 offset:4096
v_mfma_f32_16x16x32_bf16 v[44:47], v[32:35], a[128:131], v[44:47]
ds_read_b128 v[60:63], v49 offset:4096
v_mfma_f32_16x16x32_bf16 v[244:247], v[32:35], a[164:167], v[244:247]
v_mfma_f32_16x16x32_bf16 v[244:247], v[36:39], a[228:231], v[244:247]
v_mfma_f32_16x16x32_bf16 v[116:119], v[36:39], a[232:235], v[116:119]
v_mfma_f32_16x16x32_bf16 v[116:119], v[32:35], a[168:171], v[116:119]
s_waitcnt lgkmcnt(2)
buffer_load_dwordx4 v83, s[20:23], s80 offen lds
v_mfma_f32_16x16x32_bf16 a[144:147], a[112:115], v[160:163], a[144:147]
s_add_u32 m0, s84, 131072
buffer_store_dwordx4 v[192:195], v1, s[28:31], s81 offen sc1
v_mfma_f32_16x16x32_bf16 a[144:147], a[184:187], v[164:167], a[144:147]
s_add_u32 s80, s89, 128
v_mfma_f32_16x16x32_bf16 a[156:159], a[192:195], v[164:167], a[156:159]
v_mfma_f32_16x16x32_bf16 a[156:159], a[116:119], v[160:163], a[156:159]
v_mfma_f32_16x16x32_bf16 a[28:31], a[100:103], v[160:163], a[28:31]
v_mfma_f32_16x16x32_bf16 a[28:31], a[200:203], v[164:167], a[28:31]
v_mfma_f32_16x16x32_bf16 a[76:79], a[212:215], v[164:167], a[76:79]
v_mfma_f32_16x16x32_bf16 a[76:79], a[120:123], v[160:163], a[76:79]
v_mfma_f32_16x16x32_bf16 v[72:75], v[160:163], a[124:127], v[72:75]
v_mfma_f32_16x16x32_bf16 v[72:75], v[164:167], a[220:223], v[72:75]
v_mfma_f32_16x16x32_bf16 v[76:79], v[164:167], a[224:227], v[76:79]
ds_read_b128 v[32:35], v48 offset:6144
v_mfma_f32_16x16x32_bf16 v[76:79], v[160:163], a[128:131], v[76:79]
ds_read_b128 v[36:39], v49 offset:6144
v_mfma_f32_16x16x32_bf16 v[248:251], v[160:163], a[164:167], v[248:251]
v_mfma_f32_16x16x32_bf16 v[248:251], v[164:167], a[228:231], v[248:251]
v_mfma_f32_16x16x32_bf16 v[120:123], v[164:167], a[232:235], v[120:123]
v_cvt_pk_bf16_f32 v56, v56, v57
v_cvt_pk_bf16_f32 v57, v58, v59
v_mfma_f32_16x16x32_bf16 v[120:123], v[160:163], a[168:171], v[120:123]
s_waitcnt lgkmcnt(2)
v_cvt_pk_bf16_f32 v58, v72, v73
v_cvt_pk_bf16_f32 v59, v74, v75
v_mfma_f32_16x16x32_bf16 a[152:155], a[112:115], v[16:19], a[152:155]
v_cvt_pk_bf16_f32 v44, v44, v45
v_cvt_pk_bf16_f32 v45, v46, v47
v_mfma_f32_16x16x32_bf16 a[152:155], a[184:187], v[60:63], a[152:155]
v_cvt_pk_bf16_f32 v46, v76, v77
v_cvt_pk_bf16_f32 v47, v78, v79
v_mfma_f32_16x16x32_bf16 a[12:15], a[192:195], v[60:63], a[12:15]
v_cvt_pk_bf16_f32 v244, v244, v245
v_cvt_pk_bf16_f32 v245, v246, v247
v_mfma_f32_16x16x32_bf16 a[12:15], a[116:119], v[16:19], a[12:15]
v_cvt_pk_bf16_f32 v246, v248, v249
v_cvt_pk_bf16_f32 v247, v250, v251
v_mfma_f32_16x16x32_bf16 a[160:163], a[100:103], v[16:19], a[160:163]
v_cvt_pk_bf16_f32 v116, v116, v117
v_cvt_pk_bf16_f32 v117, v118, v119
v_mfma_f32_16x16x32_bf16 a[160:163], a[200:203], v[60:63], a[160:163]
v_cvt_pk_bf16_f32 v118, v120, v121
v_cvt_pk_bf16_f32 v119, v122, v123
v_mfma_f32_16x16x32_bf16 a[80:83], a[212:215], v[60:63], a[80:83]
v_mfma_f32_16x16x32_bf16 a[80:83], a[120:123], v[16:19], a[80:83]
s_waitcnt vmcnt(18)
v_mfma_f32_16x16x32_bf16 v[232:235], v[16:19], a[124:127], v[232:235]
s_barrier
v_mfma_f32_16x16x32_bf16 v[232:235], v[60:63], a[220:223], v[232:235]
buffer_load_dwordx4 v80, s[16:19], s80 offen lds
v_mfma_f32_16x16x32_bf16 v[236:239], v[60:63], a[224:227], v[236:239]
s_add_u32 m0, s84, 132096
buffer_store_dwordx4 v[168:171], v1, s[28:31], s81 offen offset:1024 sc1
ds_read_b128 v[72:75], v48 offset:16384
v_mfma_f32_16x16x32_bf16 v[236:239], v[16:19], a[128:131], v[236:239]
s_add_u32 s80, s89, 8320
s_add_u32 s81, s93, 4096
ds_read_b128 v[76:79], v49 offset:16384
v_mfma_f32_16x16x32_bf16 v[252:255], v[16:19], a[164:167], v[252:255]
buffer_store_dwordx4 v[56:59], v1, s[28:31], s81 offen
v_mfma_f32_16x16x32_bf16 v[252:255], v[60:63], a[228:231], v[252:255]
v_mfma_f32_16x16x32_bf16 v[124:127], v[60:63], a[232:235], v[124:127]
v_mfma_f32_16x16x32_bf16 v[124:127], v[16:19], a[168:171], v[124:127]
s_waitcnt lgkmcnt(2)
buffer_load_dwordx4 v81, s[16:19], s80 offen lds
v_mfma_f32_16x16x32_bf16 a[0:3], a[112:115], v[32:35], a[0:3]
s_add_u32 m0, s84, 133120
v_and_b32 v14, 31, v0
v_lshlrev_b32 v14, 3, v14
v_mfma_f32_16x16x32_bf16 a[0:3], a[184:187], v[36:39], a[0:3]
s_add_u32 s80, s89, 16512
v_mfma_f32_16x16x32_bf16 a[16:19], a[192:195], v[36:39], a[16:19]
v_mfma_f32_16x16x32_bf16 a[16:19], a[116:119], v[32:35], a[16:19]
v_mfma_f32_16x16x32_bf16 a[64:67], a[100:103], v[32:35], a[64:67]
v_mfma_f32_16x16x32_bf16 a[64:67], a[200:203], v[36:39], a[64:67]
buffer_load_dwordx4 v80, s[16:19], s80 offen lds
v_mfma_f32_16x16x32_bf16 a[84:87], a[212:215], v[36:39], a[84:87]
s_add_u32 m0, s84, 134144
s_add_u32 s80, s89, 24704
v_mfma_f32_16x16x32_bf16 a[84:87], a[120:123], v[32:35], a[84:87]
v_mfma_f32_16x16x32_bf16 v[28:31], v[32:35], a[124:127], v[28:31]
v_mfma_f32_16x16x32_bf16 v[28:31], v[36:39], a[220:223], v[28:31]
v_mfma_f32_16x16x32_bf16 v[240:243], v[36:39], a[224:227], v[240:243]
ds_read_b128 v[16:19], v48 offset:18432
v_mfma_f32_16x16x32_bf16 v[240:243], v[32:35], a[128:131], v[240:243]
buffer_load_dwordx4 v81, s[16:19], s80 offen lds
v_mfma_f32_16x16x32_bf16 v[112:115], v[32:35], a[164:167], v[112:115]
s_add_u32 m0, s84, 135168
s_add_u32 s80, s90, 128
ds_read_b128 v[56:59], v49 offset:18432
v_mfma_f32_16x16x32_bf16 v[112:115], v[36:39], a[228:231], v[112:115]
v_mfma_f32_16x16x32_bf16 v[128:131], v[36:39], a[232:235], v[128:131]
v_cvt_pk_bf16_f32 v232, v232, v233
v_cvt_pk_bf16_f32 v233, v234, v235
v_mfma_f32_16x16x32_bf16 v[128:131], v[32:35], a[168:171], v[128:131]
s_waitcnt lgkmcnt(2)
v_cvt_pk_bf16_f32 v234, v28, v29
v_cvt_pk_bf16_f32 v235, v30, v31
v_mfma_f32_16x16x32_bf16 a[60:63], a[112:115], v[72:75], a[60:63]
v_cvt_pk_bf16_f32 v236, v236, v237
v_cvt_pk_bf16_f32 v237, v238, v239
v_mfma_f32_16x16x32_bf16 a[60:63], a[184:187], v[76:79], a[60:63]
buffer_load_dwordx4 v80, s[16:19], s80 offen lds
v_mfma_f32_16x16x32_bf16 a[96:99], a[192:195], v[76:79], a[96:99]
s_add_u32 m0, s84, 136192
buffer_store_dwordx4 v[44:47], v1, s[28:31], s81 offen offset:1024
v_cvt_pk_bf16_f32 v238, v240, v241
v_cvt_pk_bf16_f32 v239, v242, v243
v_cvt_pk_bf16_f32 v252, v252, v253
v_mfma_f32_16x16x32_bf16 a[96:99], a[116:119], v[72:75], a[96:99]
s_add_u32 s80, s90, 8320
v_cvt_pk_bf16_f32 v253, v254, v255
v_cvt_pk_bf16_f32 v254, v112, v113
v_mfma_f32_16x16x32_bf16 a[104:107], a[100:103], v[72:75], a[104:107]
v_cvt_pk_bf16_f32 v255, v114, v115
v_cvt_pk_bf16_f32 v124, v124, v125
v_mfma_f32_16x16x32_bf16 a[104:107], a[200:203], v[76:79], a[104:107]
v_cvt_pk_bf16_f32 v125, v126, v127
v_cvt_pk_bf16_f32 v126, v128, v129
v_mfma_f32_16x16x32_bf16 a[108:111], a[212:215], v[76:79], a[108:111]
v_cvt_pk_bf16_f32 v127, v130, v131
v_mfma_f32_16x16x32_bf16 a[108:111], a[120:123], v[72:75], a[108:111]
buffer_load_dwordx4 v81, s[16:19], s80 offen lds
v_mfma_f32_16x16x32_bf16 v[132:135], v[72:75], a[124:127], v[132:135]
s_add_u32 m0, s84, 137216
s_add_u32 s80, s90, 16512
v_mfma_f32_16x16x32_bf16 v[132:135], v[76:79], a[220:223], v[132:135]
v_mfma_f32_16x16x32_bf16 v[136:139], v[76:79], a[224:227], v[136:139]
ds_read_b128 v[32:35], v48 offset:20480
v_mfma_f32_16x16x32_bf16 v[136:139], v[72:75], a[128:131], v[136:139]
ds_read_b128 v[36:39], v49 offset:20480
v_mfma_f32_16x16x32_bf16 v[140:143], v[72:75], a[164:167], v[140:143]
v_mfma_f32_16x16x32_bf16 v[140:143], v[76:79], a[228:231], v[140:143]
buffer_load_dwordx4 v80, s[16:19], s80 offen lds
v_mfma_f32_16x16x32_bf16 v[96:99], v[76:79], a[232:235], v[96:99]
s_add_u32 m0, s84, 138240
s_add_u32 s80, s90, 24704
buffer_load_dword v8, v14, s[36:39], 0 offen sc1
v_mfma_f32_16x16x32_bf16 v[96:99], v[72:75], a[168:171], v[96:99]
s_waitcnt vmcnt(9) lgkmcnt(2)
buffer_store_dword v13, v2, s[28:31], s62 offen sc1
v_mfma_f32_16x16x32_bf16 a[188:191], a[112:115], v[16:19], a[188:191]
v_mfma_f32_16x16x32_bf16 a[188:191], a[184:187], v[56:59], a[188:191]
v_mfma_f32_16x16x32_bf16 a[180:183], a[192:195], v[56:59], a[180:183]
v_mfma_f32_16x16x32_bf16 a[180:183], a[116:119], v[16:19], a[180:183]
buffer_load_dwordx4 v81, s[16:19], s80 offen lds
v_mfma_f32_16x16x32_bf16 a[176:179], a[100:103], v[16:19], a[176:179]
s_add_u32 m0, s83, 57344
s_add_u32 s80, s92, 229376
v_mfma_f32_16x16x32_bf16 a[176:179], a[200:203], v[56:59], a[176:179]
v_mfma_f32_16x16x32_bf16 a[172:175], a[212:215], v[56:59], a[172:175]
buffer_store_dwordx4 v[244:247], v1, s[28:31], s81 offen offset:2048
v_mfma_f32_16x16x32_bf16 a[172:175], a[120:123], v[16:19], a[172:175]
v_mfma_f32_16x16x32_bf16 v[20:23], v[16:19], a[124:127], v[20:23]
v_mfma_f32_16x16x32_bf16 v[20:23], v[56:59], a[220:223], v[20:23]
buffer_load_dwordx4 v84, s[24:27], s80 offen lds
v_mfma_f32_16x16x32_bf16 v[64:67], v[56:59], a[224:227], v[64:67]
s_add_u32 m0, s83, 58368
ds_read_b128 v[72:75], v48 offset:22528
v_accvgpr_read_b32 v28, a140
v_mfma_f32_16x16x32_bf16 v[64:67], v[16:19], a[128:131], v[64:67]
s_add_u32 s80, s92, 258048
ds_read_b128 v[44:47], v49 offset:22528
v_accvgpr_read_b32 v29, a141
v_mfma_f32_16x16x32_bf16 v[40:43], v[16:19], a[164:167], v[40:43]
v_accvgpr_read_b32 v30, a142
v_accvgpr_read_b32 v31, a143
v_mfma_f32_16x16x32_bf16 v[40:43], v[56:59], a[228:231], v[40:43]
v_accvgpr_read_b32 v60, a4
v_accvgpr_read_b32 v61, a5
v_mfma_f32_16x16x32_bf16 v[24:27], v[56:59], a[232:235], v[24:27]
v_cvt_pk_bf16_f32 v132, v132, v133
v_cvt_pk_bf16_f32 v133, v134, v135
v_mfma_f32_16x16x32_bf16 v[24:27], v[16:19], a[168:171], v[24:27]
s_waitcnt lgkmcnt(2)
buffer_load_dwordx4 v85, s[24:27], s80 offen lds
v_mfma_f32_16x16x32_bf16 a[196:199], a[112:115], v[32:35], a[196:199]
s_add_u32 m0, s83, 0
v_cvt_pk_bf16_f32 v134, v20, v21
v_cvt_pk_bf16_f32 v135, v22, v23
v_mfma_f32_16x16x32_bf16 a[196:199], a[184:187], v[36:39], a[196:199]
s_add_u32 s80, s91, 524288
v_cvt_pk_bf16_f32 v136, v136, v137
v_cvt_pk_bf16_f32 v137, v138, v139
v_mfma_f32_16x16x32_bf16 a[204:207], a[192:195], v[36:39], a[204:207]
v_cvt_pk_bf16_f32 v138, v64, v65
v_cvt_pk_bf16_f32 v139, v66, v67
v_mfma_f32_16x16x32_bf16 a[204:207], a[116:119], v[32:35], a[204:207]
v_cvt_pk_bf16_f32 v140, v140, v141
v_cvt_pk_bf16_f32 v141, v142, v143
v_mfma_f32_16x16x32_bf16 a[208:211], a[100:103], v[32:35], a[208:211]
v_cvt_pk_bf16_f32 v142, v40, v41
v_cvt_pk_bf16_f32 v143, v42, v43
v_mfma_f32_16x16x32_bf16 a[208:211], a[200:203], v[36:39], a[208:211]
buffer_load_dwordx4 v82, s[20:23], s80 offen lds
v_mfma_f32_16x16x32_bf16 a[216:219], a[212:215], v[36:39], a[216:219]
s_add_u32 m0, s83, 1024
v_cvt_pk_bf16_f32 v96, v96, v97
v_cvt_pk_bf16_f32 v97, v98, v99
v_mfma_f32_16x16x32_bf16 a[216:219], a[120:123], v[32:35], a[216:219]
s_add_u32 s80, s91, 589824
v_cvt_pk_bf16_f32 v98, v24, v25
v_cvt_pk_bf16_f32 v99, v26, v27
v_mfma_f32_16x16x32_bf16 v[104:107], v[32:35], a[124:127], v[104:107]
ds_read_b128 a[136:139], v92 offset:32768
v_accvgpr_read_b32 v62, a6
v_mfma_f32_16x16x32_bf16 v[104:107], v[36:39], a[220:223], v[104:107]
ds_read_b128 a[252:255], v93 offset:32768
v_accvgpr_read_b32 v63, a7
v_mfma_f32_16x16x32_bf16 v[108:111], v[36:39], a[224:227], v[108:111]
ds_read_b128 a[132:135], v92 offset:34816
v_mul_f32 v28, s85, v28
v_mfma_f32_16x16x32_bf16 v[108:111], v[32:35], a[128:131], v[108:111]
buffer_load_dwordx4 v83, s[20:23], s80 offen lds
v_mfma_f32_16x16x32_bf16 v[144:147], v[32:35], a[164:167], v[144:147]
s_add_u32 m0, s83, 8192
buffer_store_dwordx4 v[116:119], v1, s[28:31], s81 offen offset:3072
ds_read_b128 a[140:143], v93 offset:34816
v_mul_f32 v29, s85, v29
v_mul_f32 v30, s85, v30
v_mfma_f32_16x16x32_bf16 v[144:147], v[36:39], a[228:231], v[144:147]
s_add_u32 s80, s91, 524416
ds_read_b128 a[4:7], v92 offset:36864
v_mul_f32 v31, s85, v31
v_mfma_f32_16x16x32_bf16 v[148:151], v[36:39], a[232:235], v[148:151]
s_barrier
v_mfma_f32_16x16x32_bf16 v[148:151], v[32:35], a[168:171], v[148:151]
s_waitcnt lgkmcnt(5)
ds_read_b64_tr_b16 a[8:9], v88 offset:32768
v_mul_f32 v60, s85, v60
v_mfma_f32_16x16x32_bf16 a[148:151], a[112:115], v[72:75], a[148:151]
ds_read_b64_tr_b16 a[10:11], v88 offset:33280
v_mul_f32 v61, s85, v61
v_mfma_f32_16x16x32_bf16 a[148:151], a[184:187], v[44:47], a[148:151]
buffer_load_dwordx4 v82, s[20:23], s80 offen lds
v_mfma_f32_16x16x32_bf16 a[24:27], a[192:195], v[44:47], a[24:27]
s_add_u32 m0, s83, 9216
ds_read_b64_tr_b16 a[72:73], v88 offset:36864
v_mul_f32 v62, s85, v62
v_mfma_f32_16x16x32_bf16 a[24:27], a[116:119], v[72:75], a[24:27]
s_add_u32 s80, s91, 589952
ds_read_b64_tr_b16 a[74:75], v88 offset:37376
v_mul_f32 v63, s85, v63
v_mfma_f32_16x16x32_bf16 a[52:55], a[100:103], v[72:75], a[52:55]
ds_read_b128 a[92:95], v93 offset:36864
v_cvt_pk_bf16_f32 v28, v28, v29
v_mfma_f32_16x16x32_bf16 a[52:55], a[200:203], v[44:47], a[52:55]
ds_read_b128 a[32:35], v92 offset:38912
v_cvt_pk_bf16_f32 v29, v30, v31
v_mfma_f32_16x16x32_bf16 a[88:91], a[212:215], v[44:47], a[88:91]
ds_read_b128 a[36:39], v93 offset:38912
v_cvt_pk_bf16_f32 v30, v60, v61
v_mfma_f32_16x16x32_bf16 a[88:91], a[120:123], v[72:75], a[88:91]
buffer_load_dwordx4 v83, s[20:23], s80 offen lds
v_mfma_f32_16x16x32_bf16 v[156:159], v[72:75], a[124:127], v[156:159]
L_pad4:
s_cbranch_execz L_pad8
s_add_u32 m0, s84, 65536
ds_read_b64_tr_b16 a[40:41], v89 offset:32768
v_cvt_pk_bf16_f32 v31, v62, v63
v_mfma_f32_16x16x32_bf16 v[156:159], v[44:47], a[220:223], v[156:159]
s_add_u32 s80, s89, 256
ds_read_b64_tr_b16 a[42:43], v89 offset:33280
v_accvgpr_read_b32 v16, a20
v_mfma_f32_16x16x32_bf16 v[68:71], v[44:47], a[224:227], v[68:71]
ds_read_b64_tr_b16 a[44:45], v89 offset:36864
v_accvgpr_read_b32 v17, a21
v_mfma_f32_16x16x32_bf16 v[68:71], v[72:75], a[128:131], v[68:71]
ds_read_b64_tr_b16 a[46:47], v89 offset:37376
v_accvgpr_read_b32 v18, a22
v_mfma_f32_16x16x32_bf16 v[52:55], v[72:75], a[164:167], v[52:55]
v_accvgpr_read_b32 v19, a23
v_accvgpr_read_b32 v32, a68
v_mfma_f32_16x16x32_bf16 v[52:55], v[44:47], a[228:231], v[52:55]
v_accvgpr_read_b32 v33, a69
v_accvgpr_read_b32 v34, a70
v_mfma_f32_16x16x32_bf16 v[152:155], v[44:47], a[232:235], v[152:155]
v_cvt_pk_bf16_f32 v104, v104, v105
v_cvt_pk_bf16_f32 v105, v106, v107
v_mfma_f32_16x16x32_bf16 v[152:155], v[72:75], a[168:171], v[152:155]
s_waitcnt lgkmcnt(4)
ds_read_b64_tr_b16 a[48:49], v90 offset:32768
v_cvt_pk_bf16_f32 v106, v156, v157
v_mfma_f32_16x16x32_bf16 a[20:23], a[8:11], a[136:139], 0
ds_read_b64_tr_b16 a[50:51], v90 offset:33280
v_cvt_pk_bf16_f32 v107, v158, v159
v_mfma_f32_16x16x32_bf16 a[20:23], a[72:75], a[252:255], a[20:23]
buffer_store_dwordx4 v[28:31], v1, s[28:31], s93 offen
ds_read_b64_tr_b16 a[56:57], v90 offset:36864
v_cvt_pk_bf16_f32 v108, v108, v109
v_cvt_pk_bf16_f32 v109, v110, v111
v_mfma_f32_16x16x32_bf16 a[100:103], a[72:75], a[140:143], 0
ds_read_b64_tr_b16 a[58:59], v90 offset:37376
v_cvt_pk_bf16_f32 v110, v68, v69
v_mfma_f32_16x16x32_bf16 a[100:103], a[8:11], a[132:135], a[100:103]
v_cvt_pk_bf16_f32 v111, v70, v71
v_cvt_pk_bf16_f32 v144, v144, v145
v_mfma_f32_16x16x32_bf16 a[112:115], a[8:11], a[4:7], 0
v_cvt_pk_bf16_f32 v145, v146, v147
v_cvt_pk_bf16_f32 v146, v52, v53
v_mfma_f32_16x16x32_bf16 a[112:115], a[72:75], a[92:95], a[112:115]
v_cvt_pk_bf16_f32 v147, v54, v55
v_cvt_pk_bf16_f32 v148, v148, v149
v_mfma_f32_16x16x32_bf16 a[116:119], a[72:75], a[36:39], 0
v_cvt_pk_bf16_f32 v149, v150, v151
v_cvt_pk_bf16_f32 v150, v152, v153
v_mfma_f32_16x16x32_bf16 a[116:119], a[8:11], a[32:35], a[116:119]
s_waitcnt lgkmcnt(4)
ds_read_b64_tr_b16 a[120:121], v91 offset:32768
v_cvt_pk_bf16_f32 v151, v154, v155
v_mfma_f32_16x16x32_bf16 a[124:127], a[40:43], a[136:139], 0
ds_read_b64_tr_b16 a[122:123], v91 offset:33280
v_accvgpr_read_b32 v35, a71
v_mfma_f32_16x16x32_bf16 a[124:127], a[44:47], a[252:255], a[124:127]
ds_read_b64_tr_b16 a[72:73], v91 offset:36864
v_mul_f32 v16, s85, v16
v_mfma_f32_16x16x32_bf16 a[128:131], a[44:47], a[140:143], 0
ds_read_b64_tr_b16 a[74:75], v91 offset:37376
v_mul_f32 v17, s85, v17
v_mfma_f32_16x16x32_bf16 a[128:131], a[40:43], a[132:135], a[128:131]
v_mul_f32 v18, s85, v18
v_mul_f32 v19, s85, v19
v_mfma_f32_16x16x32_bf16 a[8:11], a[40:43], a[4:7], 0
v_mul_f32 v32, s85, v32
v_mul_f32 v33, s85, v33
v_mfma_f32_16x16x32_bf16 a[8:11], a[44:47], a[92:95], a[8:11]
v_mul_f32 v34, s85, v34
v_mul_f32 v35, s85, v35
v_mfma_f32_16x16x32_bf16 a[68:71], a[44:47], a[36:39], 0
s_barrier
v_mfma_f32_16x16x32_bf16 a[68:71], a[40:43], a[32:35], a[68:71]
s_waitcnt lgkmcnt(4)
buffer_load_dwordx4 v80, s[16:19], s80 offen lds
v_mfma_f32_16x16x32_bf16 a[164:167], a[48:51], a[136:139], 0
s_add_u32 m0, s84, 66560
ds_read_b64_tr_b16 a[168:169], v88 offset:40960
v_cvt_pk_bf16_f32 v16, v16, v17
v_mfma_f32_16x16x32_bf16 a[164:167], a[56:59], a[252:255], a[164:167]
s_add_u32 s80, s89, 8448
ds_read_b64_tr_b16 a[170:171], v88 offset:41472
v_cvt_pk_bf16_f32 v17, v18, v19
v_mfma_f32_16x16x32_bf16 a[40:43], a[56:59], a[140:143], 0
ds_read_b64_tr_b16 a[44:45], v88 offset:45056
v_cvt_pk_bf16_f32 v18, v32, v33
v_mfma_f32_16x16x32_bf16 a[40:43], a[48:51], a[132:135], a[40:43]
ds_read_b64_tr_b16 a[46:47], v88 offset:45568
v_cvt_pk_bf16_f32 v19, v34, v35
v_mfma_f32_16x16x32_bf16 a[184:187], a[48:51], a[4:7], 0
v_accvgpr_read_b32 v20, a144
v_accvgpr_read_b32 v21, a145
v_mfma_f32_16x16x32_bf16 a[184:187], a[56:59], a[92:95], a[184:187]
buffer_load_dwordx4 v81, s[16:19], s80 offen lds
v_mfma_f32_16x16x32_bf16 a[192:195], a[56:59], a[36:39], 0
s_add_u32 m0, s84, 67584
buffer_store_dwordx4 v[16:19], v1, s[28:31], s93 offen offset:1024
v_accvgpr_read_b32 v22, a146
v_accvgpr_read_b32 v23, a147
v_accvgpr_read_b32 v36, a156
v_mfma_f32_16x16x32_bf16 a[192:195], a[48:51], a[32:35], a[192:195]
s_waitcnt lgkmcnt(4)
ds_read_b64_tr_b16 a[200:201], v89 offset:40960
v_accvgpr_read_b32 v37, a157
v_mfma_f32_16x16x32_bf16 a[212:215], a[120:123], a[136:139], 0
s_add_u32 s80, s89, 16640
ds_read_b64_tr_b16 a[202:203], v89 offset:41472
v_accvgpr_read_b32 v38, a158
v_mfma_f32_16x16x32_bf16 a[212:215], a[72:75], a[252:255], a[212:215]
ds_read_b64_tr_b16 a[144:145], v89 offset:45056
v_accvgpr_read_b32 v39, a159
v_mfma_f32_16x16x32_bf16 a[48:51], a[72:75], a[140:143], 0
ds_read_b64_tr_b16 a[146:147], v89 offset:45568
v_mul_f32 v20, s85, v20
v_mfma_f32_16x16x32_bf16 a[48:51], a[120:123], a[132:135], a[48:51]
buffer_load_dwordx4 v80, s[16:19], s80 offen lds
v_mfma_f32_16x16x32_bf16 a[56:59], a[120:123], a[4:7], 0
s_add_u32 m0, s84, 68608
v_mul_f32 v21, s85, v21
v_mul_f32 v22, s85, v22
v_mfma_f32_16x16x32_bf16 a[56:59], a[72:75], a[92:95], a[56:59]
s_add_u32 s80, s89, 24832
v_mul_f32 v23, s85, v23
v_mul_f32 v36, s85, v36
v_mfma_f32_16x16x32_bf16 a[220:223], a[72:75], a[36:39], 0
v_mul_f32 v37, s85, v37
v_mul_f32 v38, s85, v38
v_mfma_f32_16x16x32_bf16 a[220:223], a[120:123], a[32:35], a[220:223]
s_waitcnt lgkmcnt(4)
ds_read_b64_tr_b16 a[156:157], v90 offset:40960
v_mul_f32 v39, s85, v39
v_mfma_f32_16x16x32_bf16 v[16:19], a[168:171], a[136:139], 0
ds_read_b64_tr_b16 a[158:159], v90 offset:41472
v_cvt_pk_bf16_f32 v20, v20, v21
v_mfma_f32_16x16x32_bf16 v[16:19], a[44:47], a[252:255], v[16:19]
buffer_load_dwordx4 v81, s[16:19], s80 offen lds
v_mfma_f32_16x16x32_bf16 v[32:35], a[44:47], a[140:143], 0
s_add_u32 m0, s84, 69632
ds_read_b64_tr_b16 a[72:73], v90 offset:45056
v_cvt_pk_bf16_f32 v21, v22, v23
v_mfma_f32_16x16x32_bf16 v[32:35], a[168:171], a[132:135], v[32:35]
s_add_u32 s80, s90, 256
ds_read_b64_tr_b16 a[74:75], v90 offset:45568
v_cvt_pk_bf16_f32 v22, v36, v37
v_mfma_f32_16x16x32_bf16 v[48:51], a[168:171], a[4:7], 0
v_cvt_pk_bf16_f32 v23, v38, v39
v_accvgpr_read_b32 v72, a28
v_mfma_f32_16x16x32_bf16 v[48:51], a[44:47], a[92:95], v[48:51]
v_accvgpr_read_b32 v73, a29
v_accvgpr_read_b32 v74, a30
v_mfma_f32_16x16x32_bf16 v[64:67], a[44:47], a[36:39], 0
v_accvgpr_read_b32 v75, a31
v_accvgpr_read_b32 v24, a76
v_mfma_f32_16x16x32_bf16 v[64:67], a[168:171], a[32:35], v[64:67]
s_waitcnt lgkmcnt(4)
buffer_load_dwordx4 v80, s[16:19], s80 offen lds
v_mfma_f32_16x16x32_bf16 v[100:103], a[200:203], a[136:139], 0
s_add_u32 m0, s84, 70656
ds_read_b64_tr_b16 a[120:121], v91 offset:40960
v_accvgpr_read_b32 v25, a77
v_mfma_f32_16x16x32_bf16 v[100:103], a[144:147], a[252:255], v[100:103]
s_add_u32 s80, s90, 8448
ds_read_b64_tr_b16 a[122:123], v91 offset:41472
v_accvgpr_read_b32 v26, a78
v_mfma_f32_16x16x32_bf16 v[152:155], a[144:147], a[140:143], 0
ds_read_b64_tr_b16 a[28:29], v91 offset:45056
v_accvgpr_read_b32 v27, a79
v_mfma_f32_16x16x32_bf16 v[152:155], a[200:203], a[132:135], v[152:155]
buffer_store_dwordx4 v[20:23], v1, s[28:31], s93 offen offset:2048
ds_read_b64_tr_b16 a[30:31], v91 offset:45568
v_mul_f32 v72, s85, v72
v_mul_f32 v73, s85, v73
v_mfma_f32_16x16x32_bf16 v[156:159], a[200:203], a[4:7], 0
s_waitcnt vmcnt(25)
ds_read_b128 a[44:47], v94 offset:0
v_mul_f32 v74, s85, v74
v_mfma_f32_16x16x32_bf16 v[156:159], a[144:147], a[92:95], v[156:159]
buffer_load_dwordx4 v81, s[16:19], s80 offen lds
v_mfma_f32_16x16x32_bf16 v[160:163], a[144:147], a[36:39], 0
s_add_u32 m0, s84, 71680
ds_read_b128 a[76:79], v95 offset:0
v_mul_f32 v75, s85, v75
v_mfma_f32_16x16x32_bf16 v[160:163], a[200:203], a[32:35], v[160:163]
s_waitcnt lgkmcnt(6)
ds_read_b64_tr_b16 a[168:169], v88 offset:49152
v_mul_f32 v24, s85, v24
v_mfma_f32_16x16x32_bf16 v[20:23], a[156:159], a[136:139], 0
s_add_u32 s80, s90, 16640
ds_read_b64_tr_b16 a[170:171], v88 offset:49664
v_mul_f32 v25, s85, v25
v_mfma_f32_16x16x32_bf16 v[20:23], a[72:75], a[252:255], v[20:23]
ds_read_b64_tr_b16 a[144:145], v88 offset:53248
v_mul_f32 v26, s85, v26
v_mfma_f32_16x16x32_bf16 v[36:39], a[72:75], a[140:143], 0
s_waitcnt vmcnt(19)
v_and_b32 v4, 0xff, v8
v_cmp_ne_u32 vcc, 0xff, v4
s_nop 0
s_cbranch_vccnz L_spin1
L_back1:
v_readlane_b32 s101, v8, s4
v_mfma_f32_16x16x32_bf16 v[36:39], a[156:159], a[132:135], v[36:39]
buffer_load_dwordx4 v80, s[16:19], s80 offen lds
v_mfma_f32_16x16x32_bf16 v[52:55], a[156:159], a[4:7], 0
s_add_u32 m0, s84, 72704
s_andn2_b32 s101, s101, 0xff
s_xor_b32 s65, s65, s101
v_mfma_f32_16x16x32_bf16 v[52:55], a[72:75], a[92:95], v[52:55]
s_add_u32 s80, s90, 24832
ds_read_b64_tr_b16 a[146:147], v88 offset:53760
v_mul_f32 v27, s85, v27
v_mfma_f32_16x16x32_bf16 v[68:71], a[72:75], a[36:39], 0
s_mul_i32 s101, s70, 14
ds_read_b128 a[200:203], v94 offset:2048
v_cvt_pk_bf16_f32 v72, v72, v73
v_mfma_f32_16x16x32_bf16 v[68:71], a[156:159], a[32:35], v[68:71]
s_waitcnt lgkmcnt(5)
ds_read_b64_tr_b16 a[224:225], v89 offset:49152
v_cvt_pk_bf16_f32 v73, v74, v75
v_mfma_f32_16x16x32_bf16 v[164:167], a[120:123], a[136:139], 0
s_add_u32 s101, s101, 6272
ds_read_b64_tr_b16 a[226:227], v89 offset:49664
v_cvt_pk_bf16_f32 v74, v24, v25
v_mfma_f32_16x16x32_bf16 v[164:167], a[28:31], a[252:255], v[164:167]
buffer_load_dwordx4 v81, s[16:19], s80 offen lds
v_mfma_f32_16x16x32_bf16 v[168:171], a[28:31], a[140:143], 0
s_add_u32 m0, s83, 16384
ds_read_b64_tr_b16 a[156:157], v89 offset:53248
v_cvt_pk_bf16_f32 v75, v26, v27
v_mfma_f32_16x16x32_bf16 v[168:171], a[120:123], a[132:135], v[168:171]
s_add_u32 s80, s92, 458752
ds_read_b64_tr_b16 a[158:159], v89 offset:53760
v_and_b32 v4, 31, v0
v_mfma_f32_16x16x32_bf16 v[172:175], a[120:123], a[4:7], 0
ds_read_b128 a[72:75], v95 offset:2048
v_min_u32 v6, 13, v4
v_mfma_f32_16x16x32_bf16 v[172:175], a[28:31], a[92:95], v[172:175]
ds_read_b128 a[228:231], v94 offset:4096
v_add_u32 v6, s101, v6
v_mfma_f32_16x16x32_bf16 v[176:179], a[28:31], a[36:39], 0
ds_read_b128 a[232:235], v95 offset:4096
v_lshl_add_u32 v6, s71, 8, v6
v_mfma_f32_16x16x32_bf16 v[176:179], a[120:123], a[32:35], v[176:179]
s_waitcnt lgkmcnt(7)
buffer_load_dwordx4 v84, s[24:27], s80 offen lds
v_mfma_f32_16x16x32_bf16 v[24:27], a[168:171], a[136:139], 0
s_add_u32 m0, s83, 17408
ds_read_b64_tr_b16 a[236:237], v90 offset:49152
v_lshl_add_u32 v4, s4, 5, v4
v_mfma_f32_16x16x32_bf16 v[24:27], a[144:147], a[252:255], v[24:27]
s_add_u32 s80, s92, 487424
buffer_store_dwordx4 v[72:75], v1, s[28:31], s93 offen offset:3072
ds_read_b64_tr_b16 a[238:239], v90 offset:49664
v_mfma_f32_16x16x32_bf16 v[40:43], a[144:147], a[140:143], 0
s_add_u32 s81, s94, 4096
ds_read_b64_tr_b16 a[28:29], v90 offset:53248
v_mfma_f32_16x16x32_bf16 v[40:43], a[168:171], a[132:135], v[40:43]
s_cmp_lg_u32 s65, 0
s_cbranch_scc1 L_wb1
L_wb1b:
ds_read_b64_tr_b16 a[30:31], v90 offset:53760
v_mfma_f32_16x16x32_bf16 v[56:59], a[168:171], a[4:7], 0
s_mov_b32 s72, 0
s_mov_b32 s73, -1
v_cndmask_b32 v4, v4, v6, s[72:73]
v_mfma_f32_16x16x32_bf16 v[56:59], a[144:147], a[92:95], v[56:59]
buffer_load_dwordx4 v85, s[24:27], s80 offen lds
v_mfma_f32_16x16x32_bf16 v[72:75], a[144:147], a[36:39], 0
s_waitcnt vmcnt(22)
s_add_u32 m0, s83, 24576
ds_read_b128 a[120:123], v94 offset:6144
v_mfma_f32_16x16x32_bf16 v[72:75], a[168:171], a[32:35], v[72:75]
s_waitcnt lgkmcnt(5)
ds_read_b64_tr_b16 a[240:241], v91 offset:49152
v_lshlrev_b32 v14, 2, v4
v_mfma_f32_16x16x32_bf16 v[180:183], a[224:227], a[136:139], 0
s_add_u32 s80, s91, 1048576
s_mov_b32 s101, 79691776
ds_read_b64_tr_b16 a[242:243], v91 offset:49664
v_mfma_f32_16x16x32_bf16 v[180:183], a[156:159], a[252:255], v[180:183]
ds_read_b64_tr_b16 a[144:145], v91 offset:53248
v_mfma_f32_16x16x32_bf16 v[184:187], a[156:159], a[140:143], 0
ds_read_b64_tr_b16 a[146:147], v91 offset:53760
v_mfma_f32_16x16x32_bf16 v[184:187], a[224:227], a[132:135], v[184:187]
buffer_load_dwordx4 v82, s[20:23], s80 offen lds
v_mfma_f32_16x16x32_bf16 v[188:191], a[224:227], a[4:7], 0
s_add_u32 m0, s83, 25600
s_add_u32 s80, s91, 1114112
ds_read_b128 a[168:171], v95 offset:6144
v_mfma_f32_16x16x32_bf16 v[188:191], a[156:159], a[92:95], v[188:191]
s_waitcnt vmcnt(15)
v_mfma_f32_16x16x32_bf16 v[192:195], a[156:159], a[36:39], 0
s_barrier
v_mfma_f32_16x16x32_bf16 v[192:195], a[224:227], a[32:35], v[192:195]
s_waitcnt lgkmcnt(5)
ds_read_b64_tr_b16 a[244:245], v88 offset:57344
v_mfma_f32_16x16x32_bf16 v[28:31], a[236:239], a[136:139], 0
ds_read_b64_tr_b16 a[246:247], v88 offset:57856
v_mfma_f32_16x16x32_bf16 v[28:31], a[28:31], a[252:255], v[28:31]
buffer_load_dwordx4 v83, s[20:23], s80 offen lds
v_mfma_f32_16x16x32_bf16 v[44:47], a[28:31], a[140:143], 0
s_add_u32 m0, s83, 32768
s_add_u32 s80, s91, 1048704
ds_read_b64_tr_b16 a[156:157], v88 offset:61440
v_mfma_f32_16x16x32_bf16 v[44:47], a[236:239], a[132:135], v[44:47]
ds_read_b64_tr_b16 a[158:159], v88 offset:61952
v_mfma_f32_16x16x32_bf16 v[60:63], a[236:239], a[4:7], 0
v_mfma_f32_16x16x32_bf16 v[60:63], a[28:31], a[92:95], v[60:63]
v_mfma_f32_16x16x32_bf16 v[76:79], a[28:31], a[36:39], 0
buffer_store_dwordx4 v[232:235], v1, s[28:31], s81 offen
v_mfma_f32_16x16x32_bf16 v[76:79], a[236:239], a[32:35], v[76:79]
s_waitcnt lgkmcnt(4)
ds_read_b64_tr_b16 a[224:225], v89 offset:57344
v_mfma_f32_16x16x32_bf16 v[196:199], a[240:243], a[136:139], 0
buffer_load_dwordx4 v82, s[20:23], s80 offen lds
v_mfma_f32_16x16x32_bf16 v[196:199], a[144:147], a[252:255], v[196:199]
s_add_u32 m0, s83, 33792
s_add_u32 s80, s91, 1114240
ds_read_b64_tr_b16 a[226:227], v89 offset:57856
v_mfma_f32_16x16x32_bf16 v[200:203], a[144:147], a[140:143], 0
ds_read_b64_tr_b16 a[28:29], v89 offset:61440
v_mfma_f32_16x16x32_bf16 v[200:203], a[240:243], a[132:135], v[200:203]
ds_read_b64_tr_b16 a[30:31], v89 offset:61952
v_mfma_f32_16x16x32_bf16 v[204:207], a[240:243], a[4:7], 0
v_mfma_f32_16x16x32_bf16 v[204:207], a[144:147], a[92:95], v[204:207]
v_mfma_f32_16x16x32_bf16 v[208:211], a[144:147], a[36:39], 0
buffer_load_dwordx4 v83, s[20:23], s80 offen lds
v_mfma_f32_16x16x32_bf16 v[208:211], a[240:243], a[32:35], v[208:211]
s_waitcnt lgkmcnt(4)
s_add_u32 m0, s84, 98304
ds_read_b64_tr_b16 a[136:137], v90 offset:57344
v_mfma_f32_16x16x32_bf16 a[20:23], a[244:247], a[44:47], a[20:23]
s_add_u32 s80, s89, 384
ds_read_b64_tr_b16 a[138:139], v90 offset:57856
v_mfma_f32_16x16x32_bf16 a[20:23], a[156:159], a[76:79], a[20:23]
ds_read_b64_tr_b16 a[252:253], v90 offset:61440
v_mfma_f32_16x16x32_bf16 a[100:103], a[156:159], a[72:75], a[100:103]
ds_read_b64_tr_b16 a[254:255], v90 offset:61952
v_mfma_f32_16x16x32_bf16 a[100:103], a[244:247], a[200:203], a[100:103]
v_mfma_f32_16x16x32_bf16 a[112:115], a[244:247], a[228:231], a[112:115]
s_mul_i32 s97, s71, 1512448
buffer_load_dwordx4 v80, s[16:19], s80 offen lds
v_mfma_f32_16x16x32_bf16 a[112:115], a[156:159], a[232:235], a[112:115]
s_add_u32 m0, s84, 99328
s_add_u32 s80, s89, 8576
s_mul_i32 s98, s3, 377856
v_mfma_f32_16x16x32_bf16 a[116:119], a[156:159], a[168:171], a[116:119]
s_add_u32 s97, s97, s98
s_mul_i32 s98, s70, 28672
s_add_u32 s97, s97, s98
v_mfma_f32_16x16x32_bf16 a[116:119], a[244:247], a[120:123], a[116:119]
s_waitcnt vmcnt(7) lgkmcnt(4)
buffer_store_dword v13, v2, s[28:31], s99 offen sc1
v_mfma_f32_16x16x32_bf16 a[124:127], a[224:227], a[44:47], a[124:127]
s_add_u32 s99, s99, 4096
s_add_u32 s97, s97, 63176704
ds_read_b64_tr_b16 a[132:133], v91 offset:57344
v_mfma_f32_16x16x32_bf16 a[124:127], a[28:31], a[76:79], a[124:127]
s_add_u32 s98, s97, 0
s_mov_b32 s8, 0x000f0000
ds_read_b64_tr_b16 a[134:135], v91 offset:57856
v_mfma_f32_16x16x32_bf16 a[128:131], a[28:31], a[72:75], a[128:131]
s_mov_b32 s9, 0x0fff00ff
buffer_load_dwordx4 v81, s[16:19], s80 offen lds
v_mfma_f32_16x16x32_bf16 a[128:131], a[224:227], a[200:203], a[128:131]
s_add_u32 m0, s84, 100352
buffer_store_dwordx4 v[236:239], v1, s[28:31], s81 offen offset:1024
ds_read_b64_tr_b16 a[140:141], v91 offset:61440
v_mfma_f32_16x16x32_bf16 a[8:11], a[224:227], a[228:231], a[8:11]
s_add_u32 s80, s89, 16768
s_mov_b32 s10, 0x001f0001
ds_read_b64_tr_b16 a[142:143], v91 offset:61952
v_mfma_f32_16x16x32_bf16 a[8:11], a[28:31], a[232:235], a[8:11]
s_mov_b32 s11, 0x1fff01ff
s_mov_b32 s12, 0x003f0003
s_mov_b32 s13, 0x3fff03ff
v_mfma_f32_16x16x32_bf16 a[68:71], a[28:31], a[168:171], a[68:71]
s_mov_b32 s14, 0x007f0007
s_mov_b32 s15, 0x7fff07ff
v_mfma_f32_16x16x32_bf16 a[68:71], a[224:227], a[120:123], a[68:71]
s_waitcnt lgkmcnt(4)
ds_read_b64_tr_b16 a[144:145], v88 offset:0
v_mfma_f32_16x16x32_bf16 a[164:167], a[136:139], a[44:47], a[164:167]
s_cmp_eq_u32 s5, 7
s_cselect_b32 s44, 63, 33
ds_read_b64_tr_b16 a[146:147], v88 offset:512
v_mfma_f32_16x16x32_bf16 a[164:167], a[252:255], a[76:79], a[164:167]
s_lshl2_add_u32 s6, s69, s70
buffer_load_dwordx4 v80, s[16:19], s80 offen lds
v_mfma_f32_16x16x32_bf16 a[40:43], a[252:255], a[72:75], a[40:43]
s_add_u32 m0, s84, 101376
s_add_u32 s80, s89, 24960
ds_read_b64_tr_b16 a[4:5], v88 offset:4096
v_mfma_f32_16x16x32_bf16 a[40:43], a[136:139], a[200:203], a[40:43]
s_mul_i32 s86, s6, 275456
s_add_u32 s86, s86, s83
ds_read_b64_tr_b16 a[6:7], v88 offset:4608
v_mfma_f32_16x16x32_bf16 a[184:187], a[136:139], a[228:231], a[184:187]
s_add_u32 s86, s86, 36700160
s_lshr_b32 s7, s2, 5
s_add_u32 s7, s7, s71
v_mfma_f32_16x16x32_bf16 a[184:187], a[252:255], a[232:235], a[184:187]
s_mul_i32 s6, s70, 36864
s_add_u32 s87, s97, s6
s_sub_u32 s87, s87, 262144
v_mfma_f32_16x16x32_bf16 a[192:195], a[252:255], a[168:171], a[192:195]
s_mov_b32 s32, s87
s_mov_b32 s45, s86
s_add_u32 s6, s87, 4096
v_mfma_f32_16x16x32_bf16 a[192:195], a[136:139], a[120:123], a[192:195]
s_waitcnt lgkmcnt(4)
buffer_load_dwordx4 v81, s[16:19], s80 offen lds
v_mfma_f32_16x16x32_bf16 a[212:215], a[132:135], a[44:47], a[212:215]
s_add_u32 m0, s84, 102400
s_add_u32 s80, s90, 384
ds_read_b64_tr_b16 a[156:157], v89 offset:0
v_mfma_f32_16x16x32_bf16 a[212:215], a[140:143], a[76:79], a[212:215]
s_add_u32 s34, s28, s6
s_addc_u32 s35, s29, 0
ds_read_b64_tr_b16 a[158:159], v89 offset:512
v_mfma_f32_16x16x32_bf16 a[48:51], a[140:143], a[72:75], a[48:51]
s_add_u32 s6, s87, 12288
ds_read_b64_tr_b16 a[136:137], v89 offset:4096
v_mfma_f32_16x16x32_bf16 a[48:51], a[132:135], a[200:203], a[48:51]
s_add_u32 s46, s28, s6
s_addc_u32 s47, s29, 0
ds_read_b64_tr_b16 a[138:139], v89 offset:4608
v_mfma_f32_16x16x32_bf16 a[56:59], a[132:135], a[228:231], a[56:59]
s_lshl2_add_u32 s6, s69, s71
s_lshl2_add_u32 s6, s6, s70
s_mul_i32 s88, s6, 27648
v_mfma_f32_16x16x32_bf16 a[56:59], a[140:143], a[232:235], a[56:59]
s_add_u32 s88, s88, s83
buffer_load_dwordx4 v80, s[16:19], s80 offen lds
v_mfma_f32_16x16x32_bf16 a[220:223], a[140:143], a[168:171], a[220:223]
s_add_u32 m0, s84, 103424
s_add_u32 s80, s90, 8576
s_add_u32 s88, s88, 70254592
v_mfma_f32_16x16x32_bf16 a[220:223], a[132:135], a[120:123], a[220:223]
s_waitcnt lgkmcnt(4)
s_lshl3_add_u32 s6, s6, s3
ds_read_b64_tr_b16 a[252:253], v90 offset:0
v_mfma_f32_16x16x32_bf16 v[16:19], a[144:147], a[44:47], v[16:19]
s_lshl4_add_u32 s87, s6, 79740928
buffer_store_dwordx4 v[252:255], v1, s[28:31], s81 offen offset:2048
ds_read_b64_tr_b16 a[254:255], v90 offset:512
v_mfma_f32_16x16x32_bf16 v[16:19], a[4:7], a[76:79], v[16:19]
ds_read_b64_tr_b16 a[140:141], v90 offset:4096
v_mfma_f32_16x16x32_bf16 v[32:35], a[4:7], a[72:75], v[32:35]
ds_read_b64_tr_b16 a[142:143], v90 offset:4608
v_mfma_f32_16x16x32_bf16 v[32:35], a[144:147], a[200:203], v[32:35]
buffer_load_dwordx4 v81, s[16:19], s80 offen lds
v_mfma_f32_16x16x32_bf16 v[48:51], a[144:147], a[228:231], v[48:51]
s_add_u32 m0, s84, 104448
v_accvgpr_read_b32 v232, a152
v_accvgpr_read_b32 v233, a153
v_mfma_f32_16x16x32_bf16 v[48:51], a[4:7], a[232:235], v[48:51]
s_add_u32 s80, s90, 16768
v_accvgpr_read_b32 v234, a154
v_accvgpr_read_b32 v235, a155
v_mfma_f32_16x16x32_bf16 v[64:67], a[4:7], a[168:171], v[64:67]
v_accvgpr_read_b32 v236, a12
v_accvgpr_read_b32 v237, a13
v_mfma_f32_16x16x32_bf16 v[64:67], a[144:147], a[120:123], v[64:67]
s_waitcnt lgkmcnt(4)
ds_read_b64_tr_b16 a[132:133], v91 offset:0
v_accvgpr_read_b32 v238, a14
v_mfma_f32_16x16x32_bf16 v[100:103], a[156:159], a[44:47], v[100:103]
ds_read_b64_tr_b16 a[134:135], v91 offset:512
v_accvgpr_read_b32 v239, a15
v_mfma_f32_16x16x32_bf16 v[100:103], a[136:139], a[76:79], v[100:103]
buffer_load_dwordx4 v80, s[16:19], s80 offen lds
v_mfma_f32_16x16x32_bf16 v[152:155], a[136:139], a[72:75], v[152:155]
s_add_u32 m0, s84, 105472
ds_read_b64_tr_b16 a[144:145], v91 offset:4096
v_mul_f32 v232, s85, v232
v_mfma_f32_16x16x32_bf16 v[152:155], a[156:159], a[200:203], v[152:155]
s_add_u32 s80, s90, 24960
ds_read_b64_tr_b16 a[146:147], v91 offset:4608
v_mul_f32 v233, s85, v233
v_mfma_f32_16x16x32_bf16 v[156:159], a[156:159], a[228:231], v[156:159]
ds_read_b128 a[152:155], v92 offset:0
v_mul_f32 v234, s85, v234
v_mfma_f32_16x16x32_bf16 v[156:159], a[136:139], a[232:235], v[156:159]
ds_read_b128 a[4:7], v93 offset:0
v_mul_f32 v235, s85, v235
v_mfma_f32_16x16x32_bf16 v[160:163], a[136:139], a[168:171], v[160:163]
v_mul_f32 v236, s85, v236
v_mul_f32 v237, s85, v237
v_mfma_f32_16x16x32_bf16 v[160:163], a[156:159], a[120:123], v[160:163]
s_waitcnt lgkmcnt(6)
buffer_load_dwordx4 v81, s[16:19], s80 offen lds
v_mfma_f32_16x16x32_bf16 v[20:23], a[252:255], a[44:47], v[20:23]
s_add_u32 m0, s83, 40960
ds_read_b64_tr_b16 a[12:13], v88 offset:8192
v_mul_f32 v238, s85, v238
v_mfma_f32_16x16x32_bf16 v[20:23], a[140:143], a[76:79], v[20:23]
s_add_u32 s80, s92, 688128
ds_read_b64_tr_b16 a[14:15], v88 offset:8704
v_mul_f32 v239, s85, v239
v_mfma_f32_16x16x32_bf16 v[36:39], a[140:143], a[72:75], v[36:39]
ds_read_b64_tr_b16 a[136:137], v88 offset:12288
v_cvt_pk_bf16_f32 v232, v232, v233
v_mfma_f32_16x16x32_bf16 v[36:39], a[252:255], a[200:203], v[36:39]
ds_read_b64_tr_b16 a[138:139], v88 offset:12800
v_cvt_pk_bf16_f32 v233, v234, v235
v_mfma_f32_16x16x32_bf16 v[52:55], a[252:255], a[228:231], v[52:55]
ds_read_b128 a[156:159], v92 offset:2048
v_cvt_pk_bf16_f32 v234, v236, v237
v_mfma_f32_16x16x32_bf16 v[52:55], a[140:143], a[232:235], v[52:55]
buffer_load_dwordx4 v84, s[24:27], s80 offen lds
v_mfma_f32_16x16x32_bf16 v[68:71], a[140:143], a[168:171], v[68:71]
s_add_u32 m0, s83, 41984
buffer_store_dwordx4 v[124:127], v1, s[28:31], s81 offen offset:3072
ds_read_b128 a[28:31], v93 offset:2048
v_cvt_pk_bf16_f32 v235, v238, v239
v_mfma_f32_16x16x32_bf16 v[68:71], a[252:255], a[120:123], v[68:71]
s_waitcnt lgkmcnt(6)
s_add_u32 s80, s92, 716800
ds_read_b64_tr_b16 a[92:93], v89 offset:8192
v_mfma_f32_16x16x32_bf16 v[164:167], a[132:135], a[44:47], v[164:167]
ds_read_b64_tr_b16 a[94:95], v89 offset:8704
v_accvgpr_read_b32 v240, a160
v_mfma_f32_16x16x32_bf16 v[164:167], a[144:147], a[76:79], v[164:167]
ds_read_b64_tr_b16 a[140:141], v89 offset:12288
v_accvgpr_read_b32 v241, a161
v_mfma_f32_16x16x32_bf16 v[168:171], a[144:147], a[72:75], v[168:171]
ds_read_b64_tr_b16 a[142:143], v89 offset:12800
v_accvgpr_read_b32 v242, a162
v_mfma_f32_16x16x32_bf16 v[168:171], a[132:135], a[200:203], v[168:171]
buffer_load_dwordx4 v85, s[24:27], s80 offen lds
v_mfma_f32_16x16x32_bf16 v[172:175], a[132:135], a[228:231], v[172:175]
s_add_u32 m0, s83, 49152
ds_read_b128 a[252:255], v92 offset:4096
v_accvgpr_read_b32 v243, a163
v_mfma_f32_16x16x32_bf16 v[172:175], a[144:147], a[232:235], v[172:175]
s_add_u32 s80, s91, 1572864
ds_read_b128 a[32:35], v93 offset:4096
v_accvgpr_read_b32 v236, a80
v_mfma_f32_16x16x32_bf16 v[176:179], a[144:147], a[168:171], v[176:179]
v_accvgpr_read_b32 v237, a81
v_accvgpr_read_b32 v238, a82
v_mfma_f32_16x16x32_bf16 v[176:179], a[132:135], a[120:123], v[176:179]
s_waitcnt lgkmcnt(6)
ds_read_b64_tr_b16 a[36:37], v90 offset:8192
v_accvgpr_read_b32 v239, a83
v_mfma_f32_16x16x32_bf16 v[24:27], a[12:15], a[44:47], v[24:27]
ds_read_b64_tr_b16 a[38:39], v90 offset:8704
v_mul_f32 v240, s85, v240
v_mfma_f32_16x16x32_bf16 v[24:27], a[136:139], a[76:79], v[24:27]
ds_read_b64_tr_b16 a[144:145], v90 offset:12288
v_mul_f32 v241, s85, v241
v_mfma_f32_16x16x32_bf16 v[40:43], a[136:139], a[72:75], v[40:43]
ds_read_b64_tr_b16 a[146:147], v90 offset:12800
v_mul_f32 v242, s85, v242
v_mfma_f32_16x16x32_bf16 v[40:43], a[12:15], a[200:203], v[40:43]
ds_read_b128 a[132:135], v92 offset:6144
v_mul_f32 v243, s85, v243
v_mfma_f32_16x16x32_bf16 v[56:59], a[12:15], a[228:231], v[56:59]
L_pad5:
s_cbranch_execz L_pad9
ds_read_b128 a[160:163], v93 offset:6144
v_mul_f32 v236, s85, v236
v_mfma_f32_16x16x32_bf16 v[56:59], a[136:139], a[232:235], v[56:59]
v_mul_f32 v237, s85, v237
v_mul_f32 v238, s85, v238
v_mfma_f32_16x16x32_bf16 v[72:75], a[136:139], a[168:171], v[72:75]
v_mul_f32 v239, s85, v239
v_cvt_pk_bf16_f32 v240, v240, v241
v_mfma_f32_16x16x32_bf16 v[72:75], a[12:15], a[120:123], v[72:75]
s_waitcnt lgkmcnt(6)
ds_read_b64_tr_b16 a[80:81], v91 offset:8192
v_cvt_pk_bf16_f32 v241, v242, v243
v_mfma_f32_16x16x32_bf16 v[180:183], a[92:95], a[44:47], v[180:183]
ds_read_b64_tr_b16 a[82:83], v91 offset:8704
v_cvt_pk_bf16_f32 v242, v236, v237
v_mfma_f32_16x16x32_bf16 v[180:183], a[140:143], a[76:79], v[180:183]
ds_read_b64_tr_b16 a[136:137], v91 offset:12288
v_cvt_pk_bf16_f32 v243, v238, v239
v_mfma_f32_16x16x32_bf16 v[184:187], a[140:143], a[72:75], v[184:187]
ds_read_b64_tr_b16 a[138:139], v91 offset:12800
v_mfma_f32_16x16x32_bf16 v[184:187], a[92:95], a[200:203], v[184:187]
buffer_store_dwordx4 v[232:235], v1, s[28:31], s94 offen
v_mfma_f32_16x16x32_bf16 v[188:191], a[92:95], a[228:231], v[188:191]
v_mfma_f32_16x16x32_bf16 v[188:191], a[140:143], a[232:235], v[188:191]
s_waitcnt vmcnt(15)
v_mfma_f32_16x16x32_bf16 v[192:195], a[140:143], a[168:171], v[192:195]
s_barrier
v_mfma_f32_16x16x32_bf16 v[192:195], a[92:95], a[120:123], v[192:195]
s_waitcnt lgkmcnt(4)
buffer_load_dwordx4 v82, s[20:23], s80 offen lds
v_mfma_f32_16x16x32_bf16 v[28:31], a[36:39], a[44:47], v[28:31]
s_add_u32 m0, s83, 50176
ds_read_b64_tr_b16 a[12:13], v88 offset:16384
v_accvgpr_read_b32 v232, a0
v_mfma_f32_16x16x32_bf16 v[28:31], a[144:147], a[76:79], v[28:31]
s_add_u32 s80, s91, 1638400
ds_read_b64_tr_b16 a[14:15], v88 offset:16896
v_accvgpr_read_b32 v233, a1
v_mfma_f32_16x16x32_bf16 v[44:47], a[144:147], a[72:75], v[44:47]
ds_read_b64_tr_b16 a[140:141], v88 offset:20480
v_accvgpr_read_b32 v234, a2
v_mfma_f32_16x16x32_bf16 v[44:47], a[36:39], a[200:203], v[44:47]
ds_read_b64_tr_b16 a[142:143], v88 offset:20992
v_accvgpr_read_b32 v235, a3
v_mfma_f32_16x16x32_bf16 v[60:63], a[36:39], a[228:231], v[60:63]
v_accvgpr_read_b32 v236, a16
v_accvgpr_read_b32 v237, a17
v_mfma_f32_16x16x32_bf16 v[60:63], a[144:147], a[232:235], v[60:63]
buffer_load_dwordx4 v83, s[20:23], s80 offen lds
v_mfma_f32_16x16x32_bf16 v[76:79], a[144:147], a[168:171], v[76:79]
s_add_u32 m0, s83, 57344
v_accvgpr_read_b32 v238, a18
v_accvgpr_read_b32 v239, a19
v_mfma_f32_16x16x32_bf16 v[76:79], a[36:39], a[120:123], v[76:79]
s_waitcnt lgkmcnt(4)
ds_read_b64_tr_b16 a[0:1], v89 offset:16384
v_mul_f32 v232, s85, v232
v_mfma_f32_16x16x32_bf16 v[196:199], a[80:83], a[44:47], v[196:199]
s_add_u32 s80, s91, 1572992
ds_read_b64_tr_b16 a[2:3], v89 offset:16896
v_mul_f32 v233, s85, v233
v_mfma_f32_16x16x32_bf16 v[196:199], a[136:139], a[76:79], v[196:199]
ds_read_b64_tr_b16 a[144:145], v89 offset:20480
v_mul_f32 v234, s85, v234
v_mfma_f32_16x16x32_bf16 v[200:203], a[136:139], a[72:75], v[200:203]
ds_read_b64_tr_b16 a[146:147], v89 offset:20992
v_mul_f32 v235, s85, v235
v_mfma_f32_16x16x32_bf16 v[200:203], a[80:83], a[200:203], v[200:203]
buffer_load_dwordx4 v82, s[20:23], s80 offen lds
v_mfma_f32_16x16x32_bf16 v[204:207], a[80:83], a[228:231], v[204:207]
s_add_u32 m0, s83, 58368
v_mul_f32 v236, s85, v236
v_mul_f32 v237, s85, v237
v_mfma_f32_16x16x32_bf16 v[204:207], a[136:139], a[232:235], v[204:207]
s_add_u32 s80, s91, 1638528
v_mul_f32 v238, s85, v238
v_mul_f32 v239, s85, v239
v_mfma_f32_16x16x32_bf16 v[208:211], a[136:139], a[168:171], v[208:211]
v_cvt_pk_bf16_f32 v232, v232, v233
v_cvt_pk_bf16_f32 v233, v234, v235
v_mfma_f32_16x16x32_bf16 v[208:211], a[80:83], a[120:123], v[208:211]
s_waitcnt lgkmcnt(4)
ds_read_b64_tr_b16 a[16:17], v90 offset:16384
v_cvt_pk_bf16_f32 v234, v236, v237
v_mfma_f32_16x16x32_bf16 a[20:23], a[12:15], a[152:155], a[20:23]
buffer_store_dwordx4 v[240:243], v1, s[28:31], s94 offen offset:1024
ds_read_b64_tr_b16 a[18:19], v90 offset:16896
v_cvt_pk_bf16_f32 v235, v238, v239
v_mfma_f32_16x16x32_bf16 a[20:23], a[140:143], a[4:7], a[20:23]
ds_read_b64_tr_b16 a[136:137], v90 offset:20480
v_mfma_f32_16x16x32_bf16 a[100:103], a[140:143], a[28:31], a[100:103]
buffer_load_dwordx4 v83, s[20:23], s80 offen lds
v_mfma_f32_16x16x32_bf16 a[100:103], a[12:15], a[156:159], a[100:103]
s_add_u32 m0, s84, 131072
ds_read_b64_tr_b16 a[138:139], v90 offset:20992
v_accvgpr_read_b32 v244, a64
v_mfma_f32_16x16x32_bf16 a[112:115], a[12:15], a[252:255], a[112:115]
s_add_u32 s80, s89, 512
v_accvgpr_read_b32 v245, a65
v_accvgpr_read_b32 v246, a66
v_mfma_f32_16x16x32_bf16 a[112:115], a[140:143], a[32:35], a[112:115]
v_accvgpr_read_b32 v247, a67
v_accvgpr_read_b32 v236, a84
v_mfma_f32_16x16x32_bf16 a[116:119], a[140:143], a[160:163], a[116:119]
v_accvgpr_read_b32 v237, a85
v_accvgpr_read_b32 v238, a86
v_mfma_f32_16x16x32_bf16 a[116:119], a[12:15], a[132:135], a[116:119]
s_waitcnt lgkmcnt(4)
ds_read_b64_tr_b16 a[72:73], v91 offset:16384
v_accvgpr_read_b32 v239, a87
v_mfma_f32_16x16x32_bf16 a[124:127], a[0:3], a[152:155], a[124:127]
buffer_load_dwordx4 v80, s[16:19], s80 offen lds
v_mfma_f32_16x16x32_bf16 a[124:127], a[144:147], a[4:7], a[124:127]
s_add_u32 m0, s84, 132096
ds_read_b64_tr_b16 a[74:75], v91 offset:16896
v_mul_f32 v244, s85, v244
v_mfma_f32_16x16x32_bf16 a[128:131], a[144:147], a[28:31], a[128:131]
s_add_u32 s80, s89, 8704
ds_read_b64_tr_b16 a[140:141], v91 offset:20480
v_mul_f32 v245, s85, v245
v_mfma_f32_16x16x32_bf16 a[128:131], a[0:3], a[156:159], a[128:131]
ds_read_b64_tr_b16 a[142:143], v91 offset:20992
v_mul_f32 v246, s85, v246
v_mfma_f32_16x16x32_bf16 a[8:11], a[0:3], a[252:255], a[8:11]
v_mul_f32 v247, s85, v247
v_mul_f32 v236, s85, v236
v_mfma_f32_16x16x32_bf16 a[8:11], a[144:147], a[32:35], a[8:11]
v_mul_f32 v237, s85, v237
v_mul_f32 v238, s85, v238
v_mfma_f32_16x16x32_bf16 a[68:71], a[144:147], a[160:163], a[68:71]
buffer_load_dwordx4 v81, s[16:19], s80 offen lds
v_mfma_f32_16x16x32_bf16 a[68:71], a[0:3], a[132:135], a[68:71]
s_waitcnt lgkmcnt(4)
ds_read_b64_tr_b16 a[12:13], v88 offset:24576
v_mul_f32 v239, s85, v239
v_mfma_f32_16x16x32_bf16 a[164:167], a[16:19], a[152:155], a[164:167]
s_add_u32 m0, s84, 133120
ds_read_b64_tr_b16 a[14:15], v88 offset:25088
v_cvt_pk_bf16_f32 v244, v244, v245
v_mfma_f32_16x16x32_bf16 a[164:167], a[136:139], a[4:7], a[164:167]
s_add_u32 s80, s89, 16896
ds_read_b64_tr_b16 a[144:145], v88 offset:28672
v_cvt_pk_bf16_f32 v245, v246, v247
v_mfma_f32_16x16x32_bf16 a[40:43], a[136:139], a[28:31], a[40:43]
ds_read_b64_tr_b16 a[146:147], v88 offset:29184
v_cvt_pk_bf16_f32 v246, v236, v237
v_mfma_f32_16x16x32_bf16 a[40:43], a[16:19], a[156:159], a[40:43]
v_cvt_pk_bf16_f32 v247, v238, v239
v_mfma_f32_16x16x32_bf16 a[184:187], a[16:19], a[252:255], a[184:187]
buffer_load_dwordx4 v80, s[16:19], s80 offen lds
v_mfma_f32_16x16x32_bf16 a[184:187], a[136:139], a[32:35], a[184:187]
s_add_u32 m0, s84, 134144
s_add_u32 s80, s89, 25088
v_mfma_f32_16x16x32_bf16 a[192:195], a[136:139], a[160:163], a[192:195]
buffer_store_dwordx4 v[232:235], v1, s[28:31], s94 offen offset:2048
v_mfma_f32_16x16x32_bf16 a[192:195], a[16:19], a[132:135], a[192:195]
s_waitcnt lgkmcnt(4)
ds_read_b64_tr_b16 a[0:1], v89 offset:24576
v_mfma_f32_16x16x32_bf16 a[212:215], a[72:75], a[152:155], a[212:215]
ds_read_b64_tr_b16 a[2:3], v89 offset:25088
v_mfma_f32_16x16x32_bf16 a[212:215], a[140:143], a[4:7], a[212:215]
ds_read_b64_tr_b16 a[64:65], v89 offset:28672
v_mfma_f32_16x16x32_bf16 a[48:51], a[140:143], a[28:31], a[48:51]
buffer_load_dwordx4 v81, s[16:19], s80 offen lds
v_mfma_f32_16x16x32_bf16 a[48:51], a[72:75], a[156:159], a[48:51]
s_add_u32 m0, s84, 135168
s_add_u32 s80, s90, 512
ds_read_b64_tr_b16 a[66:67], v89 offset:29184
v_mfma_f32_16x16x32_bf16 a[56:59], a[72:75], a[252:255], a[56:59]
v_mfma_f32_16x16x32_bf16 a[56:59], a[140:143], a[32:35], a[56:59]
v_mfma_f32_16x16x32_bf16 a[220:223], a[140:143], a[160:163], a[220:223]
v_mfma_f32_16x16x32_bf16 a[220:223], a[72:75], a[132:135], a[220:223]
s_waitcnt lgkmcnt(4)
ds_read_b64_tr_b16 a[136:137], v90 offset:24576
v_mfma_f32_16x16x32_bf16 v[16:19], a[12:15], a[152:155], v[16:19]
buffer_load_dwordx4 v80, s[16:19], s80 offen lds
v_mfma_f32_16x16x32_bf16 v[16:19], a[144:147], a[4:7], v[16:19]
s_add_u32 m0, s84, 136192
s_add_u32 s80, s90, 8704
ds_read_b64_tr_b16 a[138:139], v90 offset:25088
v_mfma_f32_16x16x32_bf16 v[32:35], a[144:147], a[28:31], v[32:35]
ds_read_b64_tr_b16 a[140:141], v90 offset:28672
v_mfma_f32_16x16x32_bf16 v[32:35], a[12:15], a[156:159], v[32:35]
ds_read_b64_tr_b16 a[142:143], v90 offset:29184
v_mfma_f32_16x16x32_bf16 v[48:51], a[12:15], a[252:255], v[48:51]
v_mfma_f32_16x16x32_bf16 v[48:51], a[144:147], a[32:35], v[48:51]
v_mfma_f32_16x16x32_bf16 v[64:67], a[144:147], a[160:163], v[64:67]
buffer_load_dwordx4 v81, s[16:19], s80 offen lds
v_mfma_f32_16x16x32_bf16 v[64:67], a[12:15], a[132:135], v[64:67]
s_waitcnt lgkmcnt(4)
s_add_u32 m0, s84, 137216
ds_read_b64_tr_b16 a[16:17], v91 offset:24576
v_mfma_f32_16x16x32_bf16 v[100:103], a[0:3], a[152:155], v[100:103]
s_add_u32 s80, s90, 16896
ds_read_b64_tr_b16 a[18:19], v91 offset:25088
v_mfma_f32_16x16x32_bf16 v[100:103], a[64:67], a[4:7], v[100:103]
ds_read_b64_tr_b16 a[72:73], v91 offset:28672
v_mfma_f32_16x16x32_bf16 v[152:155], a[64:67], a[28:31], v[152:155]
ds_read_b64_tr_b16 a[74:75], v91 offset:29184
v_mfma_f32_16x16x32_bf16 v[152:155], a[0:3], a[156:159], v[152:155]
s_waitcnt vmcnt(24)
buffer_store_dwordx4 v[244:247], v1, s[28:31], s94 offen offset:3072
ds_read_b128 a[144:147], v92 offset:32768
v_mfma_f32_16x16x32_bf16 v[156:159], a[0:3], a[252:255], v[156:159]
s_add_u32 s81, s95, 4096
ds_read_b128 a[12:15], v93 offset:32768
v_mfma_f32_16x16x32_bf16 v[156:159], a[64:67], a[32:35], v[156:159]
buffer_load_dwordx4 v80, s[16:19], s80 offen lds
v_mfma_f32_16x16x32_bf16 v[160:163], a[64:67], a[160:163], v[160:163]
s_add_u32 m0, s84, 138240
s_add_u32 s80, s90, 25088
v_mfma_f32_16x16x32_bf16 v[160:163], a[0:3], a[132:135], v[160:163]
s_waitcnt lgkmcnt(6)
ds_read_b64_tr_b16 a[76:77], v88 offset:32768
v_mfma_f32_16x16x32_bf16 v[20:23], a[136:139], a[152:155], v[20:23]
ds_read_b64_tr_b16 a[78:79], v88 offset:33280
v_mfma_f32_16x16x32_bf16 v[20:23], a[140:143], a[4:7], v[20:23]
ds_read_b64_tr_b16 a[80:81], v88 offset:36864
v_mfma_f32_16x16x32_bf16 v[36:39], a[140:143], a[28:31], v[36:39]
ds_read_b64_tr_b16 a[82:83], v88 offset:37376
v_mfma_f32_16x16x32_bf16 v[36:39], a[136:139], a[156:159], v[36:39]
buffer_load_dwordx4 v81, s[16:19], s80 offen lds
v_mfma_f32_16x16x32_bf16 v[52:55], a[136:139], a[252:255], v[52:55]
s_waitcnt vmcnt(24)
s_add_u32 m0, s83, 0
ds_read_b128 a[0:3], v92 offset:34816
v_mfma_f32_16x16x32_bf16 v[52:55], a[140:143], a[32:35], v[52:55]
s_add_u32 s80, s92, 917504
ds_read_b128 a[64:67], v93 offset:34816
v_mfma_f32_16x16x32_bf16 v[68:71], a[140:143], a[160:163], v[68:71]
v_mfma_f32_16x16x32_bf16 v[68:71], a[136:139], a[132:135], v[68:71]
s_waitcnt lgkmcnt(6)
ds_read_b64_tr_b16 a[84:85], v89 offset:32768
v_mfma_f32_16x16x32_bf16 v[164:167], a[16:19], a[152:155], v[164:167]
ds_read_b64_tr_b16 a[86:87], v89 offset:33280
v_mfma_f32_16x16x32_bf16 v[164:167], a[72:75], a[4:7], v[164:167]
buffer_load_dwordx4 v84, s[24:27], s80 offen lds
v_mfma_f32_16x16x32_bf16 v[168:171], a[72:75], a[28:31], v[168:171]
s_add_u32 m0, s83, 1024
s_add_u32 s80, s92, 946176
ds_read_b64_tr_b16 a[140:141], v89 offset:36864
v_mfma_f32_16x16x32_bf16 v[168:171], a[16:19], a[156:159], v[168:171]
ds_read_b64_tr_b16 a[142:143], v89 offset:37376
v_mfma_f32_16x16x32_bf16 v[172:175], a[16:19], a[252:255], v[172:175]
s_waitcnt vmcnt(22)
ds_read_b128 a[136:139], v92 offset:36864
v_mfma_f32_16x16x32_bf16 v[172:175], a[72:75], a[32:35], v[172:175]
ds_read_b128 a[92:95], v93 offset:36864
v_mfma_f32_16x16x32_bf16 v[176:179], a[72:75], a[160:163], v[176:179]
v_mfma_f32_16x16x32_bf16 v[176:179], a[16:19], a[132:135], v[176:179]
s_waitcnt lgkmcnt(6)
buffer_load_dwordx4 v85, s[24:27], s80 offen lds
v_mfma_f32_16x16x32_bf16 v[24:27], a[76:79], a[152:155], v[24:27]
s_add_u32 m0, s83, 8192
buffer_store_dwordx4 v[132:135], v1, s[28:31], s81 offen
ds_read_b64_tr_b16 a[36:37], v90 offset:32768
v_mfma_f32_16x16x32_bf16 v[24:27], a[80:83], a[4:7], v[24:27]
s_add_u32 s80, s91, 2097152
ds_read_b64_tr_b16 a[38:39], v90 offset:33280
v_mfma_f32_16x16x32_bf16 v[40:43], a[80:83], a[28:31], v[40:43]
ds_read_b64_tr_b16 a[16:17], v90 offset:36864
v_mfma_f32_16x16x32_bf16 v[40:43], a[76:79], a[156:159], v[40:43]
ds_read_b64_tr_b16 a[18:19], v90 offset:37376
v_mfma_f32_16x16x32_bf16 v[56:59], a[76:79], a[252:255], v[56:59]
s_waitcnt vmcnt(22)
ds_read_b128 a[72:75], v92 offset:38912
v_mfma_f32_16x16x32_bf16 v[56:59], a[80:83], a[32:35], v[56:59]
ds_read_b128 a[44:47], v93 offset:38912
v_mfma_f32_16x16x32_bf16 v[72:75], a[80:83], a[160:163], v[72:75]
v_mfma_f32_16x16x32_bf16 v[72:75], a[76:79], a[132:135], v[72:75]
s_waitcnt lgkmcnt(6)
ds_read_b64_tr_b16 a[120:121], v91 offset:32768
v_mfma_f32_16x16x32_bf16 v[180:183], a[84:87], a[152:155], v[180:183]
ds_read_b64_tr_b16 a[122:123], v91 offset:33280
v_mfma_f32_16x16x32_bf16 v[180:183], a[140:143], a[4:7], v[180:183]
ds_read_b64_tr_b16 a[168:169], v91 offset:36864
v_mfma_f32_16x16x32_bf16 v[184:187], a[140:143], a[28:31], v[184:187]
ds_read_b64_tr_b16 a[170:171], v91 offset:37376
v_mfma_f32_16x16x32_bf16 v[184:187], a[84:87], a[156:159], v[184:187]
v_mfma_f32_16x16x32_bf16 v[188:191], a[84:87], a[252:255], v[188:191]
v_mfma_f32_16x16x32_bf16 v[188:191], a[140:143], a[32:35], v[188:191]
s_waitcnt vmcnt(13)
v_mfma_f32_16x16x32_bf16 v[192:195], a[140:143], a[160:163], v[192:195]
s_barrier
v_mfma_f32_16x16x32_bf16 v[192:195], a[84:87], a[132:135], v[192:195]
s_waitcnt lgkmcnt(4)
buffer_load_dwordx4 v82, s[20:23], s80 offen lds
v_mfma_f32_16x16x32_bf16 v[28:31], a[36:39], a[152:155], v[28:31]
s_add_u32 m0, s83, 9216
s_add_u32 s80, s91, 2162688
ds_read_b64_tr_b16 a[76:77], v88 offset:40960
v_mfma_f32_16x16x32_bf16 v[28:31], a[16:19], a[4:7], v[28:31]
ds_read_b64_tr_b16 a[78:79], v88 offset:41472
v_mfma_f32_16x16x32_bf16 v[44:47], a[16:19], a[28:31], v[44:47]
ds_read_b64_tr_b16 a[140:141], v88 offset:45056
v_mfma_f32_16x16x32_bf16 v[44:47], a[36:39], a[156:159], v[44:47]
ds_read_b64_tr_b16 a[142:143], v88 offset:45568
v_mfma_f32_16x16x32_bf16 v[60:63], a[36:39], a[252:255], v[60:63]
v_mfma_f32_16x16x32_bf16 v[60:63], a[16:19], a[32:35], v[60:63]
buffer_load_dwordx4 v83, s[20:23], s80 offen lds
v_mfma_f32_16x16x32_bf16 v[76:79], a[16:19], a[160:163], v[76:79]
s_add_u32 m0, s83, 16384
buffer_store_dwordx4 v[136:139], v1, s[28:31], s81 offen offset:1024
v_mfma_f32_16x16x32_bf16 v[76:79], a[36:39], a[132:135], v[76:79]
s_waitcnt lgkmcnt(4)
s_add_u32 s80, s91, 2097280
ds_read_b64_tr_b16 a[80:81], v89 offset:40960
v_mfma_f32_16x16x32_bf16 v[196:199], a[120:123], a[152:155], v[196:199]
ds_read_b64_tr_b16 a[82:83], v89 offset:41472
v_mfma_f32_16x16x32_bf16 v[196:199], a[168:171], a[4:7], v[196:199]
ds_read_b64_tr_b16 a[84:85], v89 offset:45056
v_mfma_f32_16x16x32_bf16 v[200:203], a[168:171], a[28:31], v[200:203]
ds_read_b64_tr_b16 a[86:87], v89 offset:45568
v_mfma_f32_16x16x32_bf16 v[200:203], a[120:123], a[156:159], v[200:203]
buffer_load_dwordx4 v82, s[20:23], s80 offen lds
v_mfma_f32_16x16x32_bf16 v[204:207], a[120:123], a[252:255], v[204:207]
s_add_u32 m0, s83, 17408
s_add_u32 s80, s91, 2162816
v_mfma_f32_16x16x32_bf16 v[204:207], a[168:171], a[32:35], v[204:207]
v_mfma_f32_16x16x32_bf16 v[208:211], a[168:171], a[160:163], v[208:211]
v_mfma_f32_16x16x32_bf16 v[208:211], a[120:123], a[132:135], v[208:211]
s_waitcnt lgkmcnt(4)
ds_read_b64_tr_b16 a[152:153], v90 offset:40960
v_mfma_f32_16x16x32_bf16 a[20:23], a[76:79], a[144:147], a[20:23]
ds_read_b64_tr_b16 a[154:155], v90 offset:41472
v_mfma_f32_16x16x32_bf16 a[20:23], a[140:143], a[12:15], a[20:23]
buffer_load_dwordx4 v83, s[20:23], s80 offen lds
v_mfma_f32_16x16x32_bf16 a[100:103], a[140:143], a[64:67], a[100:103]
s_add_u32 m0, s84, 65536
s_add_u32 s80, s89, 640
ds_read_b64_tr_b16 a[252:253], v90 offset:45056
v_mfma_f32_16x16x32_bf16 a[100:103], a[76:79], a[0:3], a[100:103]
ds_read_b64_tr_b16 a[254:255], v90 offset:45568
v_mfma_f32_16x16x32_bf16 a[112:115], a[76:79], a[136:139], a[112:115]
v_mfma_f32_16x16x32_bf16 a[112:115], a[140:143], a[92:95], a[112:115]
v_mfma_f32_16x16x32_bf16 a[116:119], a[140:143], a[44:47], a[116:119]
v_mfma_f32_16x16x32_bf16 a[116:119], a[76:79], a[72:75], a[116:119]
s_waitcnt lgkmcnt(4)
buffer_load_dwordx4 v80, s[16:19], s80 offen lds
v_mfma_f32_16x16x32_bf16 a[124:127], a[80:83], a[144:147], a[124:127]
s_add_u32 m0, s84, 66560
s_add_u32 s80, s89, 8832
ds_read_b64_tr_b16 a[132:133], v91 offset:40960
v_mfma_f32_16x16x32_bf16 a[124:127], a[84:87], a[12:15], a[124:127]
ds_read_b64_tr_b16 a[134:135], v91 offset:41472
v_mfma_f32_16x16x32_bf16 a[128:131], a[84:87], a[64:67], a[128:131]
ds_read_b64_tr_b16 a[140:141], v91 offset:45056
v_mfma_f32_16x16x32_bf16 a[128:131], a[80:83], a[0:3], a[128:131]
buffer_store_dwordx4 v[140:143], v1, s[28:31], s81 offen offset:2048
ds_read_b64_tr_b16 a[142:143], v91 offset:45568
v_mfma_f32_16x16x32_bf16 a[8:11], a[80:83], a[136:139], a[8:11]
v_mfma_f32_16x16x32_bf16 a[8:11], a[84:87], a[92:95], a[8:11]
buffer_load_dwordx4 v81, s[16:19], s80 offen lds
v_mfma_f32_16x16x32_bf16 a[68:71], a[84:87], a[44:47], a[68:71]
s_add_u32 m0, s84, 67584
v_accvgpr_read_b32 v232, a60
v_accvgpr_read_b32 v233, a61
v_mfma_f32_16x16x32_bf16 a[68:71], a[80:83], a[72:75], a[68:71]
s_waitcnt lgkmcnt(4)
ds_read_b64_tr_b16 a[4:5], v88 offset:49152
v_accvgpr_read_b32 v234, a62
v_mfma_f32_16x16x32_bf16 a[164:167], a[152:155], a[144:147], a[164:167]
s_add_u32 s80, s89, 17024
ds_read_b64_tr_b16 a[6:7], v88 offset:49664
v_accvgpr_read_b32 v235, a63
v_mfma_f32_16x16x32_bf16 a[164:167], a[252:255], a[12:15], a[164:167]
ds_read_b64_tr_b16 a[156:157], v88 offset:53248
v_accvgpr_read_b32 v236, a96
v_mfma_f32_16x16x32_bf16 a[40:43], a[252:255], a[64:67], a[40:43]
ds_read_b64_tr_b16 a[158:159], v88 offset:53760
v_accvgpr_read_b32 v237, a97
v_mfma_f32_16x16x32_bf16 a[40:43], a[152:155], a[0:3], a[40:43]
buffer_load_dwordx4 v80, s[16:19], s80 offen lds
v_mfma_f32_16x16x32_bf16 a[184:187], a[152:155], a[136:139], a[184:187]
s_add_u32 m0, s84, 68608
v_accvgpr_read_b32 v238, a98
v_accvgpr_read_b32 v239, a99
v_mfma_f32_16x16x32_bf16 a[184:187], a[252:255], a[92:95], a[184:187]
s_add_u32 s80, s89, 25216
v_mul_f32 v232, s85, v232
v_mul_f32 v233, s85, v233
v_mfma_f32_16x16x32_bf16 a[192:195], a[252:255], a[44:47], a[192:195]
v_mul_f32 v234, s85, v234
v_mul_f32 v235, s85, v235
v_mfma_f32_16x16x32_bf16 a[192:195], a[152:155], a[72:75], a[192:195]
s_waitcnt lgkmcnt(4)
ds_read_b64_tr_b16 a[16:17], v89 offset:49152
v_mul_f32 v236, s85, v236
v_mfma_f32_16x16x32_bf16 a[212:215], a[132:135], a[144:147], a[212:215]
ds_read_b64_tr_b16 a[18:19], v89 offset:49664
v_mul_f32 v237, s85, v237
v_mfma_f32_16x16x32_bf16 a[212:215], a[140:143], a[12:15], a[212:215]
buffer_load_dwordx4 v81, s[16:19], s80 offen lds
v_mfma_f32_16x16x32_bf16 a[48:51], a[140:143], a[64:67], a[48:51]
s_add_u32 m0, s84, 69632
ds_read_b64_tr_b16 a[252:253], v89 offset:53248
v_mul_f32 v238, s85, v238
v_mfma_f32_16x16x32_bf16 a[48:51], a[132:135], a[0:3], a[48:51]
s_add_u32 s80, s90, 640
ds_read_b64_tr_b16 a[254:255], v89 offset:53760
v_mul_f32 v239, s85, v239
v_mfma_f32_16x16x32_bf16 a[56:59], a[132:135], a[136:139], a[56:59]
v_cvt_pk_bf16_f32 v232, v232, v233
v_cvt_pk_bf16_f32 v233, v234, v235
v_mfma_f32_16x16x32_bf16 a[56:59], a[140:143], a[92:95], a[56:59]
v_cvt_pk_bf16_f32 v234, v236, v237
v_cvt_pk_bf16_f32 v235, v238, v239
v_mfma_f32_16x16x32_bf16 a[220:223], a[140:143], a[44:47], a[220:223]
v_mfma_f32_16x16x32_bf16 a[220:223], a[132:135], a[72:75], a[220:223]
s_waitcnt lgkmcnt(4)
buffer_load_dwordx4 v80, s[16:19], s80 offen lds
v_mfma_f32_16x16x32_bf16 v[16:19], a[4:7], a[144:147], v[16:19]
s_add_u32 m0, s84, 70656
buffer_store_dwordx4 v[96:99], v1, s[28:31], s81 offen offset:3072
ds_read_b64_tr_b16 a[152:153], v90 offset:49152
v_mfma_f32_16x16x32_bf16 v[16:19], a[156:159], a[12:15], v[16:19]
s_add_u32 s80, s90, 8832
ds_read_b64_tr_b16 a[154:155], v90 offset:49664
v_mfma_f32_16x16x32_bf16 v[32:35], a[156:159], a[64:67], v[32:35]
ds_read_b64_tr_b16 a[132:133], v90 offset:53248
v_mfma_f32_16x16x32_bf16 v[32:35], a[4:7], a[0:3], v[32:35]
ds_read_b64_tr_b16 a[134:135], v90 offset:53760
v_accvgpr_read_b32 v236, a104
v_mfma_f32_16x16x32_bf16 v[48:51], a[4:7], a[136:139], v[48:51]
v_accvgpr_read_b32 v237, a105
v_accvgpr_read_b32 v238, a106
v_mfma_f32_16x16x32_bf16 v[48:51], a[156:159], a[92:95], v[48:51]
buffer_load_dwordx4 v81, s[16:19], s80 offen lds
v_mfma_f32_16x16x32_bf16 v[64:67], a[156:159], a[44:47], v[64:67]
s_add_u32 m0, s84, 71680
v_accvgpr_read_b32 v239, a107
v_accvgpr_read_b32 v240, a108
v_mfma_f32_16x16x32_bf16 v[64:67], a[4:7], a[72:75], v[64:67]
s_waitcnt lgkmcnt(4)
ds_read_b64_tr_b16 a[140:141], v91 offset:49152
v_accvgpr_read_b32 v241, a109
v_mfma_f32_16x16x32_bf16 v[100:103], a[16:19], a[144:147], v[100:103]
s_add_u32 s80, s90, 17024
ds_read_b64_tr_b16 a[142:143], v91 offset:49664
v_accvgpr_read_b32 v242, a110
v_mfma_f32_16x16x32_bf16 v[100:103], a[252:255], a[12:15], v[100:103]
ds_read_b64_tr_b16 a[156:157], v91 offset:53248
v_accvgpr_read_b32 v243, a111
v_mfma_f32_16x16x32_bf16 v[152:155], a[252:255], a[64:67], v[152:155]
ds_read_b64_tr_b16 a[158:159], v91 offset:53760
v_mul_f32 v236, s85, v236
v_mfma_f32_16x16x32_bf16 v[152:155], a[16:19], a[0:3], v[152:155]
buffer_load_dwordx4 v80, s[16:19], s80 offen lds
v_mfma_f32_16x16x32_bf16 v[156:159], a[16:19], a[136:139], v[156:159]
s_waitcnt vmcnt(25)
s_add_u32 m0, s84, 72704
ds_read_b128 a[4:7], v94 offset:0
v_mfma_f32_16x16x32_bf16 v[156:159], a[252:255], a[92:95], v[156:159]
s_add_u32 s80, s90, 25216
ds_read_b128 a[28:31], v95 offset:0
v_mul_f32 v237, s85, v237
v_mfma_f32_16x16x32_bf16 v[160:163], a[252:255], a[44:47], v[160:163]
v_mul_f32 v238, s85, v238
v_mul_f32 v239, s85, v239
v_mfma_f32_16x16x32_bf16 v[160:163], a[16:19], a[72:75], v[160:163]
s_waitcnt lgkmcnt(6)
ds_read_b64_tr_b16 a[160:161], v88 offset:57344
v_mul_f32 v240, s85, v240
v_mfma_f32_16x16x32_bf16 v[20:23], a[152:155], a[144:147], v[20:23]
ds_read_b64_tr_b16 a[162:163], v88 offset:57856
v_mul_f32 v241, s85, v241
v_mfma_f32_16x16x32_bf16 v[20:23], a[132:135], a[12:15], v[20:23]
buffer_load_dwordx4 v81, s[16:19], s80 offen lds
v_mfma_f32_16x16x32_bf16 v[36:39], a[132:135], a[64:67], v[36:39]
s_add_u32 m0, s83, 24576
ds_read_b64_tr_b16 a[252:253], v88 offset:61440
v_mul_f32 v242, s85, v242
v_mfma_f32_16x16x32_bf16 v[36:39], a[152:155], a[0:3], v[36:39]
s_add_u32 s80, s92, 1146880
ds_read_b64_tr_b16 a[254:255], v88 offset:61952
v_mul_f32 v243, s85, v243
v_mfma_f32_16x16x32_bf16 v[52:55], a[152:155], a[136:139], v[52:55]
s_waitcnt vmcnt(23)
ds_read_b128 a[16:19], v94 offset:2048
v_cvt_pk_bf16_f32 v236, v236, v237
v_mfma_f32_16x16x32_bf16 v[52:55], a[132:135], a[92:95], v[52:55]
buffer_store_dwordx4 v[232:235], v1, s[28:31], s95 offen
ds_read_b128 a[76:79], v95 offset:2048
v_cvt_pk_bf16_f32 v237, v238, v239
v_cvt_pk_bf16_f32 v238, v240, v241
v_mfma_f32_16x16x32_bf16 v[68:71], a[132:135], a[44:47], v[68:71]
v_cvt_pk_bf16_f32 v239, v242, v243
v_mfma_f32_16x16x32_bf16 v[68:71], a[152:155], a[72:75], v[68:71]
s_waitcnt lgkmcnt(6)
buffer_load_dwordx4 v84, s[24:27], s80 offen lds
v_mfma_f32_16x16x32_bf16 v[164:167], a[140:143], a[144:147], v[164:167]
s_add_u32 m0, s83, 25600
ds_read_b64_tr_b16 a[80:81], v89 offset:57344
v_accvgpr_read_b32 v232, a188
v_mfma_f32_16x16x32_bf16 v[164:167], a[156:159], a[12:15], v[164:167]
s_add_u32 s80, s92, 1175552
ds_read_b64_tr_b16 a[82:83], v89 offset:57856
v_accvgpr_read_b32 v233, a189
v_mfma_f32_16x16x32_bf16 v[168:171], a[156:159], a[64:67], v[168:171]
ds_read_b64_tr_b16 a[132:133], v89 offset:61440
v_accvgpr_read_b32 v234, a190
v_mfma_f32_16x16x32_bf16 v[168:171], a[140:143], a[0:3], v[168:171]
ds_read_b64_tr_b16 a[134:135], v89 offset:61952
v_accvgpr_read_b32 v235, a191
v_mfma_f32_16x16x32_bf16 v[172:175], a[140:143], a[136:139], v[172:175]
s_waitcnt vmcnt(23)
ds_read_b128 a[152:155], v94 offset:4096
v_accvgpr_read_b32 v240, a180
v_mfma_f32_16x16x32_bf16 v[172:175], a[156:159], a[92:95], v[172:175]
buffer_load_dwordx4 v85, s[24:27], s80 offen lds
v_mfma_f32_16x16x32_bf16 v[176:179], a[156:159], a[44:47], v[176:179]
s_add_u32 m0, s83, 32768
ds_read_b128 a[84:87], v95 offset:4096
v_accvgpr_read_b32 v241, a181
v_mfma_f32_16x16x32_bf16 v[176:179], a[140:143], a[72:75], v[176:179]
s_waitcnt lgkmcnt(6)
ds_read_b64_tr_b16 a[32:33], v90 offset:57344
v_accvgpr_read_b32 v242, a182
v_mfma_f32_16x16x32_bf16 v[24:27], a[160:163], a[144:147], v[24:27]
s_add_u32 s80, s91, 2621440
ds_read_b64_tr_b16 a[34:35], v90 offset:57856
v_accvgpr_read_b32 v243, a183
v_mfma_f32_16x16x32_bf16 v[24:27], a[252:255], a[12:15], v[24:27]
ds_read_b64_tr_b16 a[156:157], v90 offset:61440
v_mul_f32 v232, s85, v232
v_mfma_f32_16x16x32_bf16 v[40:43], a[252:255], a[64:67], v[40:43]
ds_read_b64_tr_b16 a[158:159], v90 offset:61952
v_mul_f32 v233, s85, v233
v_mfma_f32_16x16x32_bf16 v[40:43], a[160:163], a[0:3], v[40:43]
s_waitcnt vmcnt(21)
ds_read_b128 a[140:143], v94 offset:6144
v_mul_f32 v234, s85, v234
v_mfma_f32_16x16x32_bf16 v[56:59], a[160:163], a[136:139], v[56:59]
ds_read_b128 a[36:39], v95 offset:6144
v_mul_f32 v235, s85, v235
v_mfma_f32_16x16x32_bf16 v[56:59], a[252:255], a[92:95], v[56:59]
v_mul_f32 v240, s85, v240
v_mul_f32 v241, s85, v241
v_mfma_f32_16x16x32_bf16 v[72:75], a[252:255], a[44:47], v[72:75]
v_mul_f32 v242, s85, v242
v_mul_f32 v243, s85, v243
v_mfma_f32_16x16x32_bf16 v[72:75], a[160:163], a[72:75], v[72:75]
s_waitcnt lgkmcnt(6)
ds_read_b64_tr_b16 a[60:61], v91 offset:57344
v_cvt_pk_bf16_f32 v232, v232, v233
v_mfma_f32_16x16x32_bf16 v[180:183], a[80:83], a[144:147], v[180:183]
ds_read_b64_tr_b16 a[62:63], v91 offset:57856
v_cvt_pk_bf16_f32 v233, v234, v235
v_mfma_f32_16x16x32_bf16 v[180:183], a[132:135], a[12:15], v[180:183]
ds_read_b64_tr_b16 a[252:253], v91 offset:61440
v_cvt_pk_bf16_f32 v234, v240, v241
v_mfma_f32_16x16x32_bf16 v[184:187], a[132:135], a[64:67], v[184:187]
L_pad6:
s_cbranch_execz L_pad10
ds_read_b64_tr_b16 a[254:255], v91 offset:61952
v_cvt_pk_bf16_f32 v235, v242, v243
v_mfma_f32_16x16x32_bf16 v[184:187], a[80:83], a[0:3], v[184:187]
buffer_store_dwordx4 v[236:239], v1, s[28:31], s95 offen offset:1024
v_mfma_f32_16x16x32_bf16 v[188:191], a[80:83], a[136:139], v[188:191]
v_mfma_f32_16x16x32_bf16 v[188:191], a[132:135], a[92:95], v[188:191]
s_waitcnt vmcnt(14)
v_accvgpr_read_b32 v252, a176
v_accvgpr_read_b32 v253, a177
v_mfma_f32_16x16x32_bf16 v[192:195], a[132:135], a[44:47], v[192:195]
s_barrier
v_mfma_f32_16x16x32_bf16 v[192:195], a[80:83], a[72:75], v[192:195]
s_waitcnt lgkmcnt(4)
buffer_load_dwordx4 v82, s[20:23], s80 offen lds
v_mfma_f32_16x16x32_bf16 v[28:31], a[32:35], a[144:147], v[28:31]
s_add_u32 m0, s83, 33792
ds_read_b64_tr_b16 a[160:161], v88 offset:0
v_accvgpr_read_b32 v254, a178
v_mfma_f32_16x16x32_bf16 v[28:31], a[156:159], a[12:15], v[28:31]
s_add_u32 s80, s91, 2686976
ds_read_b64_tr_b16 a[162:163], v88 offset:512
v_accvgpr_read_b32 v255, a179
v_mfma_f32_16x16x32_bf16 v[44:47], a[156:159], a[64:67], v[44:47]
ds_read_b64_tr_b16 a[132:133], v88 offset:4096
v_accvgpr_read_b32 v236, a172
v_mfma_f32_16x16x32_bf16 v[44:47], a[32:35], a[0:3], v[44:47]
ds_read_b64_tr_b16 a[134:135], v88 offset:4608
v_accvgpr_read_b32 v237, a173
v_mfma_f32_16x16x32_bf16 v[60:63], a[32:35], a[136:139], v[60:63]
v_accvgpr_read_b32 v238, a174
v_accvgpr_read_b32 v239, a175
v_mfma_f32_16x16x32_bf16 v[60:63], a[156:159], a[92:95], v[60:63]
buffer_load_dwordx4 v83, s[20:23], s80 offen lds
v_mfma_f32_16x16x32_bf16 v[76:79], a[156:159], a[44:47], v[76:79]
s_add_u32 m0, s83, 40960
v_mul_f32 v252, s85, v252
v_mul_f32 v253, s85, v253
v_mfma_f32_16x16x32_bf16 v[76:79], a[32:35], a[72:75], v[76:79]
s_waitcnt lgkmcnt(4)
ds_read_b64_tr_b16 a[80:81], v89 offset:0
v_mul_f32 v254, s85, v254
v_mfma_f32_16x16x32_bf16 v[196:199], a[60:63], a[144:147], v[196:199]
s_add_u32 s80, s91, 2621568
ds_read_b64_tr_b16 a[82:83], v89 offset:512
v_mul_f32 v255, s85, v255
v_mfma_f32_16x16x32_bf16 v[196:199], a[252:255], a[12:15], v[196:199]
ds_read_b64_tr_b16 a[156:157], v89 offset:4096
v_mul_f32 v236, s85, v236
v_mfma_f32_16x16x32_bf16 v[200:203], a[252:255], a[64:67], v[200:203]
ds_read_b64_tr_b16 a[158:159], v89 offset:4608
v_mul_f32 v237, s85, v237
v_mfma_f32_16x16x32_bf16 v[200:203], a[60:63], a[0:3], v[200:203]
buffer_load_dwordx4 v82, s[20:23], s80 offen lds
v_mfma_f32_16x16x32_bf16 v[204:207], a[60:63], a[136:139], v[204:207]
s_add_u32 m0, s83, 41984
v_mul_f32 v238, s85, v238
v_mul_f32 v239, s85, v239
v_mfma_f32_16x16x32_bf16 v[204:207], a[252:255], a[92:95], v[204:207]
s_add_u32 s80, s91, 2687104
v_cvt_pk_bf16_f32 v252, v252, v253
v_cvt_pk_bf16_f32 v253, v254, v255
v_mfma_f32_16x16x32_bf16 v[208:211], a[252:255], a[44:47], v[208:211]
v_cvt_pk_bf16_f32 v254, v236, v237
v_cvt_pk_bf16_f32 v255, v238, v239
v_mfma_f32_16x16x32_bf16 v[208:211], a[60:63], a[72:75], v[208:211]
s_waitcnt lgkmcnt(4)
ds_read_b64_tr_b16 a[144:145], v90 offset:0
v_mov_b32 v12, 0x3f803f80
v_mfma_f32_16x16x32_bf16 a[20:23], a[160:163], a[4:7], a[20:23]
buffer_store_dwordx4 v[232:235], v1, s[28:31], s95 offen offset:2048
ds_read_b64_tr_b16 a[146:147], v90 offset:512
v_accvgpr_write_b32 a136, v12
v_accvgpr_write_b32 a137, v12
v_mfma_f32_16x16x32_bf16 a[20:23], a[132:135], a[28:31], a[20:23]
ds_read_b64_tr_b16 a[0:1], v90 offset:4096
v_accvgpr_write_b32 a138, v12
v_mfma_f32_16x16x32_bf16 a[100:103], a[132:135], a[76:79], a[100:103]
buffer_load_dwordx4 v83, s[20:23], s80 offen lds
v_mfma_f32_16x16x32_bf16 a[100:103], a[160:163], a[16:19], a[100:103]
s_add_u32 m0, s84, 98304
ds_read_b64_tr_b16 a[2:3], v90 offset:4608
v_accvgpr_write_b32 a139, v12
v_mfma_f32_16x16x32_bf16 a[112:115], a[160:163], a[152:155], a[112:115]
s_add_u32 s80, s89, 768
v_accvgpr_write_b32 a252, -1
v_accvgpr_write_b32 a253, -1
v_mfma_f32_16x16x32_bf16 a[112:115], a[132:135], a[84:87], a[112:115]
v_accvgpr_write_b32 a254, -1
v_accvgpr_write_b32 a255, -1
v_mfma_f32_16x16x32_bf16 a[116:119], a[132:135], a[36:39], a[116:119]
v_mov_b32 v12, 0xf149f2ca
v_mov_b32 v232, 0
v_mfma_f32_16x16x32_bf16 a[116:119], a[160:163], a[140:143], a[116:119]
s_waitcnt lgkmcnt(4)
ds_read_b64_tr_b16 a[12:13], v91 offset:0
v_mov_b32 v233, 0
v_mfma_f32_16x16x32_bf16 a[124:127], a[80:83], a[4:7], a[124:127]
buffer_load_dwordx4 v80, s[16:19], s80 offen lds
v_mfma_f32_16x16x32_bf16 a[124:127], a[156:159], a[28:31], a[124:127]
s_add_u32 m0, s84, 99328
ds_read_b64_tr_b16 a[14:15], v91 offset:512
v_mov_b32 v234, 0
v_mfma_f32_16x16x32_bf16 a[128:131], a[156:159], a[76:79], a[128:131]
s_add_u32 s80, s89, 8960
ds_read_b64_tr_b16 a[132:133], v91 offset:4096
v_mov_b32 v235, 0
v_mfma_f32_16x16x32_bf16 a[128:131], a[80:83], a[16:19], a[128:131]
ds_read_b64_tr_b16 a[134:135], v91 offset:4608
v_mov_b32 v236, 0
v_mfma_f32_16x16x32_bf16 a[8:11], a[80:83], a[152:155], a[8:11]
v_mov_b32 v237, 0
v_mov_b32 v238, 0
v_mfma_f32_16x16x32_bf16 a[8:11], a[156:159], a[84:87], a[8:11]
v_mov_b32 v239, 0
v_mov_b32 v240, 0
v_mfma_f32_16x16x32_bf16 a[68:71], a[156:159], a[36:39], a[68:71]
buffer_load_dwordx4 v81, s[16:19], s80 offen lds
v_mfma_f32_16x16x32_bf16 a[68:71], a[80:83], a[140:143], a[68:71]
s_waitcnt lgkmcnt(4)
ds_read_b64_tr_b16 a[160:161], v88 offset:8192
v_mov_b32 v241, 0
v_mfma_f32_16x16x32_bf16 a[164:167], a[144:147], a[4:7], a[164:167]
s_add_u32 m0, s84, 100352
ds_read_b64_tr_b16 a[162:163], v88 offset:8704
v_mov_b32 v242, 0
v_mfma_f32_16x16x32_bf16 a[164:167], a[0:3], a[28:31], a[164:167]
s_add_u32 s80, s89, 17152
ds_read_b64_tr_b16 a[156:157], v88 offset:12288
v_mov_b32 v243, 0
v_mfma_f32_16x16x32_bf16 a[40:43], a[0:3], a[76:79], a[40:43]
ds_read_b64_tr_b16 a[158:159], v88 offset:12800
v_mov_b32 v244, 0
v_mfma_f32_16x16x32_bf16 a[40:43], a[144:147], a[16:19], a[40:43]
v_mov_b32 v245, 0
v_mov_b32 v246, 0
v_mfma_f32_16x16x32_bf16 a[184:187], a[144:147], a[152:155], a[184:187]
buffer_load_dwordx4 v80, s[16:19], s80 offen lds
v_mfma_f32_16x16x32_bf16 a[184:187], a[0:3], a[84:87], a[184:187]
s_add_u32 m0, s84, 101376
buffer_store_dwordx4 v[252:255], v1, s[28:31], s95 offen offset:3072
v_mov_b32 v247, 0
v_cndmask_b32 v248, v240, v12, s[8:9]
v_cndmask_b32 v249, v241, v12, s[10:11]
v_mfma_f32_16x16x32_bf16 a[192:195], a[0:3], a[36:39], a[192:195]
s_add_u32 s80, s89, 25344
v_cndmask_b32 v250, v242, v12, s[12:13]
v_cndmask_b32 v251, v243, v12, s[14:15]
v_mfma_f32_16x16x32_bf16 a[192:195], a[144:147], a[140:143], a[192:195]
s_waitcnt lgkmcnt(4)
ds_read_b64_tr_b16 a[64:65], v89 offset:8192
v_cndmask_b32 v252, v244, v12, s[8:9]
v_mfma_f32_16x16x32_bf16 a[212:215], a[12:15], a[4:7], a[212:215]
s_add_u32 s81, s96, 4096
ds_read_b64_tr_b16 a[66:67], v89 offset:8704
v_cndmask_b32 v253, v245, v12, s[10:11]
v_mfma_f32_16x16x32_bf16 a[212:215], a[132:135], a[28:31], a[212:215]
ds_read_b64_tr_b16 a[0:1], v89 offset:12288
v_cndmask_b32 v254, v246, v12, s[12:13]
v_mfma_f32_16x16x32_bf16 a[48:51], a[132:135], a[76:79], a[48:51]
buffer_load_dwordx4 v81, s[16:19], s80 offen lds
v_mfma_f32_16x16x32_bf16 a[48:51], a[12:15], a[16:19], a[48:51]
s_add_u32 m0, s84, 102400
ds_read_b64_tr_b16 a[2:3], v89 offset:12800
v_cndmask_b32 v255, v247, v12, s[14:15]
v_mfma_f32_16x16x32_bf16 a[56:59], a[12:15], a[152:155], a[56:59]
s_add_u32 s80, s90, 768
v_mov_b32 v112, 0
v_mov_b32 v113, 0
v_mfma_f32_16x16x32_bf16 a[56:59], a[132:135], a[84:87], a[56:59]
v_mov_b32 v114, 0
v_mov_b32 v115, 0
v_mfma_f32_16x16x32_bf16 a[220:223], a[132:135], a[36:39], a[220:223]
v_mov_b32 v116, 0
v_mov_b32 v117, 0
v_mfma_f32_16x16x32_bf16 a[220:223], a[12:15], a[140:143], a[220:223]
s_waitcnt lgkmcnt(4)
ds_read_b64_tr_b16 a[144:145], v90 offset:8192
v_mov_b32 v118, 0
v_mfma_f32_16x16x32_bf16 v[16:19], a[160:163], a[4:7], v[16:19]
buffer_load_dwordx4 v80, s[16:19], s80 offen lds
v_mfma_f32_16x16x32_bf16 v[16:19], a[156:159], a[28:31], v[16:19]
s_add_u32 m0, s84, 103424
ds_read_b64_tr_b16 a[146:147], v90 offset:8704
v_mov_b32 v119, 0
v_mfma_f32_16x16x32_bf16 v[32:35], a[156:159], a[76:79], v[32:35]
s_add_u32 s80, s90, 8960
ds_read_b64_tr_b16 a[132:133], v90 offset:12288
v_mov_b32 v120, 0
v_mfma_f32_16x16x32_bf16 v[32:35], a[160:163], a[16:19], v[32:35]
ds_read_b64_tr_b16 a[134:135], v90 offset:12800
v_mov_b32 v121, 0
v_mfma_f32_16x16x32_bf16 v[48:51], a[160:163], a[152:155], v[48:51]
v_mov_b32 v122, 0
v_mov_b32 v123, 0
v_mfma_f32_16x16x32_bf16 v[48:51], a[156:159], a[84:87], v[48:51]
v_mov_b32 v124, 0
v_mov_b32 v125, 0
v_mfma_f32_16x16x32_bf16 v[64:67], a[156:159], a[36:39], v[64:67]
buffer_load_dwordx4 v81, s[16:19], s80 offen lds
v_mfma_f32_16x16x32_bf16 v[64:67], a[160:163], a[140:143], v[64:67]
s_waitcnt lgkmcnt(4)
ds_read_b64_tr_b16 a[12:13], v91 offset:8192
v_mov_b32 v126, 0
v_mfma_f32_16x16x32_bf16 v[100:103], a[64:67], a[4:7], v[100:103]
s_add_u32 m0, s84, 104448
ds_read_b64_tr_b16 a[14:15], v91 offset:8704
v_mov_b32 v127, 0
v_mfma_f32_16x16x32_bf16 v[100:103], a[0:3], a[28:31], v[100:103]
s_add_u32 s80, s90, 17152
ds_read_b64_tr_b16 a[156:157], v91 offset:12288
v_mov_b32 v128, 0
v_mfma_f32_16x16x32_bf16 v[152:155], a[0:3], a[76:79], v[152:155]
buffer_store_dwordx4 v[104:107], v1, s[28:31], s81 offen
ds_read_b64_tr_b16 a[158:159], v91 offset:12800
v_mov_b32 v129, 0
v_mov_b32 v130, 0
v_mfma_f32_16x16x32_bf16 v[152:155], a[64:67], a[16:19], v[152:155]
s_waitcnt vmcnt(24)
ds_read_b128 a[160:163], v92 offset:0
v_mov_b32 v131, 0
v_mfma_f32_16x16x32_bf16 v[156:159], a[64:67], a[152:155], v[156:159]
buffer_load_dwordx4 v80, s[16:19], s80 offen lds
v_mfma_f32_16x16x32_bf16 v[156:159], a[0:3], a[84:87], v[156:159]
s_add_u32 m0, s84, 105472
ds_read_b128 a[72:75], v93 offset:0
v_mov_b32 v132, 0
v_mfma_f32_16x16x32_bf16 v[160:163], a[0:3], a[36:39], v[160:163]
s_add_u32 s80, s90, 25344
v_mov_b32 v133, 0
v_mov_b32 v134, 0
v_mfma_f32_16x16x32_bf16 v[160:163], a[64:67], a[140:143], v[160:163]
s_waitcnt lgkmcnt(6)
ds_read_b64_tr_b16 a[80:81], v88 offset:16384
v_mov_b32 v135, 0
v_mfma_f32_16x16x32_bf16 v[20:23], a[144:147], a[4:7], v[20:23]
ds_read_b64_tr_b16 a[82:83], v88 offset:16896
v_mov_b32 v136, 0
v_mfma_f32_16x16x32_bf16 v[20:23], a[132:135], a[28:31], v[20:23]
ds_read_b64_tr_b16 a[0:1], v88 offset:20480
v_mov_b32 v137, 0
v_mfma_f32_16x16x32_bf16 v[36:39], a[132:135], a[76:79], v[36:39]
buffer_load_dwordx4 v81, s[16:19], s80 offen lds
v_mfma_f32_16x16x32_bf16 v[36:39], a[144:147], a[16:19], v[36:39]
s_add_u32 m0, s84, 131072
ds_read_b64_tr_b16 a[2:3], v88 offset:20992
v_mov_b32 v138, 0
v_mfma_f32_16x16x32_bf16 v[52:55], a[144:147], a[152:155], v[52:55]
s_waitcnt vmcnt(24)
s_add_u32 s80, s89, 896
ds_read_b128 a[64:67], v92 offset:2048
v_mfma_f32_16x16x32_bf16 v[52:55], a[132:135], a[84:87], v[52:55]
ds_read_b128 a[92:95], v93 offset:2048
v_mov_b32 v139, 0
v_mfma_f32_16x16x32_bf16 v[68:71], a[132:135], a[36:39], v[68:71]
v_mov_b32 v140, 0
v_mov_b32 v141, 0
v_mfma_f32_16x16x32_bf16 v[68:71], a[144:147], a[140:143], v[68:71]
s_waitcnt lgkmcnt(6)
ds_read_b64_tr_b16 a[32:33], v89 offset:16384
v_mov_b32 v142, 0
v_mfma_f32_16x16x32_bf16 v[164:167], a[12:15], a[4:7], v[164:167]
buffer_load_dwordx4 v80, s[16:19], s80 offen lds
v_mfma_f32_16x16x32_bf16 v[164:167], a[156:159], a[28:31], v[164:167]
s_add_u32 m0, s84, 132096
ds_read_b64_tr_b16 a[34:35], v89 offset:16896
v_mov_b32 v143, 0
v_mfma_f32_16x16x32_bf16 v[168:171], a[156:159], a[76:79], v[168:171]
s_add_u32 s80, s89, 9088
ds_read_b64_tr_b16 a[144:145], v89 offset:20480
v_accvgpr_write_b32 a132, 0
v_mfma_f32_16x16x32_bf16 v[168:171], a[12:15], a[16:19], v[168:171]
ds_read_b64_tr_b16 a[146:147], v89 offset:20992
v_accvgpr_write_b32 a133, 0
v_mfma_f32_16x16x32_bf16 v[172:175], a[12:15], a[152:155], v[172:175]
s_waitcnt vmcnt(22)
ds_read_b128 a[44:47], v92 offset:4096
v_accvgpr_write_b32 a134, 0
v_mfma_f32_16x16x32_bf16 v[172:175], a[156:159], a[84:87], v[172:175]
ds_read_b128 a[60:63], v93 offset:4096
v_accvgpr_write_b32 a135, 0
v_mfma_f32_16x16x32_bf16 v[176:179], a[156:159], a[36:39], v[176:179]
buffer_load_dwordx4 v81, s[16:19], s80 offen lds
v_mfma_f32_16x16x32_bf16 v[176:179], a[12:15], a[140:143], v[176:179]
s_waitcnt lgkmcnt(6)
s_add_u32 m0, s84, 133120
ds_read_b64_tr_b16 a[96:97], v90 offset:16384
v_mfma_f32_16x16x32_bf16 v[24:27], a[80:83], a[4:7], v[24:27]
s_add_u32 s80, s89, 17280
buffer_store_dwordx4 v[108:111], v1, s[28:31], s81 offen offset:1024
ds_read_b64_tr_b16 a[98:99], v90 offset:16896
v_mfma_f32_16x16x32_bf16 v[24:27], a[0:3], a[28:31], v[24:27]
ds_read_b64_tr_b16 a[156:157], v90 offset:20480
v_mfma_f32_16x16x32_bf16 v[40:43], a[0:3], a[76:79], v[40:43]
ds_read_b64_tr_b16 a[158:159], v90 offset:20992
v_mfma_f32_16x16x32_bf16 v[40:43], a[80:83], a[16:19], v[40:43]
s_waitcnt vmcnt(22)
ds_read_b128 a[12:15], v92 offset:6144
v_mfma_f32_16x16x32_bf16 v[56:59], a[80:83], a[152:155], v[56:59]
buffer_load_dwordx4 v80, s[16:19], s80 offen lds
v_mfma_f32_16x16x32_bf16 v[56:59], a[0:3], a[84:87], v[56:59]
s_add_u32 m0, s84, 134144
s_add_u32 s80, s89, 25472
ds_read_b128 a[104:107], v93 offset:6144
v_mfma_f32_16x16x32_bf16 v[72:75], a[0:3], a[36:39], v[72:75]
v_mfma_f32_16x16x32_bf16 v[72:75], a[80:83], a[140:143], v[72:75]
s_waitcnt lgkmcnt(6)
ds_read_b64_tr_b16 a[108:109], v91 offset:16384
v_mfma_f32_16x16x32_bf16 v[180:183], a[32:35], a[4:7], v[180:183]
ds_read_b64_tr_b16 a[110:111], v91 offset:16896
v_mfma_f32_16x16x32_bf16 v[180:183], a[144:147], a[28:31], v[180:183]
ds_read_b64_tr_b16 a[120:121], v91 offset:20480
v_mfma_f32_16x16x32_bf16 v[184:187], a[144:147], a[76:79], v[184:187]
buffer_load_dwordx4 v81, s[16:19], s80 offen lds
v_mfma_f32_16x16x32_bf16 v[184:187], a[32:35], a[16:19], v[184:187]
s_add_u32 m0, s84, 135168
s_add_u32 s80, s90, 896
ds_read_b64_tr_b16 a[122:123], v91 offset:20992
v_mfma_f32_16x16x32_bf16 v[188:191], a[32:35], a[152:155], v[188:191]
v_mfma_f32_16x16x32_bf16 v[188:191], a[144:147], a[84:87], v[188:191]
s_waitcnt vmcnt(15)
v_mfma_f32_16x16x32_bf16 v[192:195], a[144:147], a[36:39], v[192:195]
s_barrier
v_mfma_f32_16x16x32_bf16 v[192:195], a[32:35], a[140:143], v[192:195]
s_waitcnt lgkmcnt(4)
ds_read_b64_tr_b16 a[0:1], v88 offset:24576
v_mfma_f32_16x16x32_bf16 v[28:31], a[96:99], a[4:7], v[28:31]
buffer_load_dwordx4 v80, s[16:19], s80 offen lds
v_mfma_f32_16x16x32_bf16 v[28:31], a[156:159], a[28:31], v[28:31]
s_add_u32 m0, s84, 136192
s_add_u32 s80, s90, 9088
ds_read_b64_tr_b16 a[2:3], v88 offset:25088
v_mfma_f32_16x16x32_bf16 v[44:47], a[156:159], a[76:79], v[44:47]
ds_read_b64_tr_b16 a[144:145], v88 offset:28672
v_mfma_f32_16x16x32_bf16 v[44:47], a[96:99], a[16:19], v[44:47]
ds_read_b64_tr_b16 a[146:147], v88 offset:29184
v_mfma_f32_16x16x32_bf16 v[60:63], a[96:99], a[152:155], v[60:63]
v_mfma_f32_16x16x32_bf16 v[60:63], a[156:159], a[84:87], v[60:63]
buffer_store_dwordx4 v[144:147], v1, s[28:31], s81 offen offset:2048
v_mfma_f32_16x16x32_bf16 v[76:79], a[156:159], a[36:39], v[76:79]
v_mfma_f32_16x16x32_bf16 v[76:79], a[96:99], a[140:143], v[76:79]
s_waitcnt lgkmcnt(4)
buffer_load_dwordx4 v81, s[16:19], s80 offen lds
v_mfma_f32_16x16x32_bf16 v[196:199], a[108:111], a[4:7], v[196:199]
s_add_u32 m0, s84, 137216
ds_read_b64_tr_b16 a[80:81], v89 offset:24576
v_accvgpr_read_b32 v96, a196
v_mfma_f32_16x16x32_bf16 v[196:199], a[120:123], a[28:31], v[196:199]
s_add_u32 s80, s90, 17280
ds_read_b64_tr_b16 a[82:83], v89 offset:25088
v_accvgpr_read_b32 v97, a197
v_mfma_f32_16x16x32_bf16 v[200:203], a[120:123], a[76:79], v[200:203]
ds_read_b64_tr_b16 a[156:157], v89 offset:28672
v_accvgpr_read_b32 v98, a198
v_mfma_f32_16x16x32_bf16 v[200:203], a[108:111], a[16:19], v[200:203]
ds_read_b64_tr_b16 a[158:159], v89 offset:29184
v_accvgpr_read_b32 v99, a199
v_mfma_f32_16x16x32_bf16 v[204:207], a[108:111], a[152:155], v[204:207]
v_accvgpr_read_b32 v104, a204
v_accvgpr_read_b32 v105, a205
v_mfma_f32_16x16x32_bf16 v[204:207], a[120:123], a[84:87], v[204:207]
buffer_load_dwordx4 v80, s[16:19], s80 offen lds
v_mfma_f32_16x16x32_bf16 v[208:211], a[120:123], a[36:39], v[208:211]
s_add_u32 m0, s84, 138240
v_accvgpr_read_b32 v106, a206
v_accvgpr_read_b32 v107, a207
v_mfma_f32_16x16x32_bf16 v[208:211], a[108:111], a[140:143], v[208:211]
s_waitcnt lgkmcnt(4)
ds_read_b64_tr_b16 a[152:153], v90 offset:24576
v_mul_f32 v96, s85, v96
v_mfma_f32_16x16x32_bf16 a[20:23], a[0:3], a[160:163], a[20:23]
s_add_u32 s80, s90, 25472
buffer_load_dword v8, v14, s[28:31], s101 offen sc1
v_mfma_f32_16x16x32_bf16 a[20:23], a[144:147], a[72:75], a[20:23]
ds_read_b64_tr_b16 a[154:155], v90 offset:25088
v_mul_f32 v97, s85, v97
v_mfma_f32_16x16x32_bf16 a[100:103], a[144:147], a[92:95], a[100:103]
ds_read_b64_tr_b16 a[140:141], v90 offset:28672
v_mul_f32 v98, s85, v98
v_mfma_f32_16x16x32_bf16 a[100:103], a[0:3], a[64:67], a[100:103]
buffer_load_dwordx4 v81, s[16:19], s80 offen lds
v_mfma_f32_16x16x32_bf16 a[112:115], a[0:3], a[44:47], a[112:115]
s_add_u32 m0, s83, 49152
ds_read_b64_tr_b16 a[142:143], v90 offset:29184
v_mul_f32 v99, s85, v99
v_mfma_f32_16x16x32_bf16 a[112:115], a[144:147], a[60:63], a[112:115]
s_add_u32 s80, s92, 1376256
v_mul_f32 v104, s85, v104
v_mul_f32 v105, s85, v105
v_mfma_f32_16x16x32_bf16 a[116:119], a[144:147], a[104:107], a[116:119]
v_mul_f32 v106, s85, v106
v_mul_f32 v107, s85, v107
v_mfma_f32_16x16x32_bf16 a[116:119], a[0:3], a[12:15], a[116:119]
s_waitcnt lgkmcnt(4)
ds_read_b64_tr_b16 a[4:5], v91 offset:24576
v_cvt_pk_bf16_f32 v96, v96, v97
v_mfma_f32_16x16x32_bf16 a[124:127], a[80:83], a[160:163], a[124:127]
ds_read_b64_tr_b16 a[6:7], v91 offset:25088
v_cvt_pk_bf16_f32 v97, v98, v99
v_mfma_f32_16x16x32_bf16 a[124:127], a[156:159], a[72:75], a[124:127]
buffer_load_dwordx4 v84, s[24:27], s80 offen lds
v_mfma_f32_16x16x32_bf16 a[128:131], a[156:159], a[92:95], a[128:131]
s_add_u32 m0, s83, 50176
buffer_store_dwordx4 v[148:151], v1, s[28:31], s81 offen offset:3072
ds_read_b64_tr_b16 a[144:145], v91 offset:28672
v_cvt_pk_bf16_f32 v98, v104, v105
v_cvt_pk_bf16_f32 v99, v106, v107
v_mfma_f32_16x16x32_bf16 a[128:131], a[80:83], a[64:67], a[128:131]
s_add_u32 s80, s92, 1404928
ds_read_b64_tr_b16 a[146:147], v91 offset:29184
v_mfma_f32_16x16x32_bf16 a[8:11], a[80:83], a[44:47], a[8:11]
v_mfma_f32_16x16x32_bf16 a[8:11], a[156:159], a[60:63], a[8:11]
v_accvgpr_read_b32 v108, a208
v_accvgpr_read_b32 v109, a209
v_mfma_f32_16x16x32_bf16 a[68:71], a[156:159], a[104:107], a[68:71]
v_accvgpr_read_b32 v110, a210
v_accvgpr_read_b32 v111, a211
v_mfma_f32_16x16x32_bf16 a[68:71], a[80:83], a[12:15], a[68:71]
s_waitcnt lgkmcnt(4)
buffer_load_dwordx4 v85, s[24:27], s80 offen lds
v_mfma_f32_16x16x32_bf16 a[164:167], a[152:155], a[160:163], a[164:167]
s_add_u32 m0, s83, 57344
ds_read_b64_tr_b16 a[0:1], v88 offset:32768
v_accvgpr_read_b32 v104, a216
v_mfma_f32_16x16x32_bf16 a[164:167], a[140:143], a[72:75], a[164:167]
s_add_u32 s80, s92, 1605632
ds_read_b64_tr_b16 a[2:3], v88 offset:33280
v_accvgpr_read_b32 v105, a217
v_mfma_f32_16x16x32_bf16 a[40:43], a[140:143], a[92:95], a[40:43]
ds_read_b64_tr_b16 a[156:157], v88 offset:36864
v_accvgpr_read_b32 v106, a218
v_mfma_f32_16x16x32_bf16 a[40:43], a[152:155], a[64:67], a[40:43]
ds_read_b64_tr_b16 a[158:159], v88 offset:37376
v_accvgpr_read_b32 v107, a219
v_mfma_f32_16x16x32_bf16 a[184:187], a[152:155], a[44:47], a[184:187]
s_waitcnt vmcnt(22)
ds_read_b128 a[32:35], v92 offset:32768
v_mul_f32 v108, s85, v108
v_mfma_f32_16x16x32_bf16 a[184:187], a[140:143], a[60:63], a[184:187]
buffer_load_dwordx4 v84, s[24:27], s80 offen lds
v_mfma_f32_16x16x32_bf16 a[192:195], a[140:143], a[104:107], a[192:195]
s_add_u32 m0, s83, 58368
ds_read_b128 a[36:39], v93 offset:32768
v_mul_f32 v109, s85, v109
v_mfma_f32_16x16x32_bf16 a[192:195], a[152:155], a[12:15], a[192:195]
s_waitcnt lgkmcnt(6)
ds_read_b64_tr_b16 a[16:17], v89 offset:32768
v_mul_f32 v110, s85, v110
v_mfma_f32_16x16x32_bf16 a[212:215], a[4:7], a[160:163], a[212:215]
s_add_u32 s80, s92, 1634304
ds_read_b64_tr_b16 a[18:19], v89 offset:33280
v_mul_f32 v111, s85, v111
v_mfma_f32_16x16x32_bf16 a[212:215], a[144:147], a[72:75], a[212:215]
ds_read_b64_tr_b16 a[140:141], v89 offset:36864
v_mul_f32 v104, s85, v104
v_mfma_f32_16x16x32_bf16 a[48:51], a[144:147], a[92:95], a[48:51]
ds_read_b64_tr_b16 a[142:143], v89 offset:37376
v_mul_f32 v105, s85, v105
v_mfma_f32_16x16x32_bf16 a[48:51], a[4:7], a[64:67], a[48:51]
buffer_load_dwordx4 v85, s[24:27], s80 offen lds
v_mfma_f32_16x16x32_bf16 a[56:59], a[4:7], a[44:47], a[56:59]
s_waitcnt vmcnt(21)
s_add_u32 m0, s83, 0
ds_read_b128 a[96:99], v92 offset:34816
v_mfma_f32_16x16x32_bf16 a[56:59], a[144:147], a[60:63], a[56:59]
s_add_u32 s80, s91, 3145728
ds_read_b128 a[108:111], v93 offset:34816
v_mul_f32 v106, s85, v106
v_mfma_f32_16x16x32_bf16 a[220:223], a[144:147], a[104:107], a[220:223]
s_waitcnt vmcnt(19)
ds_read_b128 a[120:123], v92 offset:36864
v_mul_f32 v107, s85, v107
v_mfma_f32_16x16x32_bf16 a[220:223], a[4:7], a[12:15], a[220:223]
s_waitcnt lgkmcnt(7)
ds_read_b64_tr_b16 a[152:153], v90 offset:32768
v_cvt_pk_bf16_f32 v108, v108, v109
v_mfma_f32_16x16x32_bf16 v[16:19], a[0:3], a[160:163], v[16:19]
buffer_store_dwordx4 v[96:99], v1, s[28:31], s96 offen
ds_read_b64_tr_b16 a[154:155], v90 offset:33280
v_cvt_pk_bf16_f32 v109, v110, v111
v_cvt_pk_bf16_f32 v110, v104, v105
v_mfma_f32_16x16x32_bf16 v[16:19], a[156:159], a[72:75], v[16:19]
ds_read_b64_tr_b16 a[144:145], v90 offset:36864
v_cvt_pk_bf16_f32 v111, v106, v107
v_mfma_f32_16x16x32_bf16 v[32:35], a[156:159], a[92:95], v[32:35]
buffer_load_dwordx4 v82, s[20:23], s80 offen lds
v_mfma_f32_16x16x32_bf16 v[32:35], a[0:3], a[64:67], v[32:35]
s_add_u32 m0, s83, 1024
ds_read_b64_tr_b16 a[146:147], v90 offset:37376
v_accvgpr_read_b32 v84, a148
v_mfma_f32_16x16x32_bf16 v[48:51], a[0:3], a[44:47], v[48:51]
s_add_u32 s80, s91, 3211264
ds_read_b128 a[168:171], v93 offset:36864
v_accvgpr_read_b32 v85, a149
v_mfma_f32_16x16x32_bf16 v[48:51], a[156:159], a[60:63], v[48:51]
s_waitcnt vmcnt(18)
ds_read_b128 a[172:175], v92 offset:38912
v_accvgpr_read_b32 v86, a150
v_mfma_f32_16x16x32_bf16 v[64:67], a[156:159], a[104:107], v[64:67]
ds_read_b128 a[176:179], v93 offset:38912
v_accvgpr_read_b32 v87, a151
v_mfma_f32_16x16x32_bf16 v[64:67], a[0:3], a[12:15], v[64:67]
s_waitcnt lgkmcnt(7)
ds_read_b64_tr_b16 a[4:5], v91 offset:32768
v_accvgpr_read_b32 v96, a24
v_mfma_f32_16x16x32_bf16 v[100:103], a[16:19], a[160:163], v[100:103]
buffer_load_dwordx4 v83, s[20:23], s80 offen lds
v_mfma_f32_16x16x32_bf16 v[100:103], a[140:143], a[72:75], v[100:103]
s_add_u32 m0, s83, 8192
ds_read_b64_tr_b16 a[6:7], v91 offset:33280
v_accvgpr_read_b32 v97, a25
v_mfma_f32_16x16x32_bf16 v[152:155], a[140:143], a[92:95], v[152:155]
s_add_u32 s80, s91, 3670016
ds_read_b64_tr_b16 a[148:149], v91 offset:36864
v_accvgpr_read_b32 v98, a26
v_mfma_f32_16x16x32_bf16 v[152:155], a[16:19], a[64:67], v[152:155]
ds_read_b64_tr_b16 a[150:151], v91 offset:37376
v_accvgpr_read_b32 v99, a27
v_mfma_f32_16x16x32_bf16 v[156:159], a[16:19], a[44:47], v[156:159]
v_mul_f32 v84, s85, v84
v_mul_f32 v85, s85, v85
v_mfma_f32_16x16x32_bf16 v[156:159], a[140:143], a[60:63], v[156:159]
v_mul_f32 v86, s85, v86
v_mul_f32 v87, s85, v87
v_mfma_f32_16x16x32_bf16 v[160:163], a[140:143], a[104:107], v[160:163]
buffer_load_dwordx4 v82, s[20:23], s80 offen lds
v_mfma_f32_16x16x32_bf16 v[160:163], a[16:19], a[12:15], v[160:163]
s_waitcnt lgkmcnt(4)
ds_read_b64_tr_b16 a[0:1], v88 offset:40960
v_mul_f32 v96, s85, v96
v_mfma_f32_16x16x32_bf16 v[20:23], a[152:155], a[160:163], v[20:23]
s_add_u32 m0, s83, 9216
ds_read_b64_tr_b16 a[2:3], v88 offset:41472
v_mul_f32 v97, s85, v97
v_mfma_f32_16x16x32_bf16 v[20:23], a[144:147], a[72:75], v[20:23]
s_add_u32 s80, s91, 3735552
ds_read_b64_tr_b16 a[140:141], v88 offset:45056
v_mul_f32 v98, s85, v98
v_mfma_f32_16x16x32_bf16 v[36:39], a[144:147], a[92:95], v[36:39]
ds_read_b64_tr_b16 a[142:143], v88 offset:45568
v_mul_f32 v99, s85, v99
v_mfma_f32_16x16x32_bf16 v[36:39], a[152:155], a[64:67], v[36:39]
s_waitcnt vmcnt(18)
ds_read_b128 a[180:183], v94 offset:0
v_cvt_pk_bf16_f32 v84, v84, v85
v_mfma_f32_16x16x32_bf16 v[52:55], a[152:155], a[44:47], v[52:55]
buffer_load_dwordx4 v83, s[20:23], s80 offen lds
v_mfma_f32_16x16x32_bf16 v[52:55], a[144:147], a[60:63], v[52:55]
s_add_u32 m0, s83, 16384
buffer_store_dwordx4 v[108:111], v1, s[28:31], s96 offen offset:1024
ds_read_b128 a[188:191], v95 offset:0
v_cvt_pk_bf16_f32 v85, v86, v87
v_cvt_pk_bf16_f32 v86, v96, v97
v_mfma_f32_16x16x32_bf16 v[68:71], a[144:147], a[104:107], v[68:71]
s_waitcnt vmcnt(17)
s_add_u32 s80, s91, 3145856
ds_read_b128 a[196:199], v94 offset:2048
v_mfma_f32_16x16x32_bf16 v[68:71], a[152:155], a[12:15], v[68:71]
s_waitcnt lgkmcnt(7)
ds_read_b64_tr_b16 a[156:157], v89 offset:40960
v_cvt_pk_bf16_f32 v87, v98, v99
v_mfma_f32_16x16x32_bf16 v[164:167], a[4:7], a[160:163], v[164:167]
ds_read_b64_tr_b16 a[158:159], v89 offset:41472
v_accvgpr_read_b32 v104, a52
v_mfma_f32_16x16x32_bf16 v[164:167], a[148:151], a[72:75], v[164:167]
ds_read_b64_tr_b16 a[144:145], v89 offset:45056
v_accvgpr_read_b32 v105, a53
v_mfma_f32_16x16x32_bf16 v[168:171], a[148:151], a[92:95], v[168:171]
ds_read_b64_tr_b16 a[146:147], v89 offset:45568
v_accvgpr_read_b32 v106, a54
v_mfma_f32_16x16x32_bf16 v[168:171], a[4:7], a[64:67], v[168:171]
L_pad7:
s_cbranch_execz L_pad11
ds_read_b128 a[200:203], v95 offset:2048
v_accvgpr_read_b32 v107, a55
v_mfma_f32_16x16x32_bf16 v[172:175], a[4:7], a[44:47], v[172:175]
s_waitcnt vmcnt(14)
ds_read_b128 a[204:207], v94 offset:4096
v_accvgpr_read_b32 v96, a88
v_mfma_f32_16x16x32_bf16 v[172:175], a[148:151], a[60:63], v[172:175]
v_accvgpr_read_b32 v97, a89
v_accvgpr_read_b32 v98, a90
v_mfma_f32_16x16x32_bf16 v[176:179], a[148:151], a[104:107], v[176:179]
v_accvgpr_read_b32 v99, a91
v_mul_f32 v104, s85, v104
v_mfma_f32_16x16x32_bf16 v[176:179], a[4:7], a[12:15], v[176:179]
s_waitcnt lgkmcnt(6)
ds_read_b64_tr_b16 a[152:153], v90 offset:40960
v_mul_f32 v105, s85, v105
v_mfma_f32_16x16x32_bf16 v[24:27], a[0:3], a[160:163], v[24:27]
ds_read_b64_tr_b16 a[154:155], v90 offset:41472
v_mul_f32 v106, s85, v106
v_mfma_f32_16x16x32_bf16 v[24:27], a[140:143], a[72:75], v[24:27]
ds_read_b64_tr_b16 a[148:149], v90 offset:45056
v_mul_f32 v107, s85, v107
v_mfma_f32_16x16x32_bf16 v[40:43], a[140:143], a[92:95], v[40:43]
ds_read_b64_tr_b16 a[150:151], v90 offset:45568
v_mul_f32 v96, s85, v96
v_mfma_f32_16x16x32_bf16 v[40:43], a[0:3], a[64:67], v[40:43]
ds_read_b128 a[52:55], v95 offset:4096
v_mul_f32 v97, s85, v97
v_mfma_f32_16x16x32_bf16 v[56:59], a[0:3], a[44:47], v[56:59]
s_waitcnt vmcnt(11)
ds_read_b128 a[208:211], v94 offset:6144
v_mul_f32 v98, s85, v98
v_mfma_f32_16x16x32_bf16 v[56:59], a[140:143], a[60:63], v[56:59]
ds_read_b128 a[216:219], v95 offset:6144
v_mul_f32 v99, s85, v99
v_mfma_f32_16x16x32_bf16 v[72:75], a[140:143], a[104:107], v[72:75]
v_cmp_gt_u32 vcc, 1, v8
s_nop 0
s_cbranch_vccnz L_spin2
L_back2:
v_mfma_f32_16x16x32_bf16 v[72:75], a[0:3], a[12:15], v[72:75]
s_waitcnt lgkmcnt(7)
ds_read_b64_tr_b16 a[4:5], v91 offset:40960
v_cvt_pk_bf16_f32 v104, v104, v105
v_mfma_f32_16x16x32_bf16 v[180:183], a[156:159], a[160:163], v[180:183]
s_mul_i32 s101, s70, 32
ds_read_b64_tr_b16 a[6:7], v91 offset:41472
v_cvt_pk_bf16_f32 v105, v106, v107
v_mfma_f32_16x16x32_bf16 v[180:183], a[144:147], a[72:75], v[180:183]
s_add_u32 s101, s101, 5120
ds_read_b64_tr_b16 a[140:141], v91 offset:45056
v_cvt_pk_bf16_f32 v106, v96, v97
v_mfma_f32_16x16x32_bf16 v[184:187], a[144:147], a[92:95], v[184:187]
buffer_store_dwordx4 v[84:87], v1, s[28:31], s96 offen offset:2048
ds_read_b64_tr_b16 a[142:143], v91 offset:45568
v_cvt_pk_bf16_f32 v107, v98, v99
v_and_b32 v4, 31, v0
v_mfma_f32_16x16x32_bf16 v[184:187], a[156:159], a[64:67], v[184:187]
v_min_u32 v6, 31, v4
v_add_u32 v6, s101, v6
v_mfma_f32_16x16x32_bf16 v[188:191], a[156:159], a[44:47], v[188:191]
v_lshl_add_u32 v6, s71, 8, v6
v_lshl_add_u32 v4, s4, 5, v4
v_mfma_f32_16x16x32_bf16 v[188:191], a[144:147], a[60:63], v[188:191]
s_waitcnt vmcnt(7)
s_mov_b32 s72, 0
s_mov_b32 s73, -1
v_mfma_f32_16x16x32_bf16 v[192:195], a[144:147], a[104:107], v[192:195]
s_barrier
v_mfma_f32_16x16x32_bf16 v[192:195], a[156:159], a[12:15], v[192:195]
s_waitcnt lgkmcnt(4)
buffer_load_dwordx4 v82, s[20:23], s80 offen lds
v_mfma_f32_16x16x32_bf16 v[28:31], a[152:155], a[160:163], v[28:31]
s_add_u32 m0, s83, 17408
ds_read_b64_tr_b16 a[0:1], v88 offset:49152
v_cndmask_b32 v4, v4, v6, s[72:73]
v_mfma_f32_16x16x32_bf16 v[28:31], a[148:151], a[72:75], v[28:31]
s_add_u32 s80, s91, 3211392
ds_read_b64_tr_b16 a[2:3], v88 offset:49664
v_lshlrev_b32 v10, 2, v4
v_mfma_f32_16x16x32_bf16 v[44:47], a[148:151], a[92:95], v[44:47]
ds_read_b64_tr_b16 a[144:145], v88 offset:53248
v_min_u32 v9, 13, v0
v_mfma_f32_16x16x32_bf16 v[44:47], a[152:155], a[64:67], v[44:47]
ds_read_b64_tr_b16 a[146:147], v88 offset:53760
v_lshlrev_b32 v9, 2, v9
v_mfma_f32_16x16x32_bf16 v[60:63], a[152:155], a[44:47], v[60:63]
ds_read_b64_tr_b16 a[156:157], v88 offset:57344
v_and_b32 v6, 1, v0
v_mfma_f32_16x16x32_bf16 v[60:63], a[148:151], a[60:63], v[60:63]
buffer_load_dwordx4 v83, s[20:23], s80 offen lds
v_mfma_f32_16x16x32_bf16 v[76:79], a[148:151], a[104:107], v[76:79]
s_add_u32 m0, s83, 24576
ds_read_b64_tr_b16 a[158:159], v88 offset:57856
v_mul_u32_u24 v6, 14336, v6
v_mfma_f32_16x16x32_bf16 v[76:79], a[152:155], a[12:15], v[76:79]
s_waitcnt lgkmcnt(6)
s_add_u32 s80, s91, 3670144
ds_read_b64_tr_b16 a[16:17], v88 offset:61440
v_mfma_f32_16x16x32_bf16 v[196:199], a[4:7], a[160:163], v[196:199]
s_lshr_b32 s101, s2, 3
s_lshl2_add_u32 s101, s101, s3
ds_read_b64_tr_b16 a[18:19], v88 offset:61952
v_mfma_f32_16x16x32_bf16 v[196:199], a[140:143], a[72:75], v[196:199]
s_lshl_b32 s101, s101, 7
s_add_u32 s101, s101, L_att-L_pc2
v_mfma_f32_16x16x32_bf16 v[200:203], a[140:143], a[92:95], v[200:203]
s_getpc_b64 s[72:73]
L_pc2:
v_mfma_f32_16x16x32_bf16 v[200:203], a[4:7], a[64:67], v[200:203]
s_add_u32 s72, s72, s101
s_addc_u32 s73, s73, 0
v_mfma_f32_16x16x32_bf16 v[204:207], a[4:7], a[44:47], v[204:207]
buffer_load_dwordx4 v82, s[20:23], s80 offen lds
v_mfma_f32_16x16x32_bf16 v[204:207], a[140:143], a[60:63], v[204:207]
s_add_u32 m0, s83, 25600
s_add_u32 s80, s91, 3735680
v_mfma_f32_16x16x32_bf16 v[208:211], a[140:143], a[104:107], v[208:211]
v_mfma_f32_16x16x32_bf16 v[208:211], a[4:7], a[12:15], v[208:211]
s_waitcnt lgkmcnt(2)
ds_read_b64_tr_b16 a[148:149], v89 offset:49152
v_mfma_f32_16x16x32_bf16 a[20:23], a[0:3], a[32:35], a[20:23]
buffer_store_dwordx4 v[104:107], v1, s[28:31], s96 offen offset:3072
ds_read_b64_tr_b16 a[150:151], v89 offset:49664
v_mfma_f32_16x16x32_bf16 a[20:23], a[144:147], a[36:39], a[20:23]
s_cmp_lg_u32 s65, 0
s_cbranch_scc1 L_wb2
L_wb2b:
ds_read_b64_tr_b16 a[152:153], v89 offset:53248
v_mfma_f32_16x16x32_bf16 a[20:23], a[156:159], a[180:183], a[20:23]
s_waitcnt lgkmcnt(3)
buffer_load_dwordx4 v83, s[20:23], s80 offen lds
v_mfma_f32_16x16x32_bf16 a[20:23], a[16:19], a[188:191], a[20:23]
s_mov_b32 s38, 4096
s_add_u32 m0, s82, 65536
ds_read_b64_tr_b16 a[154:155], v89 offset:53760
v_mfma_f32_16x16x32_bf16 a[100:103], a[16:19], a[200:203], a[100:103]
s_add_u32 s80, s56, 0
ds_read_b64_tr_b16 a[140:141], v89 offset:57344
v_mfma_f32_16x16x32_bf16 a[100:103], a[156:159], a[196:199], a[100:103]
s_add_u32 s36, s28, s80
s_addc_u32 s37, s29, 0
ds_read_b64_tr_b16 a[142:143], v89 offset:57856
v_mfma_f32_16x16x32_bf16 a[100:103], a[144:147], a[108:111], a[100:103]
ds_read_b64_tr_b16 a[4:5], v89 offset:61440
v_mfma_f32_16x16x32_bf16 a[100:103], a[0:3], a[96:99], a[100:103]
ds_read_b64_tr_b16 a[6:7], v89 offset:61952
v_mfma_f32_16x16x32_bf16 a[112:115], a[0:3], a[120:123], a[112:115]
buffer_load_dwordx4 v1, s[36:39], 0 offen sc1 lds
v_mfma_f32_16x16x32_bf16 a[112:115], a[144:147], a[168:171], a[112:115]
v_mfma_f32_16x16x32_bf16 a[112:115], a[156:159], a[204:207], a[112:115]
v_mfma_f32_16x16x32_bf16 a[112:115], a[16:19], a[52:55], a[112:115]
v_mfma_f32_16x16x32_bf16 a[116:119], a[16:19], a[216:219], a[116:119]
v_mfma_f32_16x16x32_bf16 a[116:119], a[156:159], a[208:211], a[116:119]
v_mfma_f32_16x16x32_bf16 a[116:119], a[144:147], a[176:179], a[116:119]
buffer_load_dwordx4 v1, s[36:39], 0 offen offset:1024 sc1 lds
v_mfma_f32_16x16x32_bf16 a[116:119], a[0:3], a[172:175], a[116:119]
s_waitcnt lgkmcnt(1)
ds_read_b64_tr_b16 a[12:13], v90 offset:49152
v_mfma_f32_16x16x32_bf16 a[124:127], a[148:151], a[32:35], a[124:127]
ds_read_b64_tr_b16 a[14:15], v90 offset:49664
v_mfma_f32_16x16x32_bf16 a[124:127], a[152:155], a[36:39], a[124:127]
ds_read_b64_tr_b16 a[24:25], v90 offset:53248
v_mfma_f32_16x16x32_bf16 a[124:127], a[140:143], a[180:183], a[124:127]
s_waitcnt lgkmcnt(3)
ds_read_b64_tr_b16 a[26:27], v90 offset:53760
v_mfma_f32_16x16x32_bf16 a[124:127], a[4:7], a[188:191], a[124:127]
ds_read_b64_tr_b16 a[144:145], v90 offset:57344
v_mfma_f32_16x16x32_bf16 a[128:131], a[4:7], a[200:203], a[128:131]
ds_read_b64_tr_b16 a[146:147], v90 offset:57856
buffer_load_dwordx4 v1, s[36:39], 0 offen offset:2048 sc1 lds
v_mfma_f32_16x16x32_bf16 a[128:131], a[140:143], a[196:199], a[128:131]
ds_read_b64_tr_b16 a[0:1], v90 offset:61440
v_mfma_f32_16x16x32_bf16 a[128:131], a[152:155], a[108:111], a[128:131]
global_load_ubyte v8, v6, s[72:73] sc1
ds_read_b64_tr_b16 a[2:3], v90 offset:61952
v_mfma_f32_16x16x32_bf16 a[128:131], a[148:151], a[96:99], a[128:131]
v_readlane_b32 s18, v5, 1
v_readlane_b32 s19, v5, 2
v_mfma_f32_16x16x32_bf16 a[8:11], a[148:151], a[120:123], a[8:11]
v_readlane_b32 s20, v5, 3
v_readlane_b32 s21, v5, 4
v_mfma_f32_16x16x32_bf16 a[8:11], a[152:155], a[168:171], a[8:11]
v_readlane_b32 s22, v5, 5
v_readlane_b32 s23, v5, 6
v_mfma_f32_16x16x32_bf16 a[8:11], a[140:143], a[204:207], a[8:11]
s_mov_b32 s81, 0
buffer_load_dwordx4 v1, s[36:39], 0 offen offset:3072 sc1 lds
v_accvgpr_read_b32 v80, a20
v_mfma_f32_16x16x32_bf16 a[8:11], a[4:7], a[52:55], a[8:11]
s_add_u32 m0, s82, 98304
v_accvgpr_read_b32 v81, a21
v_accvgpr_read_b32 v82, a22
v_mfma_f32_16x16x32_bf16 a[68:71], a[4:7], a[216:219], a[68:71]
s_add_u32 s80, s56, 17408
v_accvgpr_read_b32 v83, a23
v_accvgpr_read_b32 v84, a124
v_mfma_f32_16x16x32_bf16 a[68:71], a[140:143], a[208:211], a[68:71]
s_add_u32 s36, s28, s80
s_addc_u32 s37, s29, 0
v_accvgpr_read_b32 v85, a125
v_mfma_f32_16x16x32_bf16 a[68:71], a[152:155], a[176:179], a[68:71]
s_mov_b64 s[16:17], 0x70
v_mov_b32 v4, 1073741824
v_cndmask_b32 v5, v4, v5, s[16:17]
v_mfma_f32_16x16x32_bf16 a[68:71], a[148:151], a[172:175], a[68:71]
s_waitcnt lgkmcnt(0)
ds_read_b64_tr_b16 a[4:5], v91 offset:49152
v_accvgpr_read_b32 v86, a126
v_mfma_f32_16x16x32_bf16 a[164:167], a[12:15], a[32:35], a[164:167]
s_add_u32 s24, s66, 6
ds_read_b64_tr_b16 a[6:7], v91 offset:49664
buffer_load_dwordx4 v1, s[36:39], 0 offen sc1 lds
v_mfma_f32_16x16x32_bf16 a[164:167], a[24:27], a[36:39], a[164:167]
s_mov_b32 s60, 1342177280
ds_read_b64_tr_b16 a[140:141], v91 offset:53248
v_accvgpr_read_b32 v87, a127
v_mfma_f32_16x16x32_bf16 a[164:167], a[144:147], a[180:183], a[164:167]
s_mov_b32 s61, 2
ds_read_b64_tr_b16 a[142:143], v91 offset:53760
v_cvt_pk_bf16_f32 v80, v80, v81
v_mfma_f32_16x16x32_bf16 a[164:167], a[0:3], a[188:191], a[164:167]
s_bitset1_b64 s[60:61], s24
ds_read_b64_tr_b16 a[148:149], v91 offset:57344
v_cvt_pk_bf16_f32 v81, v82, v83
v_mfma_f32_16x16x32_bf16 a[40:43], a[0:3], a[200:203], a[40:43]
s_bitset1_b64 s[60:61], s59
ds_read_b64_tr_b16 a[150:151], v91 offset:57856
v_cvt_pk_bf16_f32 v82, v84, v85
v_mfma_f32_16x16x32_bf16 a[40:43], a[144:147], a[196:199], a[40:43]
s_sub_u32 s6, s66, 0
ds_read_b64_tr_b16 a[152:153], v91 offset:61440
v_cvt_pk_bf16_f32 v83, v86, v87
v_mfma_f32_16x16x32_bf16 a[40:43], a[24:27], a[108:111], a[40:43]
s_bitset1_b64 s[60:61], s6
ds_read_b64_tr_b16 a[154:155], v91 offset:61952
buffer_load_dwordx4 v1, s[36:39], 0 offen offset:1024 sc1 lds
v_mfma_f32_16x16x32_bf16 a[40:43], a[12:15], a[96:99], a[40:43]
s_lshl2_add_u32 s6, s69, s70
v_pk_max_i16 v80, v80, 0
v_pk_max_i16 v81, v81, 0
v_mfma_f32_16x16x32_bf16 a[184:187], a[12:15], a[120:123], a[184:187]
s_lshl_b32 s6, s6, 7
v_pk_max_i16 v82, v82, 0
v_pk_max_i16 v83, v83, 0
v_mfma_f32_16x16x32_bf16 a[184:187], a[24:27], a[168:171], a[184:187]
s_add_u32 s27, s6, 79699968
buffer_store_dwordx4 v[80:83], v1, s[28:31], s48 offen sc1
v_accvgpr_read_b32 v84, a100
v_accvgpr_read_b32 v85, a101
v_accvgpr_read_b32 v86, a102
v_mfma_f32_16x16x32_bf16 a[184:187], a[144:147], a[204:207], a[184:187]
s_add_u32 s90, s6, 79708160
v_accvgpr_read_b32 v87, a103
v_accvgpr_read_b32 v92, a128
v_mfma_f32_16x16x32_bf16 a[184:187], a[0:3], a[52:55], a[184:187]
s_add_u32 s7, s70, 1
v_accvgpr_read_b32 v93, a129
v_accvgpr_read_b32 v94, a130
v_mfma_f32_16x16x32_bf16 a[192:195], a[0:3], a[216:219], a[192:195]
s_and_b32 s7, s7, 3
buffer_load_dwordx4 v1, s[36:39], 0 offen offset:2048 sc1 lds
v_accvgpr_read_b32 v95, a131
v_mfma_f32_16x16x32_bf16 a[192:195], a[144:147], a[208:211], a[192:195]
s_waitcnt vmcnt(10)
buffer_store_dword v13, v2, s[28:31], s99 offen sc1
v_mfma_f32_16x16x32_bf16 a[192:195], a[24:27], a[176:179], a[192:195]
s_barrier
v_mfma_f32_16x16x32_bf16 a[192:195], a[12:15], a[172:175], a[192:195]
s_waitcnt lgkmcnt(0)
ds_read_b64_tr_b16 a[0:1], v88 offset:0
v_cvt_pk_bf16_f32 v84, v84, v85
v_mfma_f32_16x16x32_bf16 a[212:215], a[4:7], a[32:35], a[212:215]
s_lshl_b32 s89, s69, 8
ds_read_b64_tr_b16 a[2:3], v88 offset:512
v_cvt_pk_bf16_f32 v85, v86, v87
v_mfma_f32_16x16x32_bf16 a[212:215], a[140:143], a[36:39], a[212:215]
s_add_u32 s89, s89, s7
ds_read_b64_tr_b16 a[144:145], v88 offset:4096
v_cvt_pk_bf16_f32 v86, v92, v93
v_mfma_f32_16x16x32_bf16 a[212:215], a[148:151], a[180:183], a[212:215]
s_lshl2_add_u32 s89, s89, 69206016
ds_read_b64_tr_b16 a[146:147], v88 offset:4608
buffer_load_dwordx4 v1, s[36:39], 0 offen offset:3072 sc1 lds
v_mfma_f32_16x16x32_bf16 a[212:215], a[152:155], a[188:191], a[212:215]
s_add_u32 m0, s82, 147456
ds_read_b64_tr_b16 a[156:157], v88 offset:8192
v_cvt_pk_bf16_f32 v87, v94, v95
v_mfma_f32_16x16x32_bf16 a[48:51], a[152:155], a[200:203], a[48:51]
s_add_u32 s80, s56, 1096704
ds_read_b64_tr_b16 a[158:159], v88 offset:8704
v_pk_max_i16 v84, v84, 0
v_mfma_f32_16x16x32_bf16 a[48:51], a[148:151], a[196:199], a[48:51]
s_add_u32 s40, s28, s80
s_addc_u32 s41, s29, 0
ds_read_b64_tr_b16 a[12:13], v88 offset:12288
v_mfma_f32_16x16x32_bf16 a[48:51], a[140:143], a[108:111], a[48:51]
s_bfe_u32 s6, s21, 0x80007
ds_read_b64_tr_b16 a[14:15], v88 offset:12800
v_pk_max_i16 v85, v85, 0
v_mfma_f32_16x16x32_bf16 a[48:51], a[4:7], a[96:99], a[48:51]
s_xor_b32 s6, s6, 0x80
v_pk_max_i16 v86, v86, 0
v_pk_max_i16 v87, v87, 0
v_mfma_f32_16x16x32_bf16 a[56:59], a[4:7], a[120:123], a[56:59]
s_mul_i32 s6, s6, 27648
buffer_store_dwordx4 v[84:87], v1, s[28:31], s49 offen sc1
v_accvgpr_read_b32 v80, a112
v_accvgpr_read_b32 v81, a113
v_accvgpr_read_b32 v82, a114
v_mfma_f32_16x16x32_bf16 a[56:59], a[140:143], a[168:171], a[56:59]
s_add_u32 s6, s6, s83
v_accvgpr_read_b32 v83, a115
v_accvgpr_read_b32 v92, a8
v_mfma_f32_16x16x32_bf16 a[56:59], a[148:151], a[204:207], a[56:59]
s_add_u32 s95, s6, 70254592
buffer_load_dwordx4 v1, s[40:43], 0 offen sc1 lds
v_accvgpr_read_b32 v93, a9
v_mfma_f32_16x16x32_bf16 a[56:59], a[152:155], a[52:55], a[56:59]
s_bfe_u32 s6, s22, 0x80007
v_accvgpr_read_b32 v94, a10
v_accvgpr_read_b32 v95, a11
v_mfma_f32_16x16x32_bf16 a[220:223], a[152:155], a[216:219], a[220:223]
s_xor_b32 s6, s6, 0x80
v_cvt_pk_bf16_f32 v80, v80, v81
v_cvt_pk_bf16_f32 v81, v82, v83
v_mfma_f32_16x16x32_bf16 a[220:223], a[148:151], a[208:211], a[220:223]
s_mul_i32 s6, s6, 27648
v_cvt_pk_bf16_f32 v82, v92, v93
v_cvt_pk_bf16_f32 v83, v94, v95
v_mfma_f32_16x16x32_bf16 a[220:223], a[140:143], a[176:179], a[220:223]
s_add_u32 s6, s6, s83
v_pk_max_i16 v80, v80, 0
v_pk_max_i16 v81, v81, 0
v_mfma_f32_16x16x32_bf16 a[220:223], a[4:7], a[172:175], a[220:223]
s_waitcnt lgkmcnt(0)
ds_read_b64_tr_b16 a[152:153], v89 offset:0
v_pk_max_i16 v82, v82, 0
v_mfma_f32_16x16x32_bf16 v[16:19], a[0:3], a[32:35], v[16:19]
s_add_u32 s96, s6, 70262784
ds_read_b64_tr_b16 a[154:155], v89 offset:512
buffer_load_dwordx4 v1, s[40:43], 0 offen offset:1024 sc1 lds
v_mfma_f32_16x16x32_bf16 v[16:19], a[144:147], a[36:39], v[16:19]
s_bfe_u32 s6, s23, 0x80007
ds_read_b64_tr_b16 a[148:149], v89 offset:4096
v_pk_max_i16 v83, v83, 0
v_mfma_f32_16x16x32_bf16 v[16:19], a[156:159], a[180:183], v[16:19]
s_xor_b32 s6, s6, 0x80
buffer_store_dwordx4 v[80:83], v1, s[28:31], s50 offen sc1
ds_read_b64_tr_b16 a[150:151], v89 offset:4608
v_accvgpr_read_b32 v84, a116
v_accvgpr_read_b32 v85, a117
v_mfma_f32_16x16x32_bf16 v[16:19], a[12:15], a[188:191], v[16:19]
s_mul_i32 s6, s6, 27648
ds_read_b64_tr_b16 a[4:5], v89 offset:8192
v_accvgpr_read_b32 v86, a118
v_mfma_f32_16x16x32_bf16 v[32:35], a[12:15], a[200:203], v[32:35]
s_add_u32 s6, s6, s83
ds_read_b64_tr_b16 a[6:7], v89 offset:8704
v_accvgpr_read_b32 v87, a119
v_mfma_f32_16x16x32_bf16 v[32:35], a[156:159], a[196:199], v[32:35]
s_add_u32 s85, s6, 70270976
ds_read_b64_tr_b16 a[8:9], v89 offset:12288
v_accvgpr_read_b32 v80, a68
v_mfma_f32_16x16x32_bf16 v[32:35], a[144:147], a[108:111], v[32:35]
s_and_b32 s6, s69, 1
ds_read_b64_tr_b16 a[10:11], v89 offset:12800
buffer_load_dwordx4 v1, s[40:43], 0 offen offset:2048 sc1 lds
v_mfma_f32_16x16x32_bf16 v[32:35], a[0:3], a[96:99], v[32:35]
s_lshl2_add_u32 s6, s6, s70
v_accvgpr_read_b32 v81, a69
v_accvgpr_read_b32 v82, a70
v_mfma_f32_16x16x32_bf16 v[48:51], a[0:3], a[120:123], v[48:51]
s_lshr_b32 s7, s69, 1
buffer_load_dwordx4 a[140:143], v1, s[28:31], s98 offen sc1
v_mfma_f32_16x16x32_bf16 v[48:51], a[144:147], a[168:171], v[48:51]
s_lshl_b32 s7, s7, 3
v_accvgpr_read_b32 v83, a71
v_cvt_pk_bf16_f32 v84, v84, v85
v_mfma_f32_16x16x32_bf16 v[48:51], a[156:159], a[204:207], v[48:51]
s_sub_u32 s93, 120, s7
v_cvt_pk_bf16_f32 v85, v86, v87
v_cvt_pk_bf16_f32 v86, v80, v81
v_mfma_f32_16x16x32_bf16 v[48:51], a[12:15], a[52:55], v[48:51]
s_add_u32 s93, s93, s6
v_cvt_pk_bf16_f32 v87, v82, v83
v_pk_max_i16 v84, v84, 0
v_mfma_f32_16x16x32_bf16 v[64:67], a[12:15], a[216:219], v[64:67]
s_xor_b32 s6, s6, 6
buffer_load_dwordx4 v1, s[40:43], 0 offen offset:3072 sc1 lds
v_pk_max_i16 v85, v85, 0
v_mfma_f32_16x16x32_bf16 v[64:67], a[156:159], a[208:211], v[64:67]
s_add_u32 m0, s82, 131072
v_pk_max_i16 v86, v86, 0
v_pk_max_i16 v87, v87, 0
v_mfma_f32_16x16x32_bf16 v[64:67], a[144:147], a[176:179], v[64:67]
s_add_u32 s80, s56, 34816
buffer_store_dwordx4 v[84:87], v1, s[28:31], s51 offen sc1
v_accvgpr_read_b32 v80, a164
v_accvgpr_read_b32 v81, a165
v_accvgpr_read_b32 v82, a166
v_mfma_f32_16x16x32_bf16 v[64:67], a[0:3], a[172:175], v[64:67]
s_waitcnt lgkmcnt(0)
ds_read_b64_tr_b16 a[156:157], v90 offset:0
v_accvgpr_read_b32 v83, a167
v_mfma_f32_16x16x32_bf16 v[100:103], a[152:155], a[32:35], v[100:103]
s_add_u32 s36, s28, s80
s_addc_u32 s37, s29, 0
ds_read_b64_tr_b16 a[158:159], v90 offset:512
v_mfma_f32_16x16x32_bf16 v[100:103], a[148:151], a[36:39], v[100:103]
s_add_u32 s92, s7, s6
ds_read_b64_tr_b16 a[12:13], v90 offset:4096
v_accvgpr_read_b32 v84, a212
v_mfma_f32_16x16x32_bf16 v[100:103], a[4:7], a[180:183], v[100:103]
s_lshl2_add_u32 s6, s71, s3
ds_read_b64_tr_b16 a[14:15], v90 offset:4608
buffer_load_dwordx4 v1, s[36:39], 0 offen sc1 lds
v_mfma_f32_16x16x32_bf16 v[100:103], a[8:11], a[188:191], v[100:103]
s_lshl_b32 s6, s6, 6
ds_read_b64_tr_b16 a[0:1], v90 offset:8192
v_accvgpr_read_b32 v85, a213
v_mfma_f32_16x16x32_bf16 v[152:155], a[8:11], a[200:203], v[152:155]
s_lshl_b32 s93, s93, 14
ds_read_b64_tr_b16 a[2:3], v90 offset:8704
v_accvgpr_read_b32 v86, a214
v_mfma_f32_16x16x32_bf16 v[152:155], a[4:7], a[196:199], v[152:155]
s_add_u32 s93, s93, s6
ds_read_b64_tr_b16 a[16:17], v90 offset:12288
v_accvgpr_read_b32 v87, a215
v_mfma_f32_16x16x32_bf16 v[152:155], a[148:151], a[108:111], v[152:155]
s_lshl_b32 s92, s92, 14
buffer_load_dwordx4 a[144:147], v1, s[28:31], s98 offen offset:1024 sc1
v_mfma_f32_16x16x32_bf16 v[152:155], a[152:155], a[96:99], v[152:155]
s_add_u32 s92, s92, s6
ds_read_b64_tr_b16 a[18:19], v90 offset:12800
v_cvt_pk_bf16_f32 v80, v80, v81
v_mfma_f32_16x16x32_bf16 v[156:159], a[152:155], a[120:123], v[156:159]
s_add_u32 s72, s46, 8192
s_addc_u32 s73, s47, 0
v_cvt_pk_bf16_f32 v16, v16, v17
v_mfma_f32_16x16x32_bf16 v[156:159], a[148:151], a[168:171], v[156:159]
s_mov_b32 s65, 4294949888
v_cvt_pk_bf16_f32 v17, v18, v19
v_cvt_pk_bf16_f32 v18, v100, v101
v_mfma_f32_16x16x32_bf16 v[156:159], a[4:7], a[204:207], v[156:159]
s_mov_b64 s[16:17], 0
buffer_load_dwordx4 v1, s[36:39], 0 offen offset:1024 sc1 lds
v_cvt_pk_bf16_f32 v19, v102, v103
v_mfma_f32_16x16x32_bf16 v[156:159], a[8:11], a[52:55], v[156:159]
s_mov_b32 s25, 1073741824
v_cvt_pk_bf16_f32 v81, v82, v83
v_cvt_pk_bf16_f32 v82, v84, v85
v_mfma_f32_16x16x32_bf16 v[160:163], a[8:11], a[216:219], v[160:163]
v_cvt_pk_bf16_f32 v32, v32, v33
v_cvt_pk_bf16_f32 v33, v34, v35
v_mfma_f32_16x16x32_bf16 v[160:163], a[4:7], a[208:211], v[160:163]
v_cvt_pk_bf16_f32 v34, v152, v153
v_cvt_pk_bf16_f32 v35, v154, v155
v_mfma_f32_16x16x32_bf16 v[160:163], a[148:151], a[176:179], v[160:163]
v_cvt_pk_bf16_f32 v83, v86, v87
v_pk_max_i16 v80, v80, 0
v_mfma_f32_16x16x32_bf16 v[160:163], a[152:155], a[172:175], v[160:163]
s_waitcnt lgkmcnt(1)
ds_read_b64_tr_b16 a[20:21], v91 offset:0
v_pk_max_i16 v81, v81, 0
v_mfma_f32_16x16x32_bf16 v[20:23], a[156:159], a[32:35], v[20:23]
ds_read_b64_tr_b16 a[22:23], v91 offset:512
v_cvt_pk_bf16_f32 v48, v48, v49
v_mfma_f32_16x16x32_bf16 v[20:23], a[12:15], a[36:39], v[20:23]
v_cvt_pk_bf16_f32 v49, v50, v51
v_cvt_pk_bf16_f32 v50, v156, v157
v_mfma_f32_16x16x32_bf16 v[20:23], a[0:3], a[180:183], v[20:23]
s_waitcnt lgkmcnt(2)
ds_read_b64_tr_b16 a[24:25], v91 offset:4096
v_cvt_pk_bf16_f32 v51, v158, v159
v_mfma_f32_16x16x32_bf16 v[20:23], a[16:19], a[188:191], v[20:23]
ds_read_b64_tr_b16 a[26:27], v91 offset:4608
buffer_load_dwordx4 v1, s[36:39], 0 offen offset:2048 sc1 lds
v_mfma_f32_16x16x32_bf16 v[36:39], a[16:19], a[200:203], v[36:39]
buffer_load_dwordx4 a[148:151], v1, s[28:31], s98 offen offset:2048 sc1
v_mfma_f32_16x16x32_bf16 v[36:39], a[0:3], a[196:199], v[36:39]
ds_read_b64_tr_b16 a[28:29], v91 offset:8192
v_cvt_pk_bf16_f32 v64, v64, v65
v_mfma_f32_16x16x32_bf16 v[36:39], a[12:15], a[108:111], v[36:39]
ds_read_b64_tr_b16 a[30:31], v91 offset:8704
v_cvt_pk_bf16_f32 v65, v66, v67
v_mfma_f32_16x16x32_bf16 v[36:39], a[156:159], a[96:99], v[36:39]
ds_read_b64_tr_b16 a[160:161], v91 offset:12288
v_cvt_pk_bf16_f32 v66, v160, v161
v_mfma_f32_16x16x32_bf16 v[52:55], a[156:159], a[120:123], v[52:55]
ds_read_b64_tr_b16 a[162:163], v91 offset:12800
v_cvt_pk_bf16_f32 v67, v162, v163
v_mfma_f32_16x16x32_bf16 v[52:55], a[12:15], a[168:171], v[52:55]
buffer_load_dwordx4 v1, s[36:39], 0 offen offset:3072 sc1 lds
v_pk_max_i16 v82, v82, 0
v_mfma_f32_16x16x32_bf16 v[52:55], a[0:3], a[204:207], v[52:55]
s_add_u32 m0, s82, 49152
v_pk_max_i16 v83, v83, 0
v_accvgpr_read_b32 v84, a40
v_mfma_f32_16x16x32_bf16 v[52:55], a[16:19], a[52:55], v[52:55]
s_add_u32 s80, s56, 1079296
buffer_store_dwordx4 v[80:83], v1, s[28:31], s48 offen offset:1024 sc1
v_accvgpr_read_b32 v85, a41
v_accvgpr_read_b32 v86, a42
v_accvgpr_read_b32 v87, a43
v_mfma_f32_16x16x32_bf16 v[68:71], a[16:19], a[216:219], v[68:71]
s_add_u32 s40, s28, s80
s_addc_u32 s41, s29, 0
v_accvgpr_read_b32 v92, a48
v_mfma_f32_16x16x32_bf16 v[68:71], a[0:3], a[208:211], v[68:71]
s_waitcnt vmcnt(21)
v_accvgpr_read_b32 v93, a49
v_accvgpr_read_b32 v94, a50
v_mfma_f32_16x16x32_bf16 v[68:71], a[12:15], a[176:179], v[68:71]
s_barrier
v_mfma_f32_16x16x32_bf16 v[68:71], a[156:159], a[172:175], v[68:71]
s_waitcnt lgkmcnt(2)
ds_read_b64_tr_b16 a[64:65], v88 offset:16384
buffer_load_dwordx4 v1, s[40:43], 0 offen sc1 lds
v_mfma_f32_16x16x32_bf16 v[164:167], a[20:23], a[32:35], v[164:167]
ds_read_b64_tr_b16 a[66:67], v88 offset:16896
v_accvgpr_read_b32 v95, a51
v_mfma_f32_16x16x32_bf16 v[164:167], a[24:27], a[36:39], v[164:167]
ds_read_b64_tr_b16 a[68:69], v88 offset:20480
v_cvt_pk_bf16_f32 v84, v84, v85
v_mfma_f32_16x16x32_bf16 v[164:167], a[28:31], a[180:183], v[164:167]
s_waitcnt lgkmcnt(3)
buffer_load_dwordx4 a[152:155], v1, s[28:31], s98 offen offset:3072 sc1
v_mfma_f32_16x16x32_bf16 v[164:167], a[160:163], a[188:191], v[164:167]
s_add_u32 s98, s97, 4096
ds_read_b64_tr_b16 a[70:71], v88 offset:20992
v_cvt_pk_bf16_f32 v85, v86, v87
v_mfma_f32_16x16x32_bf16 v[168:171], a[160:163], a[200:203], v[168:171]
ds_read_b64_tr_b16 a[72:73], v88 offset:24576
v_cvt_pk_bf16_f32 v86, v92, v93
v_mfma_f32_16x16x32_bf16 v[168:171], a[28:31], a[196:199], v[168:171]
ds_read_b64_tr_b16 a[74:75], v88 offset:25088
buffer_load_dwordx4 v1, s[40:43], 0 offen offset:1024 sc1 lds
v_mfma_f32_16x16x32_bf16 v[168:171], a[24:27], a[108:111], v[168:171]
ds_read_b64_tr_b16 a[76:77], v88 offset:28672
v_cvt_pk_bf16_f32 v87, v94, v95
v_mfma_f32_16x16x32_bf16 v[168:171], a[20:23], a[96:99], v[168:171]
ds_read_b64_tr_b16 a[78:79], v88 offset:29184
v_pk_max_i16 v84, v84, 0
v_mfma_f32_16x16x32_bf16 v[172:175], a[20:23], a[120:123], v[172:175]
v_cvt_pk_bf16_f32 v20, v20, v21
v_cvt_pk_bf16_f32 v21, v22, v23
v_mfma_f32_16x16x32_bf16 v[172:175], a[24:27], a[168:171], v[172:175]
v_cvt_pk_bf16_f32 v22, v164, v165
v_cvt_pk_bf16_f32 v23, v166, v167
v_mfma_f32_16x16x32_bf16 v[172:175], a[28:31], a[204:207], v[172:175]
ds_read_b128 a[0:3], v3 offset:0
v_pk_max_i16 v85, v85, 0
v_mfma_f32_16x16x32_bf16 v[172:175], a[160:163], a[52:55], v[172:175]
ds_read_b128 a[4:7], v3 offset:1024
buffer_load_dwordx4 v1, s[40:43], 0 offen offset:2048 sc1 lds
v_mfma_f32_16x16x32_bf16 v[176:179], a[160:163], a[216:219], v[176:179]
v_cvt_pk_bf16_f32 v36, v36, v37
v_cvt_pk_bf16_f32 v37, v38, v39
v_mfma_f32_16x16x32_bf16 v[176:179], a[28:31], a[208:211], v[176:179]
v_cvt_pk_bf16_f32 v38, v168, v169
v_cvt_pk_bf16_f32 v39, v170, v171
v_mfma_f32_16x16x32_bf16 v[176:179], a[24:27], a[176:179], v[176:179]
L_pad8:
s_cbranch_execz L_pad12
ds_read_b128 a[8:11], v3 offset:8192
v_pk_max_i16 v86, v86, 0
v_mfma_f32_16x16x32_bf16 v[176:179], a[20:23], a[172:175], v[176:179]
s_waitcnt lgkmcnt(4)
ds_read_b64_tr_b16 a[80:81], v89 offset:16384
v_pk_max_i16 v87, v87, 0
v_mfma_f32_16x16x32_bf16 v[24:27], a[64:67], a[32:35], v[24:27]
buffer_store_dwordx4 v[84:87], v1, s[28:31], s49 offen offset:1024 sc1
ds_read_b64_tr_b16 a[82:83], v89 offset:16896
v_cvt_pk_bf16_f32 v52, v52, v53
v_cvt_pk_bf16_f32 v53, v54, v55
v_mfma_f32_16x16x32_bf16 v[24:27], a[68:71], a[36:39], v[24:27]
v_cvt_pk_bf16_f32 v54, v172, v173
v_cvt_pk_bf16_f32 v55, v174, v175
v_mfma_f32_16x16x32_bf16 v[24:27], a[72:75], a[180:183], v[24:27]
s_waitcnt lgkmcnt(5)
buffer_load_dwordx4 a[156:159], v1, s[28:31], s98 offen sc1
v_mfma_f32_16x16x32_bf16 v[24:27], a[76:79], a[188:191], v[24:27]
ds_read_b64_tr_b16 a[84:85], v89 offset:20480
buffer_load_dwordx4 v1, s[40:43], 0 offen offset:3072 sc1 lds
v_mfma_f32_16x16x32_bf16 v[40:43], a[76:79], a[200:203], v[40:43]
s_add_u32 m0, s82, 32768
ds_read_b64_tr_b16 a[86:87], v89 offset:20992
v_cvt_pk_bf16_f32 v68, v68, v69
v_mfma_f32_16x16x32_bf16 v[40:43], a[72:75], a[196:199], v[40:43]
s_add_u32 s80, s56, 52224
ds_read_b64_tr_b16 a[88:89], v89 offset:24576
v_cvt_pk_bf16_f32 v69, v70, v71
v_mfma_f32_16x16x32_bf16 v[40:43], a[68:71], a[108:111], v[40:43]
s_add_u32 s36, s28, s80
s_addc_u32 s37, s29, 0
ds_read_b64_tr_b16 a[90:91], v89 offset:25088
v_mfma_f32_16x16x32_bf16 v[40:43], a[64:67], a[96:99], v[40:43]
ds_read_b64_tr_b16 a[92:93], v89 offset:28672
v_cvt_pk_bf16_f32 v70, v176, v177
v_mfma_f32_16x16x32_bf16 v[56:59], a[64:67], a[120:123], v[56:59]
ds_read_b64_tr_b16 a[94:95], v89 offset:29184
v_cvt_pk_bf16_f32 v71, v178, v179
v_mfma_f32_16x16x32_bf16 v[56:59], a[68:71], a[168:171], v[56:59]
ds_read_b128 a[12:15], v3 offset:9216
buffer_load_dwordx4 v1, s[36:39], 0 offen sc1 lds
v_mfma_f32_16x16x32_bf16 v[56:59], a[72:75], a[204:207], v[56:59]
ds_read_b128 a[16:19], v3 offset:11264
v_accvgpr_read_b32 v80, a184
v_mfma_f32_16x16x32_bf16 v[56:59], a[76:79], a[52:55], v[56:59]
ds_read_b128 a[20:23], v3 offset:10240
v_accvgpr_read_b32 v81, a185
v_mfma_f32_16x16x32_bf16 v[72:75], a[76:79], a[216:219], v[72:75]
ds_read_b128 a[24:27], v3 offset:3072
v_accvgpr_read_b32 v82, a186
v_mfma_f32_16x16x32_bf16 v[72:75], a[72:75], a[208:211], v[72:75]
ds_read_b128 a[28:31], v3 offset:2048
v_accvgpr_read_b32 v83, a187
v_mfma_f32_16x16x32_bf16 v[72:75], a[68:71], a[176:179], v[72:75]
buffer_load_dwordx4 a[160:163], v1, s[28:31], s98 offen offset:1024 sc1
v_mfma_f32_16x16x32_bf16 v[72:75], a[64:67], a[172:175], v[72:75]
s_waitcnt lgkmcnt(7)
ds_read_b64_tr_b16 a[40:41], v90 offset:16384
buffer_load_dwordx4 v1, s[36:39], 0 offen offset:1024 sc1 lds
v_mfma_f32_16x16x32_bf16 v[180:183], a[80:83], a[32:35], v[180:183]
ds_read_b64_tr_b16 a[42:43], v90 offset:16896
v_accvgpr_read_b32 v84, a56
v_mfma_f32_16x16x32_bf16 v[180:183], a[84:87], a[36:39], v[180:183]
ds_read_b64_tr_b16 a[44:45], v90 offset:20480
v_accvgpr_read_b32 v85, a57
v_mfma_f32_16x16x32_bf16 v[180:183], a[88:91], a[180:183], v[180:183]
s_waitcnt lgkmcnt(7)
ds_read_b64_tr_b16 a[46:47], v90 offset:20992
v_accvgpr_read_b32 v86, a58
v_mfma_f32_16x16x32_bf16 v[180:183], a[92:95], a[188:191], v[180:183]
ds_read_b64_tr_b16 a[48:49], v90 offset:24576
v_accvgpr_read_b32 v87, a59
v_mfma_f32_16x16x32_bf16 v[184:187], a[92:95], a[200:203], v[184:187]
ds_read_b64_tr_b16 a[50:51], v90 offset:25088
v_cvt_pk_bf16_f32 v80, v80, v81
v_mfma_f32_16x16x32_bf16 v[184:187], a[88:91], a[196:199], v[184:187]
ds_read_b64_tr_b16 a[60:61], v90 offset:28672
buffer_load_dwordx4 v1, s[36:39], 0 offen offset:2048 sc1 lds
v_mfma_f32_16x16x32_bf16 v[184:187], a[84:87], a[108:111], v[184:187]
ds_read_b64_tr_b16 a[62:63], v90 offset:29184
v_cvt_pk_bf16_f32 v81, v82, v83
v_mfma_f32_16x16x32_bf16 v[184:187], a[80:83], a[96:99], v[184:187]
ds_read_b128 a[64:67], v3 offset:4096
v_cvt_pk_bf16_f32 v82, v84, v85
v_mfma_f32_16x16x32_bf16 v[188:191], a[80:83], a[120:123], v[188:191]
v_cvt_pk_bf16_f32 v24, v24, v25
v_cvt_pk_bf16_f32 v25, v26, v27
v_mfma_f32_16x16x32_bf16 v[188:191], a[84:87], a[168:171], v[188:191]
v_cvt_pk_bf16_f32 v26, v180, v181
v_cvt_pk_bf16_f32 v27, v182, v183
v_mfma_f32_16x16x32_bf16 v[188:191], a[88:91], a[204:207], v[188:191]
ds_read_b128 a[68:71], v3 offset:5120
v_cvt_pk_bf16_f32 v83, v86, v87
v_mfma_f32_16x16x32_bf16 v[188:191], a[92:95], a[52:55], v[188:191]
ds_read_b128 a[72:75], v3 offset:6144
buffer_load_dwordx4 v1, s[36:39], 0 offen offset:3072 sc1 lds
v_mfma_f32_16x16x32_bf16 v[192:195], a[92:95], a[216:219], v[192:195]
v_cvt_pk_bf16_f32 v40, v40, v41
v_cvt_pk_bf16_f32 v41, v42, v43
v_mfma_f32_16x16x32_bf16 v[192:195], a[88:91], a[208:211], v[192:195]
v_cvt_pk_bf16_f32 v42, v184, v185
v_cvt_pk_bf16_f32 v43, v186, v187
v_mfma_f32_16x16x32_bf16 v[192:195], a[84:87], a[176:179], v[192:195]
ds_read_b128 a[76:79], v3 offset:7168
v_pk_max_i16 v80, v80, 0
v_mfma_f32_16x16x32_bf16 v[192:195], a[80:83], a[172:175], v[192:195]
s_waitcnt lgkmcnt(4)
ds_read_b64_tr_b16 a[56:57], v91 offset:16384
v_pk_max_i16 v81, v81, 0
v_mfma_f32_16x16x32_bf16 v[28:31], a[40:43], a[32:35], v[28:31]
ds_read_b64_tr_b16 a[58:59], v91 offset:16896
v_cvt_pk_bf16_f32 v56, v56, v57
v_mfma_f32_16x16x32_bf16 v[28:31], a[44:47], a[36:39], v[28:31]
v_cvt_pk_bf16_f32 v57, v58, v59
v_cvt_pk_bf16_f32 v58, v188, v189
v_mfma_f32_16x16x32_bf16 v[28:31], a[48:51], a[180:183], v[28:31]
ds_read_b64_tr_b16 a[100:101], v91 offset:20480
v_cvt_pk_bf16_f32 v59, v190, v191
v_mfma_f32_16x16x32_bf16 v[28:31], a[60:63], a[188:191], v[28:31]
ds_read_b64_tr_b16 a[102:103], v91 offset:20992
v_pk_max_i16 v82, v82, 0
v_mfma_f32_16x16x32_bf16 v[44:47], a[60:63], a[200:203], v[44:47]
ds_read_b64_tr_b16 a[104:105], v91 offset:24576
v_cvt_pk_bf16_f32 v72, v72, v73
v_mfma_f32_16x16x32_bf16 v[44:47], a[48:51], a[196:199], v[44:47]
ds_read_b64_tr_b16 a[106:107], v91 offset:25088
v_cvt_pk_bf16_f32 v73, v74, v75
v_mfma_f32_16x16x32_bf16 v[44:47], a[44:47], a[108:111], v[44:47]
ds_read_b64_tr_b16 a[112:113], v91 offset:28672
v_cvt_pk_bf16_f32 v74, v192, v193
v_mfma_f32_16x16x32_bf16 v[44:47], a[40:43], a[96:99], v[44:47]
ds_read_b64_tr_b16 a[114:115], v91 offset:29184
v_cvt_pk_bf16_f32 v75, v194, v195
v_mfma_f32_16x16x32_bf16 v[60:63], a[40:43], a[120:123], v[60:63]
ds_read_b128 a[80:83], v3 offset:12288
v_pk_max_i16 v83, v83, 0
v_mfma_f32_16x16x32_bf16 v[60:63], a[44:47], a[168:171], v[60:63]
buffer_store_dwordx4 v[80:83], v1, s[28:31], s50 offen offset:1024 sc1
ds_read_b128 a[84:87], v3 offset:13312
v_accvgpr_read_b32 v84, a192
v_accvgpr_read_b32 v85, a193
v_mfma_f32_16x16x32_bf16 v[60:63], a[48:51], a[204:207], v[60:63]
ds_read_b128 a[88:91], v3 offset:14336
v_accvgpr_read_b32 v86, a194
v_mfma_f32_16x16x32_bf16 v[60:63], a[60:63], a[52:55], v[60:63]
ds_read_b128 a[92:95], v3 offset:15360
v_accvgpr_read_b32 v87, a195
v_mfma_f32_16x16x32_bf16 v[76:79], a[60:63], a[216:219], v[76:79]
v_accvgpr_read_b32 v80, a220
v_accvgpr_read_b32 v81, a221
v_mfma_f32_16x16x32_bf16 v[76:79], a[48:51], a[208:211], v[76:79]
v_accvgpr_read_b32 v82, a222
v_accvgpr_read_b32 v83, a223
v_mfma_f32_16x16x32_bf16 v[76:79], a[44:47], a[176:179], v[76:79]
v_cvt_pk_bf16_f32 v84, v84, v85
v_cvt_pk_bf16_f32 v85, v86, v87
v_mfma_f32_16x16x32_bf16 v[76:79], a[40:43], a[172:175], v[76:79]
s_waitcnt lgkmcnt(5)
v_cvt_pk_bf16_f32 v86, v80, v81
v_cvt_pk_bf16_f32 v87, v82, v83
v_mfma_f32_16x16x32_bf16 v[196:199], a[56:59], a[32:35], v[196:199]
v_pk_max_i16 v84, v84, 0
v_pk_max_i16 v85, v85, 0
v_mfma_f32_16x16x32_bf16 v[196:199], a[100:103], a[36:39], v[196:199]
v_pk_max_i16 v86, v86, 0
v_pk_max_i16 v87, v87, 0
v_mfma_f32_16x16x32_bf16 v[196:199], a[104:107], a[180:183], v[196:199]
s_waitcnt lgkmcnt(2)
buffer_store_dwordx4 v[84:87], v1, s[28:31], s51 offen offset:1024 sc1
v_mfma_f32_16x16x32_bf16 v[196:199], a[112:115], a[188:191], v[196:199]
v_mfma_f32_16x16x32_bf16 v[200:203], a[112:115], a[200:203], v[200:203]
v_mfma_f32_16x16x32_bf16 v[200:203], a[104:107], a[196:199], v[200:203]
v_mfma_f32_16x16x32_bf16 v[200:203], a[100:103], a[108:111], v[200:203]
v_mfma_f32_16x16x32_bf16 v[200:203], a[56:59], a[96:99], v[200:203]
v_mfma_f32_16x16x32_bf16 v[204:207], a[56:59], a[120:123], v[204:207]
v_cvt_pk_bf16_f32 v28, v28, v29
v_cvt_pk_bf16_f32 v29, v30, v31
v_mfma_f32_16x16x32_bf16 v[204:207], a[100:103], a[168:171], v[204:207]
v_cvt_pk_bf16_f32 v30, v196, v197
v_cvt_pk_bf16_f32 v31, v198, v199
v_mfma_f32_16x16x32_bf16 v[204:207], a[104:107], a[204:207], v[204:207]
v_mfma_f32_16x16x32_bf16 v[204:207], a[112:115], a[52:55], v[204:207]
v_mfma_f32_16x16x32_bf16 v[208:211], a[112:115], a[216:219], v[208:211]
s_waitcnt vmcnt(29)
v_cvt_pk_bf16_f32 v44, v44, v45
v_cvt_pk_bf16_f32 v45, v46, v47
v_mfma_f32_16x16x32_bf16 v[208:211], a[104:107], a[208:211], v[208:211]
s_barrier
v_mfma_f32_16x16x32_bf16 v[208:211], a[100:103], a[176:179], v[208:211]
v_cvt_pk_bf16_f32 v46, v200, v201
v_cvt_pk_bf16_f32 v47, v202, v203
v_mfma_f32_16x16x32_bf16 v[208:211], a[56:59], a[172:175], v[208:211]
v_cvt_pk_bf16_f32 v60, v60, v61
v_cvt_pk_bf16_f32 v61, v62, v63
v_cvt_pk_bf16_f32 v62, v204, v205
v_cvt_pk_bf16_f32 v63, v206, v207
v_cvt_pk_bf16_f32 v76, v76, v77
v_cvt_pk_bf16_f32 v77, v78, v79
s_nop 1
v_cvt_pk_bf16_f32 v78, v208, v209
v_cvt_pk_bf16_f32 v79, v210, v211
L_att:
v_add_u32 v3, 98304, v1
s_waitcnt lgkmcnt(8)
v_mfma_f32_16x16x32_bf16 v[208:211], a[0:3], v[16:19], v[232:235]
s_mov_b32 s101, 79695872
s_add_u32 s57, s56, 1061888
ds_read_b128 a[32:35], v3 offset:0
v_mfma_f32_16x16x32_bf16 v[208:211], a[4:7], v[20:23], v[208:211]
s_add_u32 s40, s28, s57
s_addc_u32 s41, s29, 0
ds_read_b128 a[36:39], v3 offset:1024
v_mfma_f32_16x16x32_bf16 v[208:211], a[8:11], v[24:27], v[208:211]
s_add_u32 s6, s97, 8192
s_add_u32 s26, s56, 69632
ds_read_b128 a[40:43], v3 offset:8192
v_mfma_f32_16x16x32_bf16 v[208:211], a[12:15], v[28:31], v[208:211]
s_add_u32 s98, s28, s6
s_addc_u32 s99, s29, 0
ds_read_b128 a[44:47], v3 offset:9216
v_mfma_f32_16x16x32_bf16 v[212:215], a[16:19], v[28:31], v[232:235]
s_add_u32 s48, s98, 8192
s_addc_u32 s49, s99, 0
ds_read_b128 a[48:51], v3 offset:11264
v_mfma_f32_16x16x32_bf16 v[212:215], a[20:23], v[24:27], v[212:215]
s_add_u32 s50, s48, 8192
s_addc_u32 s51, s49, 0
ds_read_b128 a[52:55], v3 offset:10240
v_mfma_f32_16x16x32_bf16 v[212:215], a[24:27], v[20:23], v[212:215]
s_mov_b32 s62, 32768
s_mov_b32 s58, 1
ds_read_b128 a[56:59], v3 offset:3072
v_mfma_f32_16x16x32_bf16 v[212:215], a[28:31], v[16:19], v[212:215]
s_mov_b32 s64, 17408
s_cmp_eq_u32 s59, 1
ds_read_b128 a[60:63], v3 offset:2048
buffer_load_dword v8, v10, s[28:31], s101 offen sc1
s_cbranch_scc1 L_DFL
L_DF:
v_mfma_f32_16x16x32_bf16 v[216:219], a[0:3], v[48:51], v[240:243]
s_add_u32 s7, s63, s62
v_exp_f32 v208, v208
v_mfma_f32_16x16x32_bf16 v[216:219], a[4:7], v[52:55], v[216:219]
s_add_u32 m0, s7, 16384
v_exp_f32 v209, v209
v_mfma_f32_16x16x32_bf16 v[216:219], a[8:11], v[56:59], v[216:219]
s_add_u32 s36, s28, s26
v_exp_f32 v210, v210
v_mfma_f32_16x16x32_bf16 v[216:219], a[12:15], v[60:63], v[216:219]
s_addc_u32 s37, s29, 0
v_exp_f32 v211, v211
v_mfma_f32_16x16x32_bf16 v[220:223], a[16:19], v[60:63], v[240:243]
s_add_u32 s26, s26, s64
v_exp_f32 v212, v212
v_mfma_f32_16x16x32_bf16 v[220:223], a[20:23], v[56:59], v[220:223]
s_add_u32 s57, s57, s65
v_exp_f32 v213, v213
v_mfma_f32_16x16x32_bf16 v[220:223], a[24:27], v[52:55], v[220:223]
s_add_u32 s62, s62, 32768
v_exp_f32 v214, v214
v_mfma_f32_16x16x32_bf16 v[220:223], a[28:31], v[48:51], v[220:223]
s_and_b32 s62, s62, 131071
v_exp_f32 v215, v215
s_add_u32 s6, s62, 32768
buffer_load_dwordx4 v1, s[40:43], 0 offen sc1 lds
v_cvt_pk_bf16_f32 v224, v208, v209
s_and_b32 s6, s6, 131071
global_load_dwordx4 a[164:167], v1, s[98:99] offset:-2048 sc1
v_cvt_pk_bf16_f32 v225, v210, v211
v_cvt_pk_bf16_f32 v226, v212, v213
s_add_u32 s58, s58, 1
buffer_load_dwordx4 v1, s[40:43], 0 offen offset:1024 sc1 lds
v_cvt_pk_bf16_f32 v227, v214, v215
v_mfma_f32_16x16x32_bf16 v[208:211], a[0:3], v[64:67], v[244:247]
s_add_u32 s6, s6, 32768
v_exp_f32 v216, v216
v_mfma_f32_16x16x32_bf16 v[208:211], a[4:7], v[68:71], v[208:211]
ds_read_b128 a[96:99], v3 offset:4096
v_mov_b32 v7, v216
v_mfma_f32_16x16x32_bf16 v[208:211], a[8:11], v[72:75], v[208:211]
v_exp_f32 v217, v217
v_mfma_f32_16x16x32_bf16 v[208:211], a[12:15], v[76:79], v[208:211]
global_load_dwordx4 a[168:171], v1, s[98:99] offset:-1024 sc1
v_cvt_pk_bf16_f32 v228, v216, v217
v_add_f32 v7, v7, v217
v_mfma_f32_16x16x32_bf16 v[212:215], a[16:19], v[76:79], v[244:247]
v_exp_f32 v218, v218
v_mfma_f32_16x16x32_bf16 v[212:215], a[20:23], v[72:75], v[212:215]
buffer_load_dwordx4 v1, s[40:43], 0 offen offset:2048 sc1 lds
v_add_f32 v7, v7, v218
v_mfma_f32_16x16x32_bf16 v[212:215], a[24:27], v[68:71], v[212:215]
v_exp_f32 v219, v219
v_mfma_f32_16x16x32_bf16 v[212:215], a[28:31], v[64:67], v[212:215]
s_waitcnt lgkmcnt(1)
v_cvt_pk_bf16_f32 v229, v218, v219
v_add_f32 v7, v7, v219
v_mfma_f32_16x16x32_bf16 v[80:83], a[64:67], v[224:227], 0
v_exp_f32 v220, v220
v_mfma_f32_16x16x32_bf16 v[84:87], a[68:71], v[224:227], 0
global_load_dwordx4 a[172:175], v1, s[98:99] offset:0 sc1
v_add_f32 v7, v7, v220
v_mfma_f32_16x16x32_bf16 v[88:91], a[72:75], v[224:227], 0
v_exp_f32 v221, v221
v_mfma_f32_16x16x32_bf16 v[92:95], a[76:79], v[224:227], 0
v_cvt_pk_bf16_f32 v230, v220, v221
v_add_f32 v7, v7, v221
v_mfma_f32_16x16x32_bf16 v[96:99], a[80:83], v[224:227], 0
v_exp_f32 v222, v222
v_mfma_f32_16x16x32_bf16 v[100:103], a[84:87], v[224:227], 0
buffer_load_dwordx4 v1, s[40:43], 0 offen offset:3072 sc1 lds
v_add_f32 v7, v7, v222
v_mfma_f32_16x16x32_bf16 v[104:107], a[88:91], v[224:227], 0
s_mov_b32 m0, s7
v_exp_f32 v223, v223
v_mfma_f32_16x16x32_bf16 v[108:111], a[92:95], v[224:227], 0
s_add_u32 s40, s28, s57
global_load_dwordx4 a[176:179], v1, s[98:99] offset:1024 sc1
v_cvt_pk_bf16_f32 v231, v222, v223
v_add_f32 v7, v7, v223
v_mfma_f32_16x16x32_bf16 a[128:131], a[136:139], v[224:227], 0
s_addc_u32 s41, s29, 0
s_mov_b32 s42, s38
ds_read_b128 a[100:103], v3 offset:5120
v_mfma_f32_16x16x32_bf16 v[216:219], a[0:3], v[32:35], v[236:239]
s_bitcmp1_b64 s[60:61], s58
v_exp_f32 v208, v208
v_mfma_f32_16x16x32_bf16 v[216:219], a[4:7], v[36:39], v[216:219]
ds_read_b128 a[104:107], v3 offset:6144
v_mov_b32 v14, v208
v_mfma_f32_16x16x32_bf16 v[216:219], a[8:11], v[40:43], v[216:219]
v_exp_f32 v209, v209
v_mfma_f32_16x16x32_bf16 v[216:219], a[12:15], v[44:47], v[216:219]
global_load_dwordx4 a[180:183], v1, s[98:99] offset:2048 sc1
v_cvt_pk_bf16_f32 v224, v208, v209
v_add_f32 v14, v14, v209
v_mfma_f32_16x16x32_bf16 v[220:223], a[16:19], v[44:47], v[236:239]
v_exp_f32 v210, v210
v_mfma_f32_16x16x32_bf16 v[220:223], a[20:23], v[40:43], v[220:223]
buffer_load_dwordx4 v1, s[36:39], 0 offen sc1 lds
v_add_f32 v14, v14, v210
v_mfma_f32_16x16x32_bf16 v[220:223], a[24:27], v[36:39], v[220:223]
v_exp_f32 v211, v211
v_mfma_f32_16x16x32_bf16 v[220:223], a[28:31], v[32:35], v[220:223]
v_cvt_pk_bf16_f32 v225, v210, v211
v_add_f32 v14, v14, v211
v_mfma_f32_16x16x32_bf16 v[144:147], a[64:67], v[228:231], 0
v_exp_f32 v212, v212
v_mfma_f32_16x16x32_bf16 v[148:151], a[68:71], v[228:231], 0
ds_read_b128 a[108:111], v3 offset:7168
v_add_f32 v14, v14, v212
v_mfma_f32_16x16x32_bf16 v[152:155], a[72:75], v[228:231], 0
v_exp_f32 v213, v213
v_mfma_f32_16x16x32_bf16 v[156:159], a[76:79], v[228:231], 0
global_load_dwordx4 a[184:187], v1, s[98:99] offset:3072 sc1
v_cvt_pk_bf16_f32 v226, v212, v213
v_add_f32 v14, v14, v213
v_mfma_f32_16x16x32_bf16 v[160:163], a[80:83], v[228:231], 0
v_exp_f32 v214, v214
v_mfma_f32_16x16x32_bf16 v[164:167], a[84:87], v[228:231], 0
buffer_load_dwordx4 v1, s[36:39], 0 offen offset:1024 sc1 lds
v_add_f32 v14, v14, v214
v_mfma_f32_16x16x32_bf16 v[168:171], a[88:91], v[228:231], 0
v_exp_f32 v215, v215
v_mfma_f32_16x16x32_bf16 v[172:175], a[92:95], v[228:231], 0
v_cvt_pk_bf16_f32 v227, v214, v215
v_add_f32 v14, v14, v215
v_mfma_f32_16x16x32_bf16 v[208:211], a[32:35], v[16:19], v[232:235]
v_exp_f32 v216, v216
v_mfma_f32_16x16x32_bf16 v[208:211], a[36:39], v[20:23], v[208:211]
v_exp_f32 v217, v217
v_mfma_f32_16x16x32_bf16 v[208:211], a[40:43], v[24:27], v[208:211]
ds_read_b128 a[112:115], v3 offset:12288
v_cvt_pk_bf16_f32 v228, v216, v217
v_mfma_f32_16x16x32_bf16 v[208:211], a[44:47], v[28:31], v[208:211]
v_exp_f32 v218, v218
v_mfma_f32_16x16x32_bf16 v[212:215], a[48:51], v[28:31], v[232:235]
buffer_load_dwordx4 v1, s[36:39], 0 offen offset:2048 sc1 lds
v_mfma_f32_16x16x32_bf16 v[212:215], a[52:55], v[24:27], v[212:215]
v_exp_f32 v219, v219
v_mfma_f32_16x16x32_bf16 v[212:215], a[56:59], v[20:23], v[212:215]
ds_read_b128 a[116:119], v3 offset:13312
v_cvt_pk_bf16_f32 v229, v218, v219
v_mfma_f32_16x16x32_bf16 v[212:215], a[60:63], v[16:19], v[212:215]
v_exp_f32 v220, v220
v_mfma_f32_16x16x32_bf16 v[176:179], a[64:67], v[224:227], 0
buffer_load_dwordx4 v1, s[36:39], 0 offen offset:3072 sc1 lds
v_mfma_f32_16x16x32_bf16 v[180:183], a[68:71], v[224:227], 0
v_exp_f32 v221, v221
v_mfma_f32_16x16x32_bf16 v[184:187], a[72:75], v[224:227], 0
ds_read_b128 a[120:123], v3 offset:14336
v_cvt_pk_bf16_f32 v230, v220, v221
v_mfma_f32_16x16x32_bf16 v[188:191], a[76:79], v[224:227], 0
v_exp_f32 v222, v222
v_mfma_f32_16x16x32_bf16 v[192:195], a[80:83], v[224:227], 0
ds_read_b128 a[124:127], v3 offset:15360
v_add_u32 v3, s6, v1
v_mfma_f32_16x16x32_bf16 v[196:199], a[84:87], v[224:227], 0
v_exp_f32 v223, v223
v_mfma_f32_16x16x32_bf16 v[200:203], a[88:91], v[224:227], 0
global_load_dwordx4 a[188:191], v1, s[48:49] offset:-4096 sc1
v_cvt_pk_bf16_f32 v231, v222, v223
v_mfma_f32_16x16x32_bf16 v[204:207], a[92:95], v[224:227], 0
global_load_dwordx4 a[192:195], v1, s[48:49] offset:-3072 sc1
s_waitcnt vmcnt(16)
v_cmp_gt_u32 vcc, 1, v8
s_nop 0
s_cbranch_vccnz L_spin3
L_back3:
v_mov_b32 v13, 1
buffer_store_dword v13, v2, s[28:31], s18 offen sc1
s_cmp_lg_u32 s5, 0
s_cbranch_scc1 L_DP1
s_cmp_eq_u32 s59, 2
s_cbranch_scc1 L_DL_0
.p2align 4
L_D1_0:
v_mfma_f32_16x16x32_bf16 v[216:219], a[32:35], v[48:51], v[240:243]
s_add_u32 s7, s63, s62
v_exp_f32 v208, v208
v_mfma_f32_16x16x32_bf16 v[216:219], a[36:39], v[52:55], v[216:219]
s_barrier
v_mfma_f32_16x16x32_bf16 v[216:219], a[40:43], v[56:59], v[216:219]
s_add_u32 m0, s7, 16384
v_exp_f32 v209, v209
v_mfma_f32_16x16x32_bf16 v[216:219], a[44:47], v[60:63], v[216:219]
s_add_u32 s36, s28, s26
v_exp_f32 v210, v210
v_mfma_f32_16x16x32_bf16 v[220:223], a[48:51], v[60:63], v[240:243]
s_addc_u32 s37, s29, 0
ds_read_b128 a[0:3], v3 offset:0
v_cvt_pk_bf16_f32 v224, v208, v209
v_mfma_f32_16x16x32_bf16 v[220:223], a[52:55], v[56:59], v[220:223]
s_add_u32 s26, s26, s64
v_exp_f32 v211, v211
v_mfma_f32_16x16x32_bf16 v[220:223], a[56:59], v[52:55], v[220:223]
s_add_u32 s57, s57, s65
ds_read_b128 a[4:7], v3 offset:1024
buffer_load_dwordx4 v1, s[40:43], 0 offen sc1 lds
v_mfma_f32_16x16x32_bf16 v[220:223], a[60:63], v[48:51], v[220:223]
s_add_u32 s62, s62, 32768
v_exp_f32 v212, v212
v_mfma_f32_16x16x32_bf16 v[112:115], a[64:67], v[228:231], v[112:115]
s_and_b32 s62, s62, 131071
ds_read_b128 a[8:11], v3 offset:8192
v_cvt_pk_bf16_f32 v225, v210, v211
v_mfma_f32_16x16x32_bf16 v[116:119], a[68:71], v[228:231], v[116:119]
s_add_u32 s6, s62, 32768
s_and_b32 s6, s6, 131071
ds_read_b128 a[12:15], v3 offset:9216
v_mfma_f32_16x16x32_bf16 v[120:123], a[72:75], v[228:231], v[120:123]
s_add_u32 s58, s58, 1
v_exp_f32 v213, v213
v_mfma_f32_16x16x32_bf16 v[124:127], a[76:79], v[228:231], v[124:127]
s_add_u32 s6, s6, 32768
ds_read_b128 a[16:19], v3 offset:11264
buffer_load_dwordx4 v1, s[40:43], 0 offen offset:1024 sc1 lds
v_mfma_f32_16x16x32_bf16 v[128:131], a[80:83], v[228:231], v[128:131]
v_exp_f32 v214, v214
v_mfma_f32_16x16x32_bf16 v[132:135], a[84:87], v[228:231], v[132:135]
ds_read_b128 a[20:23], v3 offset:10240
v_cvt_pk_bf16_f32 v226, v212, v213
v_mfma_f32_16x16x32_bf16 v[136:139], a[88:91], v[228:231], v[136:139]
v_exp_f32 v215, v215
v_mfma_f32_16x16x32_bf16 v[140:143], a[92:95], v[228:231], v[140:143]
ds_read_b128 a[24:27], v3 offset:3072
v_cvt_pk_bf16_f32 v227, v214, v215
v_mfma_f32_16x16x32_bf16 a[132:135], a[136:139], v[228:231], a[132:135]
ds_read_b128 a[28:31], v3 offset:2048
v_mfma_f32_16x16x32_bf16 v[208:211], a[32:35], v[64:67], v[244:247]
v_exp_f32 v216, v216
v_mfma_f32_16x16x32_bf16 v[208:211], a[36:39], v[68:71], v[208:211]
ds_read_b128 a[64:67], v3 offset:4096
v_add_f32 v7, v7, v216
v_mfma_f32_16x16x32_bf16 v[208:211], a[40:43], v[72:75], v[208:211]
v_exp_f32 v217, v217
v_mfma_f32_16x16x32_bf16 v[208:211], a[44:47], v[76:79], v[208:211]
v_cvt_pk_bf16_f32 v228, v216, v217
v_add_f32 v7, v7, v217
v_mfma_f32_16x16x32_bf16 v[212:215], a[48:51], v[76:79], v[244:247]
v_exp_f32 v218, v218
v_mfma_f32_16x16x32_bf16 v[212:215], a[52:55], v[72:75], v[212:215]
buffer_load_dwordx4 v1, s[40:43], 0 offen offset:2048 sc1 lds
v_add_f32 v7, v7, v218
v_mfma_f32_16x16x32_bf16 v[212:215], a[56:59], v[68:71], v[212:215]
v_exp_f32 v219, v219
v_mfma_f32_16x16x32_bf16 v[212:215], a[60:63], v[64:67], v[212:215]
s_waitcnt lgkmcnt(1)
v_cvt_pk_bf16_f32 v229, v218, v219
v_add_f32 v7, v7, v219
v_mfma_f32_16x16x32_bf16 v[80:83], a[96:99], v[224:227], v[80:83]
v_exp_f32 v220, v220
v_mfma_f32_16x16x32_bf16 v[84:87], a[100:103], v[224:227], v[84:87]
v_add_f32 v7, v7, v220
v_mfma_f32_16x16x32_bf16 v[88:91], a[104:107], v[224:227], v[88:91]
v_exp_f32 v221, v221
v_mfma_f32_16x16x32_bf16 v[92:95], a[108:111], v[224:227], v[92:95]
v_cvt_pk_bf16_f32 v230, v220, v221
v_add_f32 v7, v7, v221
v_mfma_f32_16x16x32_bf16 v[96:99], a[112:115], v[224:227], v[96:99]
v_exp_f32 v222, v222
v_mfma_f32_16x16x32_bf16 v[100:103], a[116:119], v[224:227], v[100:103]
buffer_load_dwordx4 v1, s[40:43], 0 offen offset:3072 sc1 lds
v_add_f32 v7, v7, v222
v_mfma_f32_16x16x32_bf16 v[104:107], a[120:123], v[224:227], v[104:107]
s_mov_b32 m0, s7
v_exp_f32 v223, v223
v_mfma_f32_16x16x32_bf16 v[108:111], a[124:127], v[224:227], v[108:111]
s_add_u32 s40, s28, s57
v_cvt_pk_bf16_f32 v231, v222, v223
v_add_f32 v7, v7, v223
v_mfma_f32_16x16x32_bf16 a[128:131], a[136:139], v[224:227], a[128:131]
s_addc_u32 s41, s29, 0
s_bitcmp1_b64 s[60:61], s58
ds_read_b128 a[68:71], v3 offset:5120
v_mfma_f32_16x16x32_bf16 v[216:219], a[32:35], v[32:35], v[236:239]
v_exp_f32 v208, v208
v_mfma_f32_16x16x32_bf16 v[216:219], a[36:39], v[36:39], v[216:219]
ds_read_b128 a[72:75], v3 offset:6144
v_add_f32 v14, v14, v208
v_mfma_f32_16x16x32_bf16 v[216:219], a[40:43], v[40:43], v[216:219]
v_exp_f32 v209, v209
v_mfma_f32_16x16x32_bf16 v[216:219], a[44:47], v[44:47], v[216:219]
v_cvt_pk_bf16_f32 v224, v208, v209
v_add_f32 v14, v14, v209
v_mfma_f32_16x16x32_bf16 v[220:223], a[48:51], v[44:47], v[236:239]
v_exp_f32 v210, v210
v_mfma_f32_16x16x32_bf16 v[220:223], a[52:55], v[40:43], v[220:223]
buffer_load_dwordx4 v1, s[36:39], 0 offen sc1 lds
v_add_f32 v14, v14, v210
v_mfma_f32_16x16x32_bf16 v[220:223], a[56:59], v[36:39], v[220:223]
v_exp_f32 v211, v211
v_mfma_f32_16x16x32_bf16 v[220:223], a[60:63], v[32:35], v[220:223]
v_cvt_pk_bf16_f32 v225, v210, v211
v_add_f32 v14, v14, v211
v_mfma_f32_16x16x32_bf16 v[144:147], a[96:99], v[228:231], v[144:147]
v_exp_f32 v212, v212
v_mfma_f32_16x16x32_bf16 v[148:151], a[100:103], v[228:231], v[148:151]
ds_read_b128 a[76:79], v3 offset:7168
v_add_f32 v14, v14, v212
v_mfma_f32_16x16x32_bf16 v[152:155], a[104:107], v[228:231], v[152:155]
v_exp_f32 v213, v213
v_mfma_f32_16x16x32_bf16 v[156:159], a[108:111], v[228:231], v[156:159]
v_cvt_pk_bf16_f32 v226, v212, v213
v_add_f32 v14, v14, v213
v_mfma_f32_16x16x32_bf16 v[160:163], a[112:115], v[228:231], v[160:163]
v_exp_f32 v214, v214
v_mfma_f32_16x16x32_bf16 v[164:167], a[116:119], v[228:231], v[164:167]
buffer_load_dwordx4 v1, s[36:39], 0 offen offset:1024 sc1 lds
v_add_f32 v14, v14, v214
v_mfma_f32_16x16x32_bf16 v[168:171], a[120:123], v[228:231], v[168:171]
v_exp_f32 v215, v215
v_mfma_f32_16x16x32_bf16 v[172:175], a[124:127], v[228:231], v[172:175]
v_cvt_pk_bf16_f32 v227, v214, v215
v_add_f32 v14, v14, v215
v_mfma_f32_16x16x32_bf16 v[208:211], a[0:3], v[16:19], v[232:235]
v_exp_f32 v216, v216
v_mfma_f32_16x16x32_bf16 v[208:211], a[4:7], v[20:23], v[208:211]
v_exp_f32 v217, v217
v_mfma_f32_16x16x32_bf16 v[208:211], a[8:11], v[24:27], v[208:211]
ds_read_b128 a[80:83], v3 offset:12288
v_cvt_pk_bf16_f32 v228, v216, v217
v_mfma_f32_16x16x32_bf16 v[208:211], a[12:15], v[28:31], v[208:211]
v_exp_f32 v218, v218
v_mfma_f32_16x16x32_bf16 v[212:215], a[16:19], v[28:31], v[232:235]
buffer_load_dwordx4 v1, s[36:39], 0 offen offset:2048 sc1 lds
v_mfma_f32_16x16x32_bf16 v[212:215], a[20:23], v[24:27], v[212:215]
v_exp_f32 v219, v219
v_mfma_f32_16x16x32_bf16 v[212:215], a[24:27], v[20:23], v[212:215]
ds_read_b128 a[84:87], v3 offset:13312
v_cvt_pk_bf16_f32 v229, v218, v219
v_mfma_f32_16x16x32_bf16 v[212:215], a[28:31], v[16:19], v[212:215]
v_exp_f32 v220, v220
v_mfma_f32_16x16x32_bf16 v[176:179], a[96:99], v[224:227], v[176:179]
buffer_load_dwordx4 v1, s[36:39], 0 offen offset:3072 sc1 lds
v_mfma_f32_16x16x32_bf16 v[180:183], a[100:103], v[224:227], v[180:183]
v_exp_f32 v221, v221
v_mfma_f32_16x16x32_bf16 v[184:187], a[104:107], v[224:227], v[184:187]
ds_read_b128 a[88:91], v3 offset:14336
v_cvt_pk_bf16_f32 v230, v220, v221
v_mfma_f32_16x16x32_bf16 v[188:191], a[108:111], v[224:227], v[188:191]
v_exp_f32 v222, v222
v_mfma_f32_16x16x32_bf16 v[192:195], a[112:115], v[224:227], v[192:195]
ds_read_b128 a[92:95], v3 offset:15360
v_add_u32 v3, s6, v1
v_mfma_f32_16x16x32_bf16 v[196:199], a[116:119], v[224:227], v[196:199]
v_exp_f32 v223, v223
v_mfma_f32_16x16x32_bf16 v[200:203], a[120:123], v[224:227], v[200:203]
s_waitcnt vmcnt(12)
v_cvt_pk_bf16_f32 v231, v222, v223
v_mfma_f32_16x16x32_bf16 v[204:207], a[124:127], v[224:227], v[204:207]
s_cbranch_scc1 L_x1
L_D0_0:
v_mfma_f32_16x16x32_bf16 v[216:219], a[0:3], v[48:51], v[240:243]
s_add_u32 s7, s63, s62
v_exp_f32 v208, v208
v_mfma_f32_16x16x32_bf16 v[216:219], a[4:7], v[52:55], v[216:219]
L_pad9:
s_cbranch_execz L_pad13
s_barrier
v_mfma_f32_16x16x32_bf16 v[216:219], a[8:11], v[56:59], v[216:219]
s_add_u32 m0, s7, 16384
v_exp_f32 v209, v209
v_mfma_f32_16x16x32_bf16 v[216:219], a[12:15], v[60:63], v[216:219]
s_add_u32 s36, s28, s26
v_exp_f32 v210, v210
v_mfma_f32_16x16x32_bf16 v[220:223], a[16:19], v[60:63], v[240:243]
s_addc_u32 s37, s29, 0
ds_read_b128 a[32:35], v3 offset:0
v_cvt_pk_bf16_f32 v224, v208, v209
v_mfma_f32_16x16x32_bf16 v[220:223], a[20:23], v[56:59], v[220:223]
s_add_u32 s26, s26, s64
v_exp_f32 v211, v211
v_mfma_f32_16x16x32_bf16 v[220:223], a[24:27], v[52:55], v[220:223]
s_add_u32 s57, s57, s65
ds_read_b128 a[36:39], v3 offset:1024
buffer_load_dwordx4 v1, s[40:43], 0 offen sc1 lds
v_mfma_f32_16x16x32_bf16 v[220:223], a[28:31], v[48:51], v[220:223]
s_add_u32 s62, s62, 32768
v_exp_f32 v212, v212
v_mfma_f32_16x16x32_bf16 v[112:115], a[96:99], v[228:231], v[112:115]
s_and_b32 s62, s62, 131071
ds_read_b128 a[40:43], v3 offset:8192
v_cvt_pk_bf16_f32 v225, v210, v211
v_mfma_f32_16x16x32_bf16 v[116:119], a[100:103], v[228:231], v[116:119]
s_add_u32 s6, s62, 32768
s_and_b32 s6, s6, 131071
ds_read_b128 a[44:47], v3 offset:9216
v_mfma_f32_16x16x32_bf16 v[120:123], a[104:107], v[228:231], v[120:123]
s_add_u32 s58, s58, 1
v_exp_f32 v213, v213
v_mfma_f32_16x16x32_bf16 v[124:127], a[108:111], v[228:231], v[124:127]
s_add_u32 s6, s6, 32768
ds_read_b128 a[48:51], v3 offset:11264
buffer_load_dwordx4 v1, s[40:43], 0 offen offset:1024 sc1 lds
v_mfma_f32_16x16x32_bf16 v[128:131], a[112:115], v[228:231], v[128:131]
v_exp_f32 v214, v214
v_mfma_f32_16x16x32_bf16 v[132:135], a[116:119], v[228:231], v[132:135]
ds_read_b128 a[52:55], v3 offset:10240
v_cvt_pk_bf16_f32 v226, v212, v213
v_mfma_f32_16x16x32_bf16 v[136:139], a[120:123], v[228:231], v[136:139]
v_exp_f32 v215, v215
v_mfma_f32_16x16x32_bf16 v[140:143], a[124:127], v[228:231], v[140:143]
ds_read_b128 a[56:59], v3 offset:3072
v_cvt_pk_bf16_f32 v227, v214, v215
v_mfma_f32_16x16x32_bf16 a[132:135], a[136:139], v[228:231], a[132:135]
ds_read_b128 a[60:63], v3 offset:2048
v_mfma_f32_16x16x32_bf16 v[208:211], a[0:3], v[64:67], v[244:247]
v_exp_f32 v216, v216
v_mfma_f32_16x16x32_bf16 v[208:211], a[4:7], v[68:71], v[208:211]
ds_read_b128 a[96:99], v3 offset:4096
v_add_f32 v7, v7, v216
v_mfma_f32_16x16x32_bf16 v[208:211], a[8:11], v[72:75], v[208:211]
v_exp_f32 v217, v217
v_mfma_f32_16x16x32_bf16 v[208:211], a[12:15], v[76:79], v[208:211]
v_cvt_pk_bf16_f32 v228, v216, v217
v_add_f32 v7, v7, v217
v_mfma_f32_16x16x32_bf16 v[212:215], a[16:19], v[76:79], v[244:247]
v_exp_f32 v218, v218
v_mfma_f32_16x16x32_bf16 v[212:215], a[20:23], v[72:75], v[212:215]
buffer_load_dwordx4 v1, s[40:43], 0 offen offset:2048 sc1 lds
v_add_f32 v7, v7, v218
v_mfma_f32_16x16x32_bf16 v[212:215], a[24:27], v[68:71], v[212:215]
v_exp_f32 v219, v219
v_mfma_f32_16x16x32_bf16 v[212:215], a[28:31], v[64:67], v[212:215]
s_waitcnt lgkmcnt(1)
v_cvt_pk_bf16_f32 v229, v218, v219
v_add_f32 v7, v7, v219
v_mfma_f32_16x16x32_bf16 v[80:83], a[64:67], v[224:227], v[80:83]
v_exp_f32 v220, v220
v_mfma_f32_16x16x32_bf16 v[84:87], a[68:71], v[224:227], v[84:87]
v_add_f32 v7, v7, v220
v_mfma_f32_16x16x32_bf16 v[88:91], a[72:75], v[224:227], v[88:91]
v_exp_f32 v221, v221
v_mfma_f32_16x16x32_bf16 v[92:95], a[76:79], v[224:227], v[92:95]
v_cvt_pk_bf16_f32 v230, v220, v221
v_add_f32 v7, v7, v221
v_mfma_f32_16x16x32_bf16 v[96:99], a[80:83], v[224:227], v[96:99]
v_exp_f32 v222, v222
v_mfma_f32_16x16x32_bf16 v[100:103], a[84:87], v[224:227], v[100:103]
buffer_load_dwordx4 v1, s[40:43], 0 offen offset:3072 sc1 lds
v_add_f32 v7, v7, v222
v_mfma_f32_16x16x32_bf16 v[104:107], a[88:91], v[224:227], v[104:107]
s_mov_b32 m0, s7
v_exp_f32 v223, v223
v_mfma_f32_16x16x32_bf16 v[108:111], a[92:95], v[224:227], v[108:111]
s_add_u32 s40, s28, s57
v_cvt_pk_bf16_f32 v231, v222, v223
v_add_f32 v7, v7, v223
v_mfma_f32_16x16x32_bf16 a[128:131], a[136:139], v[224:227], a[128:131]
s_addc_u32 s41, s29, 0
s_bitcmp1_b64 s[60:61], s58
ds_read_b128 a[100:103], v3 offset:5120
v_mfma_f32_16x16x32_bf16 v[216:219], a[0:3], v[32:35], v[236:239]
v_exp_f32 v208, v208
v_mfma_f32_16x16x32_bf16 v[216:219], a[4:7], v[36:39], v[216:219]
ds_read_b128 a[104:107], v3 offset:6144
v_add_f32 v14, v14, v208
v_mfma_f32_16x16x32_bf16 v[216:219], a[8:11], v[40:43], v[216:219]
v_exp_f32 v209, v209
v_mfma_f32_16x16x32_bf16 v[216:219], a[12:15], v[44:47], v[216:219]
v_cvt_pk_bf16_f32 v224, v208, v209
v_add_f32 v14, v14, v209
v_mfma_f32_16x16x32_bf16 v[220:223], a[16:19], v[44:47], v[236:239]
v_exp_f32 v210, v210
v_mfma_f32_16x16x32_bf16 v[220:223], a[20:23], v[40:43], v[220:223]
buffer_load_dwordx4 v1, s[36:39], 0 offen sc1 lds
v_add_f32 v14, v14, v210
v_mfma_f32_16x16x32_bf16 v[220:223], a[24:27], v[36:39], v[220:223]
v_exp_f32 v211, v211
v_mfma_f32_16x16x32_bf16 v[220:223], a[28:31], v[32:35], v[220:223]
v_cvt_pk_bf16_f32 v225, v210, v211
v_add_f32 v14, v14, v211
v_mfma_f32_16x16x32_bf16 v[144:147], a[64:67], v[228:231], v[144:147]
v_exp_f32 v212, v212
v_mfma_f32_16x16x32_bf16 v[148:151], a[68:71], v[228:231], v[148:151]
ds_read_b128 a[108:111], v3 offset:7168
v_add_f32 v14, v14, v212
v_mfma_f32_16x16x32_bf16 v[152:155], a[72:75], v[228:231], v[152:155]
v_exp_f32 v213, v213
v_mfma_f32_16x16x32_bf16 v[156:159], a[76:79], v[228:231], v[156:159]
v_cvt_pk_bf16_f32 v226, v212, v213
v_add_f32 v14, v14, v213
v_mfma_f32_16x16x32_bf16 v[160:163], a[80:83], v[228:231], v[160:163]
v_exp_f32 v214, v214
v_mfma_f32_16x16x32_bf16 v[164:167], a[84:87], v[228:231], v[164:167]
buffer_load_dwordx4 v1, s[36:39], 0 offen offset:1024 sc1 lds
v_add_f32 v14, v14, v214
v_mfma_f32_16x16x32_bf16 v[168:171], a[88:91], v[228:231], v[168:171]
v_exp_f32 v215, v215
v_mfma_f32_16x16x32_bf16 v[172:175], a[92:95], v[228:231], v[172:175]
v_cvt_pk_bf16_f32 v227, v214, v215
v_add_f32 v14, v14, v215
v_mfma_f32_16x16x32_bf16 v[208:211], a[32:35], v[16:19], v[232:235]
v_exp_f32 v216, v216
v_mfma_f32_16x16x32_bf16 v[208:211], a[36:39], v[20:23], v[208:211]
v_exp_f32 v217, v217
v_mfma_f32_16x16x32_bf16 v[208:211], a[40:43], v[24:27], v[208:211]
ds_read_b128 a[112:115], v3 offset:12288
v_cvt_pk_bf16_f32 v228, v216, v217
v_mfma_f32_16x16x32_bf16 v[208:211], a[44:47], v[28:31], v[208:211]
v_exp_f32 v218, v218
v_mfma_f32_16x16x32_bf16 v[212:215], a[48:51], v[28:31], v[232:235]
buffer_load_dwordx4 v1, s[36:39], 0 offen offset:2048 sc1 lds
v_mfma_f32_16x16x32_bf16 v[212:215], a[52:55], v[24:27], v[212:215]
v_exp_f32 v219, v219
v_mfma_f32_16x16x32_bf16 v[212:215], a[56:59], v[20:23], v[212:215]
ds_read_b128 a[116:119], v3 offset:13312
v_cvt_pk_bf16_f32 v229, v218, v219
v_mfma_f32_16x16x32_bf16 v[212:215], a[60:63], v[16:19], v[212:215]
v_exp_f32 v220, v220
v_mfma_f32_16x16x32_bf16 v[176:179], a[64:67], v[224:227], v[176:179]
buffer_load_dwordx4 v1, s[36:39], 0 offen offset:3072 sc1 lds
v_mfma_f32_16x16x32_bf16 v[180:183], a[68:71], v[224:227], v[180:183]
v_exp_f32 v221, v221
v_mfma_f32_16x16x32_bf16 v[184:187], a[72:75], v[224:227], v[184:187]
ds_read_b128 a[120:123], v3 offset:14336
v_cvt_pk_bf16_f32 v230, v220, v221
v_mfma_f32_16x16x32_bf16 v[188:191], a[76:79], v[224:227], v[188:191]
v_exp_f32 v222, v222
v_mfma_f32_16x16x32_bf16 v[192:195], a[80:83], v[224:227], v[192:195]
ds_read_b128 a[124:127], v3 offset:15360
v_add_u32 v3, s6, v1
v_mfma_f32_16x16x32_bf16 v[196:199], a[84:87], v[224:227], v[196:199]
v_exp_f32 v223, v223
v_mfma_f32_16x16x32_bf16 v[200:203], a[88:91], v[224:227], v[200:203]
s_waitcnt vmcnt(12)
v_cvt_pk_bf16_f32 v231, v222, v223
v_mfma_f32_16x16x32_bf16 v[204:207], a[92:95], v[224:227], v[204:207]
s_cbranch_scc0 L_D1_0
s_cmp_ge_u32 s58, 28
s_cbranch_scc1 L_evd
L_DL_0:
v_mfma_f32_16x16x32_bf16 v[216:219], a[32:35], v[48:51], v[248:251]
s_add_u32 s7, s63, s62
v_exp_f32 v208, v208
v_mfma_f32_16x16x32_bf16 v[216:219], a[36:39], v[52:55], v[216:219]
s_barrier
v_mfma_f32_16x16x32_bf16 v[216:219], a[40:43], v[56:59], v[216:219]
s_add_u32 m0, s7, 16384
v_exp_f32 v209, v209
v_mfma_f32_16x16x32_bf16 v[216:219], a[44:47], v[60:63], v[216:219]
s_add_u32 s36, s28, s26
v_exp_f32 v210, v210
v_mfma_f32_16x16x32_bf16 v[220:223], a[48:51], v[60:63], v[240:243]
s_addc_u32 s37, s29, 0
ds_read_b128 a[0:3], v3 offset:0
v_cvt_pk_bf16_f32 v224, v208, v209
v_mfma_f32_16x16x32_bf16 v[220:223], a[52:55], v[56:59], v[220:223]
s_add_u32 s26, s26, s64
v_exp_f32 v211, v211
v_mfma_f32_16x16x32_bf16 v[220:223], a[56:59], v[52:55], v[220:223]
s_add_u32 s57, s57, s65
ds_read_b128 a[4:7], v3 offset:1024
buffer_load_dwordx4 v1, s[40:43], 0 offen sc1 lds
v_mfma_f32_16x16x32_bf16 v[220:223], a[60:63], v[48:51], v[220:223]
s_add_u32 s62, s62, 32768
v_exp_f32 v212, v212
v_mfma_f32_16x16x32_bf16 v[112:115], a[64:67], v[228:231], v[112:115]
s_and_b32 s62, s62, 131071
buffer_store_dwordx4 a[252:255], v1, s[28:31], s95 offen offset:0 sc1
ds_read_b128 a[8:11], v3 offset:8192
v_cvt_pk_bf16_f32 v225, v210, v211
v_mfma_f32_16x16x32_bf16 v[116:119], a[68:71], v[228:231], v[116:119]
s_add_u32 s6, s62, 32768
s_and_b32 s6, s6, 131071
ds_read_b128 a[12:15], v3 offset:9216
v_mfma_f32_16x16x32_bf16 v[120:123], a[72:75], v[228:231], v[120:123]
s_add_u32 s58, s58, 1
v_exp_f32 v213, v213
v_mfma_f32_16x16x32_bf16 v[124:127], a[76:79], v[228:231], v[124:127]
s_add_u32 s6, s6, 32768
ds_read_b128 a[16:19], v3 offset:11264
buffer_load_dwordx4 v1, s[40:43], 0 offen offset:1024 sc1 lds
v_mfma_f32_16x16x32_bf16 v[128:131], a[80:83], v[228:231], v[128:131]
v_exp_f32 v214, v214
v_mfma_f32_16x16x32_bf16 v[132:135], a[84:87], v[228:231], v[132:135]
ds_read_b128 a[20:23], v3 offset:10240
v_cvt_pk_bf16_f32 v226, v212, v213
v_mfma_f32_16x16x32_bf16 v[136:139], a[88:91], v[228:231], v[136:139]
v_exp_f32 v215, v215
v_mfma_f32_16x16x32_bf16 v[140:143], a[92:95], v[228:231], v[140:143]
ds_read_b128 a[24:27], v3 offset:3072
v_cvt_pk_bf16_f32 v227, v214, v215
v_mfma_f32_16x16x32_bf16 a[132:135], a[136:139], v[228:231], a[132:135]
ds_read_b128 a[28:31], v3 offset:2048
global_load_dwordx4 a[196:199], v1, s[48:49] offset:-2048 sc1
v_mfma_f32_16x16x32_bf16 v[208:211], a[32:35], v[64:67], v[244:247]
buffer_store_dwordx4 a[252:255], v1, s[28:31], s95 offen offset:1024 sc1
v_exp_f32 v216, v216
v_mfma_f32_16x16x32_bf16 v[208:211], a[36:39], v[68:71], v[208:211]
ds_read_b128 a[64:67], v3 offset:4096
v_add_f32 v7, v7, v216
v_mfma_f32_16x16x32_bf16 v[208:211], a[40:43], v[72:75], v[208:211]
v_exp_f32 v217, v217
v_mfma_f32_16x16x32_bf16 v[208:211], a[44:47], v[76:79], v[208:211]
v_cvt_pk_bf16_f32 v228, v216, v217
v_add_f32 v7, v7, v217
v_mfma_f32_16x16x32_bf16 v[212:215], a[48:51], v[76:79], v[252:255]
v_exp_f32 v218, v218
v_mfma_f32_16x16x32_bf16 v[212:215], a[52:55], v[72:75], v[212:215]
buffer_load_dwordx4 v1, s[40:43], 0 offen offset:2048 sc1 lds
v_add_f32 v7, v7, v218
v_mfma_f32_16x16x32_bf16 v[212:215], a[56:59], v[68:71], v[212:215]
v_exp_f32 v219, v219
v_mfma_f32_16x16x32_bf16 v[212:215], a[60:63], v[64:67], v[212:215]
s_waitcnt lgkmcnt(1)
v_cvt_pk_bf16_f32 v229, v218, v219
v_add_f32 v7, v7, v219
v_mfma_f32_16x16x32_bf16 v[80:83], a[96:99], v[224:227], v[80:83]
v_mov_b32 v230, 0
v_mov_b32 v231, 0
v_mfma_f32_16x16x32_bf16 v[84:87], a[100:103], v[224:227], v[84:87]
buffer_store_dwordx4 a[252:255], v1, s[28:31], s96 offen offset:0 sc1
v_mfma_f32_16x16x32_bf16 v[88:91], a[104:107], v[224:227], v[88:91]
v_mfma_f32_16x16x32_bf16 v[92:95], a[108:111], v[224:227], v[92:95]
v_mfma_f32_16x16x32_bf16 v[96:99], a[112:115], v[224:227], v[96:99]
v_mfma_f32_16x16x32_bf16 v[100:103], a[116:119], v[224:227], v[100:103]
buffer_load_dwordx4 v1, s[40:43], 0 offen offset:3072 sc1 lds
v_mfma_f32_16x16x32_bf16 v[104:107], a[120:123], v[224:227], v[104:107]
s_mov_b32 m0, s7
s_add_u32 s40, s28, s57
s_addc_u32 s41, s29, 0
v_mfma_f32_16x16x32_bf16 v[108:111], a[124:127], v[224:227], v[108:111]
s_cmp_lg_u32 s67, 0
s_cselect_b64 vcc, -1, 0
s_bitcmp1_b64 s[60:61], s58
v_mfma_f32_16x16x32_bf16 a[128:131], a[136:139], v[224:227], a[128:131]
ds_read_b128 a[68:71], v3 offset:5120
global_load_dwordx4 a[200:203], v1, s[48:49] offset:-1024 sc1
v_mfma_f32_16x16x32_bf16 v[216:219], a[32:35], v[32:35], v[236:239]
v_exp_f32 v208, v208
v_mfma_f32_16x16x32_bf16 v[216:219], a[36:39], v[36:39], v[216:219]
buffer_store_dwordx4 a[252:255], v1, s[28:31], s96 offen offset:1024 sc1
ds_read_b128 a[72:75], v3 offset:6144
v_add_f32 v14, v14, v208
v_mfma_f32_16x16x32_bf16 v[216:219], a[40:43], v[40:43], v[216:219]
v_exp_f32 v209, v209
v_mfma_f32_16x16x32_bf16 v[216:219], a[44:47], v[44:47], v[216:219]
v_cvt_pk_bf16_f32 v224, v208, v209
v_add_f32 v14, v14, v209
v_mfma_f32_16x16x32_bf16 v[220:223], a[48:51], v[44:47], v[236:239]
v_exp_f32 v210, v210
v_mfma_f32_16x16x32_bf16 v[220:223], a[52:55], v[40:43], v[220:223]
buffer_load_dwordx4 v1, s[36:39], 0 offen sc1 lds
v_add_f32 v14, v14, v210
v_mfma_f32_16x16x32_bf16 v[220:223], a[56:59], v[36:39], v[220:223]
v_exp_f32 v211, v211
v_mfma_f32_16x16x32_bf16 v[220:223], a[60:63], v[32:35], v[220:223]
v_cvt_pk_bf16_f32 v225, v210, v211
v_add_f32 v14, v14, v211
v_mfma_f32_16x16x32_bf16 v[144:147], a[96:99], v[228:231], v[144:147]
v_exp_f32 v212, v212
v_mfma_f32_16x16x32_bf16 v[148:151], a[100:103], v[228:231], v[148:151]
ds_read_b128 a[76:79], v3 offset:7168
v_add_f32 v14, v14, v212
v_mfma_f32_16x16x32_bf16 v[152:155], a[104:107], v[228:231], v[152:155]
buffer_store_dwordx4 a[252:255], v1, s[28:31], s85 offen offset:0 sc1
v_exp_f32 v213, v213
v_mfma_f32_16x16x32_bf16 v[156:159], a[108:111], v[228:231], v[156:159]
v_cvt_pk_bf16_f32 v226, v212, v213
v_add_f32 v14, v14, v213
v_mfma_f32_16x16x32_bf16 v[160:163], a[112:115], v[228:231], v[160:163]
v_exp_f32 v214, v214
v_mfma_f32_16x16x32_bf16 v[164:167], a[116:119], v[228:231], v[164:167]
buffer_load_dwordx4 v1, s[36:39], 0 offen offset:1024 sc1 lds
v_add_f32 v14, v14, v214
v_mfma_f32_16x16x32_bf16 v[168:171], a[120:123], v[228:231], v[168:171]
v_exp_f32 v215, v215
v_mfma_f32_16x16x32_bf16 v[172:175], a[124:127], v[228:231], v[172:175]
v_cvt_pk_bf16_f32 v227, v214, v215
v_add_f32 v14, v14, v215
v_mfma_f32_16x16x32_bf16 v[208:211], a[0:3], v[16:19], v[232:235]
v_exp_f32 v216, v216
v_mfma_f32_16x16x32_bf16 v[208:211], a[4:7], v[20:23], v[208:211]
v_exp_f32 v217, v217
v_mfma_f32_16x16x32_bf16 v[208:211], a[8:11], v[24:27], v[208:211]
ds_read_b128 a[80:83], v3 offset:12288
v_cvt_pk_bf16_f32 v228, v216, v217
v_mfma_f32_16x16x32_bf16 v[208:211], a[12:15], v[28:31], v[208:211]
buffer_store_dwordx4 a[252:255], v1, s[28:31], s85 offen offset:1024 sc1
v_exp_f32 v218, v218
v_mfma_f32_16x16x32_bf16 v[212:215], a[16:19], v[28:31], v[232:235]
v_mfma_f32_16x16x32_bf16 v[212:215], a[20:23], v[24:27], v[212:215]
v_exp_f32 v219, v219
v_mfma_f32_16x16x32_bf16 v[212:215], a[24:27], v[20:23], v[212:215]
ds_read_b128 a[84:87], v3 offset:13312
buffer_load_dwordx4 v1, s[36:39], 0 offen offset:2048 sc1 lds
v_mfma_f32_16x16x32_bf16 v[212:215], a[28:31], v[16:19], v[212:215]
v_exp_f32 v220, v220
v_mfma_f32_16x16x32_bf16 v[176:179], a[96:99], v[224:227], v[176:179]
buffer_load_dwordx4 v1, s[36:39], 0 offen offset:3072 sc1 lds
v_cvt_pk_bf16_f32 v229, v218, v219
v_mfma_f32_16x16x32_bf16 v[180:183], a[100:103], v[224:227], v[180:183]
v_exp_f32 v221, v221
v_mfma_f32_16x16x32_bf16 v[184:187], a[104:107], v[224:227], v[184:187]
ds_read_b128 a[88:91], v3 offset:14336
v_cvt_pk_bf16_f32 v230, v220, v221
v_mfma_f32_16x16x32_bf16 v[188:191], a[108:111], v[224:227], v[188:191]
v_exp_f32 v222, v222
v_mfma_f32_16x16x32_bf16 v[192:195], a[112:115], v[224:227], v[192:195]
ds_read_b128 a[92:95], v3 offset:15360
v_add_u32 v3, s6, v1
v_mfma_f32_16x16x32_bf16 v[196:199], a[116:119], v[224:227], v[196:199]
v_exp_f32 v223, v223
v_mfma_f32_16x16x32_bf16 v[200:203], a[120:123], v[224:227], v[200:203]
s_waitcnt vmcnt(16)
global_load_dwordx4 a[204:207], v1, s[48:49] offset:0 sc1
v_cvt_pk_bf16_f32 v231, v222, v223
v_mfma_f32_16x16x32_bf16 v[204:207], a[124:127], v[224:227], v[204:207]
s_cbranch_vccnz L_DL_0r
L_DL_0b:
s_cbranch_scc1 L_ev
L_SF_0:
v_mfma_f32_16x16x32_bf16 v[216:219], a[0:3], v[32:35], v[236:239]
s_add_u32 s7, s63, s62
v_exp_f32 v208, v208
v_mfma_f32_16x16x32_bf16 v[216:219], a[4:7], v[36:39], v[216:219]
s_barrier
v_mfma_f32_16x16x32_bf16 v[216:219], a[8:11], v[40:43], v[216:219]
s_add_u32 m0, s7, 16384
v_exp_f32 v209, v209
v_mfma_f32_16x16x32_bf16 v[216:219], a[12:15], v[44:47], v[216:219]
s_add_u32 s36, s28, s26
v_exp_f32 v210, v210
v_mfma_f32_16x16x32_bf16 v[220:223], a[16:19], v[44:47], v[236:239]
s_addc_u32 s37, s29, 0
ds_read_b128 a[32:35], v3 offset:16384
v_cvt_pk_bf16_f32 v224, v208, v209
v_mfma_f32_16x16x32_bf16 v[220:223], a[20:23], v[40:43], v[220:223]
s_add_u32 s26, s26, s64
v_exp_f32 v211, v211
v_mfma_f32_16x16x32_bf16 v[220:223], a[24:27], v[36:39], v[220:223]
s_add_u32 s57, s57, s65
ds_read_b128 a[36:39], v3 offset:17408
buffer_load_dwordx4 v1, s[40:43], 0 offen sc1 lds
v_mfma_f32_16x16x32_bf16 v[220:223], a[28:31], v[32:35], v[220:223]
s_add_u32 s62, s62, 32768
v_exp_f32 v212, v212
v_mfma_f32_16x16x32_bf16 v[112:115], a[96:99], v[228:231], v[112:115]
s_and_b32 s62, s62, 131071
ds_read_b128 a[40:43], v3 offset:24576
v_cvt_pk_bf16_f32 v225, v210, v211
v_mfma_f32_16x16x32_bf16 v[116:119], a[100:103], v[228:231], v[116:119]
s_add_u32 s6, s62, 32768
ds_read_b128 a[44:47], v3 offset:25600
global_load_dwordx4 a[208:211], v1, s[48:49] offset:1024 sc1
v_mfma_f32_16x16x32_bf16 v[120:123], a[104:107], v[228:231], v[120:123]
s_and_b32 s6, s6, 131071
v_exp_f32 v213, v213
v_mfma_f32_16x16x32_bf16 v[124:127], a[108:111], v[228:231], v[124:127]
s_add_u32 s58, s58, 1
ds_read_b128 a[48:51], v3 offset:27648
buffer_load_dwordx4 v1, s[40:43], 0 offen offset:1024 sc1 lds
v_mfma_f32_16x16x32_bf16 v[128:131], a[112:115], v[228:231], v[128:131]
s_add_u32 s6, s6, 32768
v_exp_f32 v214, v214
v_mfma_f32_16x16x32_bf16 v[132:135], a[116:119], v[228:231], v[132:135]
ds_read_b128 a[52:55], v3 offset:26624
v_cvt_pk_bf16_f32 v226, v212, v213
v_mfma_f32_16x16x32_bf16 v[136:139], a[120:123], v[228:231], v[136:139]
v_exp_f32 v215, v215
v_mfma_f32_16x16x32_bf16 v[140:143], a[124:127], v[228:231], v[140:143]
ds_read_b128 a[56:59], v3 offset:19456
v_cvt_pk_bf16_f32 v227, v214, v215
v_mfma_f32_16x16x32_bf16 a[132:135], a[136:139], v[228:231], a[132:135]
s_waitcnt lgkmcnt(3)
ds_read_b128 a[60:63], v3 offset:18432
global_load_dwordx4 a[212:215], v1, s[48:49] offset:2048 sc1
v_mfma_f32_16x16x32_bf16 v[208:211], a[32:35], v[16:19], v[248:251]
v_exp_f32 v216, v216
v_mfma_f32_16x16x32_bf16 v[208:211], a[36:39], v[20:23], v[208:211]
ds_read_b128 a[96:99], v3 offset:20480
v_mfma_f32_16x16x32_bf16 v[208:211], a[40:43], v[24:27], v[208:211]
v_exp_f32 v217, v217
v_mfma_f32_16x16x32_bf16 v[208:211], a[44:47], v[28:31], v[208:211]
s_waitcnt lgkmcnt(3)
ds_read_b128 a[100:103], v3 offset:21504
v_cvt_pk_bf16_f32 v228, v216, v217
v_mfma_f32_16x16x32_bf16 v[212:215], a[48:51], v[28:31], v[232:235]
v_exp_f32 v218, v218
v_mfma_f32_16x16x32_bf16 v[212:215], a[52:55], v[24:27], v[212:215]
s_waitcnt lgkmcnt(3)
ds_read_b128 a[104:107], v3 offset:22528
buffer_load_dwordx4 v1, s[40:43], 0 offen offset:2048 sc1 lds
v_mfma_f32_16x16x32_bf16 v[212:215], a[56:59], v[20:23], v[212:215]
s_waitcnt lgkmcnt(3)
v_exp_f32 v219, v219
v_mfma_f32_16x16x32_bf16 v[212:215], a[60:63], v[16:19], v[212:215]
ds_read_b128 a[108:111], v3 offset:23552
v_cvt_pk_bf16_f32 v229, v218, v219
v_mfma_f32_16x16x32_bf16 v[80:83], a[64:67], v[224:227], v[80:83]
v_exp_f32 v220, v220
v_mfma_f32_16x16x32_bf16 v[84:87], a[68:71], v[224:227], v[84:87]
ds_read_b128 a[112:115], v3 offset:28672
global_load_dwordx4 a[216:219], v1, s[48:49] offset:3072 sc1
v_mfma_f32_16x16x32_bf16 v[88:91], a[72:75], v[224:227], v[88:91]
v_exp_f32 v221, v221
v_mfma_f32_16x16x32_bf16 v[92:95], a[76:79], v[224:227], v[92:95]
ds_read_b128 a[116:119], v3 offset:29696
v_cvt_pk_bf16_f32 v230, v220, v221
v_mfma_f32_16x16x32_bf16 v[96:99], a[80:83], v[224:227], v[96:99]
v_exp_f32 v222, v222
v_mfma_f32_16x16x32_bf16 v[100:103], a[84:87], v[224:227], v[100:103]
ds_read_b128 a[120:123], v3 offset:30720
buffer_load_dwordx4 v1, s[40:43], 0 offen offset:3072 sc1 lds
v_mfma_f32_16x16x32_bf16 v[104:107], a[88:91], v[224:227], v[104:107]
s_mov_b32 m0, s7
v_exp_f32 v223, v223
v_mfma_f32_16x16x32_bf16 v[108:111], a[92:95], v[224:227], v[108:111]
s_add_u32 s40, s28, s57
ds_read_b128 a[124:127], v3 offset:31744
v_cvt_pk_bf16_f32 v231, v222, v223
v_mfma_f32_16x16x32_bf16 a[128:131], a[136:139], v[224:227], a[128:131]
s_addc_u32 s41, s29, 0
s_bitcmp1_b64 s[60:61], s58
global_load_dwordx4 a[220:223], v1, s[50:51] offset:-4096 sc1
v_mfma_f32_16x16x32_bf16 v[216:219], a[32:35], v[32:35], v[236:239]
v_exp_f32 v208, v208
v_mfma_f32_16x16x32_bf16 v[216:219], a[36:39], v[36:39], v[216:219]
ds_read_b128 a[0:3], v3 offset:0
v_mfma_f32_16x16x32_bf16 v[216:219], a[40:43], v[40:43], v[216:219]
v_exp_f32 v209, v209
v_mfma_f32_16x16x32_bf16 v[216:219], a[44:47], v[44:47], v[216:219]
ds_read_b128 a[4:7], v3 offset:1024
v_cvt_pk_bf16_f32 v224, v208, v209
v_mfma_f32_16x16x32_bf16 v[220:223], a[48:51], v[44:47], v[252:255]
v_exp_f32 v210, v210
v_mfma_f32_16x16x32_bf16 v[220:223], a[52:55], v[40:43], v[220:223]
ds_read_b128 a[8:11], v3 offset:8192
buffer_load_dwordx4 v1, s[36:39], 0 offen sc1 lds
v_mfma_f32_16x16x32_bf16 v[220:223], a[56:59], v[36:39], v[220:223]
v_exp_f32 v211, v211
v_mfma_f32_16x16x32_bf16 v[220:223], a[60:63], v[32:35], v[220:223]
ds_read_b128 a[12:15], v3 offset:9216
v_cvt_pk_bf16_f32 v225, v210, v211
v_mfma_f32_16x16x32_bf16 v[112:115], a[64:67], v[228:231], v[112:115]
global_load_dwordx4 a[224:227], v1, s[50:51] offset:-3072 sc1
v_mov_b32 v226, 0
v_mov_b32 v227, 0
v_mfma_f32_16x16x32_bf16 v[116:119], a[68:71], v[228:231], v[116:119]
ds_read_b128 a[16:19], v3 offset:11264
v_mfma_f32_16x16x32_bf16 v[120:123], a[72:75], v[228:231], v[120:123]
v_mfma_f32_16x16x32_bf16 v[124:127], a[76:79], v[228:231], v[124:127]
ds_read_b128 a[20:23], v3 offset:10240
v_mfma_f32_16x16x32_bf16 v[128:131], a[80:83], v[228:231], v[128:131]
global_load_dwordx4 a[228:231], v1, s[50:51] offset:-2048 sc1
v_mfma_f32_16x16x32_bf16 v[132:135], a[84:87], v[228:231], v[132:135]
ds_read_b128 a[24:27], v3 offset:3072
buffer_load_dwordx4 v1, s[36:39], 0 offen offset:1024 sc1 lds
v_mfma_f32_16x16x32_bf16 v[136:139], a[88:91], v[228:231], v[136:139]
v_mfma_f32_16x16x32_bf16 v[140:143], a[92:95], v[228:231], v[140:143]
ds_read_b128 a[28:31], v3 offset:2048
v_mfma_f32_16x16x32_bf16 a[132:135], a[136:139], v[228:231], a[132:135]
s_waitcnt lgkmcnt(3)
global_load_dwordx4 a[232:235], v1, s[50:51] offset:-1024 sc1
v_mfma_f32_16x16x32_bf16 v[208:211], a[0:3], v[16:19], v[232:235]
v_exp_f32 v216, v216
v_mfma_f32_16x16x32_bf16 v[208:211], a[4:7], v[20:23], v[208:211]
v_exp_f32 v217, v217
v_mfma_f32_16x16x32_bf16 v[208:211], a[8:11], v[24:27], v[208:211]
ds_read_b128 a[64:67], v3 offset:4096
v_cvt_pk_bf16_f32 v228, v216, v217
v_mfma_f32_16x16x32_bf16 v[208:211], a[12:15], v[28:31], v[208:211]
v_exp_f32 v218, v218
v_mfma_f32_16x16x32_bf16 v[212:215], a[16:19], v[28:31], v[232:235]
s_waitcnt lgkmcnt(2)
ds_read_b128 a[68:71], v3 offset:5120
buffer_load_dwordx4 v1, s[36:39], 0 offen offset:2048 sc1 lds
v_mfma_f32_16x16x32_bf16 v[212:215], a[20:23], v[24:27], v[212:215]
v_exp_f32 v219, v219
v_mfma_f32_16x16x32_bf16 v[212:215], a[24:27], v[20:23], v[212:215]
s_waitcnt lgkmcnt(2)
ds_read_b128 a[72:75], v3 offset:6144
v_cvt_pk_bf16_f32 v229, v218, v219
v_mfma_f32_16x16x32_bf16 v[212:215], a[28:31], v[16:19], v[212:215]
v_exp_f32 v220, v220
v_mfma_f32_16x16x32_bf16 v[80:83], a[96:99], v[224:227], v[80:83]
ds_read_b128 a[76:79], v3 offset:7168
buffer_load_dwordx4 v1, s[36:39], 0 offen offset:3072 sc1 lds
v_mfma_f32_16x16x32_bf16 v[84:87], a[100:103], v[224:227], v[84:87]
v_exp_f32 v221, v221
v_mfma_f32_16x16x32_bf16 v[88:91], a[104:107], v[224:227], v[88:91]
ds_read_b128 a[80:83], v3 offset:12288
v_cvt_pk_bf16_f32 v230, v220, v221
v_mfma_f32_16x16x32_bf16 v[92:95], a[108:111], v[224:227], v[92:95]
v_exp_f32 v222, v222
v_mfma_f32_16x16x32_bf16 v[96:99], a[112:115], v[224:227], v[96:99]
ds_read_b128 a[84:87], v3 offset:13312
global_load_dwordx4 a[236:239], v1, s[50:51] offset:0 sc1
v_mfma_f32_16x16x32_bf16 v[100:103], a[116:119], v[224:227], v[100:103]
v_exp_f32 v223, v223
v_mfma_f32_16x16x32_bf16 v[104:107], a[120:123], v[224:227], v[104:107]
ds_read_b128 a[88:91], v3 offset:14336
v_cvt_pk_bf16_f32 v231, v222, v223
v_mfma_f32_16x16x32_bf16 v[108:111], a[124:127], v[224:227], v[108:111]
s_waitcnt vmcnt(16)
ds_read_b128 a[92:95], v3 offset:15360
v_add_u32 v3, s6, v1
v_mfma_f32_16x16x32_bf16 a[128:131], a[136:139], v[224:227], a[128:131]
global_load_dwordx4 a[240:243], v1, s[50:51] offset:1024 sc1
global_load_dwordx4 a[244:247], v1, s[50:51] offset:2048 sc1
global_load_dwordx4 a[248:251], v1, s[50:51] offset:3072 sc1
s_cbranch_scc1 L_ev
s_cmp_lt_u32 s58, s24
s_cbranch_scc1 L_R_0
.p2align 4
L_S_0:
v_mfma_f32_16x16x32_bf16 v[216:219], a[0:3], v[32:35], v[236:239]
s_barrier
v_mfma_f32_16x16x32_bf16 v[216:219], a[4:7], v[36:39], v[216:219]
s_add_u32 s7, s63, s62
s_add_u32 m0, s7, 16384
ds_read_b128 a[32:35], v3 offset:16384
v_mfma_f32_16x16x32_bf16 v[216:219], a[8:11], v[40:43], v[216:219]
s_add_u32 s36, s28, s26
s_addc_u32 s37, s29, 0
ds_read_b128 a[36:39], v3 offset:17408
v_mfma_f32_16x16x32_bf16 v[216:219], a[12:15], v[44:47], v[216:219]
s_add_u32 s26, s26, s64
s_add_u32 s57, s57, s65
ds_read_b128 a[40:43], v3 offset:24576
v_mfma_f32_16x16x32_bf16 v[220:223], a[16:19], v[44:47], v[236:239]
s_add_u32 s62, s62, 32768
s_and_b32 s62, s62, 131071
ds_read_b128 a[44:47], v3 offset:25600
v_mfma_f32_16x16x32_bf16 v[220:223], a[20:23], v[40:43], v[220:223]
s_add_u32 s6, s62, 32768
v_exp_f32 v208, v208
v_mfma_f32_16x16x32_bf16 v[220:223], a[24:27], v[36:39], v[220:223]
s_and_b32 s6, s6, 131071
ds_read_b128 a[48:51], v3 offset:27648
buffer_load_dwordx4 v1, s[40:43], 0 offen sc1 lds
v_mfma_f32_16x16x32_bf16 v[220:223], a[28:31], v[32:35], v[220:223]
s_add_u32 s58, s58, 1
v_exp_f32 v209, v209
v_mfma_f32_16x16x32_bf16 a[132:135], a[136:139], v[228:231], a[132:135]
s_waitcnt lgkmcnt(4)
ds_read_b128 a[52:55], v3 offset:26624
v_cvt_pk_bf16_f32 v224, v208, v209
v_mfma_f32_16x16x32_bf16 v[144:147], a[32:35], v[16:19], v[232:235]
s_waitcnt lgkmcnt(4)
v_exp_f32 v216, v216
v_mfma_f32_16x16x32_bf16 v[144:147], a[36:39], v[20:23], v[144:147]
s_waitcnt lgkmcnt(3)
s_add_u32 s6, s6, 32768
ds_read_b128 a[56:59], v3 offset:19456
v_mfma_f32_16x16x32_bf16 v[144:147], a[40:43], v[24:27], v[144:147]
s_waitcnt lgkmcnt(3)
v_exp_f32 v217, v217
v_mfma_f32_16x16x32_bf16 v[144:147], a[44:47], v[28:31], v[144:147]
ds_read_b128 a[60:63], v3 offset:18432
v_cvt_pk_bf16_f32 v160, v216, v217
v_mfma_f32_16x16x32_bf16 v[152:155], a[44:47], v[44:47], v[236:239]
v_exp_f32 v218, v218
v_mfma_f32_16x16x32_bf16 v[152:155], a[40:43], v[40:43], v[152:155]
ds_read_b128 a[0:3], v3 offset:0
buffer_load_dwordx4 v1, s[40:43], 0 offen offset:1024 sc1 lds
v_mfma_f32_16x16x32_bf16 v[152:155], a[36:39], v[36:39], v[152:155]
v_exp_f32 v219, v219
v_mfma_f32_16x16x32_bf16 v[152:155], a[32:35], v[32:35], v[152:155]
s_waitcnt lgkmcnt(3)
ds_read_b128 a[4:7], v3 offset:1024
v_cvt_pk_bf16_f32 v161, v218, v219
v_mfma_f32_16x16x32_bf16 v[156:159], a[48:51], v[44:47], v[236:239]
v_exp_f32 v220, v220
v_mfma_f32_16x16x32_bf16 v[156:159], a[52:55], v[40:43], v[156:159]
s_waitcnt lgkmcnt(3)
ds_read_b128 a[8:11], v3 offset:8192
v_mfma_f32_16x16x32_bf16 v[156:159], a[56:59], v[36:39], v[156:159]
s_waitcnt lgkmcnt(3)
v_exp_f32 v221, v221
v_mfma_f32_16x16x32_bf16 v[156:159], a[60:63], v[32:35], v[156:159]
L_pad10:
s_cbranch_execz L_pad14
ds_read_b128 a[12:15], v3 offset:9216
v_cvt_pk_bf16_f32 v162, v220, v221
v_mfma_f32_16x16x32_bf16 v[148:151], a[60:63], v[16:19], v[232:235]
v_exp_f32 v222, v222
v_mfma_f32_16x16x32_bf16 v[148:151], a[56:59], v[20:23], v[148:151]
ds_read_b128 a[16:19], v3 offset:11264
buffer_load_dwordx4 v1, s[40:43], 0 offen offset:2048 sc1 lds
v_mfma_f32_16x16x32_bf16 v[148:151], a[52:55], v[24:27], v[148:151]
v_exp_f32 v223, v223
v_mfma_f32_16x16x32_bf16 v[148:151], a[48:51], v[28:31], v[148:151]
ds_read_b128 a[20:23], v3 offset:10240
v_cvt_pk_bf16_f32 v163, v222, v223
v_mfma_f32_16x16x32_bf16 v[112:115], a[96:99], v[228:231], v[112:115]
v_exp_f32 v210, v210
v_mfma_f32_16x16x32_bf16 v[112:115], a[64:67], v[160:163], v[112:115]
ds_read_b128 a[24:27], v3 offset:3072
v_mfma_f32_16x16x32_bf16 v[116:119], a[68:71], v[160:163], v[116:119]
v_exp_f32 v211, v211
v_mfma_f32_16x16x32_bf16 v[116:119], a[100:103], v[228:231], v[116:119]
ds_read_b128 a[28:31], v3 offset:2048
v_cvt_pk_bf16_f32 v225, v210, v211
v_mfma_f32_16x16x32_bf16 v[120:123], a[104:107], v[228:231], v[120:123]
v_exp_f32 v212, v212
v_mfma_f32_16x16x32_bf16 v[120:123], a[72:75], v[160:163], v[120:123]
ds_read_b128 a[96:99], v3 offset:20480
buffer_load_dwordx4 v1, s[40:43], 0 offen offset:3072 sc1 lds
v_mfma_f32_16x16x32_bf16 v[124:127], a[76:79], v[160:163], v[124:127]
s_mov_b32 m0, s7
v_exp_f32 v213, v213
v_mfma_f32_16x16x32_bf16 v[124:127], a[108:111], v[228:231], v[124:127]
s_add_u32 s40, s28, s57
ds_read_b128 a[100:103], v3 offset:21504
v_cvt_pk_bf16_f32 v226, v212, v213
v_mfma_f32_16x16x32_bf16 v[128:131], a[112:115], v[228:231], v[128:131]
s_addc_u32 s41, s29, 0
v_exp_f32 v214, v214
v_mfma_f32_16x16x32_bf16 v[128:131], a[80:83], v[160:163], v[128:131]
s_bitcmp1_b64 s[60:61], s58
ds_read_b128 a[104:107], v3 offset:22528
v_mfma_f32_16x16x32_bf16 v[132:135], a[84:87], v[160:163], v[132:135]
v_exp_f32 v215, v215
v_mfma_f32_16x16x32_bf16 v[132:135], a[116:119], v[228:231], v[132:135]
ds_read_b128 a[108:111], v3 offset:23552
v_cvt_pk_bf16_f32 v227, v214, v215
v_mfma_f32_16x16x32_bf16 v[136:139], a[120:123], v[228:231], v[136:139]
v_exp_f32 v144, v144
v_mfma_f32_16x16x32_bf16 v[136:139], a[88:91], v[160:163], v[136:139]
ds_read_b128 a[112:115], v3 offset:28672
buffer_load_dwordx4 v1, s[36:39], 0 offen sc1 lds
v_mfma_f32_16x16x32_bf16 v[140:143], a[92:95], v[160:163], v[140:143]
v_exp_f32 v145, v145
v_mfma_f32_16x16x32_bf16 v[140:143], a[124:127], v[228:231], v[140:143]
ds_read_b128 a[116:119], v3 offset:29696
v_cvt_pk_bf16_f32 v164, v144, v145
v_mfma_f32_16x16x32_bf16 a[132:135], a[136:139], v[160:163], a[132:135]
s_waitcnt lgkmcnt(3)
v_exp_f32 v146, v146
v_mfma_f32_16x16x32_bf16 v[208:211], a[0:3], v[16:19], v[232:235]
ds_read_b128 a[120:123], v3 offset:30720
v_mfma_f32_16x16x32_bf16 v[208:211], a[4:7], v[20:23], v[208:211]
v_exp_f32 v147, v147
v_mfma_f32_16x16x32_bf16 v[208:211], a[8:11], v[24:27], v[208:211]
ds_read_b128 a[124:127], v3 offset:31744
v_cvt_pk_bf16_f32 v165, v146, v147
v_mfma_f32_16x16x32_bf16 v[208:211], a[12:15], v[28:31], v[208:211]
v_exp_f32 v148, v148
v_mfma_f32_16x16x32_bf16 v[212:215], a[16:19], v[28:31], v[232:235]
v_exp_f32 v149, v149
v_mfma_f32_16x16x32_bf16 v[212:215], a[20:23], v[24:27], v[212:215]
buffer_load_dwordx4 v1, s[36:39], 0 offen offset:1024 sc1 lds
v_cvt_pk_bf16_f32 v166, v148, v149
v_mfma_f32_16x16x32_bf16 v[212:215], a[24:27], v[20:23], v[212:215]
v_exp_f32 v150, v150
v_mfma_f32_16x16x32_bf16 v[212:215], a[28:31], v[16:19], v[212:215]
v_exp_f32 v151, v151
v_mfma_f32_16x16x32_bf16 a[128:131], a[136:139], v[224:227], a[128:131]
v_cvt_pk_bf16_f32 v167, v150, v151
v_mfma_f32_16x16x32_bf16 v[80:83], a[64:67], v[224:227], v[80:83]
v_exp_f32 v152, v152
v_mfma_f32_16x16x32_bf16 v[80:83], a[96:99], v[164:167], v[80:83]
v_exp_f32 v153, v153
v_mfma_f32_16x16x32_bf16 v[84:87], a[100:103], v[164:167], v[84:87]
ds_read_b128 a[64:67], v3 offset:4096
v_cvt_pk_bf16_f32 v228, v152, v153
v_mfma_f32_16x16x32_bf16 v[84:87], a[68:71], v[224:227], v[84:87]
v_exp_f32 v154, v154
v_mfma_f32_16x16x32_bf16 v[88:91], a[72:75], v[224:227], v[88:91]
ds_read_b128 a[68:71], v3 offset:5120
buffer_load_dwordx4 v1, s[36:39], 0 offen offset:2048 sc1 lds
v_mfma_f32_16x16x32_bf16 v[88:91], a[104:107], v[164:167], v[88:91]
s_waitcnt lgkmcnt(2)
v_exp_f32 v155, v155
v_mfma_f32_16x16x32_bf16 v[92:95], a[108:111], v[164:167], v[92:95]
ds_read_b128 a[72:75], v3 offset:6144
v_cvt_pk_bf16_f32 v229, v154, v155
v_mfma_f32_16x16x32_bf16 v[92:95], a[76:79], v[224:227], v[92:95]
v_exp_f32 v156, v156
v_mfma_f32_16x16x32_bf16 v[96:99], a[80:83], v[224:227], v[96:99]
ds_read_b128 a[76:79], v3 offset:7168
buffer_load_dwordx4 v1, s[36:39], 0 offen offset:3072 sc1 lds
v_mfma_f32_16x16x32_bf16 v[96:99], a[112:115], v[164:167], v[96:99]
v_exp_f32 v157, v157
v_mfma_f32_16x16x32_bf16 v[100:103], a[116:119], v[164:167], v[100:103]
ds_read_b128 a[80:83], v3 offset:12288
v_cvt_pk_bf16_f32 v230, v156, v157
v_mfma_f32_16x16x32_bf16 v[100:103], a[84:87], v[224:227], v[100:103]
v_exp_f32 v158, v158
v_mfma_f32_16x16x32_bf16 v[104:107], a[88:91], v[224:227], v[104:107]
ds_read_b128 a[84:87], v3 offset:13312
v_mfma_f32_16x16x32_bf16 v[104:107], a[120:123], v[164:167], v[104:107]
v_exp_f32 v159, v159
v_mfma_f32_16x16x32_bf16 v[108:111], a[124:127], v[164:167], v[108:111]
s_waitcnt vmcnt(16)
ds_read_b128 a[88:91], v3 offset:14336
v_cvt_pk_bf16_f32 v231, v158, v159
v_mfma_f32_16x16x32_bf16 v[108:111], a[92:95], v[224:227], v[108:111]
ds_read_b128 a[92:95], v3 offset:15360
v_add_u32 v3, s6, v1
v_mfma_f32_16x16x32_bf16 a[128:131], a[136:139], v[164:167], a[128:131]
s_cbranch_scc0 L_S_0
s_cmp_lg_u32 s58, 28
s_cbranch_scc1 L_Sa_0
buffer_load_dword v8, v9, s[28:31], s27 offen sc1
s_branch L_S_0
L_Sa_0:
s_mov_b32 s64, 32768
s_mov_b32 s65, 32768
s_waitcnt vmcnt(8)
buffer_store_dword v13, v2, s[28:31], s25 offen sc1
s_add_u32 s26, s68, s81
s_add_u32 s57, s26, 16384
s_add_u32 s40, s28, s57
s_addc_u32 s41, s29, 0
v_cmp_gt_u32 vcc, 1, v8
s_nop 0
s_cbranch_vccnz L_spin4
L_back4:
L_Z_0:
v_mfma_f32_16x16x32_bf16 v[216:219], a[0:3], v[32:35], v[236:239]
s_barrier
v_mfma_f32_16x16x32_bf16 v[216:219], a[4:7], v[36:39], v[216:219]
s_add_u32 s7, s63, s62
s_add_u32 m0, s7, 16384
ds_read_b128 a[32:35], v3 offset:16384
v_mfma_f32_16x16x32_bf16 v[216:219], a[8:11], v[40:43], v[216:219]
s_add_u32 s36, s28, s26
s_addc_u32 s37, s29, 0
ds_read_b128 a[36:39], v3 offset:17408
v_mfma_f32_16x16x32_bf16 v[216:219], a[12:15], v[44:47], v[216:219]
s_add_u32 s26, s26, s64
s_add_u32 s57, s57, s65
ds_read_b128 a[40:43], v3 offset:24576
v_mfma_f32_16x16x32_bf16 v[220:223], a[16:19], v[44:47], v[236:239]
s_add_u32 s62, s62, 32768
s_and_b32 s62, s62, 131071
ds_read_b128 a[44:47], v3 offset:25600
v_mfma_f32_16x16x32_bf16 v[220:223], a[20:23], v[40:43], v[220:223]
s_add_u32 s6, s62, 32768
v_exp_f32 v208, v208
v_mfma_f32_16x16x32_bf16 v[220:223], a[24:27], v[36:39], v[220:223]
s_and_b32 s6, s6, 131071
ds_read_b128 a[48:51], v3 offset:27648
buffer_load_dwordx4 v1, s[40:43], 0 offen sc1 lds
v_mfma_f32_16x16x32_bf16 v[220:223], a[28:31], v[32:35], v[220:223]
s_add_u32 s58, s58, 1
v_exp_f32 v209, v209
v_mfma_f32_16x16x32_bf16 a[132:135], a[136:139], v[228:231], a[132:135]
s_waitcnt lgkmcnt(4)
ds_read_b128 a[52:55], v3 offset:26624
v_cvt_pk_bf16_f32 v224, v208, v209
v_mfma_f32_16x16x32_bf16 v[144:147], a[32:35], v[16:19], v[232:235]
s_waitcnt lgkmcnt(4)
v_exp_f32 v216, v216
v_mfma_f32_16x16x32_bf16 v[144:147], a[36:39], v[20:23], v[144:147]
s_waitcnt lgkmcnt(3)
ds_read_b128 a[56:59], v3 offset:19456
global_load_dwordx4 v[168:171], v1, s[34:35] offset:-4096 sc1
v_mfma_f32_16x16x32_bf16 v[144:147], a[40:43], v[24:27], v[144:147]
s_waitcnt lgkmcnt(3)
v_exp_f32 v217, v217
v_mfma_f32_16x16x32_bf16 v[144:147], a[44:47], v[28:31], v[144:147]
s_add_u32 s6, s6, 32768
ds_read_b128 a[60:63], v3 offset:18432
v_cvt_pk_bf16_f32 v160, v216, v217
v_mfma_f32_16x16x32_bf16 v[152:155], a[44:47], v[44:47], v[236:239]
v_exp_f32 v218, v218
v_mfma_f32_16x16x32_bf16 v[152:155], a[40:43], v[40:43], v[152:155]
ds_read_b128 a[0:3], v3 offset:0
buffer_load_dwordx4 v1, s[40:43], 0 offen offset:1024 sc1 lds
v_mfma_f32_16x16x32_bf16 v[152:155], a[36:39], v[36:39], v[152:155]
v_exp_f32 v219, v219
v_mfma_f32_16x16x32_bf16 v[152:155], a[32:35], v[32:35], v[152:155]
s_waitcnt lgkmcnt(3)
ds_read_b128 a[4:7], v3 offset:1024
v_cvt_pk_bf16_f32 v161, v218, v219
v_mfma_f32_16x16x32_bf16 v[156:159], a[48:51], v[44:47], v[236:239]
v_exp_f32 v220, v220
v_mfma_f32_16x16x32_bf16 v[156:159], a[52:55], v[40:43], v[156:159]
s_waitcnt lgkmcnt(3)
ds_read_b128 a[8:11], v3 offset:8192
global_load_dwordx4 v[172:175], v1, s[34:35] offset:-3072 sc1
v_mfma_f32_16x16x32_bf16 v[156:159], a[56:59], v[36:39], v[156:159]
s_waitcnt lgkmcnt(3)
v_exp_f32 v221, v221
v_mfma_f32_16x16x32_bf16 v[156:159], a[60:63], v[32:35], v[156:159]
ds_read_b128 a[12:15], v3 offset:9216
v_cvt_pk_bf16_f32 v162, v220, v221
v_mfma_f32_16x16x32_bf16 v[148:151], a[60:63], v[16:19], v[232:235]
v_exp_f32 v222, v222
v_mfma_f32_16x16x32_bf16 v[148:151], a[56:59], v[20:23], v[148:151]
ds_read_b128 a[16:19], v3 offset:11264
buffer_load_dwordx4 v1, s[40:43], 0 offen offset:2048 sc1 lds
v_mfma_f32_16x16x32_bf16 v[148:151], a[52:55], v[24:27], v[148:151]
v_exp_f32 v223, v223
v_mfma_f32_16x16x32_bf16 v[148:151], a[48:51], v[28:31], v[148:151]
ds_read_b128 a[20:23], v3 offset:10240
v_cvt_pk_bf16_f32 v163, v222, v223
v_mfma_f32_16x16x32_bf16 v[112:115], a[96:99], v[228:231], v[112:115]
v_exp_f32 v210, v210
v_mfma_f32_16x16x32_bf16 v[112:115], a[64:67], v[160:163], v[112:115]
ds_read_b128 a[24:27], v3 offset:3072
global_load_dwordx4 v[176:179], v1, s[34:35] offset:-2048 sc1
v_mfma_f32_16x16x32_bf16 v[116:119], a[68:71], v[160:163], v[116:119]
v_exp_f32 v211, v211
v_mfma_f32_16x16x32_bf16 v[116:119], a[100:103], v[228:231], v[116:119]
ds_read_b128 a[28:31], v3 offset:2048
v_cvt_pk_bf16_f32 v225, v210, v211
v_mfma_f32_16x16x32_bf16 v[120:123], a[104:107], v[228:231], v[120:123]
v_exp_f32 v212, v212
v_mfma_f32_16x16x32_bf16 v[120:123], a[72:75], v[160:163], v[120:123]
ds_read_b128 a[96:99], v3 offset:20480
buffer_load_dwordx4 v1, s[40:43], 0 offen offset:3072 sc1 lds
v_mfma_f32_16x16x32_bf16 v[124:127], a[76:79], v[160:163], v[124:127]
s_mov_b32 m0, s7
v_exp_f32 v213, v213
v_mfma_f32_16x16x32_bf16 v[124:127], a[108:111], v[228:231], v[124:127]
s_add_u32 s40, s28, s57
ds_read_b128 a[100:103], v3 offset:21504
v_cvt_pk_bf16_f32 v226, v212, v213
v_mfma_f32_16x16x32_bf16 v[128:131], a[112:115], v[228:231], v[128:131]
s_addc_u32 s41, s29, 0
v_exp_f32 v214, v214
v_mfma_f32_16x16x32_bf16 v[128:131], a[80:83], v[160:163], v[128:131]
s_bitcmp1_b64 s[60:61], s58
ds_read_b128 a[104:107], v3 offset:22528
global_load_dwordx4 v[180:183], v1, s[34:35] offset:-1024 sc1
v_mfma_f32_16x16x32_bf16 v[132:135], a[84:87], v[160:163], v[132:135]
v_exp_f32 v215, v215
v_mfma_f32_16x16x32_bf16 v[132:135], a[116:119], v[228:231], v[132:135]
ds_read_b128 a[108:111], v3 offset:23552
v_cvt_pk_bf16_f32 v227, v214, v215
v_mfma_f32_16x16x32_bf16 v[136:139], a[120:123], v[228:231], v[136:139]
v_exp_f32 v144, v144
v_mfma_f32_16x16x32_bf16 v[136:139], a[88:91], v[160:163], v[136:139]
ds_read_b128 a[112:115], v3 offset:28672
buffer_load_dwordx4 v1, s[36:39], 0 offen sc1 lds
v_mfma_f32_16x16x32_bf16 v[140:143], a[92:95], v[160:163], v[140:143]
v_exp_f32 v145, v145
v_mfma_f32_16x16x32_bf16 v[140:143], a[124:127], v[228:231], v[140:143]
ds_read_b128 a[116:119], v3 offset:29696
v_cvt_pk_bf16_f32 v164, v144, v145
v_mfma_f32_16x16x32_bf16 a[132:135], a[136:139], v[160:163], a[132:135]
s_waitcnt lgkmcnt(3)
v_exp_f32 v146, v146
v_mfma_f32_16x16x32_bf16 v[208:211], a[0:3], v[16:19], v[232:235]
ds_read_b128 a[120:123], v3 offset:30720
global_load_dwordx4 v[184:187], v1, s[34:35] offset:0 sc1
v_mfma_f32_16x16x32_bf16 v[208:211], a[4:7], v[20:23], v[208:211]
v_exp_f32 v147, v147
v_mfma_f32_16x16x32_bf16 v[208:211], a[8:11], v[24:27], v[208:211]
ds_read_b128 a[124:127], v3 offset:31744
v_cvt_pk_bf16_f32 v165, v146, v147
v_mfma_f32_16x16x32_bf16 v[208:211], a[12:15], v[28:31], v[208:211]
v_exp_f32 v148, v148
v_mfma_f32_16x16x32_bf16 v[212:215], a[16:19], v[28:31], v[232:235]
v_exp_f32 v149, v149
v_mfma_f32_16x16x32_bf16 v[212:215], a[20:23], v[24:27], v[212:215]
buffer_load_dwordx4 v1, s[36:39], 0 offen offset:1024 sc1 lds
v_cvt_pk_bf16_f32 v166, v148, v149
v_mfma_f32_16x16x32_bf16 v[212:215], a[24:27], v[20:23], v[212:215]
v_exp_f32 v150, v150
v_mfma_f32_16x16x32_bf16 v[212:215], a[28:31], v[16:19], v[212:215]
v_exp_f32 v151, v151
v_mfma_f32_16x16x32_bf16 a[128:131], a[136:139], v[224:227], a[128:131]
v_cvt_pk_bf16_f32 v167, v150, v151
v_mfma_f32_16x16x32_bf16 v[80:83], a[64:67], v[224:227], v[80:83]
v_exp_f32 v152, v152
v_mfma_f32_16x16x32_bf16 v[80:83], a[96:99], v[164:167], v[80:83]
v_exp_f32 v153, v153
v_mfma_f32_16x16x32_bf16 v[84:87], a[100:103], v[164:167], v[84:87]
ds_read_b128 a[64:67], v3 offset:4096
v_cvt_pk_bf16_f32 v228, v152, v153
v_mfma_f32_16x16x32_bf16 v[84:87], a[68:71], v[224:227], v[84:87]
v_exp_f32 v154, v154
v_mfma_f32_16x16x32_bf16 v[88:91], a[72:75], v[224:227], v[88:91]
ds_read_b128 a[68:71], v3 offset:5120
buffer_load_dwordx4 v1, s[36:39], 0 offen offset:2048 sc1 lds
v_mfma_f32_16x16x32_bf16 v[88:91], a[104:107], v[164:167], v[88:91]
s_waitcnt lgkmcnt(2)
v_exp_f32 v155, v155
v_mfma_f32_16x16x32_bf16 v[92:95], a[108:111], v[164:167], v[92:95]
ds_read_b128 a[72:75], v3 offset:6144
v_cvt_pk_bf16_f32 v229, v154, v155
v_mfma_f32_16x16x32_bf16 v[92:95], a[76:79], v[224:227], v[92:95]
v_exp_f32 v156, v156
v_mfma_f32_16x16x32_bf16 v[96:99], a[80:83], v[224:227], v[96:99]
ds_read_b128 a[76:79], v3 offset:7168
buffer_load_dwordx4 v1, s[36:39], 0 offen offset:3072 sc1 lds
v_mfma_f32_16x16x32_bf16 v[96:99], a[112:115], v[164:167], v[96:99]
v_exp_f32 v157, v157
v_mfma_f32_16x16x32_bf16 v[100:103], a[116:119], v[164:167], v[100:103]
ds_read_b128 a[80:83], v3 offset:12288
v_cvt_pk_bf16_f32 v230, v156, v157
v_mfma_f32_16x16x32_bf16 v[100:103], a[84:87], v[224:227], v[100:103]
v_exp_f32 v158, v158
v_mfma_f32_16x16x32_bf16 v[104:107], a[88:91], v[224:227], v[104:107]
ds_read_b128 a[84:87], v3 offset:13312
v_mfma_f32_16x16x32_bf16 v[104:107], a[120:123], v[164:167], v[104:107]
v_exp_f32 v159, v159
v_mfma_f32_16x16x32_bf16 v[108:111], a[124:127], v[164:167], v[108:111]
s_waitcnt vmcnt(21)
ds_read_b128 a[88:91], v3 offset:14336
v_cvt_pk_bf16_f32 v231, v158, v159
v_mfma_f32_16x16x32_bf16 v[108:111], a[92:95], v[224:227], v[108:111]
ds_read_b128 a[92:95], v3 offset:15360
v_add_u32 v3, s6, v1
v_mfma_f32_16x16x32_bf16 a[128:131], a[136:139], v[164:167], a[128:131]
v_mfma_f32_16x16x32_bf16 v[216:219], a[0:3], v[32:35], v[236:239]
s_barrier
v_mfma_f32_16x16x32_bf16 v[216:219], a[4:7], v[36:39], v[216:219]
s_add_u32 s7, s63, s62
s_add_u32 m0, s7, 16384
ds_read_b128 a[32:35], v3 offset:16384
v_mfma_f32_16x16x32_bf16 v[216:219], a[8:11], v[40:43], v[216:219]
s_add_u32 s36, s28, s26
s_addc_u32 s37, s29, 0
ds_read_b128 a[36:39], v3 offset:17408
v_mfma_f32_16x16x32_bf16 v[216:219], a[12:15], v[44:47], v[216:219]
s_add_u32 s26, s26, s64
s_add_u32 s57, s57, s65
ds_read_b128 a[40:43], v3 offset:24576
v_mfma_f32_16x16x32_bf16 v[220:223], a[16:19], v[44:47], v[236:239]
s_add_u32 s62, s62, 32768
s_and_b32 s62, s62, 131071
ds_read_b128 a[44:47], v3 offset:25600
v_mfma_f32_16x16x32_bf16 v[220:223], a[20:23], v[40:43], v[220:223]
s_add_u32 s6, s62, 32768
v_exp_f32 v208, v208
v_mfma_f32_16x16x32_bf16 v[220:223], a[24:27], v[36:39], v[220:223]
s_and_b32 s6, s6, 131071
ds_read_b128 a[48:51], v3 offset:27648
buffer_load_dwordx4 v1, s[40:43], 0 offen sc1 lds
v_mfma_f32_16x16x32_bf16 v[220:223], a[28:31], v[32:35], v[220:223]
s_add_u32 s58, s58, 1
v_exp_f32 v209, v209
v_mfma_f32_16x16x32_bf16 a[132:135], a[136:139], v[228:231], a[132:135]
s_waitcnt lgkmcnt(4)
ds_read_b128 a[52:55], v3 offset:26624
v_cvt_pk_bf16_f32 v224, v208, v209
v_mfma_f32_16x16x32_bf16 v[144:147], a[32:35], v[16:19], v[232:235]
s_waitcnt lgkmcnt(4)
v_exp_f32 v216, v216
v_mfma_f32_16x16x32_bf16 v[144:147], a[36:39], v[20:23], v[144:147]
s_waitcnt lgkmcnt(3)
ds_read_b128 a[56:59], v3 offset:19456
global_load_dwordx4 v[188:191], v1, s[34:35] offset:1024 sc1
v_mfma_f32_16x16x32_bf16 v[144:147], a[40:43], v[24:27], v[144:147]
s_waitcnt lgkmcnt(3)
v_exp_f32 v217, v217
v_mfma_f32_16x16x32_bf16 v[144:147], a[44:47], v[28:31], v[144:147]
s_add_u32 s6, s6, 32768
ds_read_b128 a[60:63], v3 offset:18432
v_cvt_pk_bf16_f32 v160, v216, v217
v_mfma_f32_16x16x32_bf16 v[152:155], a[44:47], v[44:47], v[236:239]
v_exp_f32 v218, v218
v_mfma_f32_16x16x32_bf16 v[152:155], a[40:43], v[40:43], v[152:155]
ds_read_b128 a[0:3], v3 offset:0
buffer_load_dwordx4 v1, s[40:43], 0 offen offset:1024 sc1 lds
v_mfma_f32_16x16x32_bf16 v[152:155], a[36:39], v[36:39], v[152:155]
v_exp_f32 v219, v219
v_mfma_f32_16x16x32_bf16 v[152:155], a[32:35], v[32:35], v[152:155]
s_waitcnt lgkmcnt(3)
ds_read_b128 a[4:7], v3 offset:1024
v_cvt_pk_bf16_f32 v161, v218, v219
v_mfma_f32_16x16x32_bf16 v[156:159], a[48:51], v[44:47], v[236:239]
v_exp_f32 v220, v220
v_mfma_f32_16x16x32_bf16 v[156:159], a[52:55], v[40:43], v[156:159]
s_waitcnt lgkmcnt(3)
ds_read_b128 a[8:11], v3 offset:8192
global_load_dwordx4 v[192:195], v1, s[34:35] offset:2048 sc1
v_mfma_f32_16x16x32_bf16 v[156:159], a[56:59], v[36:39], v[156:159]
s_waitcnt lgkmcnt(3)
v_exp_f32 v221, v221
v_mfma_f32_16x16x32_bf16 v[156:159], a[60:63], v[32:35], v[156:159]
ds_read_b128 a[12:15], v3 offset:9216
v_cvt_pk_bf16_f32 v162, v220, v221
v_mfma_f32_16x16x32_bf16 v[148:151], a[60:63], v[16:19], v[232:235]
v_exp_f32 v222, v222
v_mfma_f32_16x16x32_bf16 v[148:151], a[56:59], v[20:23], v[148:151]
ds_read_b128 a[16:19], v3 offset:11264
buffer_load_dwordx4 v1, s[40:43], 0 offen offset:2048 sc1 lds
v_mfma_f32_16x16x32_bf16 v[148:151], a[52:55], v[24:27], v[148:151]
v_exp_f32 v223, v223
v_mfma_f32_16x16x32_bf16 v[148:151], a[48:51], v[28:31], v[148:151]
ds_read_b128 a[20:23], v3 offset:10240
v_cvt_pk_bf16_f32 v163, v222, v223
v_mfma_f32_16x16x32_bf16 v[112:115], a[96:99], v[228:231], v[112:115]
v_exp_f32 v210, v210
v_mfma_f32_16x16x32_bf16 v[112:115], a[64:67], v[160:163], v[112:115]
ds_read_b128 a[24:27], v3 offset:3072
global_load_dwordx4 v[196:199], v1, s[34:35] offset:3072 sc1
v_mfma_f32_16x16x32_bf16 v[116:119], a[68:71], v[160:163], v[116:119]
v_exp_f32 v211, v211
v_mfma_f32_16x16x32_bf16 v[116:119], a[100:103], v[228:231], v[116:119]
ds_read_b128 a[28:31], v3 offset:2048
v_cvt_pk_bf16_f32 v225, v210, v211
v_mfma_f32_16x16x32_bf16 v[120:123], a[104:107], v[228:231], v[120:123]
v_exp_f32 v212, v212
v_mfma_f32_16x16x32_bf16 v[120:123], a[72:75], v[160:163], v[120:123]
ds_read_b128 a[96:99], v3 offset:20480
buffer_load_dwordx4 v1, s[40:43], 0 offen offset:3072 sc1 lds
v_mfma_f32_16x16x32_bf16 v[124:127], a[76:79], v[160:163], v[124:127]
s_mov_b32 m0, s7
v_exp_f32 v213, v213
v_mfma_f32_16x16x32_bf16 v[124:127], a[108:111], v[228:231], v[124:127]
s_add_u32 s40, s28, s57
ds_read_b128 a[100:103], v3 offset:21504
v_cvt_pk_bf16_f32 v226, v212, v213
v_mfma_f32_16x16x32_bf16 v[128:131], a[112:115], v[228:231], v[128:131]
s_addc_u32 s41, s29, 0
v_exp_f32 v214, v214
v_mfma_f32_16x16x32_bf16 v[128:131], a[80:83], v[160:163], v[128:131]
s_bitcmp1_b64 s[60:61], s58
ds_read_b128 a[104:107], v3 offset:22528
global_load_dwordx4 v[200:203], v1, s[46:47] offset:-4096 sc1
v_mfma_f32_16x16x32_bf16 v[132:135], a[84:87], v[160:163], v[132:135]
v_exp_f32 v215, v215
v_mfma_f32_16x16x32_bf16 v[132:135], a[116:119], v[228:231], v[132:135]
ds_read_b128 a[108:111], v3 offset:23552
v_cvt_pk_bf16_f32 v227, v214, v215
v_mfma_f32_16x16x32_bf16 v[136:139], a[120:123], v[228:231], v[136:139]
v_exp_f32 v144, v144
v_mfma_f32_16x16x32_bf16 v[136:139], a[88:91], v[160:163], v[136:139]
ds_read_b128 a[112:115], v3 offset:28672
buffer_load_dwordx4 v1, s[36:39], 0 offen sc1 lds
v_mfma_f32_16x16x32_bf16 v[140:143], a[92:95], v[160:163], v[140:143]
v_exp_f32 v145, v145
v_mfma_f32_16x16x32_bf16 v[140:143], a[124:127], v[228:231], v[140:143]
ds_read_b128 a[116:119], v3 offset:29696
v_cvt_pk_bf16_f32 v164, v144, v145
v_mfma_f32_16x16x32_bf16 a[132:135], a[136:139], v[160:163], a[132:135]
s_waitcnt lgkmcnt(3)
v_exp_f32 v146, v146
v_mfma_f32_16x16x32_bf16 v[208:211], a[0:3], v[16:19], v[232:235]
ds_read_b128 a[120:123], v3 offset:30720
v_mfma_f32_16x16x32_bf16 v[208:211], a[4:7], v[20:23], v[208:211]
v_exp_f32 v147, v147
v_mfma_f32_16x16x32_bf16 v[208:211], a[8:11], v[24:27], v[208:211]
ds_read_b128 a[124:127], v3 offset:31744
v_cvt_pk_bf16_f32 v165, v146, v147
v_mfma_f32_16x16x32_bf16 v[208:211], a[12:15], v[28:31], v[208:211]
v_exp_f32 v148, v148
v_mfma_f32_16x16x32_bf16 v[212:215], a[16:19], v[28:31], v[232:235]
v_exp_f32 v149, v149
v_mfma_f32_16x16x32_bf16 v[212:215], a[20:23], v[24:27], v[212:215]
buffer_load_dwordx4 v1, s[36:39], 0 offen offset:1024 sc1 lds
v_cvt_pk_bf16_f32 v166, v148, v149
v_mfma_f32_16x16x32_bf16 v[212:215], a[24:27], v[20:23], v[212:215]
v_exp_f32 v150, v150
v_mfma_f32_16x16x32_bf16 v[212:215], a[28:31], v[16:19], v[212:215]
v_exp_f32 v151, v151
v_mfma_f32_16x16x32_bf16 a[128:131], a[136:139], v[224:227], a[128:131]
v_cvt_pk_bf16_f32 v167, v150, v151
v_mfma_f32_16x16x32_bf16 v[80:83], a[64:67], v[224:227], v[80:83]
v_exp_f32 v152, v152
v_mfma_f32_16x16x32_bf16 v[80:83], a[96:99], v[164:167], v[80:83]
v_exp_f32 v153, v153
v_mfma_f32_16x16x32_bf16 v[84:87], a[100:103], v[164:167], v[84:87]
ds_read_b128 a[64:67], v3 offset:4096
v_cvt_pk_bf16_f32 v228, v152, v153
v_mfma_f32_16x16x32_bf16 v[84:87], a[68:71], v[224:227], v[84:87]
v_exp_f32 v154, v154
v_mfma_f32_16x16x32_bf16 v[88:91], a[72:75], v[224:227], v[88:91]
ds_read_b128 a[68:71], v3 offset:5120
buffer_load_dwordx4 v1, s[36:39], 0 offen offset:2048 sc1 lds
v_mfma_f32_16x16x32_bf16 v[88:91], a[104:107], v[164:167], v[88:91]
s_waitcnt lgkmcnt(2)
v_exp_f32 v155, v155
v_mfma_f32_16x16x32_bf16 v[92:95], a[108:111], v[164:167], v[92:95]
ds_read_b128 a[72:75], v3 offset:6144
v_cvt_pk_bf16_f32 v229, v154, v155
v_mfma_f32_16x16x32_bf16 v[92:95], a[76:79], v[224:227], v[92:95]
v_exp_f32 v156, v156
v_mfma_f32_16x16x32_bf16 v[96:99], a[80:83], v[224:227], v[96:99]
ds_read_b128 a[76:79], v3 offset:7168
buffer_load_dwordx4 v1, s[36:39], 0 offen offset:3072 sc1 lds
v_mfma_f32_16x16x32_bf16 v[96:99], a[112:115], v[164:167], v[96:99]
v_exp_f32 v157, v157
v_mfma_f32_16x16x32_bf16 v[100:103], a[116:119], v[164:167], v[100:103]
ds_read_b128 a[80:83], v3 offset:12288
v_cvt_pk_bf16_f32 v230, v156, v157
v_mfma_f32_16x16x32_bf16 v[100:103], a[84:87], v[224:227], v[100:103]
v_exp_f32 v158, v158
v_mfma_f32_16x16x32_bf16 v[104:107], a[88:91], v[224:227], v[104:107]
ds_read_b128 a[84:87], v3 offset:13312
v_mfma_f32_16x16x32_bf16 v[104:107], a[120:123], v[164:167], v[104:107]
v_exp_f32 v159, v159
v_mfma_f32_16x16x32_bf16 v[108:111], a[124:127], v[164:167], v[108:111]
s_waitcnt vmcnt(20)
ds_read_b128 a[88:91], v3 offset:14336
v_cvt_pk_bf16_f32 v231, v158, v159
v_mfma_f32_16x16x32_bf16 v[108:111], a[92:95], v[224:227], v[108:111]
ds_read_b128 a[92:95], v3 offset:15360
v_add_u32 v3, s6, v1
v_mfma_f32_16x16x32_bf16 a[128:131], a[136:139], v[164:167], a[128:131]
v_mfma_f32_16x16x32_bf16 v[216:219], a[0:3], v[32:35], v[236:239]
s_barrier
v_mfma_f32_16x16x32_bf16 v[216:219], a[4:7], v[36:39], v[216:219]
s_add_u32 s7, s63, s62
s_add_u32 m0, s7, 16384
ds_read_b128 a[32:35], v3 offset:16384
v_mfma_f32_16x16x32_bf16 v[216:219], a[8:11], v[40:43], v[216:219]
s_add_u32 s36, s28, s26
s_addc_u32 s37, s29, 0
ds_read_b128 a[36:39], v3 offset:17408
v_mfma_f32_16x16x32_bf16 v[216:219], a[12:15], v[44:47], v[216:219]
s_add_u32 s26, s26, s64
s_add_u32 s57, s57, s65
ds_read_b128 a[40:43], v3 offset:24576
v_mfma_f32_16x16x32_bf16 v[220:223], a[16:19], v[44:47], v[236:239]
s_add_u32 s62, s62, 32768
s_and_b32 s62, s62, 131071
ds_read_b128 a[44:47], v3 offset:25600
v_mfma_f32_16x16x32_bf16 v[220:223], a[20:23], v[40:43], v[220:223]
s_add_u32 s6, s62, 32768
v_exp_f32 v208, v208
v_mfma_f32_16x16x32_bf16 v[220:223], a[24:27], v[36:39], v[220:223]
s_and_b32 s6, s6, 131071
ds_read_b128 a[48:51], v3 offset:27648
buffer_load_dwordx4 v1, s[40:43], 0 offen sc1 lds
v_mfma_f32_16x16x32_bf16 v[220:223], a[28:31], v[32:35], v[220:223]
s_add_u32 s58, s58, 1
v_exp_f32 v209, v209
v_mfma_f32_16x16x32_bf16 a[132:135], a[136:139], v[228:231], a[132:135]
s_waitcnt lgkmcnt(4)
ds_read_b128 a[52:55], v3 offset:26624
v_cvt_pk_bf16_f32 v224, v208, v209
v_mfma_f32_16x16x32_bf16 v[144:147], a[32:35], v[16:19], v[232:235]
s_waitcnt lgkmcnt(4)
v_exp_f32 v216, v216
v_mfma_f32_16x16x32_bf16 v[144:147], a[36:39], v[20:23], v[144:147]
s_waitcnt lgkmcnt(3)
ds_read_b128 a[56:59], v3 offset:19456
global_load_dwordx4 v[204:207], v1, s[46:47] offset:-3072 sc1
v_mfma_f32_16x16x32_bf16 v[144:147], a[40:43], v[24:27], v[144:147]
s_waitcnt lgkmcnt(3)
v_exp_f32 v217, v217
v_mfma_f32_16x16x32_bf16 v[144:147], a[44:47], v[28:31], v[144:147]
s_add_u32 s6, s6, 32768
ds_read_b128 a[60:63], v3 offset:18432
v_cvt_pk_bf16_f32 v160, v216, v217
v_mfma_f32_16x16x32_bf16 v[152:155], a[44:47], v[44:47], v[236:239]
v_exp_f32 v218, v218
v_mfma_f32_16x16x32_bf16 v[152:155], a[40:43], v[40:43], v[152:155]
ds_read_b128 a[0:3], v3 offset:0
buffer_load_dwordx4 v1, s[40:43], 0 offen offset:1024 sc1 lds
v_mfma_f32_16x16x32_bf16 v[152:155], a[36:39], v[36:39], v[152:155]
v_exp_f32 v219, v219
v_mfma_f32_16x16x32_bf16 v[152:155], a[32:35], v[32:35], v[152:155]
s_waitcnt lgkmcnt(3)
ds_read_b128 a[4:7], v3 offset:1024
v_cvt_pk_bf16_f32 v161, v218, v219
v_mfma_f32_16x16x32_bf16 v[156:159], a[48:51], v[44:47], v[236:239]
v_exp_f32 v220, v220
v_mfma_f32_16x16x32_bf16 v[156:159], a[52:55], v[40:43], v[156:159]
s_waitcnt lgkmcnt(3)
ds_read_b128 a[8:11], v3 offset:8192
global_load_dwordx4 v[240:243], v1, s[46:47] offset:-2048 sc1
v_mfma_f32_16x16x32_bf16 v[156:159], a[56:59], v[36:39], v[156:159]
s_waitcnt lgkmcnt(3)
v_exp_f32 v221, v221
v_mfma_f32_16x16x32_bf16 v[156:159], a[60:63], v[32:35], v[156:159]
ds_read_b128 a[12:15], v3 offset:9216
v_cvt_pk_bf16_f32 v162, v220, v221
v_mfma_f32_16x16x32_bf16 v[148:151], a[60:63], v[16:19], v[232:235]
v_exp_f32 v222, v222
v_mfma_f32_16x16x32_bf16 v[148:151], a[56:59], v[20:23], v[148:151]
ds_read_b128 a[16:19], v3 offset:11264
buffer_load_dwordx4 v1, s[40:43], 0 offen offset:2048 sc1 lds
v_mfma_f32_16x16x32_bf16 v[148:151], a[52:55], v[24:27], v[148:151]
v_exp_f32 v223, v223
v_mfma_f32_16x16x32_bf16 v[148:151], a[48:51], v[28:31], v[148:151]
ds_read_b128 a[20:23], v3 offset:10240
v_cvt_pk_bf16_f32 v163, v222, v223
v_mfma_f32_16x16x32_bf16 v[112:115], a[96:99], v[228:231], v[112:115]
v_exp_f32 v210, v210
v_mfma_f32_16x16x32_bf16 v[112:115], a[64:67], v[160:163], v[112:115]
ds_read_b128 a[24:27], v3 offset:3072
global_load_dwordx4 v[248:251], v1, s[46:47] offset:-1024 sc1
v_mfma_f32_16x16x32_bf16 v[116:119], a[68:71], v[160:163], v[116:119]
v_exp_f32 v211, v211
v_mfma_f32_16x16x32_bf16 v[116:119], a[100:103], v[228:231], v[116:119]
ds_read_b128 a[28:31], v3 offset:2048
v_cvt_pk_bf16_f32 v225, v210, v211
v_mfma_f32_16x16x32_bf16 v[120:123], a[104:107], v[228:231], v[120:123]
L_pad11:
s_cbranch_execz L_pad15
v_exp_f32 v212, v212
v_mfma_f32_16x16x32_bf16 v[120:123], a[72:75], v[160:163], v[120:123]
ds_read_b128 a[96:99], v3 offset:20480
buffer_load_dwordx4 v1, s[40:43], 0 offen offset:3072 sc1 lds
v_mfma_f32_16x16x32_bf16 v[124:127], a[76:79], v[160:163], v[124:127]
s_mov_b32 m0, s7
v_exp_f32 v213, v213
v_mfma_f32_16x16x32_bf16 v[124:127], a[108:111], v[228:231], v[124:127]
s_add_u32 s40, s28, s57
ds_read_b128 a[100:103], v3 offset:21504
v_cvt_pk_bf16_f32 v226, v212, v213
v_mfma_f32_16x16x32_bf16 v[128:131], a[112:115], v[228:231], v[128:131]
s_addc_u32 s41, s29, 0
v_exp_f32 v214, v214
v_mfma_f32_16x16x32_bf16 v[128:131], a[80:83], v[160:163], v[128:131]
s_bitcmp1_b64 s[60:61], s58
ds_read_b128 a[104:107], v3 offset:22528
global_load_dwordx4 v[252:255], v1, s[46:47] offset:0 sc1
v_mfma_f32_16x16x32_bf16 v[132:135], a[84:87], v[160:163], v[132:135]
v_exp_f32 v215, v215
v_mfma_f32_16x16x32_bf16 v[132:135], a[116:119], v[228:231], v[132:135]
ds_read_b128 a[108:111], v3 offset:23552
v_cvt_pk_bf16_f32 v227, v214, v215
v_mfma_f32_16x16x32_bf16 v[136:139], a[120:123], v[228:231], v[136:139]
v_exp_f32 v144, v144
v_mfma_f32_16x16x32_bf16 v[136:139], a[88:91], v[160:163], v[136:139]
ds_read_b128 a[112:115], v3 offset:28672
buffer_load_dwordx4 v1, s[36:39], 0 offen sc1 lds
v_mfma_f32_16x16x32_bf16 v[140:143], a[92:95], v[160:163], v[140:143]
v_exp_f32 v145, v145
v_mfma_f32_16x16x32_bf16 v[140:143], a[124:127], v[228:231], v[140:143]
ds_read_b128 a[116:119], v3 offset:29696
v_cvt_pk_bf16_f32 v164, v144, v145
v_mfma_f32_16x16x32_bf16 a[132:135], a[136:139], v[160:163], a[132:135]
s_waitcnt lgkmcnt(3)
v_exp_f32 v146, v146
v_mfma_f32_16x16x32_bf16 v[208:211], a[0:3], v[16:19], v[232:235]
ds_read_b128 a[120:123], v3 offset:30720
v_mfma_f32_16x16x32_bf16 v[208:211], a[4:7], v[20:23], v[208:211]
v_exp_f32 v147, v147
v_mfma_f32_16x16x32_bf16 v[208:211], a[8:11], v[24:27], v[208:211]
ds_read_b128 a[124:127], v3 offset:31744
v_cvt_pk_bf16_f32 v165, v146, v147
v_mfma_f32_16x16x32_bf16 v[208:211], a[12:15], v[28:31], v[208:211]
v_exp_f32 v148, v148
v_mfma_f32_16x16x32_bf16 v[212:215], a[16:19], v[28:31], v[232:235]
v_exp_f32 v149, v149
v_mfma_f32_16x16x32_bf16 v[212:215], a[20:23], v[24:27], v[212:215]
buffer_load_dwordx4 v1, s[36:39], 0 offen offset:1024 sc1 lds
v_cvt_pk_bf16_f32 v166, v148, v149
v_mfma_f32_16x16x32_bf16 v[212:215], a[24:27], v[20:23], v[212:215]
v_exp_f32 v150, v150
v_mfma_f32_16x16x32_bf16 v[212:215], a[28:31], v[16:19], v[212:215]
v_exp_f32 v151, v151
v_mfma_f32_16x16x32_bf16 a[128:131], a[136:139], v[224:227], a[128:131]
v_cvt_pk_bf16_f32 v167, v150, v151
v_mfma_f32_16x16x32_bf16 v[80:83], a[64:67], v[224:227], v[80:83]
v_exp_f32 v152, v152
v_mfma_f32_16x16x32_bf16 v[80:83], a[96:99], v[164:167], v[80:83]
v_exp_f32 v153, v153
v_mfma_f32_16x16x32_bf16 v[84:87], a[100:103], v[164:167], v[84:87]
ds_read_b128 a[64:67], v3 offset:4096
v_cvt_pk_bf16_f32 v228, v152, v153
v_mfma_f32_16x16x32_bf16 v[84:87], a[68:71], v[224:227], v[84:87]
v_exp_f32 v154, v154
v_mfma_f32_16x16x32_bf16 v[88:91], a[72:75], v[224:227], v[88:91]
ds_read_b128 a[68:71], v3 offset:5120
buffer_load_dwordx4 v1, s[36:39], 0 offen offset:2048 sc1 lds
v_mfma_f32_16x16x32_bf16 v[88:91], a[104:107], v[164:167], v[88:91]
s_waitcnt lgkmcnt(2)
v_exp_f32 v155, v155
v_mfma_f32_16x16x32_bf16 v[92:95], a[108:111], v[164:167], v[92:95]
ds_read_b128 a[72:75], v3 offset:6144
v_cvt_pk_bf16_f32 v229, v154, v155
v_mfma_f32_16x16x32_bf16 v[92:95], a[76:79], v[224:227], v[92:95]
v_exp_f32 v156, v156
v_mfma_f32_16x16x32_bf16 v[96:99], a[80:83], v[224:227], v[96:99]
ds_read_b128 a[76:79], v3 offset:7168
buffer_load_dwordx4 v1, s[36:39], 0 offen offset:3072 sc1 lds
v_mfma_f32_16x16x32_bf16 v[96:99], a[112:115], v[164:167], v[96:99]
v_exp_f32 v157, v157
v_mfma_f32_16x16x32_bf16 v[100:103], a[116:119], v[164:167], v[100:103]
ds_read_b128 a[80:83], v3 offset:12288
v_cvt_pk_bf16_f32 v230, v156, v157
v_mfma_f32_16x16x32_bf16 v[100:103], a[84:87], v[224:227], v[100:103]
v_exp_f32 v158, v158
v_mfma_f32_16x16x32_bf16 v[104:107], a[88:91], v[224:227], v[104:107]
ds_read_b128 a[84:87], v3 offset:13312
v_mfma_f32_16x16x32_bf16 v[104:107], a[120:123], v[164:167], v[104:107]
v_exp_f32 v159, v159
v_mfma_f32_16x16x32_bf16 v[108:111], a[124:127], v[164:167], v[108:111]
s_waitcnt vmcnt(20)
ds_read_b128 a[88:91], v3 offset:14336
v_cvt_pk_bf16_f32 v231, v158, v159
v_mfma_f32_16x16x32_bf16 v[108:111], a[92:95], v[224:227], v[108:111]
ds_read_b128 a[92:95], v3 offset:15360
v_add_u32 v3, s6, v1
v_mfma_f32_16x16x32_bf16 a[128:131], a[136:139], v[164:167], a[128:131]
L_T0:
v_mfma_f32_16x16x32_bf16 v[216:219], a[0:3], v[32:35], v[236:239]
s_add_u32 m0, s82, 81920
v_exp_f32 v208, v208
v_mfma_f32_16x16x32_bf16 v[216:219], a[4:7], v[36:39], v[216:219]
s_add_u32 s80, s68, 98304
v_exp_f32 v209, v209
v_mfma_f32_16x16x32_bf16 v[216:219], a[8:11], v[40:43], v[216:219]
s_barrier
v_mfma_f32_16x16x32_bf16 v[216:219], a[12:15], v[44:47], v[216:219]
s_add_u32 s36, s28, s80
s_addc_u32 s37, s29, 0
buffer_load_dwordx4 v1, s[36:39], 0 offen sc1 lds
v_mfma_f32_16x16x32_bf16 v[220:223], a[16:19], v[44:47], v[244:247]
s_add_u32 s94, s32, 12288
v_exp_f32 v210, v210
v_mfma_f32_16x16x32_bf16 v[220:223], a[20:23], v[40:43], v[220:223]
s_add_u32 s40, s28, s94
s_addc_u32 s41, s29, 0
v_add_u32 v145, 65536, v1
v_mfma_f32_16x16x32_bf16 v[220:223], a[24:27], v[36:39], v[220:223]
v_exp_f32 v211, v211
v_mfma_f32_16x16x32_bf16 v[220:223], a[28:31], v[32:35], v[220:223]
s_waitcnt lgkmcnt(0)
v_cvt_pk_bf16_f32 v224, v208, v209
v_cvt_pk_bf16_f32 v225, v210, v211
v_mfma_f32_16x16x32_bf16 v[112:115], a[96:99], v[228:231], v[112:115]
v_exp_f32 v212, v212
v_mfma_f32_16x16x32_bf16 v[116:119], a[100:103], v[228:231], v[116:119]
v_exp_f32 v213, v213
v_mfma_f32_16x16x32_bf16 v[120:123], a[104:107], v[228:231], v[120:123]
buffer_load_dwordx4 v1, s[36:39], 0 offen offset:1024 sc1 lds
v_cvt_pk_bf16_f32 v226, v212, v213
v_mfma_f32_16x16x32_bf16 v[124:127], a[108:111], v[228:231], v[124:127]
v_exp_f32 v214, v214
v_mfma_f32_16x16x32_bf16 v[128:131], a[112:115], v[228:231], v[128:131]
v_exp_f32 v215, v215
v_mfma_f32_16x16x32_bf16 v[132:135], a[116:119], v[228:231], v[132:135]
v_cvt_pk_bf16_f32 v227, v214, v215
v_mov_b32 v144, v1
v_mfma_f32_16x16x32_bf16 v[136:139], a[120:123], v[228:231], v[136:139]
v_exp_f32 v216, v216
v_mfma_f32_16x16x32_bf16 v[140:143], a[124:127], v[228:231], v[140:143]
v_exp_f32 v217, v217
v_mfma_f32_16x16x32_bf16 a[132:135], a[136:139], v[228:231], a[132:135]
v_exp_f32 v218, v218
v_mfma_f32_16x16x32_bf16 a[128:131], a[136:139], v[224:227], a[128:131]
v_exp_f32 v219, v219
v_mfma_f32_16x16x32_bf16 v[80:83], a[64:67], v[224:227], v[80:83]
v_cvt_pk_bf16_f32 v228, v216, v217
v_cvt_pk_bf16_f32 v229, v218, v219
v_mfma_f32_16x16x32_bf16 v[84:87], a[68:71], v[224:227], v[84:87]
v_exp_f32 v220, v220
v_mfma_f32_16x16x32_bf16 v[88:91], a[72:75], v[224:227], v[88:91]
v_exp_f32 v221, v221
v_mfma_f32_16x16x32_bf16 v[92:95], a[76:79], v[224:227], v[92:95]
buffer_load_dwordx4 v1, s[36:39], 0 offen offset:2048 sc1 lds
v_cvt_pk_bf16_f32 v230, v220, v221
v_mfma_f32_16x16x32_bf16 v[96:99], a[80:83], v[224:227], v[96:99]
v_exp_f32 v222, v222
v_mfma_f32_16x16x32_bf16 v[100:103], a[84:87], v[224:227], v[100:103]
v_exp_f32 v223, v223
v_mfma_f32_16x16x32_bf16 v[104:107], a[88:91], v[224:227], v[104:107]
ds_read_b128 a[0:3], v145 offset:32768
v_cvt_pk_bf16_f32 v231, v222, v223
v_mfma_f32_16x16x32_bf16 v[108:111], a[92:95], v[224:227], v[108:111]
buffer_load_dwordx4 v1, s[36:39], 0 offen offset:3072 sc1 lds
ds_read_b128 a[4:7], v145 offset:33792
v_mfma_f32_16x16x32_bf16 a[132:135], a[136:139], v[228:231], a[132:135]
s_add_u32 m0, s83, 0
ds_read_b128 a[8:11], v145 offset:34816
v_accvgpr_read_b32 v7, a128
v_mfma_f32_16x16x32_bf16 v[112:115], a[64:67], v[228:231], v[112:115]
s_add_u32 s80, s45, 0
ds_read_b128 a[12:15], v145 offset:35840
v_add_u32 v146, 131072, v1
v_mfma_f32_16x16x32_bf16 v[116:119], a[68:71], v[228:231], v[116:119]
s_add_u32 s36, s28, s80
s_addc_u32 s37, s29, 0
ds_read_b128 a[16:19], v145 offset:36864
v_mfma_f32_16x16x32_bf16 v[120:123], a[72:75], v[228:231], v[120:123]
v_rcp_f32 v4, v7
v_mfma_f32_16x16x32_bf16 v[124:127], a[76:79], v[228:231], v[124:127]
ds_read_b128 a[20:23], v145 offset:37888
v_and_b32 v148, 15, v0
v_mfma_f32_16x16x32_bf16 v[128:131], a[80:83], v[228:231], v[128:131]
v_accvgpr_read_b32 v6, a132
v_min_f32 v11, v7, v6
v_mfma_f32_16x16x32_bf16 v[132:135], a[84:87], v[228:231], v[132:135]
v_cmp_nlt_f32 vcc, 0x30800000, v11
v_add_f32 v7, v7, v6
v_mfma_f32_16x16x32_bf16 v[136:139], a[88:91], v[228:231], v[136:139]
s_or_b64 s[16:17], s[16:17], vcc
ds_read_b128 a[24:27], v145 offset:38912
v_cmp_ngt_f32 vcc, 0x4e800000, v7
v_mfma_f32_16x16x32_bf16 v[140:143], a[92:95], v[228:231], v[140:143]
s_branch L_p38
.p2align 4
L_DP0:
v_mfma_f32_16x16x32_bf16 v[216:219], a[0:3], v[48:51], v[240:243]
s_add_u32 s7, s63, s62
v_exp_f32 v208, v208
v_mfma_f32_16x16x32_bf16 v[216:219], a[4:7], v[52:55], v[216:219]
s_barrier
v_mfma_f32_16x16x32_bf16 v[216:219], a[8:11], v[56:59], v[216:219]
s_add_u32 s36, s28, s26
v_exp_f32 v209, v209
v_mfma_f32_16x16x32_bf16 v[216:219], a[12:15], v[60:63], v[216:219]
s_addc_u32 s37, s29, 0
v_exp_f32 v210, v210
v_mfma_f32_16x16x32_bf16 v[220:223], a[16:19], v[60:63], v[240:243]
s_add_u32 s26, s26, s64
ds_read_b128 a[32:35], v3 offset:0
v_cvt_pk_bf16_f32 v224, v208, v209
v_mfma_f32_16x16x32_bf16 v[220:223], a[20:23], v[56:59], v[220:223]
s_add_u32 s57, s57, s65
v_exp_f32 v211, v211
v_mfma_f32_16x16x32_bf16 v[220:223], a[24:27], v[52:55], v[220:223]
s_add_u32 s62, s62, 32768
ds_read_b128 a[36:39], v3 offset:1024
v_cvt_pk_bf16_f32 v225, v210, v211
v_mfma_f32_16x16x32_bf16 v[220:223], a[28:31], v[48:51], v[220:223]
s_and_b32 s62, s62, 131071
v_exp_f32 v212, v212
v_mfma_f32_16x16x32_bf16 v[112:115], a[96:99], v[228:231], v[112:115]
s_add_u32 s6, s62, 32768
s_and_b32 s6, s6, 131071
ds_read_b128 a[40:43], v3 offset:8192
v_mfma_f32_16x16x32_bf16 v[116:119], a[100:103], v[228:231], v[116:119]
s_add_u32 s58, s58, 1
s_add_u32 s6, s6, 32768
ds_read_b128 a[44:47], v3 offset:9216
v_mfma_f32_16x16x32_bf16 v[120:123], a[104:107], v[228:231], v[120:123]
s_mov_b32 m0, s7
v_exp_f32 v213, v213
v_mfma_f32_16x16x32_bf16 v[124:127], a[108:111], v[228:231], v[124:127]
s_add_u32 s40, s28, s57
ds_read_b128 a[48:51], v3 offset:11264
v_cvt_pk_bf16_f32 v226, v212, v213
v_mfma_f32_16x16x32_bf16 v[128:131], a[112:115], v[228:231], v[128:131]
s_addc_u32 s41, s29, 0
v_exp_f32 v214, v214
v_mfma_f32_16x16x32_bf16 v[132:135], a[116:119], v[228:231], v[132:135]
s_bitcmp1_b64 s[60:61], s58
ds_read_b128 a[52:55], v3 offset:10240
v_mfma_f32_16x16x32_bf16 v[136:139], a[120:123], v[228:231], v[136:139]
v_exp_f32 v215, v215
v_mfma_f32_16x16x32_bf16 v[140:143], a[124:127], v[228:231], v[140:143]
ds_read_b128 a[56:59], v3 offset:3072
v_cvt_pk_bf16_f32 v227, v214, v215
v_mfma_f32_16x16x32_bf16 a[132:135], a[136:139], v[228:231], a[132:135]
ds_read_b128 a[60:63], v3 offset:2048
v_mfma_f32_16x16x32_bf16 v[208:211], a[0:3], v[64:67], v[244:247]
v_exp_f32 v216, v216
v_mfma_f32_16x16x32_bf16 v[208:211], a[4:7], v[68:71], v[208:211]
ds_read_b128 a[96:99], v3 offset:4096
v_add_f32 v7, v7, v216
v_mfma_f32_16x16x32_bf16 v[208:211], a[8:11], v[72:75], v[208:211]
v_exp_f32 v217, v217
v_mfma_f32_16x16x32_bf16 v[208:211], a[12:15], v[76:79], v[208:211]
v_cvt_pk_bf16_f32 v228, v216, v217
v_add_f32 v7, v7, v217
v_mfma_f32_16x16x32_bf16 v[212:215], a[16:19], v[76:79], v[244:247]
v_exp_f32 v218, v218
v_mfma_f32_16x16x32_bf16 v[212:215], a[20:23], v[72:75], v[212:215]
v_add_f32 v7, v7, v218
v_mfma_f32_16x16x32_bf16 v[212:215], a[24:27], v[68:71], v[212:215]
v_exp_f32 v219, v219
v_mfma_f32_16x16x32_bf16 v[212:215], a[28:31], v[64:67], v[212:215]
s_waitcnt lgkmcnt(1)
v_cvt_pk_bf16_f32 v229, v218, v219
v_add_f32 v7, v7, v219
v_mfma_f32_16x16x32_bf16 v[80:83], a[64:67], v[224:227], v[80:83]
v_exp_f32 v220, v220
v_mfma_f32_16x16x32_bf16 v[84:87], a[68:71], v[224:227], v[84:87]
v_add_f32 v7, v7, v220
v_mfma_f32_16x16x32_bf16 v[88:91], a[72:75], v[224:227], v[88:91]
v_exp_f32 v221, v221
v_mfma_f32_16x16x32_bf16 v[92:95], a[76:79], v[224:227], v[92:95]
v_cvt_pk_bf16_f32 v230, v220, v221
v_add_f32 v7, v7, v221
v_mfma_f32_16x16x32_bf16 v[96:99], a[80:83], v[224:227], v[96:99]
v_exp_f32 v222, v222
v_mfma_f32_16x16x32_bf16 v[100:103], a[84:87], v[224:227], v[100:103]
v_add_f32 v7, v7, v222
v_mfma_f32_16x16x32_bf16 v[104:107], a[88:91], v[224:227], v[104:107]
v_exp_f32 v223, v223
v_mfma_f32_16x16x32_bf16 v[108:111], a[92:95], v[224:227], v[108:111]
v_cvt_pk_bf16_f32 v231, v222, v223
v_add_f32 v7, v7, v223
v_mfma_f32_16x16x32_bf16 a[128:131], a[136:139], v[224:227], a[128:131]
ds_read_b128 a[100:103], v3 offset:5120
v_mfma_f32_16x16x32_bf16 v[216:219], a[0:3], v[32:35], v[236:239]
v_exp_f32 v208, v208
v_mfma_f32_16x16x32_bf16 v[216:219], a[4:7], v[36:39], v[216:219]
ds_read_b128 a[104:107], v3 offset:6144
v_add_f32 v14, v14, v208
v_mfma_f32_16x16x32_bf16 v[216:219], a[8:11], v[40:43], v[216:219]
v_exp_f32 v209, v209
v_mfma_f32_16x16x32_bf16 v[216:219], a[12:15], v[44:47], v[216:219]
v_cvt_pk_bf16_f32 v224, v208, v209
v_add_f32 v14, v14, v209
v_mfma_f32_16x16x32_bf16 v[220:223], a[16:19], v[44:47], v[236:239]
v_exp_f32 v210, v210
v_mfma_f32_16x16x32_bf16 v[220:223], a[20:23], v[40:43], v[220:223]
buffer_load_dwordx4 v1, s[36:39], 0 offen sc1 lds
v_add_f32 v14, v14, v210
v_mfma_f32_16x16x32_bf16 v[220:223], a[24:27], v[36:39], v[220:223]
v_exp_f32 v211, v211
v_mfma_f32_16x16x32_bf16 v[220:223], a[28:31], v[32:35], v[220:223]
v_cvt_pk_bf16_f32 v225, v210, v211
v_add_f32 v14, v14, v211
v_mfma_f32_16x16x32_bf16 v[144:147], a[64:67], v[228:231], v[144:147]
v_exp_f32 v212, v212
v_mfma_f32_16x16x32_bf16 v[148:151], a[68:71], v[228:231], v[148:151]
ds_read_b128 a[108:111], v3 offset:7168
v_add_f32 v14, v14, v212
v_mfma_f32_16x16x32_bf16 v[152:155], a[72:75], v[228:231], v[152:155]
v_exp_f32 v213, v213
v_mfma_f32_16x16x32_bf16 v[156:159], a[76:79], v[228:231], v[156:159]
v_cvt_pk_bf16_f32 v226, v212, v213
v_add_f32 v14, v14, v213
v_mfma_f32_16x16x32_bf16 v[160:163], a[80:83], v[228:231], v[160:163]
v_exp_f32 v214, v214
v_mfma_f32_16x16x32_bf16 v[164:167], a[84:87], v[228:231], v[164:167]
buffer_load_dwordx4 v1, s[36:39], 0 offen offset:1024 sc1 lds
v_add_f32 v14, v14, v214
v_mfma_f32_16x16x32_bf16 v[168:171], a[88:91], v[228:231], v[168:171]
v_exp_f32 v215, v215
v_mfma_f32_16x16x32_bf16 v[172:175], a[92:95], v[228:231], v[172:175]
v_cvt_pk_bf16_f32 v227, v214, v215
v_add_f32 v14, v14, v215
v_mfma_f32_16x16x32_bf16 v[208:211], a[32:35], v[16:19], v[232:235]
v_exp_f32 v216, v216
v_mfma_f32_16x16x32_bf16 v[208:211], a[36:39], v[20:23], v[208:211]
v_exp_f32 v217, v217
v_mfma_f32_16x16x32_bf16 v[208:211], a[40:43], v[24:27], v[208:211]
ds_read_b128 a[112:115], v3 offset:12288
v_cvt_pk_bf16_f32 v228, v216, v217
v_mfma_f32_16x16x32_bf16 v[208:211], a[44:47], v[28:31], v[208:211]
v_exp_f32 v218, v218
v_mfma_f32_16x16x32_bf16 v[212:215], a[48:51], v[28:31], v[232:235]
buffer_load_dwordx4 v1, s[36:39], 0 offen offset:2048 sc1 lds
v_mfma_f32_16x16x32_bf16 v[212:215], a[52:55], v[24:27], v[212:215]
v_exp_f32 v219, v219
v_mfma_f32_16x16x32_bf16 v[212:215], a[56:59], v[20:23], v[212:215]
ds_read_b128 a[116:119], v3 offset:13312
v_cvt_pk_bf16_f32 v229, v218, v219
v_mfma_f32_16x16x32_bf16 v[212:215], a[60:63], v[16:19], v[212:215]
v_exp_f32 v220, v220
v_mfma_f32_16x16x32_bf16 v[176:179], a[64:67], v[224:227], v[176:179]
buffer_load_dwordx4 v1, s[36:39], 0 offen offset:3072 sc1 lds
v_mfma_f32_16x16x32_bf16 v[180:183], a[68:71], v[224:227], v[180:183]
v_exp_f32 v221, v221
v_mfma_f32_16x16x32_bf16 v[184:187], a[72:75], v[224:227], v[184:187]
ds_read_b128 a[120:123], v3 offset:14336
v_cvt_pk_bf16_f32 v230, v220, v221
v_mfma_f32_16x16x32_bf16 v[188:191], a[76:79], v[224:227], v[188:191]
v_exp_f32 v222, v222
v_mfma_f32_16x16x32_bf16 v[192:195], a[80:83], v[224:227], v[192:195]
ds_read_b128 a[124:127], v3 offset:15360
v_add_u32 v3, s6, v1
v_mfma_f32_16x16x32_bf16 v[196:199], a[84:87], v[224:227], v[196:199]
v_exp_f32 v223, v223
v_mfma_f32_16x16x32_bf16 v[200:203], a[88:91], v[224:227], v[200:203]
s_waitcnt vmcnt(8)
v_cvt_pk_bf16_f32 v231, v222, v223
v_mfma_f32_16x16x32_bf16 v[204:207], a[92:95], v[224:227], v[204:207]
L_DP1:
v_mfma_f32_16x16x32_bf16 v[216:219], a[32:35], v[48:51], v[240:243]
s_add_u32 s7, s63, s62
v_exp_f32 v208, v208
v_mfma_f32_16x16x32_bf16 v[216:219], a[36:39], v[52:55], v[216:219]
s_barrier
v_mfma_f32_16x16x32_bf16 v[216:219], a[40:43], v[56:59], v[216:219]
s_add_u32 s36, s28, s26
v_exp_f32 v209, v209
v_mfma_f32_16x16x32_bf16 v[216:219], a[44:47], v[60:63], v[216:219]
s_addc_u32 s37, s29, 0
v_exp_f32 v210, v210
v_mfma_f32_16x16x32_bf16 v[220:223], a[48:51], v[60:63], v[240:243]
s_add_u32 s26, s26, s64
ds_read_b128 a[0:3], v3 offset:0
v_cvt_pk_bf16_f32 v224, v208, v209
v_mfma_f32_16x16x32_bf16 v[220:223], a[52:55], v[56:59], v[220:223]
s_add_u32 s57, s57, s65
v_exp_f32 v211, v211
v_mfma_f32_16x16x32_bf16 v[220:223], a[56:59], v[52:55], v[220:223]
s_add_u32 s62, s62, 32768
ds_read_b128 a[4:7], v3 offset:1024
v_cvt_pk_bf16_f32 v225, v210, v211
v_mfma_f32_16x16x32_bf16 v[220:223], a[60:63], v[48:51], v[220:223]
s_and_b32 s62, s62, 131071
v_exp_f32 v212, v212
v_mfma_f32_16x16x32_bf16 v[112:115], a[64:67], v[228:231], v[112:115]
s_add_u32 s6, s62, 32768
s_and_b32 s6, s6, 131071
ds_read_b128 a[8:11], v3 offset:8192
v_mfma_f32_16x16x32_bf16 v[116:119], a[68:71], v[228:231], v[116:119]
s_add_u32 s58, s58, 1
s_add_u32 s6, s6, 32768
ds_read_b128 a[12:15], v3 offset:9216
v_mfma_f32_16x16x32_bf16 v[120:123], a[72:75], v[228:231], v[120:123]
s_mov_b32 m0, s7
v_exp_f32 v213, v213
v_mfma_f32_16x16x32_bf16 v[124:127], a[76:79], v[228:231], v[124:127]
s_add_u32 s40, s28, s57
ds_read_b128 a[16:19], v3 offset:11264
v_cvt_pk_bf16_f32 v226, v212, v213
v_mfma_f32_16x16x32_bf16 v[128:131], a[80:83], v[228:231], v[128:131]
s_addc_u32 s41, s29, 0
v_exp_f32 v214, v214
v_mfma_f32_16x16x32_bf16 v[132:135], a[84:87], v[228:231], v[132:135]
s_bitcmp1_b64 s[60:61], s58
ds_read_b128 a[20:23], v3 offset:10240
v_mfma_f32_16x16x32_bf16 v[136:139], a[88:91], v[228:231], v[136:139]
v_exp_f32 v215, v215
v_mfma_f32_16x16x32_bf16 v[140:143], a[92:95], v[228:231], v[140:143]
ds_read_b128 a[24:27], v3 offset:3072
v_cvt_pk_bf16_f32 v227, v214, v215
v_mfma_f32_16x16x32_bf16 a[132:135], a[136:139], v[228:231], a[132:135]
ds_read_b128 a[28:31], v3 offset:2048
v_mfma_f32_16x16x32_bf16 v[208:211], a[32:35], v[64:67], v[244:247]
v_exp_f32 v216, v216
v_mfma_f32_16x16x32_bf16 v[208:211], a[36:39], v[68:71], v[208:211]
ds_read_b128 a[64:67], v3 offset:4096
v_add_f32 v7, v7, v216
v_mfma_f32_16x16x32_bf16 v[208:211], a[40:43], v[72:75], v[208:211]
v_exp_f32 v217, v217
v_mfma_f32_16x16x32_bf16 v[208:211], a[44:47], v[76:79], v[208:211]
v_cvt_pk_bf16_f32 v228, v216, v217
v_add_f32 v7, v7, v217
v_mfma_f32_16x16x32_bf16 v[212:215], a[48:51], v[76:79], v[244:247]
v_exp_f32 v218, v218
v_mfma_f32_16x16x32_bf16 v[212:215], a[52:55], v[72:75], v[212:215]
v_add_f32 v7, v7, v218
v_mfma_f32_16x16x32_bf16 v[212:215], a[56:59], v[68:71], v[212:215]
v_exp_f32 v219, v219
v_mfma_f32_16x16x32_bf16 v[212:215], a[60:63], v[64:67], v[212:215]
s_waitcnt lgkmcnt(1)
v_cvt_pk_bf16_f32 v229, v218, v219
v_add_f32 v7, v7, v219
v_mfma_f32_16x16x32_bf16 v[80:83], a[96:99], v[224:227], v[80:83]
v_exp_f32 v220, v220
v_mfma_f32_16x16x32_bf16 v[84:87], a[100:103], v[224:227], v[84:87]
v_add_f32 v7, v7, v220
v_mfma_f32_16x16x32_bf16 v[88:91], a[104:107], v[224:227], v[88:91]
v_exp_f32 v221, v221
v_mfma_f32_16x16x32_bf16 v[92:95], a[108:111], v[224:227], v[92:95]
v_cvt_pk_bf16_f32 v230, v220, v221
v_add_f32 v7, v7, v221
v_mfma_f32_16x16x32_bf16 v[96:99], a[112:115], v[224:227], v[96:99]
v_exp_f32 v222, v222
v_mfma_f32_16x16x32_bf16 v[100:103], a[116:119], v[224:227], v[100:103]
v_add_f32 v7, v7, v222
v_mfma_f32_16x16x32_bf16 v[104:107], a[120:123], v[224:227], v[104:107]
v_exp_f32 v223, v223
v_mfma_f32_16x16x32_bf16 v[108:111], a[124:127], v[224:227], v[108:111]
v_cvt_pk_bf16_f32 v231, v222, v223
v_add_f32 v7, v7, v223
v_mfma_f32_16x16x32_bf16 a[128:131], a[136:139], v[224:227], a[128:131]
ds_read_b128 a[68:71], v3 offset:5120
v_mfma_f32_16x16x32_bf16 v[216:219], a[32:35], v[32:35], v[236:239]
v_exp_f32 v208, v208
v_mfma_f32_16x16x32_bf16 v[216:219], a[36:39], v[36:39], v[216:219]
ds_read_b128 a[72:75], v3 offset:6144
v_add_f32 v14, v14, v208
v_mfma_f32_16x16x32_bf16 v[216:219], a[40:43], v[40:43], v[216:219]
v_exp_f32 v209, v209
v_mfma_f32_16x16x32_bf16 v[216:219], a[44:47], v[44:47], v[216:219]
v_cvt_pk_bf16_f32 v224, v208, v209
v_add_f32 v14, v14, v209
v_mfma_f32_16x16x32_bf16 v[220:223], a[48:51], v[44:47], v[236:239]
v_exp_f32 v210, v210
v_mfma_f32_16x16x32_bf16 v[220:223], a[52:55], v[40:43], v[220:223]
buffer_load_dwordx4 v1, s[36:39], 0 offen sc1 lds
v_add_f32 v14, v14, v210
v_mfma_f32_16x16x32_bf16 v[220:223], a[56:59], v[36:39], v[220:223]
v_exp_f32 v211, v211
v_mfma_f32_16x16x32_bf16 v[220:223], a[60:63], v[32:35], v[220:223]
v_cvt_pk_bf16_f32 v225, v210, v211
v_add_f32 v14, v14, v211
v_mfma_f32_16x16x32_bf16 v[144:147], a[96:99], v[228:231], v[144:147]
v_exp_f32 v212, v212
v_mfma_f32_16x16x32_bf16 v[148:151], a[100:103], v[228:231], v[148:151]
ds_read_b128 a[76:79], v3 offset:7168
v_add_f32 v14, v14, v212
v_mfma_f32_16x16x32_bf16 v[152:155], a[104:107], v[228:231], v[152:155]
v_exp_f32 v213, v213
v_mfma_f32_16x16x32_bf16 v[156:159], a[108:111], v[228:231], v[156:159]
v_cvt_pk_bf16_f32 v226, v212, v213
v_add_f32 v14, v14, v213
v_mfma_f32_16x16x32_bf16 v[160:163], a[112:115], v[228:231], v[160:163]
v_exp_f32 v214, v214
v_mfma_f32_16x16x32_bf16 v[164:167], a[116:119], v[228:231], v[164:167]
buffer_load_dwordx4 v1, s[36:39], 0 offen offset:1024 sc1 lds
v_add_f32 v14, v14, v214
v_mfma_f32_16x16x32_bf16 v[168:171], a[120:123], v[228:231], v[168:171]
v_exp_f32 v215, v215
v_mfma_f32_16x16x32_bf16 v[172:175], a[124:127], v[228:231], v[172:175]
v_cvt_pk_bf16_f32 v227, v214, v215
v_add_f32 v14, v14, v215
v_mfma_f32_16x16x32_bf16 v[208:211], a[0:3], v[16:19], v[232:235]
v_exp_f32 v216, v216
v_mfma_f32_16x16x32_bf16 v[208:211], a[4:7], v[20:23], v[208:211]
v_exp_f32 v217, v217
v_mfma_f32_16x16x32_bf16 v[208:211], a[8:11], v[24:27], v[208:211]
ds_read_b128 a[80:83], v3 offset:12288
v_cvt_pk_bf16_f32 v228, v216, v217
v_mfma_f32_16x16x32_bf16 v[208:211], a[12:15], v[28:31], v[208:211]
v_exp_f32 v218, v218
v_mfma_f32_16x16x32_bf16 v[212:215], a[16:19], v[28:31], v[232:235]
buffer_load_dwordx4 v1, s[36:39], 0 offen offset:2048 sc1 lds
v_mfma_f32_16x16x32_bf16 v[212:215], a[20:23], v[24:27], v[212:215]
v_exp_f32 v219, v219
v_mfma_f32_16x16x32_bf16 v[212:215], a[24:27], v[20:23], v[212:215]
ds_read_b128 a[84:87], v3 offset:13312
v_cvt_pk_bf16_f32 v229, v218, v219
v_mfma_f32_16x16x32_bf16 v[212:215], a[28:31], v[16:19], v[212:215]
v_exp_f32 v220, v220
v_mfma_f32_16x16x32_bf16 v[176:179], a[96:99], v[224:227], v[176:179]
buffer_load_dwordx4 v1, s[36:39], 0 offen offset:3072 sc1 lds
v_mfma_f32_16x16x32_bf16 v[180:183], a[100:103], v[224:227], v[180:183]
v_exp_f32 v221, v221
v_mfma_f32_16x16x32_bf16 v[184:187], a[104:107], v[224:227], v[184:187]
ds_read_b128 a[88:91], v3 offset:14336
v_cvt_pk_bf16_f32 v230, v220, v221
v_mfma_f32_16x16x32_bf16 v[188:191], a[108:111], v[224:227], v[188:191]
v_exp_f32 v222, v222
v_mfma_f32_16x16x32_bf16 v[192:195], a[112:115], v[224:227], v[192:195]
ds_read_b128 a[92:95], v3 offset:15360
v_add_u32 v3, s6, v1
v_mfma_f32_16x16x32_bf16 v[196:199], a[116:119], v[224:227], v[196:199]
v_exp_f32 v223, v223
v_mfma_f32_16x16x32_bf16 v[200:203], a[120:123], v[224:227], v[200:203]
s_waitcnt vmcnt(8)
v_cvt_pk_bf16_f32 v231, v222, v223
v_mfma_f32_16x16x32_bf16 v[204:207], a[124:127], v[224:227], v[204:207]
s_cbranch_scc0 L_DP0
s_branch L_D0_0
L_R_0:
v_mfma_f32_16x16x32_bf16 v[216:219], a[0:3], v[32:35], v[236:239]
s_add_u32 s7, s63, s62
v_exp_f32 v208, v208
v_mfma_f32_16x16x32_bf16 v[216:219], a[4:7], v[36:39], v[216:219]
s_barrier
v_mfma_f32_16x16x32_bf16 v[216:219], a[8:11], v[40:43], v[216:219]
s_add_u32 m0, s7, 16384
v_exp_f32 v209, v209
v_mfma_f32_16x16x32_bf16 v[216:219], a[12:15], v[44:47], v[216:219]
s_add_u32 s36, s28, s26
v_exp_f32 v210, v210
v_mfma_f32_16x16x32_bf16 v[220:223], a[16:19], v[44:47], v[236:239]
s_addc_u32 s37, s29, 0
ds_read_b128 a[32:35], v3 offset:16384
v_cvt_pk_bf16_f32 v224, v208, v209
v_mfma_f32_16x16x32_bf16 v[220:223], a[20:23], v[40:43], v[220:223]
s_add_u32 s26, s26, s64
v_exp_f32 v211, v211
v_mfma_f32_16x16x32_bf16 v[220:223], a[24:27], v[36:39], v[220:223]
s_add_u32 s57, s57, s65
ds_read_b128 a[36:39], v3 offset:17408
buffer_load_dwordx4 v1, s[40:43], 0 offen sc1 lds
v_mfma_f32_16x16x32_bf16 v[220:223], a[28:31], v[32:35], v[220:223]
s_add_u32 s62, s62, 32768
v_exp_f32 v212, v212
v_mfma_f32_16x16x32_bf16 v[112:115], a[96:99], v[228:231], v[112:115]
s_and_b32 s62, s62, 131071
ds_read_b128 a[40:43], v3 offset:24576
v_cvt_pk_bf16_f32 v225, v210, v211
v_mfma_f32_16x16x32_bf16 v[116:119], a[100:103], v[228:231], v[116:119]
s_add_u32 s6, s62, 32768
s_and_b32 s6, s6, 131071
ds_read_b128 a[44:47], v3 offset:25600
v_mfma_f32_16x16x32_bf16 v[120:123], a[104:107], v[228:231], v[120:123]
s_add_u32 s58, s58, 1
v_exp_f32 v213, v213
v_mfma_f32_16x16x32_bf16 v[124:127], a[108:111], v[228:231], v[124:127]
s_add_u32 s6, s6, 32768
ds_read_b128 a[48:51], v3 offset:27648
buffer_load_dwordx4 v1, s[40:43], 0 offen offset:1024 sc1 lds
v_mfma_f32_16x16x32_bf16 v[128:131], a[112:115], v[228:231], v[128:131]
v_exp_f32 v214, v214
v_mfma_f32_16x16x32_bf16 v[132:135], a[116:119], v[228:231], v[132:135]
ds_read_b128 a[52:55], v3 offset:26624
v_cvt_pk_bf16_f32 v226, v212, v213
v_mfma_f32_16x16x32_bf16 v[136:139], a[120:123], v[228:231], v[136:139]
v_exp_f32 v215, v215
v_mfma_f32_16x16x32_bf16 v[140:143], a[124:127], v[228:231], v[140:143]
ds_read_b128 a[56:59], v3 offset:19456
v_cvt_pk_bf16_f32 v227, v214, v215
v_mfma_f32_16x16x32_bf16 a[132:135], a[136:139], v[228:231], a[132:135]
s_waitcnt lgkmcnt(3)
ds_read_b128 a[60:63], v3 offset:18432
v_mfma_f32_16x16x32_bf16 v[208:211], a[32:35], v[16:19], v[232:235]
v_exp_f32 v216, v216
v_mfma_f32_16x16x32_bf16 v[208:211], a[36:39], v[20:23], v[208:211]
ds_read_b128 a[96:99], v3 offset:20480
v_mfma_f32_16x16x32_bf16 v[208:211], a[40:43], v[24:27], v[208:211]
v_exp_f32 v217, v217
v_mfma_f32_16x16x32_bf16 v[208:211], a[44:47], v[28:31], v[208:211]
s_waitcnt lgkmcnt(3)
ds_read_b128 a[100:103], v3 offset:21504
v_cvt_pk_bf16_f32 v228, v216, v217
v_mfma_f32_16x16x32_bf16 v[212:215], a[48:51], v[28:31], v[232:235]
v_exp_f32 v218, v218
v_mfma_f32_16x16x32_bf16 v[212:215], a[52:55], v[24:27], v[212:215]
s_waitcnt lgkmcnt(3)
ds_read_b128 a[104:107], v3 offset:22528
buffer_load_dwordx4 v1, s[40:43], 0 offen offset:2048 sc1 lds
v_mfma_f32_16x16x32_bf16 v[212:215], a[56:59], v[20:23], v[212:215]
s_waitcnt lgkmcnt(3)
v_exp_f32 v219, v219
v_mfma_f32_16x16x32_bf16 v[212:215], a[60:63], v[16:19], v[212:215]
ds_read_b128 a[108:111], v3 offset:23552
v_cvt_pk_bf16_f32 v229, v218, v219
v_mfma_f32_16x16x32_bf16 v[80:83], a[64:67], v[224:227], v[80:83]
v_exp_f32 v220, v220
v_mfma_f32_16x16x32_bf16 v[84:87], a[68:71], v[224:227], v[84:87]
ds_read_b128 a[112:115], v3 offset:28672
v_mfma_f32_16x16x32_bf16 v[88:91], a[72:75], v[224:227], v[88:91]
v_exp_f32 v221, v221
v_mfma_f32_16x16x32_bf16 v[92:95], a[76:79], v[224:227], v[92:95]
L_pad12:
s_cbranch_execz L_pad16
ds_read_b128 a[116:119], v3 offset:29696
v_cvt_pk_bf16_f32 v230, v220, v221
v_mfma_f32_16x16x32_bf16 v[96:99], a[80:83], v[224:227], v[96:99]
v_exp_f32 v222, v222
v_mfma_f32_16x16x32_bf16 v[100:103], a[84:87], v[224:227], v[100:103]
ds_read_b128 a[120:123], v3 offset:30720
buffer_load_dwordx4 v1, s[40:43], 0 offen offset:3072 sc1 lds
v_mfma_f32_16x16x32_bf16 v[104:107], a[88:91], v[224:227], v[104:107]
s_mov_b32 m0, s7
v_exp_f32 v223, v223
v_mfma_f32_16x16x32_bf16 v[108:111], a[92:95], v[224:227], v[108:111]
s_add_u32 s40, s28, s57
ds_read_b128 a[124:127], v3 offset:31744
v_cvt_pk_bf16_f32 v231, v222, v223
v_mfma_f32_16x16x32_bf16 a[128:131], a[136:139], v[224:227], a[128:131]
s_addc_u32 s41, s29, 0
s_bitcmp1_b64 s[60:61], s58
v_mfma_f32_16x16x32_bf16 v[216:219], a[32:35], v[32:35], v[236:239]
v_exp_f32 v208, v208
v_mfma_f32_16x16x32_bf16 v[216:219], a[36:39], v[36:39], v[216:219]
ds_read_b128 a[0:3], v3 offset:0
v_mfma_f32_16x16x32_bf16 v[216:219], a[40:43], v[40:43], v[216:219]
v_exp_f32 v209, v209
v_mfma_f32_16x16x32_bf16 v[216:219], a[44:47], v[44:47], v[216:219]
ds_read_b128 a[4:7], v3 offset:1024
v_cvt_pk_bf16_f32 v224, v208, v209
v_mfma_f32_16x16x32_bf16 v[220:223], a[48:51], v[44:47], v[236:239]
v_exp_f32 v210, v210
v_mfma_f32_16x16x32_bf16 v[220:223], a[52:55], v[40:43], v[220:223]
ds_read_b128 a[8:11], v3 offset:8192
buffer_load_dwordx4 v1, s[36:39], 0 offen sc1 lds
v_mfma_f32_16x16x32_bf16 v[220:223], a[56:59], v[36:39], v[220:223]
v_exp_f32 v211, v211
v_mfma_f32_16x16x32_bf16 v[220:223], a[60:63], v[32:35], v[220:223]
ds_read_b128 a[12:15], v3 offset:9216
v_cvt_pk_bf16_f32 v225, v210, v211
v_mfma_f32_16x16x32_bf16 v[112:115], a[64:67], v[228:231], v[112:115]
v_exp_f32 v212, v212
v_mfma_f32_16x16x32_bf16 v[116:119], a[68:71], v[228:231], v[116:119]
ds_read_b128 a[16:19], v3 offset:11264
v_mfma_f32_16x16x32_bf16 v[120:123], a[72:75], v[228:231], v[120:123]
v_exp_f32 v213, v213
v_mfma_f32_16x16x32_bf16 v[124:127], a[76:79], v[228:231], v[124:127]
ds_read_b128 a[20:23], v3 offset:10240
v_cvt_pk_bf16_f32 v226, v212, v213
v_mfma_f32_16x16x32_bf16 v[128:131], a[80:83], v[228:231], v[128:131]
v_exp_f32 v214, v214
v_mfma_f32_16x16x32_bf16 v[132:135], a[84:87], v[228:231], v[132:135]
ds_read_b128 a[24:27], v3 offset:3072
buffer_load_dwordx4 v1, s[36:39], 0 offen offset:1024 sc1 lds
v_mfma_f32_16x16x32_bf16 v[136:139], a[88:91], v[228:231], v[136:139]
v_exp_f32 v215, v215
v_mfma_f32_16x16x32_bf16 v[140:143], a[92:95], v[228:231], v[140:143]
ds_read_b128 a[28:31], v3 offset:2048
v_cvt_pk_bf16_f32 v227, v214, v215
v_mfma_f32_16x16x32_bf16 a[132:135], a[136:139], v[228:231], a[132:135]
s_waitcnt lgkmcnt(3)
v_mfma_f32_16x16x32_bf16 v[208:211], a[0:3], v[16:19], v[232:235]
v_exp_f32 v216, v216
v_mfma_f32_16x16x32_bf16 v[208:211], a[4:7], v[20:23], v[208:211]
v_exp_f32 v217, v217
v_mfma_f32_16x16x32_bf16 v[208:211], a[8:11], v[24:27], v[208:211]
ds_read_b128 a[64:67], v3 offset:4096
v_cvt_pk_bf16_f32 v228, v216, v217
v_mfma_f32_16x16x32_bf16 v[208:211], a[12:15], v[28:31], v[208:211]
v_exp_f32 v218, v218
v_mfma_f32_16x16x32_bf16 v[212:215], a[16:19], v[28:31], v[232:235]
s_waitcnt lgkmcnt(2)
ds_read_b128 a[68:71], v3 offset:5120
buffer_load_dwordx4 v1, s[36:39], 0 offen offset:2048 sc1 lds
v_mfma_f32_16x16x32_bf16 v[212:215], a[20:23], v[24:27], v[212:215]
v_exp_f32 v219, v219
v_mfma_f32_16x16x32_bf16 v[212:215], a[24:27], v[20:23], v[212:215]
s_waitcnt lgkmcnt(2)
ds_read_b128 a[72:75], v3 offset:6144
v_cvt_pk_bf16_f32 v229, v218, v219
v_mfma_f32_16x16x32_bf16 v[212:215], a[28:31], v[16:19], v[212:215]
v_exp_f32 v220, v220
v_mfma_f32_16x16x32_bf16 v[80:83], a[96:99], v[224:227], v[80:83]
ds_read_b128 a[76:79], v3 offset:7168
buffer_load_dwordx4 v1, s[36:39], 0 offen offset:3072 sc1 lds
v_mfma_f32_16x16x32_bf16 v[84:87], a[100:103], v[224:227], v[84:87]
v_exp_f32 v221, v221
v_mfma_f32_16x16x32_bf16 v[88:91], a[104:107], v[224:227], v[88:91]
ds_read_b128 a[80:83], v3 offset:12288
v_cvt_pk_bf16_f32 v230, v220, v221
v_mfma_f32_16x16x32_bf16 v[92:95], a[108:111], v[224:227], v[92:95]
v_exp_f32 v222, v222
v_mfma_f32_16x16x32_bf16 v[96:99], a[112:115], v[224:227], v[96:99]
ds_read_b128 a[84:87], v3 offset:13312
v_mfma_f32_16x16x32_bf16 v[100:103], a[116:119], v[224:227], v[100:103]
v_exp_f32 v223, v223
v_mfma_f32_16x16x32_bf16 v[104:107], a[120:123], v[224:227], v[104:107]
ds_read_b128 a[88:91], v3 offset:14336
v_cvt_pk_bf16_f32 v231, v222, v223
v_mfma_f32_16x16x32_bf16 v[108:111], a[124:127], v[224:227], v[108:111]
s_waitcnt vmcnt(16)
ds_read_b128 a[92:95], v3 offset:15360
v_add_u32 v3, s6, v1
v_mfma_f32_16x16x32_bf16 a[128:131], a[136:139], v[224:227], a[128:131]
s_cbranch_scc0 L_R_0
s_branch L_ev
L_R_1:
v_mfma_f32_16x16x32_bf16 v[216:219], a[32:35], v[32:35], v[236:239]
s_add_u32 s7, s63, s62
v_exp_f32 v208, v208
v_mfma_f32_16x16x32_bf16 v[216:219], a[36:39], v[36:39], v[216:219]
s_barrier
v_mfma_f32_16x16x32_bf16 v[216:219], a[40:43], v[40:43], v[216:219]
s_add_u32 m0, s7, 16384
v_exp_f32 v209, v209
v_mfma_f32_16x16x32_bf16 v[216:219], a[44:47], v[44:47], v[216:219]
s_add_u32 s36, s28, s26
v_exp_f32 v210, v210
v_mfma_f32_16x16x32_bf16 v[220:223], a[48:51], v[44:47], v[236:239]
s_addc_u32 s37, s29, 0
ds_read_b128 a[0:3], v3 offset:16384
v_cvt_pk_bf16_f32 v224, v208, v209
v_mfma_f32_16x16x32_bf16 v[220:223], a[52:55], v[40:43], v[220:223]
s_add_u32 s26, s26, s64
v_exp_f32 v211, v211
v_mfma_f32_16x16x32_bf16 v[220:223], a[56:59], v[36:39], v[220:223]
s_add_u32 s57, s57, s65
ds_read_b128 a[4:7], v3 offset:17408
buffer_load_dwordx4 v1, s[40:43], 0 offen sc1 lds
v_mfma_f32_16x16x32_bf16 v[220:223], a[60:63], v[32:35], v[220:223]
s_add_u32 s62, s62, 32768
v_exp_f32 v212, v212
v_mfma_f32_16x16x32_bf16 v[112:115], a[64:67], v[228:231], v[112:115]
s_and_b32 s62, s62, 131071
ds_read_b128 a[8:11], v3 offset:24576
v_cvt_pk_bf16_f32 v225, v210, v211
v_mfma_f32_16x16x32_bf16 v[116:119], a[68:71], v[228:231], v[116:119]
s_add_u32 s6, s62, 32768
s_and_b32 s6, s6, 131071
ds_read_b128 a[12:15], v3 offset:25600
v_mfma_f32_16x16x32_bf16 v[120:123], a[72:75], v[228:231], v[120:123]
s_add_u32 s58, s58, 1
v_exp_f32 v213, v213
v_mfma_f32_16x16x32_bf16 v[124:127], a[76:79], v[228:231], v[124:127]
s_add_u32 s6, s6, 32768
ds_read_b128 a[16:19], v3 offset:27648
buffer_load_dwordx4 v1, s[40:43], 0 offen offset:1024 sc1 lds
v_mfma_f32_16x16x32_bf16 v[128:131], a[80:83], v[228:231], v[128:131]
v_exp_f32 v214, v214
v_mfma_f32_16x16x32_bf16 v[132:135], a[84:87], v[228:231], v[132:135]
ds_read_b128 a[20:23], v3 offset:26624
v_cvt_pk_bf16_f32 v226, v212, v213
v_mfma_f32_16x16x32_bf16 v[136:139], a[88:91], v[228:231], v[136:139]
v_exp_f32 v215, v215
v_mfma_f32_16x16x32_bf16 v[140:143], a[92:95], v[228:231], v[140:143]
ds_read_b128 a[24:27], v3 offset:19456
v_cvt_pk_bf16_f32 v227, v214, v215
v_mfma_f32_16x16x32_bf16 a[132:135], a[136:139], v[228:231], a[132:135]
s_waitcnt lgkmcnt(3)
ds_read_b128 a[28:31], v3 offset:18432
v_mfma_f32_16x16x32_bf16 v[208:211], a[0:3], v[16:19], v[232:235]
v_exp_f32 v216, v216
v_mfma_f32_16x16x32_bf16 v[208:211], a[4:7], v[20:23], v[208:211]
ds_read_b128 a[64:67], v3 offset:20480
v_mfma_f32_16x16x32_bf16 v[208:211], a[8:11], v[24:27], v[208:211]
v_exp_f32 v217, v217
v_mfma_f32_16x16x32_bf16 v[208:211], a[12:15], v[28:31], v[208:211]
s_waitcnt lgkmcnt(3)
ds_read_b128 a[68:71], v3 offset:21504
v_cvt_pk_bf16_f32 v228, v216, v217
v_mfma_f32_16x16x32_bf16 v[212:215], a[16:19], v[28:31], v[232:235]
v_exp_f32 v218, v218
v_mfma_f32_16x16x32_bf16 v[212:215], a[20:23], v[24:27], v[212:215]
s_waitcnt lgkmcnt(3)
ds_read_b128 a[72:75], v3 offset:22528
buffer_load_dwordx4 v1, s[40:43], 0 offen offset:2048 sc1 lds
v_mfma_f32_16x16x32_bf16 v[212:215], a[24:27], v[20:23], v[212:215]
s_waitcnt lgkmcnt(3)
v_exp_f32 v219, v219
v_mfma_f32_16x16x32_bf16 v[212:215], a[28:31], v[16:19], v[212:215]
ds_read_b128 a[76:79], v3 offset:23552
v_cvt_pk_bf16_f32 v229, v218, v219
v_mfma_f32_16x16x32_bf16 v[80:83], a[96:99], v[224:227], v[80:83]
v_exp_f32 v220, v220
v_mfma_f32_16x16x32_bf16 v[84:87], a[100:103], v[224:227], v[84:87]
ds_read_b128 a[80:83], v3 offset:28672
v_mfma_f32_16x16x32_bf16 v[88:91], a[104:107], v[224:227], v[88:91]
v_exp_f32 v221, v221
v_mfma_f32_16x16x32_bf16 v[92:95], a[108:111], v[224:227], v[92:95]
ds_read_b128 a[84:87], v3 offset:29696
v_cvt_pk_bf16_f32 v230, v220, v221
v_mfma_f32_16x16x32_bf16 v[96:99], a[112:115], v[224:227], v[96:99]
v_exp_f32 v222, v222
v_mfma_f32_16x16x32_bf16 v[100:103], a[116:119], v[224:227], v[100:103]
ds_read_b128 a[88:91], v3 offset:30720
buffer_load_dwordx4 v1, s[40:43], 0 offen offset:3072 sc1 lds
v_mfma_f32_16x16x32_bf16 v[104:107], a[120:123], v[224:227], v[104:107]
s_mov_b32 m0, s7
v_exp_f32 v223, v223
v_mfma_f32_16x16x32_bf16 v[108:111], a[124:127], v[224:227], v[108:111]
s_add_u32 s40, s28, s57
ds_read_b128 a[92:95], v3 offset:31744
v_cvt_pk_bf16_f32 v231, v222, v223
v_mfma_f32_16x16x32_bf16 a[128:131], a[136:139], v[224:227], a[128:131]
s_addc_u32 s41, s29, 0
s_bitcmp1_b64 s[60:61], s58
v_mfma_f32_16x16x32_bf16 v[216:219], a[0:3], v[32:35], v[236:239]
v_exp_f32 v208, v208
v_mfma_f32_16x16x32_bf16 v[216:219], a[4:7], v[36:39], v[216:219]
ds_read_b128 a[32:35], v3 offset:0
v_mfma_f32_16x16x32_bf16 v[216:219], a[8:11], v[40:43], v[216:219]
v_exp_f32 v209, v209
v_mfma_f32_16x16x32_bf16 v[216:219], a[12:15], v[44:47], v[216:219]
ds_read_b128 a[36:39], v3 offset:1024
v_cvt_pk_bf16_f32 v224, v208, v209
v_mfma_f32_16x16x32_bf16 v[220:223], a[16:19], v[44:47], v[236:239]
v_exp_f32 v210, v210
v_mfma_f32_16x16x32_bf16 v[220:223], a[20:23], v[40:43], v[220:223]
ds_read_b128 a[40:43], v3 offset:8192
buffer_load_dwordx4 v1, s[36:39], 0 offen sc1 lds
v_mfma_f32_16x16x32_bf16 v[220:223], a[24:27], v[36:39], v[220:223]
v_exp_f32 v211, v211
v_mfma_f32_16x16x32_bf16 v[220:223], a[28:31], v[32:35], v[220:223]
ds_read_b128 a[44:47], v3 offset:9216
v_cvt_pk_bf16_f32 v225, v210, v211
v_mfma_f32_16x16x32_bf16 v[112:115], a[96:99], v[228:231], v[112:115]
v_exp_f32 v212, v212
v_mfma_f32_16x16x32_bf16 v[116:119], a[100:103], v[228:231], v[116:119]
ds_read_b128 a[48:51], v3 offset:11264
v_mfma_f32_16x16x32_bf16 v[120:123], a[104:107], v[228:231], v[120:123]
v_exp_f32 v213, v213
v_mfma_f32_16x16x32_bf16 v[124:127], a[108:111], v[228:231], v[124:127]
ds_read_b128 a[52:55], v3 offset:10240
v_cvt_pk_bf16_f32 v226, v212, v213
v_mfma_f32_16x16x32_bf16 v[128:131], a[112:115], v[228:231], v[128:131]
v_exp_f32 v214, v214
v_mfma_f32_16x16x32_bf16 v[132:135], a[116:119], v[228:231], v[132:135]
ds_read_b128 a[56:59], v3 offset:3072
buffer_load_dwordx4 v1, s[36:39], 0 offen offset:1024 sc1 lds
v_mfma_f32_16x16x32_bf16 v[136:139], a[120:123], v[228:231], v[136:139]
v_exp_f32 v215, v215
v_mfma_f32_16x16x32_bf16 v[140:143], a[124:127], v[228:231], v[140:143]
ds_read_b128 a[60:63], v3 offset:2048
v_cvt_pk_bf16_f32 v227, v214, v215
v_mfma_f32_16x16x32_bf16 a[132:135], a[136:139], v[228:231], a[132:135]
s_waitcnt lgkmcnt(3)
v_mfma_f32_16x16x32_bf16 v[208:211], a[32:35], v[16:19], v[232:235]
v_exp_f32 v216, v216
v_mfma_f32_16x16x32_bf16 v[208:211], a[36:39], v[20:23], v[208:211]
v_exp_f32 v217, v217
v_mfma_f32_16x16x32_bf16 v[208:211], a[40:43], v[24:27], v[208:211]
ds_read_b128 a[96:99], v3 offset:4096
v_cvt_pk_bf16_f32 v228, v216, v217
v_mfma_f32_16x16x32_bf16 v[208:211], a[44:47], v[28:31], v[208:211]
v_exp_f32 v218, v218
v_mfma_f32_16x16x32_bf16 v[212:215], a[48:51], v[28:31], v[232:235]
s_waitcnt lgkmcnt(2)
ds_read_b128 a[100:103], v3 offset:5120
buffer_load_dwordx4 v1, s[36:39], 0 offen offset:2048 sc1 lds
v_mfma_f32_16x16x32_bf16 v[212:215], a[52:55], v[24:27], v[212:215]
v_exp_f32 v219, v219
v_mfma_f32_16x16x32_bf16 v[212:215], a[56:59], v[20:23], v[212:215]
s_waitcnt lgkmcnt(2)
ds_read_b128 a[104:107], v3 offset:6144
v_cvt_pk_bf16_f32 v229, v218, v219
v_mfma_f32_16x16x32_bf16 v[212:215], a[60:63], v[16:19], v[212:215]
v_exp_f32 v220, v220
v_mfma_f32_16x16x32_bf16 v[80:83], a[64:67], v[224:227], v[80:83]
ds_read_b128 a[108:111], v3 offset:7168
buffer_load_dwordx4 v1, s[36:39], 0 offen offset:3072 sc1 lds
v_mfma_f32_16x16x32_bf16 v[84:87], a[68:71], v[224:227], v[84:87]
v_exp_f32 v221, v221
v_mfma_f32_16x16x32_bf16 v[88:91], a[72:75], v[224:227], v[88:91]
ds_read_b128 a[112:115], v3 offset:12288
v_cvt_pk_bf16_f32 v230, v220, v221
v_mfma_f32_16x16x32_bf16 v[92:95], a[76:79], v[224:227], v[92:95]
v_exp_f32 v222, v222
v_mfma_f32_16x16x32_bf16 v[96:99], a[80:83], v[224:227], v[96:99]
ds_read_b128 a[116:119], v3 offset:13312
v_mfma_f32_16x16x32_bf16 v[100:103], a[84:87], v[224:227], v[100:103]
v_exp_f32 v223, v223
v_mfma_f32_16x16x32_bf16 v[104:107], a[88:91], v[224:227], v[104:107]
ds_read_b128 a[120:123], v3 offset:14336
v_cvt_pk_bf16_f32 v231, v222, v223
v_mfma_f32_16x16x32_bf16 v[108:111], a[92:95], v[224:227], v[108:111]
s_waitcnt vmcnt(16)
ds_read_b128 a[124:127], v3 offset:15360
v_add_u32 v3, s6, v1
v_mfma_f32_16x16x32_bf16 a[128:131], a[136:139], v[224:227], a[128:131]
s_cbranch_scc0 L_R_1
s_branch L_ev
L_DFL:
v_mfma_f32_16x16x32_bf16 v[216:219], a[0:3], v[48:51], v[248:251]
s_add_u32 s7, s63, s62
v_exp_f32 v208, v208
v_mfma_f32_16x16x32_bf16 v[216:219], a[4:7], v[52:55], v[216:219]
s_add_u32 m0, s7, 16384
v_exp_f32 v209, v209
v_mfma_f32_16x16x32_bf16 v[216:219], a[8:11], v[56:59], v[216:219]
s_add_u32 s36, s28, s26
v_exp_f32 v210, v210
v_mfma_f32_16x16x32_bf16 v[216:219], a[12:15], v[60:63], v[216:219]
s_addc_u32 s37, s29, 0
v_exp_f32 v211, v211
v_mfma_f32_16x16x32_bf16 v[220:223], a[16:19], v[60:63], v[240:243]
s_add_u32 s26, s26, s64
v_exp_f32 v212, v212
v_mfma_f32_16x16x32_bf16 v[220:223], a[20:23], v[56:59], v[220:223]
s_add_u32 s57, s57, s65
v_exp_f32 v213, v213
v_mfma_f32_16x16x32_bf16 v[220:223], a[24:27], v[52:55], v[220:223]
s_add_u32 s62, s62, 32768
v_exp_f32 v214, v214
v_mfma_f32_16x16x32_bf16 v[220:223], a[28:31], v[48:51], v[220:223]
s_and_b32 s62, s62, 131071
v_exp_f32 v215, v215
s_add_u32 s6, s62, 32768
buffer_load_dwordx4 v1, s[40:43], 0 offen sc1 lds
v_cvt_pk_bf16_f32 v224, v208, v209
s_and_b32 s6, s6, 131071
buffer_store_dwordx4 a[252:255], v1, s[28:31], s95 offen offset:0 sc1
v_cvt_pk_bf16_f32 v225, v210, v211
v_cvt_pk_bf16_f32 v226, v212, v213
s_add_u32 s58, s58, 1
s_add_u32 s6, s6, 32768
v_cvt_pk_bf16_f32 v227, v214, v215
v_mfma_f32_16x16x32_bf16 v[208:211], a[0:3], v[64:67], v[244:247]
v_exp_f32 v216, v216
v_mfma_f32_16x16x32_bf16 v[208:211], a[4:7], v[68:71], v[208:211]
ds_read_b128 a[96:99], v3 offset:4096
buffer_load_dwordx4 v1, s[40:43], 0 offen offset:1024 sc1 lds
v_mfma_f32_16x16x32_bf16 v[208:211], a[8:11], v[72:75], v[208:211]
v_exp_f32 v217, v217
v_mfma_f32_16x16x32_bf16 v[208:211], a[12:15], v[76:79], v[208:211]
global_load_dwordx4 a[164:167], v1, s[98:99] offset:-2048 sc1
v_mov_b32 v7, v216
v_cvt_pk_bf16_f32 v228, v216, v217
v_mfma_f32_16x16x32_bf16 v[212:215], a[16:19], v[76:79], v[252:255]
v_exp_f32 v218, v218
v_mfma_f32_16x16x32_bf16 v[212:215], a[20:23], v[72:75], v[212:215]
buffer_load_dwordx4 v1, s[40:43], 0 offen offset:2048 sc1 lds
v_add_f32 v7, v7, v217
v_mfma_f32_16x16x32_bf16 v[212:215], a[24:27], v[68:71], v[212:215]
v_exp_f32 v219, v219
v_mfma_f32_16x16x32_bf16 v[212:215], a[28:31], v[64:67], v[212:215]
s_waitcnt lgkmcnt(1)
buffer_store_dwordx4 a[252:255], v1, s[28:31], s95 offen offset:1024 sc1
v_add_f32 v7, v7, v218
v_cvt_pk_bf16_f32 v229, v218, v219
v_add_f32 v7, v7, v219
v_mfma_f32_16x16x32_bf16 v[80:83], a[64:67], v[224:227], 0
v_mov_b32 v230, 0
v_mov_b32 v231, 0
v_mfma_f32_16x16x32_bf16 v[84:87], a[68:71], v[224:227], 0
global_load_dwordx4 a[168:171], v1, s[98:99] offset:-1024 sc1
v_mfma_f32_16x16x32_bf16 v[88:91], a[72:75], v[224:227], 0
v_mfma_f32_16x16x32_bf16 v[92:95], a[76:79], v[224:227], 0
v_mfma_f32_16x16x32_bf16 v[96:99], a[80:83], v[224:227], 0
v_mfma_f32_16x16x32_bf16 v[100:103], a[84:87], v[224:227], 0
buffer_load_dwordx4 v1, s[40:43], 0 offen offset:3072 sc1 lds
v_mfma_f32_16x16x32_bf16 v[104:107], a[88:91], v[224:227], 0
s_mov_b32 m0, s7
s_add_u32 s40, s28, s57
global_load_dwordx4 a[172:175], v1, s[98:99] offset:0 sc1
v_mfma_f32_16x16x32_bf16 v[108:111], a[92:95], v[224:227], 0
s_addc_u32 s41, s29, 0
s_cmp_lg_u32 s67, 0
s_cselect_b64 vcc, -1, 0
v_mfma_f32_16x16x32_bf16 a[128:131], a[136:139], v[224:227], 0
s_bitcmp1_b64 s[60:61], s58
buffer_store_dwordx4 a[252:255], v1, s[28:31], s96 offen offset:0 sc1
ds_read_b128 a[100:103], v3 offset:5120
v_mfma_f32_16x16x32_bf16 v[216:219], a[0:3], v[32:35], v[236:239]
v_exp_f32 v208, v208
v_mfma_f32_16x16x32_bf16 v[216:219], a[4:7], v[36:39], v[216:219]
ds_read_b128 a[104:107], v3 offset:6144
v_mov_b32 v14, v208
v_mfma_f32_16x16x32_bf16 v[216:219], a[8:11], v[40:43], v[216:219]
v_exp_f32 v209, v209
v_mfma_f32_16x16x32_bf16 v[216:219], a[12:15], v[44:47], v[216:219]
global_load_dwordx4 a[176:179], v1, s[98:99] offset:1024 sc1
v_cvt_pk_bf16_f32 v224, v208, v209
v_add_f32 v14, v14, v209
v_mfma_f32_16x16x32_bf16 v[220:223], a[16:19], v[44:47], v[236:239]
v_exp_f32 v210, v210
v_mfma_f32_16x16x32_bf16 v[220:223], a[20:23], v[40:43], v[220:223]
buffer_load_dwordx4 v1, s[36:39], 0 offen sc1 lds
v_add_f32 v14, v14, v210
v_mfma_f32_16x16x32_bf16 v[220:223], a[24:27], v[36:39], v[220:223]
v_exp_f32 v211, v211
v_mfma_f32_16x16x32_bf16 v[220:223], a[28:31], v[32:35], v[220:223]
global_load_dwordx4 a[180:183], v1, s[98:99] offset:2048 sc1
v_cvt_pk_bf16_f32 v225, v210, v211
v_add_f32 v14, v14, v211
v_mfma_f32_16x16x32_bf16 v[144:147], a[64:67], v[228:231], 0
buffer_store_dwordx4 a[252:255], v1, s[28:31], s96 offen offset:1024 sc1
v_exp_f32 v212, v212
v_mfma_f32_16x16x32_bf16 v[148:151], a[68:71], v[228:231], 0
ds_read_b128 a[108:111], v3 offset:7168
v_add_f32 v14, v14, v212
v_mfma_f32_16x16x32_bf16 v[152:155], a[72:75], v[228:231], 0
v_exp_f32 v213, v213
v_mfma_f32_16x16x32_bf16 v[156:159], a[76:79], v[228:231], 0
global_load_dwordx4 a[184:187], v1, s[98:99] offset:3072 sc1
v_cvt_pk_bf16_f32 v226, v212, v213
v_add_f32 v14, v14, v213
v_mfma_f32_16x16x32_bf16 v[160:163], a[80:83], v[228:231], 0
v_exp_f32 v214, v214
v_mfma_f32_16x16x32_bf16 v[164:167], a[84:87], v[228:231], 0
buffer_load_dwordx4 v1, s[36:39], 0 offen offset:1024 sc1 lds
v_add_f32 v14, v14, v214
v_mfma_f32_16x16x32_bf16 v[168:171], a[88:91], v[228:231], 0
v_exp_f32 v215, v215
v_mfma_f32_16x16x32_bf16 v[172:175], a[92:95], v[228:231], 0
global_load_dwordx4 a[188:191], v1, s[48:49] offset:-4096 sc1
v_cvt_pk_bf16_f32 v227, v214, v215
v_add_f32 v14, v14, v215
v_mfma_f32_16x16x32_bf16 v[208:211], a[32:35], v[16:19], v[232:235]
v_exp_f32 v216, v216
v_mfma_f32_16x16x32_bf16 v[208:211], a[36:39], v[20:23], v[208:211]
buffer_store_dwordx4 a[252:255], v1, s[28:31], s85 offen offset:0 sc1
v_exp_f32 v217, v217
v_mfma_f32_16x16x32_bf16 v[208:211], a[40:43], v[24:27], v[208:211]
ds_read_b128 a[112:115], v3 offset:12288
v_cvt_pk_bf16_f32 v228, v216, v217
v_mfma_f32_16x16x32_bf16 v[208:211], a[44:47], v[28:31], v[208:211]
v_exp_f32 v218, v218
v_mfma_f32_16x16x32_bf16 v[212:215], a[48:51], v[28:31], v[232:235]
buffer_load_dwordx4 v1, s[36:39], 0 offen offset:2048 sc1 lds
v_mfma_f32_16x16x32_bf16 v[212:215], a[52:55], v[24:27], v[212:215]
v_exp_f32 v219, v219
v_mfma_f32_16x16x32_bf16 v[212:215], a[56:59], v[20:23], v[212:215]
ds_read_b128 a[116:119], v3 offset:13312
v_cvt_pk_bf16_f32 v229, v218, v219
v_mfma_f32_16x16x32_bf16 v[212:215], a[60:63], v[16:19], v[212:215]
v_exp_f32 v220, v220
v_mfma_f32_16x16x32_bf16 v[176:179], a[64:67], v[224:227], 0
buffer_load_dwordx4 v1, s[36:39], 0 offen offset:3072 sc1 lds
v_mfma_f32_16x16x32_bf16 v[180:183], a[68:71], v[224:227], 0
v_exp_f32 v221, v221
v_mfma_f32_16x16x32_bf16 v[184:187], a[72:75], v[224:227], 0
buffer_store_dwordx4 a[252:255], v1, s[28:31], s85 offen offset:1024 sc1
ds_read_b128 a[120:123], v3 offset:14336
v_cvt_pk_bf16_f32 v230, v220, v221
v_mfma_f32_16x16x32_bf16 v[188:191], a[76:79], v[224:227], 0
v_exp_f32 v222, v222
v_mfma_f32_16x16x32_bf16 v[192:195], a[80:83], v[224:227], 0
ds_read_b128 a[124:127], v3 offset:15360
v_add_u32 v3, s6, v1
v_mfma_f32_16x16x32_bf16 v[196:199], a[84:87], v[224:227], 0
v_exp_f32 v223, v223
v_mfma_f32_16x16x32_bf16 v[200:203], a[88:91], v[224:227], 0
global_load_dwordx4 a[192:195], v1, s[48:49] offset:-3072 sc1
v_cvt_pk_bf16_f32 v231, v222, v223
v_mfma_f32_16x16x32_bf16 v[204:207], a[92:95], v[224:227], 0
global_load_dwordx4 a[196:199], v1, s[48:49] offset:-2048 sc1
global_load_dwordx4 a[200:203], v1, s[48:49] offset:-1024 sc1
global_load_dwordx4 a[204:207], v1, s[48:49] offset:0 sc1
s_waitcnt vmcnt(25)
s_cbranch_vccnz L_DFLr
L_DFLb:
v_cmp_gt_u32 vcc, 1, v8
s_nop 0
s_cbranch_vccnz L_spin6
L_back6:
v_mov_b32 v13, 1
buffer_store_dword v13, v2, s[28:31], s18 offen sc1
s_branch L_SF_1
L_ev:
L_pad19:
s_cbranch_execz L_padret0
s_cmp_lg_u32 s58, s24
s_cbranch_scc1 L_ev1
s_nop 4
v_mov_b32 v4, v7
v_mov_b32 v6, v14
s_nop 0
v_permlane32_swap_b32 v7, v4
v_permlane32_swap_b32 v14, v6
v_add_f32 v7, v7, v4
v_add_f32 v14, v14, v6
v_mov_b32 v4, v7
v_mov_b32 v6, v14
s_nop 0
v_permlane16_swap_b32 v7, v4
v_permlane16_swap_b32 v14, v6
v_add_f32 v4, v7, v4
v_add_f32 v6, v14, v6
v_min_f32 v7, v4, v6
v_cmp_nlt_f32 vcc, 0x30800000, v7
v_add_f32 v7, v4, v6
s_or_b64 s[16:17], s[16:17], vcc
v_cmp_ngt_f32 vcc, 0x4e800000, v7
v_rcp_f32 v4, v4
s_or_b64 s[16:17], s[16:17], vcc
v_rcp_f32 v6, v6
s_cmp_eq_u32 s67, 0
s_cselect_b64 s[16:17], s[16:17], 0
v_pk_mul_f32 v[144:145], v[144:145], v[4:5] op_sel_hi:[1,0]
v_pk_mul_f32 v[146:147], v[146:147], v[4:5] op_sel_hi:[1,0]
v_pk_mul_f32 v[148:149], v[148:149], v[4:5] op_sel_hi:[1,0]
v_pk_mul_f32 v[150:151], v[150:151], v[4:5] op_sel_hi:[1,0]
v_cvt_pk_bf16_f32 v144, v144, v145
v_cvt_pk_bf16_f32 v145, v146, v147
v_cvt_pk_bf16_f32 v146, v148, v149
v_cvt_pk_bf16_f32 v147, v150, v151
buffer_store_dwordx4 v[144:147], v1, s[28:31], s54 offen sc1
v_pk_mul_f32 v[152:153], v[152:153], v[4:5] op_sel_hi:[1,0]
v_pk_mul_f32 v[154:155], v[154:155], v[4:5] op_sel_hi:[1,0]
v_pk_mul_f32 v[156:157], v[156:157], v[4:5] op_sel_hi:[1,0]
v_pk_mul_f32 v[158:159], v[158:159], v[4:5] op_sel_hi:[1,0]
v_cvt_pk_bf16_f32 v152, v152, v153
v_cvt_pk_bf16_f32 v153, v154, v155
v_cvt_pk_bf16_f32 v154, v156, v157
v_cvt_pk_bf16_f32 v155, v158, v159
buffer_store_dwordx4 v[152:155], v1, s[28:31], s54 offen offset:1024 sc1
v_pk_mul_f32 v[160:161], v[160:161], v[4:5] op_sel_hi:[1,0]
v_pk_mul_f32 v[162:163], v[162:163], v[4:5] op_sel_hi:[1,0]
v_pk_mul_f32 v[164:165], v[164:165], v[4:5] op_sel_hi:[1,0]
v_pk_mul_f32 v[166:167], v[166:167], v[4:5] op_sel_hi:[1,0]
v_cvt_pk_bf16_f32 v160, v160, v161
v_cvt_pk_bf16_f32 v161, v162, v163
v_cvt_pk_bf16_f32 v162, v164, v165
v_cvt_pk_bf16_f32 v163, v166, v167
buffer_store_dwordx4 v[160:163], v1, s[28:31], s54 offen offset:2048 sc1
v_pk_mul_f32 v[168:169], v[168:169], v[4:5] op_sel_hi:[1,0]
v_pk_mul_f32 v[170:171], v[170:171], v[4:5] op_sel_hi:[1,0]
v_pk_mul_f32 v[172:173], v[172:173], v[4:5] op_sel_hi:[1,0]
v_pk_mul_f32 v[174:175], v[174:175], v[4:5] op_sel_hi:[1,0]
v_cvt_pk_bf16_f32 v168, v168, v169
v_cvt_pk_bf16_f32 v169, v170, v171
v_cvt_pk_bf16_f32 v170, v172, v173
v_cvt_pk_bf16_f32 v171, v174, v175
buffer_store_dwordx4 v[168:171], v1, s[28:31], s54 offen offset:3072 sc1
v_pk_mul_f32 v[176:177], v[176:177], v[6:7] op_sel_hi:[1,0]
v_pk_mul_f32 v[178:179], v[178:179], v[6:7] op_sel_hi:[1,0]
v_pk_mul_f32 v[180:181], v[180:181], v[6:7] op_sel_hi:[1,0]
v_pk_mul_f32 v[182:183], v[182:183], v[6:7] op_sel_hi:[1,0]
v_cvt_pk_bf16_f32 v176, v176, v177
v_cvt_pk_bf16_f32 v177, v178, v179
v_cvt_pk_bf16_f32 v178, v180, v181
v_cvt_pk_bf16_f32 v179, v182, v183
buffer_store_dwordx4 v[176:179], v1, s[28:31], s55 offen sc1
v_pk_mul_f32 v[184:185], v[184:185], v[6:7] op_sel_hi:[1,0]
v_pk_mul_f32 v[186:187], v[186:187], v[6:7] op_sel_hi:[1,0]
v_pk_mul_f32 v[188:189], v[188:189], v[6:7] op_sel_hi:[1,0]
v_pk_mul_f32 v[190:191], v[190:191], v[6:7] op_sel_hi:[1,0]
v_cvt_pk_bf16_f32 v184, v184, v185
v_cvt_pk_bf16_f32 v185, v186, v187
v_cvt_pk_bf16_f32 v186, v188, v189
v_cvt_pk_bf16_f32 v187, v190, v191
buffer_store_dwordx4 v[184:187], v1, s[28:31], s55 offen offset:1024 sc1
v_pk_mul_f32 v[192:193], v[192:193], v[6:7] op_sel_hi:[1,0]
v_pk_mul_f32 v[194:195], v[194:195], v[6:7] op_sel_hi:[1,0]
v_pk_mul_f32 v[196:197], v[196:197], v[6:7] op_sel_hi:[1,0]
v_pk_mul_f32 v[198:199], v[198:199], v[6:7] op_sel_hi:[1,0]
v_cvt_pk_bf16_f32 v192, v192, v193
v_cvt_pk_bf16_f32 v193, v194, v195
v_cvt_pk_bf16_f32 v194, v196, v197
v_cvt_pk_bf16_f32 v195, v198, v199
buffer_store_dwordx4 v[192:195], v1, s[28:31], s55 offen offset:2048 sc1
v_pk_mul_f32 v[200:201], v[200:201], v[6:7] op_sel_hi:[1,0]
v_pk_mul_f32 v[202:203], v[202:203], v[6:7] op_sel_hi:[1,0]
v_pk_mul_f32 v[204:205], v[204:205], v[6:7] op_sel_hi:[1,0]
v_pk_mul_f32 v[206:207], v[206:207], v[6:7] op_sel_hi:[1,0]
v_cvt_pk_bf16_f32 v200, v200, v201
v_cvt_pk_bf16_f32 v201, v202, v203
v_cvt_pk_bf16_f32 v202, v204, v205
v_cvt_pk_bf16_f32 v203, v206, v207
buffer_store_dwordx4 v[200:203], v1, s[28:31], s55 offen offset:3072 sc1
s_cmp_eq_u64 s[16:17], 0
s_cselect_b32 s25, s19, 1073741824
s_cmp_eq_u32 s58, 33
s_cbranch_scc1 L_end
s_cmp_eq_u32 s3, 0
s_cbranch_scc1 L_SF_0
s_cmp_eq_u32 s3, 1
s_cbranch_scc1 L_S_1
s_cmp_eq_u32 s3, 2
s_cbranch_scc1 L_S_0
s_branch L_S_1
L_ev1:
s_cmp_lg_u32 s58, 28
s_cbranch_scc1 L_ev2
buffer_load_dword v8, v9, s[28:31], s27 offen sc1
L_ev2:
s_cmp_lg_u32 s58, 30
s_cbranch_scc1 L_disp
s_mov_b32 s64, 32768
s_mov_b32 s65, 32768
s_waitcnt vmcnt(8)
buffer_store_dword v13, v2, s[28:31], s25 offen sc1
s_add_u32 s26, s68, s81
s_add_u32 s57, s26, 16384
s_add_u32 s40, s28, s57
s_addc_u32 s41, s29, 0
v_cmp_gt_u32 vcc, 1, v8
s_nop 0
s_cbranch_vccnz L_spin7
L_back7:
L_disp:
s_sub_i32 s101, s58, s59
s_and_b32 s7, s3, 1
s_cmp_lg_u32 s7, 0
s_cbranch_scc1 L_disp1
s_cmp_gt_u32 s58, s24
s_cbranch_scc1 L_Z_0
s_cmp_gt_i32 s101, 1
s_cbranch_scc1 L_R_0
s_cmp_eq_u32 s101, 1
s_cbranch_scc1 L_SF_0
s_cmp_eq_u32 s101, 0
s_cbranch_scc1 L_DL_0
s_bitcmp1_b32 s58, 0
s_cbranch_scc1 L_D0_0
s_branch L_D1_0
L_disp1:
s_cmp_gt_u32 s58, s24
s_cbranch_scc1 L_Z_1
s_cmp_gt_i32 s101, 1
s_cbranch_scc1 L_R_1
s_cmp_eq_u32 s101, 1
s_cbranch_scc1 L_SF_1
s_cmp_eq_u32 s101, 0
s_cbranch_scc1 L_DL_1
s_bitcmp1_b32 s58, 0
s_cbranch_scc1 L_D0_0
s_branch L_D1_0
L_evd:
s_cmp_eq_u32 s58, 32
s_cbranch_scc1 L_DL_0
s_cmp_eq_u32 s58, 30
s_cbranch_scc1 L_evd1
buffer_load_dword v8, v9, s[28:31], s27 offen sc1
s_cmp_eq_u32 s58, s59
s_cbranch_scc1 L_DL_0
s_branch L_D1_0
L_evd1:
s_mov_b32 s64, 32768
s_mov_b32 s65, 32768
s_waitcnt vmcnt(8)
buffer_store_dword v13, v2, s[28:31], s25 offen sc1
L_pad13:
s_cbranch_execz L_pad17
s_add_u32 s26, s68, s81
s_add_u32 s57, s26, 16384
s_add_u32 s40, s28, s57
s_addc_u32 s41, s29, 0
v_cmp_gt_u32 vcc, 1, v8
s_nop 0
s_cbranch_vccnz L_spin8
L_back8:
s_cmp_eq_u32 s58, s59
s_cbranch_scc1 L_DL_0
s_branch L_D1_0
L_end:
s_cmp_lg_u32 s59, 32
s_cbranch_scc1 L_end1
v_cndmask_b32 v208, v208, v12, s[8:9]
v_cndmask_b32 v209, v209, v12, s[10:11]
v_cndmask_b32 v210, v210, v12, s[12:13]
v_cndmask_b32 v211, v211, v12, s[14:15]
v_mov_b32 v212, v12
v_mov_b32 v213, v12
v_mov_b32 v214, v12
v_mov_b32 v215, v12
v_mov_b32 v244, v252
v_mov_b32 v245, v253
v_mov_b32 v246, v254
v_mov_b32 v247, v255
global_load_dwordx4 a[208:211], v1, s[48:49] offset:1024 sc1
global_load_dwordx4 a[212:215], v1, s[48:49] offset:2048 sc1
global_load_dwordx4 a[216:219], v1, s[48:49] offset:3072 sc1
global_load_dwordx4 a[220:223], v1, s[50:51] offset:-4096 sc1
global_load_dwordx4 a[224:227], v1, s[50:51] offset:-3072 sc1
global_load_dwordx4 a[228:231], v1, s[50:51] offset:-2048 sc1
global_load_dwordx4 a[232:235], v1, s[50:51] offset:-1024 sc1
global_load_dwordx4 a[236:239], v1, s[50:51] offset:0 sc1
global_load_dwordx4 a[240:243], v1, s[50:51] offset:1024 sc1
global_load_dwordx4 a[244:247], v1, s[50:51] offset:2048 sc1
global_load_dwordx4 a[248:251], v1, s[50:51] offset:3072 sc1
L_end1:
global_load_dwordx4 v[168:171], v1, s[34:35] offset:-4096 sc1
global_load_dwordx4 v[172:175], v1, s[34:35] offset:-3072 sc1
global_load_dwordx4 v[176:179], v1, s[34:35] offset:-2048 sc1
global_load_dwordx4 v[180:183], v1, s[34:35] offset:-1024 sc1
global_load_dwordx4 v[184:187], v1, s[34:35] offset:0 sc1
global_load_dwordx4 v[188:191], v1, s[34:35] offset:1024 sc1
global_load_dwordx4 v[192:195], v1, s[34:35] offset:2048 sc1
global_load_dwordx4 v[196:199], v1, s[34:35] offset:3072 sc1
global_load_dwordx4 v[200:203], v1, s[46:47] offset:-4096 sc1
global_load_dwordx4 v[204:207], v1, s[46:47] offset:-3072 sc1
global_load_dwordx4 v[240:243], v1, s[46:47] offset:-2048 sc1
global_load_dwordx4 v[248:251], v1, s[46:47] offset:-1024 sc1
global_load_dwordx4 v[252:255], v1, s[46:47] offset:0 sc1
s_bitcmp1_b32 s59, 0
s_cbranch_scc1 L_T1
s_branch L_T0
L_x1:
L_DL_1:
v_mfma_f32_16x16x32_bf16 v[216:219], a[0:3], v[48:51], v[248:251]
s_add_u32 s7, s63, s62
v_exp_f32 v208, v208
v_mfma_f32_16x16x32_bf16 v[216:219], a[4:7], v[52:55], v[216:219]
s_barrier
v_mfma_f32_16x16x32_bf16 v[216:219], a[8:11], v[56:59], v[216:219]
s_add_u32 m0, s7, 16384
v_exp_f32 v209, v209
v_mfma_f32_16x16x32_bf16 v[216:219], a[12:15], v[60:63], v[216:219]
s_add_u32 s36, s28, s26
v_exp_f32 v210, v210
v_mfma_f32_16x16x32_bf16 v[220:223], a[16:19], v[60:63], v[240:243]
s_addc_u32 s37, s29, 0
ds_read_b128 a[32:35], v3 offset:0
v_cvt_pk_bf16_f32 v224, v208, v209
v_mfma_f32_16x16x32_bf16 v[220:223], a[20:23], v[56:59], v[220:223]
s_add_u32 s26, s26, s64
v_exp_f32 v211, v211
v_mfma_f32_16x16x32_bf16 v[220:223], a[24:27], v[52:55], v[220:223]
s_add_u32 s57, s57, s65
ds_read_b128 a[36:39], v3 offset:1024
buffer_load_dwordx4 v1, s[40:43], 0 offen sc1 lds
v_mfma_f32_16x16x32_bf16 v[220:223], a[28:31], v[48:51], v[220:223]
s_add_u32 s62, s62, 32768
v_exp_f32 v212, v212
v_mfma_f32_16x16x32_bf16 v[112:115], a[96:99], v[228:231], v[112:115]
s_and_b32 s62, s62, 131071
buffer_store_dwordx4 a[252:255], v1, s[28:31], s95 offen offset:0 sc1
ds_read_b128 a[40:43], v3 offset:8192
v_cvt_pk_bf16_f32 v225, v210, v211
v_mfma_f32_16x16x32_bf16 v[116:119], a[100:103], v[228:231], v[116:119]
s_add_u32 s6, s62, 32768
s_and_b32 s6, s6, 131071
ds_read_b128 a[44:47], v3 offset:9216
v_mfma_f32_16x16x32_bf16 v[120:123], a[104:107], v[228:231], v[120:123]
s_add_u32 s58, s58, 1
v_exp_f32 v213, v213
v_mfma_f32_16x16x32_bf16 v[124:127], a[108:111], v[228:231], v[124:127]
s_add_u32 s6, s6, 32768
ds_read_b128 a[48:51], v3 offset:11264
buffer_load_dwordx4 v1, s[40:43], 0 offen offset:1024 sc1 lds
v_mfma_f32_16x16x32_bf16 v[128:131], a[112:115], v[228:231], v[128:131]
v_exp_f32 v214, v214
v_mfma_f32_16x16x32_bf16 v[132:135], a[116:119], v[228:231], v[132:135]
ds_read_b128 a[52:55], v3 offset:10240
v_cvt_pk_bf16_f32 v226, v212, v213
v_mfma_f32_16x16x32_bf16 v[136:139], a[120:123], v[228:231], v[136:139]
v_exp_f32 v215, v215
v_mfma_f32_16x16x32_bf16 v[140:143], a[124:127], v[228:231], v[140:143]
ds_read_b128 a[56:59], v3 offset:3072
v_cvt_pk_bf16_f32 v227, v214, v215
v_mfma_f32_16x16x32_bf16 a[132:135], a[136:139], v[228:231], a[132:135]
ds_read_b128 a[60:63], v3 offset:2048
global_load_dwordx4 a[196:199], v1, s[48:49] offset:-2048 sc1
v_mfma_f32_16x16x32_bf16 v[208:211], a[0:3], v[64:67], v[244:247]
buffer_store_dwordx4 a[252:255], v1, s[28:31], s95 offen offset:1024 sc1
v_exp_f32 v216, v216
v_mfma_f32_16x16x32_bf16 v[208:211], a[4:7], v[68:71], v[208:211]
ds_read_b128 a[96:99], v3 offset:4096
v_add_f32 v7, v7, v216
v_mfma_f32_16x16x32_bf16 v[208:211], a[8:11], v[72:75], v[208:211]
v_exp_f32 v217, v217
v_mfma_f32_16x16x32_bf16 v[208:211], a[12:15], v[76:79], v[208:211]
v_cvt_pk_bf16_f32 v228, v216, v217
v_add_f32 v7, v7, v217
v_mfma_f32_16x16x32_bf16 v[212:215], a[16:19], v[76:79], v[252:255]
v_exp_f32 v218, v218
v_mfma_f32_16x16x32_bf16 v[212:215], a[20:23], v[72:75], v[212:215]
buffer_load_dwordx4 v1, s[40:43], 0 offen offset:2048 sc1 lds
v_add_f32 v7, v7, v218
v_mfma_f32_16x16x32_bf16 v[212:215], a[24:27], v[68:71], v[212:215]
v_exp_f32 v219, v219
v_mfma_f32_16x16x32_bf16 v[212:215], a[28:31], v[64:67], v[212:215]
s_waitcnt lgkmcnt(1)
v_cvt_pk_bf16_f32 v229, v218, v219
v_add_f32 v7, v7, v219
v_mfma_f32_16x16x32_bf16 v[80:83], a[64:67], v[224:227], v[80:83]
v_mov_b32 v230, 0
v_mov_b32 v231, 0
v_mfma_f32_16x16x32_bf16 v[84:87], a[68:71], v[224:227], v[84:87]
buffer_store_dwordx4 a[252:255], v1, s[28:31], s96 offen offset:0 sc1
v_mfma_f32_16x16x32_bf16 v[88:91], a[72:75], v[224:227], v[88:91]
v_mfma_f32_16x16x32_bf16 v[92:95], a[76:79], v[224:227], v[92:95]
v_mfma_f32_16x16x32_bf16 v[96:99], a[80:83], v[224:227], v[96:99]
v_mfma_f32_16x16x32_bf16 v[100:103], a[84:87], v[224:227], v[100:103]
buffer_load_dwordx4 v1, s[40:43], 0 offen offset:3072 sc1 lds
v_mfma_f32_16x16x32_bf16 v[104:107], a[88:91], v[224:227], v[104:107]
s_mov_b32 m0, s7
s_add_u32 s40, s28, s57
s_addc_u32 s41, s29, 0
v_mfma_f32_16x16x32_bf16 v[108:111], a[92:95], v[224:227], v[108:111]
s_cmp_lg_u32 s67, 0
s_cselect_b64 vcc, -1, 0
s_bitcmp1_b64 s[60:61], s58
v_mfma_f32_16x16x32_bf16 a[128:131], a[136:139], v[224:227], a[128:131]
ds_read_b128 a[100:103], v3 offset:5120
global_load_dwordx4 a[200:203], v1, s[48:49] offset:-1024 sc1
v_mfma_f32_16x16x32_bf16 v[216:219], a[0:3], v[32:35], v[236:239]
v_exp_f32 v208, v208
v_mfma_f32_16x16x32_bf16 v[216:219], a[4:7], v[36:39], v[216:219]
buffer_store_dwordx4 a[252:255], v1, s[28:31], s96 offen offset:1024 sc1
ds_read_b128 a[104:107], v3 offset:6144
v_add_f32 v14, v14, v208
v_mfma_f32_16x16x32_bf16 v[216:219], a[8:11], v[40:43], v[216:219]
v_exp_f32 v209, v209
v_mfma_f32_16x16x32_bf16 v[216:219], a[12:15], v[44:47], v[216:219]
v_cvt_pk_bf16_f32 v224, v208, v209
v_add_f32 v14, v14, v209
v_mfma_f32_16x16x32_bf16 v[220:223], a[16:19], v[44:47], v[236:239]
v_exp_f32 v210, v210
v_mfma_f32_16x16x32_bf16 v[220:223], a[20:23], v[40:43], v[220:223]
buffer_load_dwordx4 v1, s[36:39], 0 offen sc1 lds
v_add_f32 v14, v14, v210
v_mfma_f32_16x16x32_bf16 v[220:223], a[24:27], v[36:39], v[220:223]
v_exp_f32 v211, v211
v_mfma_f32_16x16x32_bf16 v[220:223], a[28:31], v[32:35], v[220:223]
v_cvt_pk_bf16_f32 v225, v210, v211
v_add_f32 v14, v14, v211
v_mfma_f32_16x16x32_bf16 v[144:147], a[64:67], v[228:231], v[144:147]
v_exp_f32 v212, v212
v_mfma_f32_16x16x32_bf16 v[148:151], a[68:71], v[228:231], v[148:151]
ds_read_b128 a[108:111], v3 offset:7168
v_add_f32 v14, v14, v212
v_mfma_f32_16x16x32_bf16 v[152:155], a[72:75], v[228:231], v[152:155]
buffer_store_dwordx4 a[252:255], v1, s[28:31], s85 offen offset:0 sc1
v_exp_f32 v213, v213
v_mfma_f32_16x16x32_bf16 v[156:159], a[76:79], v[228:231], v[156:159]
v_cvt_pk_bf16_f32 v226, v212, v213
v_add_f32 v14, v14, v213
v_mfma_f32_16x16x32_bf16 v[160:163], a[80:83], v[228:231], v[160:163]
v_exp_f32 v214, v214
v_mfma_f32_16x16x32_bf16 v[164:167], a[84:87], v[228:231], v[164:167]
buffer_load_dwordx4 v1, s[36:39], 0 offen offset:1024 sc1 lds
v_add_f32 v14, v14, v214
v_mfma_f32_16x16x32_bf16 v[168:171], a[88:91], v[228:231], v[168:171]
v_exp_f32 v215, v215
v_mfma_f32_16x16x32_bf16 v[172:175], a[92:95], v[228:231], v[172:175]
v_cvt_pk_bf16_f32 v227, v214, v215
v_add_f32 v14, v14, v215
v_mfma_f32_16x16x32_bf16 v[208:211], a[32:35], v[16:19], v[232:235]
v_exp_f32 v216, v216
v_mfma_f32_16x16x32_bf16 v[208:211], a[36:39], v[20:23], v[208:211]
v_exp_f32 v217, v217
v_mfma_f32_16x16x32_bf16 v[208:211], a[40:43], v[24:27], v[208:211]
ds_read_b128 a[112:115], v3 offset:12288
v_cvt_pk_bf16_f32 v228, v216, v217
v_mfma_f32_16x16x32_bf16 v[208:211], a[44:47], v[28:31], v[208:211]
buffer_store_dwordx4 a[252:255], v1, s[28:31], s85 offen offset:1024 sc1
v_exp_f32 v218, v218
v_mfma_f32_16x16x32_bf16 v[212:215], a[48:51], v[28:31], v[232:235]
v_mfma_f32_16x16x32_bf16 v[212:215], a[52:55], v[24:27], v[212:215]
v_exp_f32 v219, v219
v_mfma_f32_16x16x32_bf16 v[212:215], a[56:59], v[20:23], v[212:215]
ds_read_b128 a[116:119], v3 offset:13312
buffer_load_dwordx4 v1, s[36:39], 0 offen offset:2048 sc1 lds
v_mfma_f32_16x16x32_bf16 v[212:215], a[60:63], v[16:19], v[212:215]
v_exp_f32 v220, v220
v_mfma_f32_16x16x32_bf16 v[176:179], a[64:67], v[224:227], v[176:179]
buffer_load_dwordx4 v1, s[36:39], 0 offen offset:3072 sc1 lds
v_cvt_pk_bf16_f32 v229, v218, v219
v_mfma_f32_16x16x32_bf16 v[180:183], a[68:71], v[224:227], v[180:183]
v_exp_f32 v221, v221
v_mfma_f32_16x16x32_bf16 v[184:187], a[72:75], v[224:227], v[184:187]
ds_read_b128 a[120:123], v3 offset:14336
v_cvt_pk_bf16_f32 v230, v220, v221
v_mfma_f32_16x16x32_bf16 v[188:191], a[76:79], v[224:227], v[188:191]
v_exp_f32 v222, v222
v_mfma_f32_16x16x32_bf16 v[192:195], a[80:83], v[224:227], v[192:195]
ds_read_b128 a[124:127], v3 offset:15360
v_add_u32 v3, s6, v1
v_mfma_f32_16x16x32_bf16 v[196:199], a[84:87], v[224:227], v[196:199]
v_exp_f32 v223, v223
v_mfma_f32_16x16x32_bf16 v[200:203], a[88:91], v[224:227], v[200:203]
s_waitcnt vmcnt(16)
global_load_dwordx4 a[204:207], v1, s[48:49] offset:0 sc1
v_cvt_pk_bf16_f32 v231, v222, v223
v_mfma_f32_16x16x32_bf16 v[204:207], a[92:95], v[224:227], v[204:207]
s_cbranch_vccnz L_DL_1r
L_DL_1b:
s_cbranch_scc1 L_ev
L_SF_1:
v_mfma_f32_16x16x32_bf16 v[216:219], a[32:35], v[32:35], v[236:239]
s_add_u32 s7, s63, s62
v_exp_f32 v208, v208
v_mfma_f32_16x16x32_bf16 v[216:219], a[36:39], v[36:39], v[216:219]
s_barrier
v_mfma_f32_16x16x32_bf16 v[216:219], a[40:43], v[40:43], v[216:219]
s_add_u32 m0, s7, 16384
v_exp_f32 v209, v209
v_mfma_f32_16x16x32_bf16 v[216:219], a[44:47], v[44:47], v[216:219]
s_add_u32 s36, s28, s26
v_exp_f32 v210, v210
v_mfma_f32_16x16x32_bf16 v[220:223], a[48:51], v[44:47], v[236:239]
s_addc_u32 s37, s29, 0
ds_read_b128 a[0:3], v3 offset:16384
v_cvt_pk_bf16_f32 v224, v208, v209
v_mfma_f32_16x16x32_bf16 v[220:223], a[52:55], v[40:43], v[220:223]
s_add_u32 s26, s26, s64
v_exp_f32 v211, v211
v_mfma_f32_16x16x32_bf16 v[220:223], a[56:59], v[36:39], v[220:223]
s_add_u32 s57, s57, s65
ds_read_b128 a[4:7], v3 offset:17408
buffer_load_dwordx4 v1, s[40:43], 0 offen sc1 lds
v_mfma_f32_16x16x32_bf16 v[220:223], a[60:63], v[32:35], v[220:223]
s_add_u32 s62, s62, 32768
v_exp_f32 v212, v212
v_mfma_f32_16x16x32_bf16 v[112:115], a[64:67], v[228:231], v[112:115]
s_and_b32 s62, s62, 131071
ds_read_b128 a[8:11], v3 offset:24576
v_cvt_pk_bf16_f32 v225, v210, v211
v_mfma_f32_16x16x32_bf16 v[116:119], a[68:71], v[228:231], v[116:119]
s_add_u32 s6, s62, 32768
ds_read_b128 a[12:15], v3 offset:25600
global_load_dwordx4 a[208:211], v1, s[48:49] offset:1024 sc1
v_mfma_f32_16x16x32_bf16 v[120:123], a[72:75], v[228:231], v[120:123]
s_and_b32 s6, s6, 131071
v_exp_f32 v213, v213
v_mfma_f32_16x16x32_bf16 v[124:127], a[76:79], v[228:231], v[124:127]
s_add_u32 s58, s58, 1
ds_read_b128 a[16:19], v3 offset:27648
buffer_load_dwordx4 v1, s[40:43], 0 offen offset:1024 sc1 lds
v_mfma_f32_16x16x32_bf16 v[128:131], a[80:83], v[228:231], v[128:131]
s_add_u32 s6, s6, 32768
v_exp_f32 v214, v214
v_mfma_f32_16x16x32_bf16 v[132:135], a[84:87], v[228:231], v[132:135]
ds_read_b128 a[20:23], v3 offset:26624
v_cvt_pk_bf16_f32 v226, v212, v213
v_mfma_f32_16x16x32_bf16 v[136:139], a[88:91], v[228:231], v[136:139]
v_exp_f32 v215, v215
v_mfma_f32_16x16x32_bf16 v[140:143], a[92:95], v[228:231], v[140:143]
ds_read_b128 a[24:27], v3 offset:19456
v_cvt_pk_bf16_f32 v227, v214, v215
v_mfma_f32_16x16x32_bf16 a[132:135], a[136:139], v[228:231], a[132:135]
s_waitcnt lgkmcnt(3)
ds_read_b128 a[28:31], v3 offset:18432
global_load_dwordx4 a[212:215], v1, s[48:49] offset:2048 sc1
v_mfma_f32_16x16x32_bf16 v[208:211], a[0:3], v[16:19], v[248:251]
v_exp_f32 v216, v216
v_mfma_f32_16x16x32_bf16 v[208:211], a[4:7], v[20:23], v[208:211]
ds_read_b128 a[64:67], v3 offset:20480
v_mfma_f32_16x16x32_bf16 v[208:211], a[8:11], v[24:27], v[208:211]
v_exp_f32 v217, v217
v_mfma_f32_16x16x32_bf16 v[208:211], a[12:15], v[28:31], v[208:211]
s_waitcnt lgkmcnt(3)
ds_read_b128 a[68:71], v3 offset:21504
v_cvt_pk_bf16_f32 v228, v216, v217
v_mfma_f32_16x16x32_bf16 v[212:215], a[16:19], v[28:31], v[232:235]
v_exp_f32 v218, v218
v_mfma_f32_16x16x32_bf16 v[212:215], a[20:23], v[24:27], v[212:215]
s_waitcnt lgkmcnt(3)
ds_read_b128 a[72:75], v3 offset:22528
buffer_load_dwordx4 v1, s[40:43], 0 offen offset:2048 sc1 lds
v_mfma_f32_16x16x32_bf16 v[212:215], a[24:27], v[20:23], v[212:215]
s_waitcnt lgkmcnt(3)
v_exp_f32 v219, v219
v_mfma_f32_16x16x32_bf16 v[212:215], a[28:31], v[16:19], v[212:215]
ds_read_b128 a[76:79], v3 offset:23552
v_cvt_pk_bf16_f32 v229, v218, v219
v_mfma_f32_16x16x32_bf16 v[80:83], a[96:99], v[224:227], v[80:83]
v_exp_f32 v220, v220
v_mfma_f32_16x16x32_bf16 v[84:87], a[100:103], v[224:227], v[84:87]
ds_read_b128 a[80:83], v3 offset:28672
global_load_dwordx4 a[216:219], v1, s[48:49] offset:3072 sc1
v_mfma_f32_16x16x32_bf16 v[88:91], a[104:107], v[224:227], v[88:91]
v_exp_f32 v221, v221
v_mfma_f32_16x16x32_bf16 v[92:95], a[108:111], v[224:227], v[92:95]
ds_read_b128 a[84:87], v3 offset:29696
v_cvt_pk_bf16_f32 v230, v220, v221
v_mfma_f32_16x16x32_bf16 v[96:99], a[112:115], v[224:227], v[96:99]
v_exp_f32 v222, v222
v_mfma_f32_16x16x32_bf16 v[100:103], a[116:119], v[224:227], v[100:103]
ds_read_b128 a[88:91], v3 offset:30720
buffer_load_dwordx4 v1, s[40:43], 0 offen offset:3072 sc1 lds
v_mfma_f32_16x16x32_bf16 v[104:107], a[120:123], v[224:227], v[104:107]
s_mov_b32 m0, s7
v_exp_f32 v223, v223
v_mfma_f32_16x16x32_bf16 v[108:111], a[124:127], v[224:227], v[108:111]
s_add_u32 s40, s28, s57
ds_read_b128 a[92:95], v3 offset:31744
v_cvt_pk_bf16_f32 v231, v222, v223
v_mfma_f32_16x16x32_bf16 a[128:131], a[136:139], v[224:227], a[128:131]
s_addc_u32 s41, s29, 0
s_bitcmp1_b64 s[60:61], s58
global_load_dwordx4 a[220:223], v1, s[50:51] offset:-4096 sc1
v_mfma_f32_16x16x32_bf16 v[216:219], a[0:3], v[32:35], v[236:239]
v_exp_f32 v208, v208
v_mfma_f32_16x16x32_bf16 v[216:219], a[4:7], v[36:39], v[216:219]
ds_read_b128 a[32:35], v3 offset:0
v_mfma_f32_16x16x32_bf16 v[216:219], a[8:11], v[40:43], v[216:219]
v_exp_f32 v209, v209
v_mfma_f32_16x16x32_bf16 v[216:219], a[12:15], v[44:47], v[216:219]
ds_read_b128 a[36:39], v3 offset:1024
v_cvt_pk_bf16_f32 v224, v208, v209
v_mfma_f32_16x16x32_bf16 v[220:223], a[16:19], v[44:47], v[252:255]
v_exp_f32 v210, v210
v_mfma_f32_16x16x32_bf16 v[220:223], a[20:23], v[40:43], v[220:223]
ds_read_b128 a[40:43], v3 offset:8192
buffer_load_dwordx4 v1, s[36:39], 0 offen sc1 lds
v_mfma_f32_16x16x32_bf16 v[220:223], a[24:27], v[36:39], v[220:223]
v_exp_f32 v211, v211
v_mfma_f32_16x16x32_bf16 v[220:223], a[28:31], v[32:35], v[220:223]
ds_read_b128 a[44:47], v3 offset:9216
v_cvt_pk_bf16_f32 v225, v210, v211
v_mfma_f32_16x16x32_bf16 v[112:115], a[96:99], v[228:231], v[112:115]
global_load_dwordx4 a[224:227], v1, s[50:51] offset:-3072 sc1
v_mov_b32 v226, 0
v_mov_b32 v227, 0
v_mfma_f32_16x16x32_bf16 v[116:119], a[100:103], v[228:231], v[116:119]
ds_read_b128 a[48:51], v3 offset:11264
v_mfma_f32_16x16x32_bf16 v[120:123], a[104:107], v[228:231], v[120:123]
v_mfma_f32_16x16x32_bf16 v[124:127], a[108:111], v[228:231], v[124:127]
ds_read_b128 a[52:55], v3 offset:10240
v_mfma_f32_16x16x32_bf16 v[128:131], a[112:115], v[228:231], v[128:131]
global_load_dwordx4 a[228:231], v1, s[50:51] offset:-2048 sc1
v_mfma_f32_16x16x32_bf16 v[132:135], a[116:119], v[228:231], v[132:135]
ds_read_b128 a[56:59], v3 offset:3072
buffer_load_dwordx4 v1, s[36:39], 0 offen offset:1024 sc1 lds
v_mfma_f32_16x16x32_bf16 v[136:139], a[120:123], v[228:231], v[136:139]
v_mfma_f32_16x16x32_bf16 v[140:143], a[124:127], v[228:231], v[140:143]
ds_read_b128 a[60:63], v3 offset:2048
v_mfma_f32_16x16x32_bf16 a[132:135], a[136:139], v[228:231], a[132:135]
s_waitcnt lgkmcnt(3)
global_load_dwordx4 a[232:235], v1, s[50:51] offset:-1024 sc1
v_mfma_f32_16x16x32_bf16 v[208:211], a[32:35], v[16:19], v[232:235]
v_exp_f32 v216, v216
v_mfma_f32_16x16x32_bf16 v[208:211], a[36:39], v[20:23], v[208:211]
v_exp_f32 v217, v217
v_mfma_f32_16x16x32_bf16 v[208:211], a[40:43], v[24:27], v[208:211]
ds_read_b128 a[96:99], v3 offset:4096
v_cvt_pk_bf16_f32 v228, v216, v217
v_mfma_f32_16x16x32_bf16 v[208:211], a[44:47], v[28:31], v[208:211]
v_exp_f32 v218, v218
v_mfma_f32_16x16x32_bf16 v[212:215], a[48:51], v[28:31], v[232:235]
s_waitcnt lgkmcnt(2)
ds_read_b128 a[100:103], v3 offset:5120
buffer_load_dwordx4 v1, s[36:39], 0 offen offset:2048 sc1 lds
v_mfma_f32_16x16x32_bf16 v[212:215], a[52:55], v[24:27], v[212:215]
v_exp_f32 v219, v219
v_mfma_f32_16x16x32_bf16 v[212:215], a[56:59], v[20:23], v[212:215]
s_waitcnt lgkmcnt(2)
ds_read_b128 a[104:107], v3 offset:6144
v_cvt_pk_bf16_f32 v229, v218, v219
v_mfma_f32_16x16x32_bf16 v[212:215], a[60:63], v[16:19], v[212:215]
v_exp_f32 v220, v220
v_mfma_f32_16x16x32_bf16 v[80:83], a[64:67], v[224:227], v[80:83]
ds_read_b128 a[108:111], v3 offset:7168
buffer_load_dwordx4 v1, s[36:39], 0 offen offset:3072 sc1 lds
v_mfma_f32_16x16x32_bf16 v[84:87], a[68:71], v[224:227], v[84:87]
v_exp_f32 v221, v221
v_mfma_f32_16x16x32_bf16 v[88:91], a[72:75], v[224:227], v[88:91]
ds_read_b128 a[112:115], v3 offset:12288
v_cvt_pk_bf16_f32 v230, v220, v221
v_mfma_f32_16x16x32_bf16 v[92:95], a[76:79], v[224:227], v[92:95]
v_exp_f32 v222, v222
v_mfma_f32_16x16x32_bf16 v[96:99], a[80:83], v[224:227], v[96:99]
ds_read_b128 a[116:119], v3 offset:13312
global_load_dwordx4 a[236:239], v1, s[50:51] offset:0 sc1
v_mfma_f32_16x16x32_bf16 v[100:103], a[84:87], v[224:227], v[100:103]
v_exp_f32 v223, v223
v_mfma_f32_16x16x32_bf16 v[104:107], a[88:91], v[224:227], v[104:107]
ds_read_b128 a[120:123], v3 offset:14336
v_cvt_pk_bf16_f32 v231, v222, v223
v_mfma_f32_16x16x32_bf16 v[108:111], a[92:95], v[224:227], v[108:111]
s_waitcnt vmcnt(16)
ds_read_b128 a[124:127], v3 offset:15360
v_add_u32 v3, s6, v1
v_mfma_f32_16x16x32_bf16 a[128:131], a[136:139], v[224:227], a[128:131]
global_load_dwordx4 a[240:243], v1, s[50:51] offset:1024 sc1
global_load_dwordx4 a[244:247], v1, s[50:51] offset:2048 sc1
global_load_dwordx4 a[248:251], v1, s[50:51] offset:3072 sc1
s_cbranch_scc1 L_ev
s_cmp_lt_u32 s58, s24
s_cbranch_scc1 L_R_1
.p2align 4
L_S_1:
v_mfma_f32_16x16x32_bf16 v[216:219], a[32:35], v[32:35], v[236:239]
s_barrier
v_mfma_f32_16x16x32_bf16 v[216:219], a[36:39], v[36:39], v[216:219]
s_add_u32 s7, s63, s62
s_add_u32 m0, s7, 16384
ds_read_b128 a[0:3], v3 offset:16384
v_mfma_f32_16x16x32_bf16 v[216:219], a[40:43], v[40:43], v[216:219]
s_add_u32 s36, s28, s26
s_addc_u32 s37, s29, 0
ds_read_b128 a[4:7], v3 offset:17408
v_mfma_f32_16x16x32_bf16 v[216:219], a[44:47], v[44:47], v[216:219]
s_add_u32 s26, s26, s64
s_add_u32 s57, s57, s65
ds_read_b128 a[8:11], v3 offset:24576
v_mfma_f32_16x16x32_bf16 v[220:223], a[48:51], v[44:47], v[236:239]
s_add_u32 s62, s62, 32768
s_and_b32 s62, s62, 131071
ds_read_b128 a[12:15], v3 offset:25600
v_mfma_f32_16x16x32_bf16 v[220:223], a[52:55], v[40:43], v[220:223]
s_add_u32 s6, s62, 32768
v_exp_f32 v208, v208
v_mfma_f32_16x16x32_bf16 v[220:223], a[56:59], v[36:39], v[220:223]
s_and_b32 s6, s6, 131071
ds_read_b128 a[16:19], v3 offset:27648
buffer_load_dwordx4 v1, s[40:43], 0 offen sc1 lds
v_mfma_f32_16x16x32_bf16 v[220:223], a[60:63], v[32:35], v[220:223]
s_add_u32 s58, s58, 1
v_exp_f32 v209, v209
v_mfma_f32_16x16x32_bf16 a[132:135], a[136:139], v[228:231], a[132:135]
s_waitcnt lgkmcnt(4)
ds_read_b128 a[20:23], v3 offset:26624
v_cvt_pk_bf16_f32 v224, v208, v209
v_mfma_f32_16x16x32_bf16 v[144:147], a[0:3], v[16:19], v[232:235]
s_waitcnt lgkmcnt(4)
v_exp_f32 v216, v216
v_mfma_f32_16x16x32_bf16 v[144:147], a[4:7], v[20:23], v[144:147]
s_waitcnt lgkmcnt(3)
s_add_u32 s6, s6, 32768
ds_read_b128 a[24:27], v3 offset:19456
v_mfma_f32_16x16x32_bf16 v[144:147], a[8:11], v[24:27], v[144:147]
s_waitcnt lgkmcnt(3)
v_exp_f32 v217, v217
v_mfma_f32_16x16x32_bf16 v[144:147], a[12:15], v[28:31], v[144:147]
ds_read_b128 a[28:31], v3 offset:18432
v_cvt_pk_bf16_f32 v160, v216, v217
v_mfma_f32_16x16x32_bf16 v[152:155], a[12:15], v[44:47], v[236:239]
v_exp_f32 v218, v218
v_mfma_f32_16x16x32_bf16 v[152:155], a[8:11], v[40:43], v[152:155]
ds_read_b128 a[32:35], v3 offset:0
buffer_load_dwordx4 v1, s[40:43], 0 offen offset:1024 sc1 lds
v_mfma_f32_16x16x32_bf16 v[152:155], a[4:7], v[36:39], v[152:155]
v_exp_f32 v219, v219
v_mfma_f32_16x16x32_bf16 v[152:155], a[0:3], v[32:35], v[152:155]
s_waitcnt lgkmcnt(3)
ds_read_b128 a[36:39], v3 offset:1024
v_cvt_pk_bf16_f32 v161, v218, v219
v_mfma_f32_16x16x32_bf16 v[156:159], a[16:19], v[44:47], v[236:239]
v_exp_f32 v220, v220
v_mfma_f32_16x16x32_bf16 v[156:159], a[20:23], v[40:43], v[156:159]
s_waitcnt lgkmcnt(3)
ds_read_b128 a[40:43], v3 offset:8192
v_mfma_f32_16x16x32_bf16 v[156:159], a[24:27], v[36:39], v[156:159]
s_waitcnt lgkmcnt(3)
v_exp_f32 v221, v221
v_mfma_f32_16x16x32_bf16 v[156:159], a[28:31], v[32:35], v[156:159]
ds_read_b128 a[44:47], v3 offset:9216
v_cvt_pk_bf16_f32 v162, v220, v221
v_mfma_f32_16x16x32_bf16 v[148:151], a[28:31], v[16:19], v[232:235]
v_exp_f32 v222, v222
v_mfma_f32_16x16x32_bf16 v[148:151], a[24:27], v[20:23], v[148:151]
ds_read_b128 a[48:51], v3 offset:11264
buffer_load_dwordx4 v1, s[40:43], 0 offen offset:2048 sc1 lds
v_mfma_f32_16x16x32_bf16 v[148:151], a[20:23], v[24:27], v[148:151]
v_exp_f32 v223, v223
v_mfma_f32_16x16x32_bf16 v[148:151], a[16:19], v[28:31], v[148:151]
ds_read_b128 a[52:55], v3 offset:10240
v_cvt_pk_bf16_f32 v163, v222, v223
v_mfma_f32_16x16x32_bf16 v[112:115], a[64:67], v[228:231], v[112:115]
v_exp_f32 v210, v210
v_mfma_f32_16x16x32_bf16 v[112:115], a[96:99], v[160:163], v[112:115]
ds_read_b128 a[56:59], v3 offset:3072
v_mfma_f32_16x16x32_bf16 v[116:119], a[100:103], v[160:163], v[116:119]
v_exp_f32 v211, v211
v_mfma_f32_16x16x32_bf16 v[116:119], a[68:71], v[228:231], v[116:119]
ds_read_b128 a[60:63], v3 offset:2048
v_cvt_pk_bf16_f32 v225, v210, v211
v_mfma_f32_16x16x32_bf16 v[120:123], a[72:75], v[228:231], v[120:123]
v_exp_f32 v212, v212
v_mfma_f32_16x16x32_bf16 v[120:123], a[104:107], v[160:163], v[120:123]
ds_read_b128 a[64:67], v3 offset:20480
buffer_load_dwordx4 v1, s[40:43], 0 offen offset:3072 sc1 lds
v_mfma_f32_16x16x32_bf16 v[124:127], a[108:111], v[160:163], v[124:127]
s_mov_b32 m0, s7
v_exp_f32 v213, v213
v_mfma_f32_16x16x32_bf16 v[124:127], a[76:79], v[228:231], v[124:127]
s_add_u32 s40, s28, s57
ds_read_b128 a[68:71], v3 offset:21504
v_cvt_pk_bf16_f32 v226, v212, v213
v_mfma_f32_16x16x32_bf16 v[128:131], a[80:83], v[228:231], v[128:131]
s_addc_u32 s41, s29, 0
v_exp_f32 v214, v214
v_mfma_f32_16x16x32_bf16 v[128:131], a[112:115], v[160:163], v[128:131]
s_bitcmp1_b64 s[60:61], s58
ds_read_b128 a[72:75], v3 offset:22528
v_mfma_f32_16x16x32_bf16 v[132:135], a[116:119], v[160:163], v[132:135]
v_exp_f32 v215, v215
v_mfma_f32_16x16x32_bf16 v[132:135], a[84:87], v[228:231], v[132:135]
ds_read_b128 a[76:79], v3 offset:23552
v_cvt_pk_bf16_f32 v227, v214, v215
v_mfma_f32_16x16x32_bf16 v[136:139], a[88:91], v[228:231], v[136:139]
v_exp_f32 v144, v144
v_mfma_f32_16x16x32_bf16 v[136:139], a[120:123], v[160:163], v[136:139]
ds_read_b128 a[80:83], v3 offset:28672
buffer_load_dwordx4 v1, s[36:39], 0 offen sc1 lds
v_mfma_f32_16x16x32_bf16 v[140:143], a[124:127], v[160:163], v[140:143]
v_exp_f32 v145, v145
v_mfma_f32_16x16x32_bf16 v[140:143], a[92:95], v[228:231], v[140:143]
ds_read_b128 a[84:87], v3 offset:29696
v_cvt_pk_bf16_f32 v164, v144, v145
v_mfma_f32_16x16x32_bf16 a[132:135], a[136:139], v[160:163], a[132:135]
s_waitcnt lgkmcnt(3)
v_exp_f32 v146, v146
v_mfma_f32_16x16x32_bf16 v[208:211], a[32:35], v[16:19], v[232:235]
ds_read_b128 a[88:91], v3 offset:30720
v_mfma_f32_16x16x32_bf16 v[208:211], a[36:39], v[20:23], v[208:211]
v_exp_f32 v147, v147
v_mfma_f32_16x16x32_bf16 v[208:211], a[40:43], v[24:27], v[208:211]
ds_read_b128 a[92:95], v3 offset:31744
v_cvt_pk_bf16_f32 v165, v146, v147
v_mfma_f32_16x16x32_bf16 v[208:211], a[44:47], v[28:31], v[208:211]
v_exp_f32 v148, v148
v_mfma_f32_16x16x32_bf16 v[212:215], a[48:51], v[28:31], v[232:235]
v_exp_f32 v149, v149
v_mfma_f32_16x16x32_bf16 v[212:215], a[52:55], v[24:27], v[212:215]
buffer_load_dwordx4 v1, s[36:39], 0 offen offset:1024 sc1 lds
v_cvt_pk_bf16_f32 v166, v148, v149
v_mfma_f32_16x16x32_bf16 v[212:215], a[56:59], v[20:23], v[212:215]
v_exp_f32 v150, v150
v_mfma_f32_16x16x32_bf16 v[212:215], a[60:63], v[16:19], v[212:215]
v_exp_f32 v151, v151
v_mfma_f32_16x16x32_bf16 a[128:131], a[136:139], v[224:227], a[128:131]
v_cvt_pk_bf16_f32 v167, v150, v151
v_mfma_f32_16x16x32_bf16 v[80:83], a[96:99], v[224:227], v[80:83]
v_exp_f32 v152, v152
v_mfma_f32_16x16x32_bf16 v[80:83], a[64:67], v[164:167], v[80:83]
v_exp_f32 v153, v153
v_mfma_f32_16x16x32_bf16 v[84:87], a[68:71], v[164:167], v[84:87]
ds_read_b128 a[96:99], v3 offset:4096
v_cvt_pk_bf16_f32 v228, v152, v153
v_mfma_f32_16x16x32_bf16 v[84:87], a[100:103], v[224:227], v[84:87]
v_exp_f32 v154, v154
v_mfma_f32_16x16x32_bf16 v[88:91], a[104:107], v[224:227], v[88:91]
ds_read_b128 a[100:103], v3 offset:5120
buffer_load_dwordx4 v1, s[36:39], 0 offen offset:2048 sc1 lds
v_mfma_f32_16x16x32_bf16 v[88:91], a[72:75], v[164:167], v[88:91]
s_waitcnt lgkmcnt(2)
v_exp_f32 v155, v155
v_mfma_f32_16x16x32_bf16 v[92:95], a[76:79], v[164:167], v[92:95]
ds_read_b128 a[104:107], v3 offset:6144
v_cvt_pk_bf16_f32 v229, v154, v155
v_mfma_f32_16x16x32_bf16 v[92:95], a[108:111], v[224:227], v[92:95]
v_exp_f32 v156, v156
v_mfma_f32_16x16x32_bf16 v[96:99], a[112:115], v[224:227], v[96:99]
ds_read_b128 a[108:111], v3 offset:7168
buffer_load_dwordx4 v1, s[36:39], 0 offen offset:3072 sc1 lds
v_mfma_f32_16x16x32_bf16 v[96:99], a[80:83], v[164:167], v[96:99]
v_exp_f32 v157, v157
v_mfma_f32_16x16x32_bf16 v[100:103], a[84:87], v[164:167], v[100:103]
ds_read_b128 a[112:115], v3 offset:12288
v_cvt_pk_bf16_f32 v230, v156, v157
v_mfma_f32_16x16x32_bf16 v[100:103], a[116:119], v[224:227], v[100:103]
v_exp_f32 v158, v158
v_mfma_f32_16x16x32_bf16 v[104:107], a[120:123], v[224:227], v[104:107]
ds_read_b128 a[116:119], v3 offset:13312
v_mfma_f32_16x16x32_bf16 v[104:107], a[88:91], v[164:167], v[104:107]
v_exp_f32 v159, v159
v_mfma_f32_16x16x32_bf16 v[108:111], a[92:95], v[164:167], v[108:111]
s_waitcnt vmcnt(16)
ds_read_b128 a[120:123], v3 offset:14336
v_cvt_pk_bf16_f32 v231, v158, v159
v_mfma_f32_16x16x32_bf16 v[108:111], a[124:127], v[224:227], v[108:111]
ds_read_b128 a[124:127], v3 offset:15360
v_add_u32 v3, s6, v1
v_mfma_f32_16x16x32_bf16 a[128:131], a[136:139], v[164:167], a[128:131]
L_pad14:
s_cbranch_execz L_pad18
s_cbranch_scc0 L_S_1
s_cmp_lg_u32 s58, 28
s_cbranch_scc1 L_Sa_1
buffer_load_dword v8, v9, s[28:31], s27 offen sc1
s_branch L_S_1
L_Sa_1:
s_mov_b32 s64, 32768
s_mov_b32 s65, 32768
s_waitcnt vmcnt(8)
buffer_store_dword v13, v2, s[28:31], s25 offen sc1
s_add_u32 s26, s68, s81
s_add_u32 s57, s26, 16384
s_add_u32 s40, s28, s57
s_addc_u32 s41, s29, 0
v_cmp_gt_u32 vcc, 1, v8
s_nop 0
s_cbranch_vccnz L_spin5
L_back5:
L_Z_1:
v_mfma_f32_16x16x32_bf16 v[216:219], a[32:35], v[32:35], v[236:239]
s_barrier
v_mfma_f32_16x16x32_bf16 v[216:219], a[36:39], v[36:39], v[216:219]
s_add_u32 s7, s63, s62
s_add_u32 m0, s7, 16384
ds_read_b128 a[0:3], v3 offset:16384
v_mfma_f32_16x16x32_bf16 v[216:219], a[40:43], v[40:43], v[216:219]
s_add_u32 s36, s28, s26
s_addc_u32 s37, s29, 0
ds_read_b128 a[4:7], v3 offset:17408
v_mfma_f32_16x16x32_bf16 v[216:219], a[44:47], v[44:47], v[216:219]
s_add_u32 s26, s26, s64
s_add_u32 s57, s57, s65
ds_read_b128 a[8:11], v3 offset:24576
v_mfma_f32_16x16x32_bf16 v[220:223], a[48:51], v[44:47], v[236:239]
s_add_u32 s62, s62, 32768
s_and_b32 s62, s62, 131071
ds_read_b128 a[12:15], v3 offset:25600
v_mfma_f32_16x16x32_bf16 v[220:223], a[52:55], v[40:43], v[220:223]
s_add_u32 s6, s62, 32768
v_exp_f32 v208, v208
v_mfma_f32_16x16x32_bf16 v[220:223], a[56:59], v[36:39], v[220:223]
s_and_b32 s6, s6, 131071
ds_read_b128 a[16:19], v3 offset:27648
buffer_load_dwordx4 v1, s[40:43], 0 offen sc1 lds
v_mfma_f32_16x16x32_bf16 v[220:223], a[60:63], v[32:35], v[220:223]
s_add_u32 s58, s58, 1
v_exp_f32 v209, v209
v_mfma_f32_16x16x32_bf16 a[132:135], a[136:139], v[228:231], a[132:135]
s_waitcnt lgkmcnt(4)
ds_read_b128 a[20:23], v3 offset:26624
v_cvt_pk_bf16_f32 v224, v208, v209
v_mfma_f32_16x16x32_bf16 v[144:147], a[0:3], v[16:19], v[232:235]
s_waitcnt lgkmcnt(4)
v_exp_f32 v216, v216
v_mfma_f32_16x16x32_bf16 v[144:147], a[4:7], v[20:23], v[144:147]
s_waitcnt lgkmcnt(3)
ds_read_b128 a[24:27], v3 offset:19456
global_load_dwordx4 v[168:171], v1, s[34:35] offset:-4096 sc1
v_mfma_f32_16x16x32_bf16 v[144:147], a[8:11], v[24:27], v[144:147]
s_waitcnt lgkmcnt(3)
v_exp_f32 v217, v217
v_mfma_f32_16x16x32_bf16 v[144:147], a[12:15], v[28:31], v[144:147]
s_add_u32 s6, s6, 32768
ds_read_b128 a[28:31], v3 offset:18432
v_cvt_pk_bf16_f32 v160, v216, v217
v_mfma_f32_16x16x32_bf16 v[152:155], a[12:15], v[44:47], v[236:239]
v_exp_f32 v218, v218
v_mfma_f32_16x16x32_bf16 v[152:155], a[8:11], v[40:43], v[152:155]
ds_read_b128 a[32:35], v3 offset:0
buffer_load_dwordx4 v1, s[40:43], 0 offen offset:1024 sc1 lds
v_mfma_f32_16x16x32_bf16 v[152:155], a[4:7], v[36:39], v[152:155]
v_exp_f32 v219, v219
v_mfma_f32_16x16x32_bf16 v[152:155], a[0:3], v[32:35], v[152:155]
s_waitcnt lgkmcnt(3)
ds_read_b128 a[36:39], v3 offset:1024
v_cvt_pk_bf16_f32 v161, v218, v219
v_mfma_f32_16x16x32_bf16 v[156:159], a[16:19], v[44:47], v[236:239]
v_exp_f32 v220, v220
v_mfma_f32_16x16x32_bf16 v[156:159], a[20:23], v[40:43], v[156:159]
s_waitcnt lgkmcnt(3)
ds_read_b128 a[40:43], v3 offset:8192
global_load_dwordx4 v[172:175], v1, s[34:35] offset:-3072 sc1
v_mfma_f32_16x16x32_bf16 v[156:159], a[24:27], v[36:39], v[156:159]
s_waitcnt lgkmcnt(3)
v_exp_f32 v221, v221
v_mfma_f32_16x16x32_bf16 v[156:159], a[28:31], v[32:35], v[156:159]
ds_read_b128 a[44:47], v3 offset:9216
v_cvt_pk_bf16_f32 v162, v220, v221
v_mfma_f32_16x16x32_bf16 v[148:151], a[28:31], v[16:19], v[232:235]
v_exp_f32 v222, v222
v_mfma_f32_16x16x32_bf16 v[148:151], a[24:27], v[20:23], v[148:151]
ds_read_b128 a[48:51], v3 offset:11264
buffer_load_dwordx4 v1, s[40:43], 0 offen offset:2048 sc1 lds
v_mfma_f32_16x16x32_bf16 v[148:151], a[20:23], v[24:27], v[148:151]
v_exp_f32 v223, v223
v_mfma_f32_16x16x32_bf16 v[148:151], a[16:19], v[28:31], v[148:151]
ds_read_b128 a[52:55], v3 offset:10240
v_cvt_pk_bf16_f32 v163, v222, v223
v_mfma_f32_16x16x32_bf16 v[112:115], a[64:67], v[228:231], v[112:115]
v_exp_f32 v210, v210
v_mfma_f32_16x16x32_bf16 v[112:115], a[96:99], v[160:163], v[112:115]
ds_read_b128 a[56:59], v3 offset:3072
global_load_dwordx4 v[176:179], v1, s[34:35] offset:-2048 sc1
v_mfma_f32_16x16x32_bf16 v[116:119], a[100:103], v[160:163], v[116:119]
v_exp_f32 v211, v211
v_mfma_f32_16x16x32_bf16 v[116:119], a[68:71], v[228:231], v[116:119]
ds_read_b128 a[60:63], v3 offset:2048
v_cvt_pk_bf16_f32 v225, v210, v211
v_mfma_f32_16x16x32_bf16 v[120:123], a[72:75], v[228:231], v[120:123]
v_exp_f32 v212, v212
v_mfma_f32_16x16x32_bf16 v[120:123], a[104:107], v[160:163], v[120:123]
ds_read_b128 a[64:67], v3 offset:20480
buffer_load_dwordx4 v1, s[40:43], 0 offen offset:3072 sc1 lds
v_mfma_f32_16x16x32_bf16 v[124:127], a[108:111], v[160:163], v[124:127]
s_mov_b32 m0, s7
v_exp_f32 v213, v213
v_mfma_f32_16x16x32_bf16 v[124:127], a[76:79], v[228:231], v[124:127]
s_add_u32 s40, s28, s57
ds_read_b128 a[68:71], v3 offset:21504
v_cvt_pk_bf16_f32 v226, v212, v213
v_mfma_f32_16x16x32_bf16 v[128:131], a[80:83], v[228:231], v[128:131]
s_addc_u32 s41, s29, 0
v_exp_f32 v214, v214
v_mfma_f32_16x16x32_bf16 v[128:131], a[112:115], v[160:163], v[128:131]
s_bitcmp1_b64 s[60:61], s58
ds_read_b128 a[72:75], v3 offset:22528
global_load_dwordx4 v[180:183], v1, s[34:35] offset:-1024 sc1
v_mfma_f32_16x16x32_bf16 v[132:135], a[116:119], v[160:163], v[132:135]
v_exp_f32 v215, v215
v_mfma_f32_16x16x32_bf16 v[132:135], a[84:87], v[228:231], v[132:135]
ds_read_b128 a[76:79], v3 offset:23552
v_cvt_pk_bf16_f32 v227, v214, v215
v_mfma_f32_16x16x32_bf16 v[136:139], a[88:91], v[228:231], v[136:139]
v_exp_f32 v144, v144
v_mfma_f32_16x16x32_bf16 v[136:139], a[120:123], v[160:163], v[136:139]
ds_read_b128 a[80:83], v3 offset:28672
buffer_load_dwordx4 v1, s[36:39], 0 offen sc1 lds
v_mfma_f32_16x16x32_bf16 v[140:143], a[124:127], v[160:163], v[140:143]
v_exp_f32 v145, v145
v_mfma_f32_16x16x32_bf16 v[140:143], a[92:95], v[228:231], v[140:143]
ds_read_b128 a[84:87], v3 offset:29696
v_cvt_pk_bf16_f32 v164, v144, v145
v_mfma_f32_16x16x32_bf16 a[132:135], a[136:139], v[160:163], a[132:135]
s_waitcnt lgkmcnt(3)
v_exp_f32 v146, v146
v_mfma_f32_16x16x32_bf16 v[208:211], a[32:35], v[16:19], v[232:235]
ds_read_b128 a[88:91], v3 offset:30720
global_load_dwordx4 v[184:187], v1, s[34:35] offset:0 sc1
v_mfma_f32_16x16x32_bf16 v[208:211], a[36:39], v[20:23], v[208:211]
v_exp_f32 v147, v147
v_mfma_f32_16x16x32_bf16 v[208:211], a[40:43], v[24:27], v[208:211]
ds_read_b128 a[92:95], v3 offset:31744
v_cvt_pk_bf16_f32 v165, v146, v147
v_mfma_f32_16x16x32_bf16 v[208:211], a[44:47], v[28:31], v[208:211]
v_exp_f32 v148, v148
v_mfma_f32_16x16x32_bf16 v[212:215], a[48:51], v[28:31], v[232:235]
v_exp_f32 v149, v149
v_mfma_f32_16x16x32_bf16 v[212:215], a[52:55], v[24:27], v[212:215]
buffer_load_dwordx4 v1, s[36:39], 0 offen offset:1024 sc1 lds
v_cvt_pk_bf16_f32 v166, v148, v149
v_mfma_f32_16x16x32_bf16 v[212:215], a[56:59], v[20:23], v[212:215]
v_exp_f32 v150, v150
v_mfma_f32_16x16x32_bf16 v[212:215], a[60:63], v[16:19], v[212:215]
v_exp_f32 v151, v151
v_mfma_f32_16x16x32_bf16 a[128:131], a[136:139], v[224:227], a[128:131]
v_cvt_pk_bf16_f32 v167, v150, v151
v_mfma_f32_16x16x32_bf16 v[80:83], a[96:99], v[224:227], v[80:83]
v_exp_f32 v152, v152
v_mfma_f32_16x16x32_bf16 v[80:83], a[64:67], v[164:167], v[80:83]
v_exp_f32 v153, v153
v_mfma_f32_16x16x32_bf16 v[84:87], a[68:71], v[164:167], v[84:87]
ds_read_b128 a[96:99], v3 offset:4096
v_cvt_pk_bf16_f32 v228, v152, v153
v_mfma_f32_16x16x32_bf16 v[84:87], a[100:103], v[224:227], v[84:87]
v_exp_f32 v154, v154
v_mfma_f32_16x16x32_bf16 v[88:91], a[104:107], v[224:227], v[88:91]
ds_read_b128 a[100:103], v3 offset:5120
buffer_load_dwordx4 v1, s[36:39], 0 offen offset:2048 sc1 lds
v_mfma_f32_16x16x32_bf16 v[88:91], a[72:75], v[164:167], v[88:91]
s_waitcnt lgkmcnt(2)
v_exp_f32 v155, v155
v_mfma_f32_16x16x32_bf16 v[92:95], a[76:79], v[164:167], v[92:95]
ds_read_b128 a[104:107], v3 offset:6144
v_cvt_pk_bf16_f32 v229, v154, v155
v_mfma_f32_16x16x32_bf16 v[92:95], a[108:111], v[224:227], v[92:95]
v_exp_f32 v156, v156
v_mfma_f32_16x16x32_bf16 v[96:99], a[112:115], v[224:227], v[96:99]
ds_read_b128 a[108:111], v3 offset:7168
buffer_load_dwordx4 v1, s[36:39], 0 offen offset:3072 sc1 lds
v_mfma_f32_16x16x32_bf16 v[96:99], a[80:83], v[164:167], v[96:99]
v_exp_f32 v157, v157
v_mfma_f32_16x16x32_bf16 v[100:103], a[84:87], v[164:167], v[100:103]
ds_read_b128 a[112:115], v3 offset:12288
v_cvt_pk_bf16_f32 v230, v156, v157
v_mfma_f32_16x16x32_bf16 v[100:103], a[116:119], v[224:227], v[100:103]
v_exp_f32 v158, v158
v_mfma_f32_16x16x32_bf16 v[104:107], a[120:123], v[224:227], v[104:107]
ds_read_b128 a[116:119], v3 offset:13312
v_mfma_f32_16x16x32_bf16 v[104:107], a[88:91], v[164:167], v[104:107]
v_exp_f32 v159, v159
v_mfma_f32_16x16x32_bf16 v[108:111], a[92:95], v[164:167], v[108:111]
s_waitcnt vmcnt(21)
ds_read_b128 a[120:123], v3 offset:14336
v_cvt_pk_bf16_f32 v231, v158, v159
v_mfma_f32_16x16x32_bf16 v[108:111], a[124:127], v[224:227], v[108:111]
ds_read_b128 a[124:127], v3 offset:15360
v_add_u32 v3, s6, v1
v_mfma_f32_16x16x32_bf16 a[128:131], a[136:139], v[164:167], a[128:131]
v_mfma_f32_16x16x32_bf16 v[216:219], a[32:35], v[32:35], v[236:239]
s_barrier
v_mfma_f32_16x16x32_bf16 v[216:219], a[36:39], v[36:39], v[216:219]
s_add_u32 s7, s63, s62
s_add_u32 m0, s7, 16384
ds_read_b128 a[0:3], v3 offset:16384
v_mfma_f32_16x16x32_bf16 v[216:219], a[40:43], v[40:43], v[216:219]
s_add_u32 s36, s28, s26
s_addc_u32 s37, s29, 0
ds_read_b128 a[4:7], v3 offset:17408
v_mfma_f32_16x16x32_bf16 v[216:219], a[44:47], v[44:47], v[216:219]
s_add_u32 s26, s26, s64
s_add_u32 s57, s57, s65
ds_read_b128 a[8:11], v3 offset:24576
v_mfma_f32_16x16x32_bf16 v[220:223], a[48:51], v[44:47], v[236:239]
s_add_u32 s62, s62, 32768
s_and_b32 s62, s62, 131071
ds_read_b128 a[12:15], v3 offset:25600
v_mfma_f32_16x16x32_bf16 v[220:223], a[52:55], v[40:43], v[220:223]
s_add_u32 s6, s62, 32768
v_exp_f32 v208, v208
v_mfma_f32_16x16x32_bf16 v[220:223], a[56:59], v[36:39], v[220:223]
s_and_b32 s6, s6, 131071
ds_read_b128 a[16:19], v3 offset:27648
buffer_load_dwordx4 v1, s[40:43], 0 offen sc1 lds
v_mfma_f32_16x16x32_bf16 v[220:223], a[60:63], v[32:35], v[220:223]
s_add_u32 s58, s58, 1
v_exp_f32 v209, v209
v_mfma_f32_16x16x32_bf16 a[132:135], a[136:139], v[228:231], a[132:135]
s_waitcnt lgkmcnt(4)
ds_read_b128 a[20:23], v3 offset:26624
v_cvt_pk_bf16_f32 v224, v208, v209
v_mfma_f32_16x16x32_bf16 v[144:147], a[0:3], v[16:19], v[232:235]
s_waitcnt lgkmcnt(4)
v_exp_f32 v216, v216
v_mfma_f32_16x16x32_bf16 v[144:147], a[4:7], v[20:23], v[144:147]
s_waitcnt lgkmcnt(3)
ds_read_b128 a[24:27], v3 offset:19456
global_load_dwordx4 v[188:191], v1, s[34:35] offset:1024 sc1
v_mfma_f32_16x16x32_bf16 v[144:147], a[8:11], v[24:27], v[144:147]
s_waitcnt lgkmcnt(3)
v_exp_f32 v217, v217
v_mfma_f32_16x16x32_bf16 v[144:147], a[12:15], v[28:31], v[144:147]
s_add_u32 s6, s6, 32768
ds_read_b128 a[28:31], v3 offset:18432
v_cvt_pk_bf16_f32 v160, v216, v217
v_mfma_f32_16x16x32_bf16 v[152:155], a[12:15], v[44:47], v[236:239]
v_exp_f32 v218, v218
v_mfma_f32_16x16x32_bf16 v[152:155], a[8:11], v[40:43], v[152:155]
ds_read_b128 a[32:35], v3 offset:0
buffer_load_dwordx4 v1, s[40:43], 0 offen offset:1024 sc1 lds
v_mfma_f32_16x16x32_bf16 v[152:155], a[4:7], v[36:39], v[152:155]
v_exp_f32 v219, v219
v_mfma_f32_16x16x32_bf16 v[152:155], a[0:3], v[32:35], v[152:155]
s_waitcnt lgkmcnt(3)
ds_read_b128 a[36:39], v3 offset:1024
v_cvt_pk_bf16_f32 v161, v218, v219
v_mfma_f32_16x16x32_bf16 v[156:159], a[16:19], v[44:47], v[236:239]
v_exp_f32 v220, v220
v_mfma_f32_16x16x32_bf16 v[156:159], a[20:23], v[40:43], v[156:159]
s_waitcnt lgkmcnt(3)
ds_read_b128 a[40:43], v3 offset:8192
global_load_dwordx4 v[192:195], v1, s[34:35] offset:2048 sc1
v_mfma_f32_16x16x32_bf16 v[156:159], a[24:27], v[36:39], v[156:159]
s_waitcnt lgkmcnt(3)
v_exp_f32 v221, v221
v_mfma_f32_16x16x32_bf16 v[156:159], a[28:31], v[32:35], v[156:159]
ds_read_b128 a[44:47], v3 offset:9216
v_cvt_pk_bf16_f32 v162, v220, v221
v_mfma_f32_16x16x32_bf16 v[148:151], a[28:31], v[16:19], v[232:235]
v_exp_f32 v222, v222
v_mfma_f32_16x16x32_bf16 v[148:151], a[24:27], v[20:23], v[148:151]
ds_read_b128 a[48:51], v3 offset:11264
buffer_load_dwordx4 v1, s[40:43], 0 offen offset:2048 sc1 lds
v_mfma_f32_16x16x32_bf16 v[148:151], a[20:23], v[24:27], v[148:151]
v_exp_f32 v223, v223
v_mfma_f32_16x16x32_bf16 v[148:151], a[16:19], v[28:31], v[148:151]
ds_read_b128 a[52:55], v3 offset:10240
v_cvt_pk_bf16_f32 v163, v222, v223
v_mfma_f32_16x16x32_bf16 v[112:115], a[64:67], v[228:231], v[112:115]
v_exp_f32 v210, v210
v_mfma_f32_16x16x32_bf16 v[112:115], a[96:99], v[160:163], v[112:115]
ds_read_b128 a[56:59], v3 offset:3072
global_load_dwordx4 v[196:199], v1, s[34:35] offset:3072 sc1
v_mfma_f32_16x16x32_bf16 v[116:119], a[100:103], v[160:163], v[116:119]
v_exp_f32 v211, v211
v_mfma_f32_16x16x32_bf16 v[116:119], a[68:71], v[228:231], v[116:119]
ds_read_b128 a[60:63], v3 offset:2048
v_cvt_pk_bf16_f32 v225, v210, v211
v_mfma_f32_16x16x32_bf16 v[120:123], a[72:75], v[228:231], v[120:123]
v_exp_f32 v212, v212
v_mfma_f32_16x16x32_bf16 v[120:123], a[104:107], v[160:163], v[120:123]
ds_read_b128 a[64:67], v3 offset:20480
buffer_load_dwordx4 v1, s[40:43], 0 offen offset:3072 sc1 lds
v_mfma_f32_16x16x32_bf16 v[124:127], a[108:111], v[160:163], v[124:127]
s_mov_b32 m0, s7
v_exp_f32 v213, v213
v_mfma_f32_16x16x32_bf16 v[124:127], a[76:79], v[228:231], v[124:127]
s_add_u32 s40, s28, s57
ds_read_b128 a[68:71], v3 offset:21504
v_cvt_pk_bf16_f32 v226, v212, v213
v_mfma_f32_16x16x32_bf16 v[128:131], a[80:83], v[228:231], v[128:131]
s_addc_u32 s41, s29, 0
v_exp_f32 v214, v214
v_mfma_f32_16x16x32_bf16 v[128:131], a[112:115], v[160:163], v[128:131]
s_bitcmp1_b64 s[60:61], s58
ds_read_b128 a[72:75], v3 offset:22528
global_load_dwordx4 v[200:203], v1, s[46:47] offset:-4096 sc1
v_mfma_f32_16x16x32_bf16 v[132:135], a[116:119], v[160:163], v[132:135]
v_exp_f32 v215, v215
v_mfma_f32_16x16x32_bf16 v[132:135], a[84:87], v[228:231], v[132:135]
ds_read_b128 a[76:79], v3 offset:23552
v_cvt_pk_bf16_f32 v227, v214, v215
v_mfma_f32_16x16x32_bf16 v[136:139], a[88:91], v[228:231], v[136:139]
v_exp_f32 v144, v144
v_mfma_f32_16x16x32_bf16 v[136:139], a[120:123], v[160:163], v[136:139]
ds_read_b128 a[80:83], v3 offset:28672
buffer_load_dwordx4 v1, s[36:39], 0 offen sc1 lds
v_mfma_f32_16x16x32_bf16 v[140:143], a[124:127], v[160:163], v[140:143]
v_exp_f32 v145, v145
v_mfma_f32_16x16x32_bf16 v[140:143], a[92:95], v[228:231], v[140:143]
ds_read_b128 a[84:87], v3 offset:29696
v_cvt_pk_bf16_f32 v164, v144, v145
v_mfma_f32_16x16x32_bf16 a[132:135], a[136:139], v[160:163], a[132:135]
s_waitcnt lgkmcnt(3)
v_exp_f32 v146, v146
v_mfma_f32_16x16x32_bf16 v[208:211], a[32:35], v[16:19], v[232:235]
ds_read_b128 a[88:91], v3 offset:30720
v_mfma_f32_16x16x32_bf16 v[208:211], a[36:39], v[20:23], v[208:211]
v_exp_f32 v147, v147
v_mfma_f32_16x16x32_bf16 v[208:211], a[40:43], v[24:27], v[208:211]
ds_read_b128 a[92:95], v3 offset:31744
v_cvt_pk_bf16_f32 v165, v146, v147
v_mfma_f32_16x16x32_bf16 v[208:211], a[44:47], v[28:31], v[208:211]
v_exp_f32 v148, v148
v_mfma_f32_16x16x32_bf16 v[212:215], a[48:51], v[28:31], v[232:235]
v_exp_f32 v149, v149
v_mfma_f32_16x16x32_bf16 v[212:215], a[52:55], v[24:27], v[212:215]
buffer_load_dwordx4 v1, s[36:39], 0 offen offset:1024 sc1 lds
v_cvt_pk_bf16_f32 v166, v148, v149
v_mfma_f32_16x16x32_bf16 v[212:215], a[56:59], v[20:23], v[212:215]
v_exp_f32 v150, v150
v_mfma_f32_16x16x32_bf16 v[212:215], a[60:63], v[16:19], v[212:215]
v_exp_f32 v151, v151
v_mfma_f32_16x16x32_bf16 a[128:131], a[136:139], v[224:227], a[128:131]
v_cvt_pk_bf16_f32 v167, v150, v151
v_mfma_f32_16x16x32_bf16 v[80:83], a[96:99], v[224:227], v[80:83]
v_exp_f32 v152, v152
v_mfma_f32_16x16x32_bf16 v[80:83], a[64:67], v[164:167], v[80:83]
v_exp_f32 v153, v153
v_mfma_f32_16x16x32_bf16 v[84:87], a[68:71], v[164:167], v[84:87]
ds_read_b128 a[96:99], v3 offset:4096
v_cvt_pk_bf16_f32 v228, v152, v153
v_mfma_f32_16x16x32_bf16 v[84:87], a[100:103], v[224:227], v[84:87]
v_exp_f32 v154, v154
v_mfma_f32_16x16x32_bf16 v[88:91], a[104:107], v[224:227], v[88:91]
ds_read_b128 a[100:103], v3 offset:5120
buffer_load_dwordx4 v1, s[36:39], 0 offen offset:2048 sc1 lds
v_mfma_f32_16x16x32_bf16 v[88:91], a[72:75], v[164:167], v[88:91]
s_waitcnt lgkmcnt(2)
v_exp_f32 v155, v155
v_mfma_f32_16x16x32_bf16 v[92:95], a[76:79], v[164:167], v[92:95]
ds_read_b128 a[104:107], v3 offset:6144
v_cvt_pk_bf16_f32 v229, v154, v155
v_mfma_f32_16x16x32_bf16 v[92:95], a[108:111], v[224:227], v[92:95]
v_exp_f32 v156, v156
v_mfma_f32_16x16x32_bf16 v[96:99], a[112:115], v[224:227], v[96:99]
ds_read_b128 a[108:111], v3 offset:7168
buffer_load_dwordx4 v1, s[36:39], 0 offen offset:3072 sc1 lds
v_mfma_f32_16x16x32_bf16 v[96:99], a[80:83], v[164:167], v[96:99]
v_exp_f32 v157, v157
v_mfma_f32_16x16x32_bf16 v[100:103], a[84:87], v[164:167], v[100:103]
ds_read_b128 a[112:115], v3 offset:12288
v_cvt_pk_bf16_f32 v230, v156, v157
v_mfma_f32_16x16x32_bf16 v[100:103], a[116:119], v[224:227], v[100:103]
v_exp_f32 v158, v158
v_mfma_f32_16x16x32_bf16 v[104:107], a[120:123], v[224:227], v[104:107]
ds_read_b128 a[116:119], v3 offset:13312
v_mfma_f32_16x16x32_bf16 v[104:107], a[88:91], v[164:167], v[104:107]
v_exp_f32 v159, v159
v_mfma_f32_16x16x32_bf16 v[108:111], a[92:95], v[164:167], v[108:111]
s_waitcnt vmcnt(20)
ds_read_b128 a[120:123], v3 offset:14336
v_cvt_pk_bf16_f32 v231, v158, v159
v_mfma_f32_16x16x32_bf16 v[108:111], a[124:127], v[224:227], v[108:111]
ds_read_b128 a[124:127], v3 offset:15360
v_add_u32 v3, s6, v1
v_mfma_f32_16x16x32_bf16 a[128:131], a[136:139], v[164:167], a[128:131]
v_mfma_f32_16x16x32_bf16 v[216:219], a[32:35], v[32:35], v[236:239]
s_barrier
v_mfma_f32_16x16x32_bf16 v[216:219], a[36:39], v[36:39], v[216:219]
s_add_u32 s7, s63, s62
s_add_u32 m0, s7, 16384
ds_read_b128 a[0:3], v3 offset:16384
v_mfma_f32_16x16x32_bf16 v[216:219], a[40:43], v[40:43], v[216:219]
s_add_u32 s36, s28, s26
s_addc_u32 s37, s29, 0
ds_read_b128 a[4:7], v3 offset:17408
v_mfma_f32_16x16x32_bf16 v[216:219], a[44:47], v[44:47], v[216:219]
s_add_u32 s26, s26, s64
s_add_u32 s57, s57, s65
ds_read_b128 a[8:11], v3 offset:24576
v_mfma_f32_16x16x32_bf16 v[220:223], a[48:51], v[44:47], v[236:239]
s_add_u32 s62, s62, 32768
s_and_b32 s62, s62, 131071
ds_read_b128 a[12:15], v3 offset:25600
v_mfma_f32_16x16x32_bf16 v[220:223], a[52:55], v[40:43], v[220:223]
s_add_u32 s6, s62, 32768
v_exp_f32 v208, v208
v_mfma_f32_16x16x32_bf16 v[220:223], a[56:59], v[36:39], v[220:223]
s_and_b32 s6, s6, 131071
ds_read_b128 a[16:19], v3 offset:27648
buffer_load_dwordx4 v1, s[40:43], 0 offen sc1 lds
v_mfma_f32_16x16x32_bf16 v[220:223], a[60:63], v[32:35], v[220:223]
s_add_u32 s58, s58, 1
v_exp_f32 v209, v209
v_mfma_f32_16x16x32_bf16 a[132:135], a[136:139], v[228:231], a[132:135]
s_waitcnt lgkmcnt(4)
ds_read_b128 a[20:23], v3 offset:26624
v_cvt_pk_bf16_f32 v224, v208, v209
v_mfma_f32_16x16x32_bf16 v[144:147], a[0:3], v[16:19], v[232:235]
s_waitcnt lgkmcnt(4)
v_exp_f32 v216, v216
v_mfma_f32_16x16x32_bf16 v[144:147], a[4:7], v[20:23], v[144:147]
s_waitcnt lgkmcnt(3)
ds_read_b128 a[24:27], v3 offset:19456
global_load_dwordx4 v[204:207], v1, s[46:47] offset:-3072 sc1
v_mfma_f32_16x16x32_bf16 v[144:147], a[8:11], v[24:27], v[144:147]
s_waitcnt lgkmcnt(3)
v_exp_f32 v217, v217
v_mfma_f32_16x16x32_bf16 v[144:147], a[12:15], v[28:31], v[144:147]
s_add_u32 s6, s6, 32768
ds_read_b128 a[28:31], v3 offset:18432
v_cvt_pk_bf16_f32 v160, v216, v217
v_mfma_f32_16x16x32_bf16 v[152:155], a[12:15], v[44:47], v[236:239]
v_exp_f32 v218, v218
v_mfma_f32_16x16x32_bf16 v[152:155], a[8:11], v[40:43], v[152:155]
ds_read_b128 a[32:35], v3 offset:0
buffer_load_dwordx4 v1, s[40:43], 0 offen offset:1024 sc1 lds
v_mfma_f32_16x16x32_bf16 v[152:155], a[4:7], v[36:39], v[152:155]
v_exp_f32 v219, v219
v_mfma_f32_16x16x32_bf16 v[152:155], a[0:3], v[32:35], v[152:155]
s_waitcnt lgkmcnt(3)
ds_read_b128 a[36:39], v3 offset:1024
v_cvt_pk_bf16_f32 v161, v218, v219
v_mfma_f32_16x16x32_bf16 v[156:159], a[16:19], v[44:47], v[236:239]
v_exp_f32 v220, v220
v_mfma_f32_16x16x32_bf16 v[156:159], a[20:23], v[40:43], v[156:159]
s_waitcnt lgkmcnt(3)
ds_read_b128 a[40:43], v3 offset:8192
global_load_dwordx4 v[240:243], v1, s[46:47] offset:-2048 sc1
v_mfma_f32_16x16x32_bf16 v[156:159], a[24:27], v[36:39], v[156:159]
s_waitcnt lgkmcnt(3)
v_exp_f32 v221, v221
v_mfma_f32_16x16x32_bf16 v[156:159], a[28:31], v[32:35], v[156:159]
ds_read_b128 a[44:47], v3 offset:9216
v_cvt_pk_bf16_f32 v162, v220, v221
v_mfma_f32_16x16x32_bf16 v[148:151], a[28:31], v[16:19], v[232:235]
v_exp_f32 v222, v222
v_mfma_f32_16x16x32_bf16 v[148:151], a[24:27], v[20:23], v[148:151]
ds_read_b128 a[48:51], v3 offset:11264
buffer_load_dwordx4 v1, s[40:43], 0 offen offset:2048 sc1 lds
v_mfma_f32_16x16x32_bf16 v[148:151], a[20:23], v[24:27], v[148:151]
v_exp_f32 v223, v223
v_mfma_f32_16x16x32_bf16 v[148:151], a[16:19], v[28:31], v[148:151]
ds_read_b128 a[52:55], v3 offset:10240
v_cvt_pk_bf16_f32 v163, v222, v223
v_mfma_f32_16x16x32_bf16 v[112:115], a[64:67], v[228:231], v[112:115]
v_exp_f32 v210, v210
v_mfma_f32_16x16x32_bf16 v[112:115], a[96:99], v[160:163], v[112:115]
ds_read_b128 a[56:59], v3 offset:3072
global_load_dwordx4 v[248:251], v1, s[46:47] offset:-1024 sc1
v_mfma_f32_16x16x32_bf16 v[116:119], a[100:103], v[160:163], v[116:119]
v_exp_f32 v211, v211
v_mfma_f32_16x16x32_bf16 v[116:119], a[68:71], v[228:231], v[116:119]
ds_read_b128 a[60:63], v3 offset:2048
v_cvt_pk_bf16_f32 v225, v210, v211
v_mfma_f32_16x16x32_bf16 v[120:123], a[72:75], v[228:231], v[120:123]
v_exp_f32 v212, v212
v_mfma_f32_16x16x32_bf16 v[120:123], a[104:107], v[160:163], v[120:123]
ds_read_b128 a[64:67], v3 offset:20480
buffer_load_dwordx4 v1, s[40:43], 0 offen offset:3072 sc1 lds
v_mfma_f32_16x16x32_bf16 v[124:127], a[108:111], v[160:163], v[124:127]
s_mov_b32 m0, s7
v_exp_f32 v213, v213
v_mfma_f32_16x16x32_bf16 v[124:127], a[76:79], v[228:231], v[124:127]
s_add_u32 s40, s28, s57
ds_read_b128 a[68:71], v3 offset:21504
v_cvt_pk_bf16_f32 v226, v212, v213
v_mfma_f32_16x16x32_bf16 v[128:131], a[80:83], v[228:231], v[128:131]
s_addc_u32 s41, s29, 0
v_exp_f32 v214, v214
v_mfma_f32_16x16x32_bf16 v[128:131], a[112:115], v[160:163], v[128:131]
s_bitcmp1_b64 s[60:61], s58
ds_read_b128 a[72:75], v3 offset:22528
global_load_dwordx4 v[252:255], v1, s[46:47] offset:0 sc1
v_mfma_f32_16x16x32_bf16 v[132:135], a[116:119], v[160:163], v[132:135]
v_exp_f32 v215, v215
v_mfma_f32_16x16x32_bf16 v[132:135], a[84:87], v[228:231], v[132:135]
ds_read_b128 a[76:79], v3 offset:23552
v_cvt_pk_bf16_f32 v227, v214, v215
v_mfma_f32_16x16x32_bf16 v[136:139], a[88:91], v[228:231], v[136:139]
v_exp_f32 v144, v144
v_mfma_f32_16x16x32_bf16 v[136:139], a[120:123], v[160:163], v[136:139]
ds_read_b128 a[80:83], v3 offset:28672
buffer_load_dwordx4 v1, s[36:39], 0 offen sc1 lds
v_mfma_f32_16x16x32_bf16 v[140:143], a[124:127], v[160:163], v[140:143]
v_exp_f32 v145, v145
v_mfma_f32_16x16x32_bf16 v[140:143], a[92:95], v[228:231], v[140:143]
ds_read_b128 a[84:87], v3 offset:29696
v_cvt_pk_bf16_f32 v164, v144, v145
v_mfma_f32_16x16x32_bf16 a[132:135], a[136:139], v[160:163], a[132:135]
s_waitcnt lgkmcnt(3)
v_exp_f32 v146, v146
v_mfma_f32_16x16x32_bf16 v[208:211], a[32:35], v[16:19], v[232:235]
ds_read_b128 a[88:91], v3 offset:30720
v_mfma_f32_16x16x32_bf16 v[208:211], a[36:39], v[20:23], v[208:211]
v_exp_f32 v147, v147
v_mfma_f32_16x16x32_bf16 v[208:211], a[40:43], v[24:27], v[208:211]
ds_read_b128 a[92:95], v3 offset:31744
v_cvt_pk_bf16_f32 v165, v146, v147
v_mfma_f32_16x16x32_bf16 v[208:211], a[44:47], v[28:31], v[208:211]
v_exp_f32 v148, v148
v_mfma_f32_16x16x32_bf16 v[212:215], a[48:51], v[28:31], v[232:235]
v_exp_f32 v149, v149
v_mfma_f32_16x16x32_bf16 v[212:215], a[52:55], v[24:27], v[212:215]
buffer_load_dwordx4 v1, s[36:39], 0 offen offset:1024 sc1 lds
v_cvt_pk_bf16_f32 v166, v148, v149
v_mfma_f32_16x16x32_bf16 v[212:215], a[56:59], v[20:23], v[212:215]
v_exp_f32 v150, v150
v_mfma_f32_16x16x32_bf16 v[212:215], a[60:63], v[16:19], v[212:215]
v_exp_f32 v151, v151
v_mfma_f32_16x16x32_bf16 a[128:131], a[136:139], v[224:227], a[128:131]
v_cvt_pk_bf16_f32 v167, v150, v151
v_mfma_f32_16x16x32_bf16 v[80:83], a[96:99], v[224:227], v[80:83]
v_exp_f32 v152, v152
v_mfma_f32_16x16x32_bf16 v[80:83], a[64:67], v[164:167], v[80:83]
v_exp_f32 v153, v153
v_mfma_f32_16x16x32_bf16 v[84:87], a[68:71], v[164:167], v[84:87]
ds_read_b128 a[96:99], v3 offset:4096
v_cvt_pk_bf16_f32 v228, v152, v153
v_mfma_f32_16x16x32_bf16 v[84:87], a[100:103], v[224:227], v[84:87]
v_exp_f32 v154, v154
v_mfma_f32_16x16x32_bf16 v[88:91], a[104:107], v[224:227], v[88:91]
ds_read_b128 a[100:103], v3 offset:5120
buffer_load_dwordx4 v1, s[36:39], 0 offen offset:2048 sc1 lds
v_mfma_f32_16x16x32_bf16 v[88:91], a[72:75], v[164:167], v[88:91]
s_waitcnt lgkmcnt(2)
v_exp_f32 v155, v155
v_mfma_f32_16x16x32_bf16 v[92:95], a[76:79], v[164:167], v[92:95]
ds_read_b128 a[104:107], v3 offset:6144
v_cvt_pk_bf16_f32 v229, v154, v155
v_mfma_f32_16x16x32_bf16 v[92:95], a[108:111], v[224:227], v[92:95]
v_exp_f32 v156, v156
v_mfma_f32_16x16x32_bf16 v[96:99], a[112:115], v[224:227], v[96:99]
ds_read_b128 a[108:111], v3 offset:7168
buffer_load_dwordx4 v1, s[36:39], 0 offen offset:3072 sc1 lds
v_mfma_f32_16x16x32_bf16 v[96:99], a[80:83], v[164:167], v[96:99]
v_exp_f32 v157, v157
v_mfma_f32_16x16x32_bf16 v[100:103], a[84:87], v[164:167], v[100:103]
ds_read_b128 a[112:115], v3 offset:12288
v_cvt_pk_bf16_f32 v230, v156, v157
v_mfma_f32_16x16x32_bf16 v[100:103], a[116:119], v[224:227], v[100:103]
v_exp_f32 v158, v158
v_mfma_f32_16x16x32_bf16 v[104:107], a[120:123], v[224:227], v[104:107]
ds_read_b128 a[116:119], v3 offset:13312
v_mfma_f32_16x16x32_bf16 v[104:107], a[88:91], v[164:167], v[104:107]
v_exp_f32 v159, v159
v_mfma_f32_16x16x32_bf16 v[108:111], a[92:95], v[164:167], v[108:111]
s_waitcnt vmcnt(20)
ds_read_b128 a[120:123], v3 offset:14336
v_cvt_pk_bf16_f32 v231, v158, v159
v_mfma_f32_16x16x32_bf16 v[108:111], a[124:127], v[224:227], v[108:111]
ds_read_b128 a[124:127], v3 offset:15360
v_add_u32 v3, s6, v1
v_mfma_f32_16x16x32_bf16 a[128:131], a[136:139], v[164:167], a[128:131]
L_T1:
v_mfma_f32_16x16x32_bf16 v[216:219], a[32:35], v[32:35], v[236:239]
s_add_u32 m0, s82, 81920
v_exp_f32 v208, v208
v_mfma_f32_16x16x32_bf16 v[216:219], a[36:39], v[36:39], v[216:219]
s_add_u32 s80, s68, 98304
v_exp_f32 v209, v209
v_mfma_f32_16x16x32_bf16 v[216:219], a[40:43], v[40:43], v[216:219]
s_barrier
v_mfma_f32_16x16x32_bf16 v[216:219], a[44:47], v[44:47], v[216:219]
s_add_u32 s36, s28, s80
s_addc_u32 s37, s29, 0
buffer_load_dwordx4 v1, s[36:39], 0 offen sc1 lds
v_mfma_f32_16x16x32_bf16 v[220:223], a[48:51], v[44:47], v[244:247]
s_add_u32 s94, s32, 12288
v_exp_f32 v210, v210
v_mfma_f32_16x16x32_bf16 v[220:223], a[52:55], v[40:43], v[220:223]
s_add_u32 s40, s28, s94
s_addc_u32 s41, s29, 0
v_add_u32 v145, 65536, v1
v_mfma_f32_16x16x32_bf16 v[220:223], a[56:59], v[36:39], v[220:223]
L_pad15:
s_cbranch_execz L_pad19
v_exp_f32 v211, v211
v_mfma_f32_16x16x32_bf16 v[220:223], a[60:63], v[32:35], v[220:223]
s_waitcnt lgkmcnt(0)
v_cvt_pk_bf16_f32 v224, v208, v209
v_cvt_pk_bf16_f32 v225, v210, v211
v_mfma_f32_16x16x32_bf16 v[112:115], a[64:67], v[228:231], v[112:115]
v_exp_f32 v212, v212
v_mfma_f32_16x16x32_bf16 v[116:119], a[68:71], v[228:231], v[116:119]
v_exp_f32 v213, v213
v_mfma_f32_16x16x32_bf16 v[120:123], a[72:75], v[228:231], v[120:123]
buffer_load_dwordx4 v1, s[36:39], 0 offen offset:1024 sc1 lds
v_cvt_pk_bf16_f32 v226, v212, v213
v_mfma_f32_16x16x32_bf16 v[124:127], a[76:79], v[228:231], v[124:127]
v_exp_f32 v214, v214
v_mfma_f32_16x16x32_bf16 v[128:131], a[80:83], v[228:231], v[128:131]
v_exp_f32 v215, v215
v_mfma_f32_16x16x32_bf16 v[132:135], a[84:87], v[228:231], v[132:135]
v_cvt_pk_bf16_f32 v227, v214, v215
v_mov_b32 v144, v1
v_mfma_f32_16x16x32_bf16 v[136:139], a[88:91], v[228:231], v[136:139]
v_exp_f32 v216, v216
v_mfma_f32_16x16x32_bf16 v[140:143], a[92:95], v[228:231], v[140:143]
v_exp_f32 v217, v217
v_mfma_f32_16x16x32_bf16 a[132:135], a[136:139], v[228:231], a[132:135]
v_exp_f32 v218, v218
v_mfma_f32_16x16x32_bf16 a[128:131], a[136:139], v[224:227], a[128:131]
v_exp_f32 v219, v219
v_mfma_f32_16x16x32_bf16 v[80:83], a[96:99], v[224:227], v[80:83]
v_cvt_pk_bf16_f32 v228, v216, v217
v_cvt_pk_bf16_f32 v229, v218, v219
v_mfma_f32_16x16x32_bf16 v[84:87], a[100:103], v[224:227], v[84:87]
v_exp_f32 v220, v220
v_mfma_f32_16x16x32_bf16 v[88:91], a[104:107], v[224:227], v[88:91]
v_exp_f32 v221, v221
v_mfma_f32_16x16x32_bf16 v[92:95], a[108:111], v[224:227], v[92:95]
buffer_load_dwordx4 v1, s[36:39], 0 offen offset:2048 sc1 lds
v_cvt_pk_bf16_f32 v230, v220, v221
v_mfma_f32_16x16x32_bf16 v[96:99], a[112:115], v[224:227], v[96:99]
v_exp_f32 v222, v222
v_mfma_f32_16x16x32_bf16 v[100:103], a[116:119], v[224:227], v[100:103]
v_exp_f32 v223, v223
v_mfma_f32_16x16x32_bf16 v[104:107], a[120:123], v[224:227], v[104:107]
ds_read_b128 a[0:3], v145 offset:32768
v_cvt_pk_bf16_f32 v231, v222, v223
v_mfma_f32_16x16x32_bf16 v[108:111], a[124:127], v[224:227], v[108:111]
buffer_load_dwordx4 v1, s[36:39], 0 offen offset:3072 sc1 lds
ds_read_b128 a[4:7], v145 offset:33792
v_mfma_f32_16x16x32_bf16 a[132:135], a[136:139], v[228:231], a[132:135]
s_add_u32 m0, s83, 0
ds_read_b128 a[8:11], v145 offset:34816
v_accvgpr_read_b32 v7, a128
v_mfma_f32_16x16x32_bf16 v[112:115], a[96:99], v[228:231], v[112:115]
s_add_u32 s80, s45, 0
ds_read_b128 a[12:15], v145 offset:35840
v_add_u32 v146, 131072, v1
v_mfma_f32_16x16x32_bf16 v[116:119], a[100:103], v[228:231], v[116:119]
s_add_u32 s36, s28, s80
s_addc_u32 s37, s29, 0
ds_read_b128 a[16:19], v145 offset:36864
v_mfma_f32_16x16x32_bf16 v[120:123], a[104:107], v[228:231], v[120:123]
v_rcp_f32 v4, v7
v_mfma_f32_16x16x32_bf16 v[124:127], a[108:111], v[228:231], v[124:127]
ds_read_b128 a[20:23], v145 offset:37888
v_and_b32 v148, 15, v0
v_mfma_f32_16x16x32_bf16 v[128:131], a[112:115], v[228:231], v[128:131]
v_accvgpr_read_b32 v6, a132
v_min_f32 v11, v7, v6
v_mfma_f32_16x16x32_bf16 v[132:135], a[116:119], v[228:231], v[132:135]
v_cmp_nlt_f32 vcc, 0x30800000, v11
v_add_f32 v7, v7, v6
v_mfma_f32_16x16x32_bf16 v[136:139], a[120:123], v[228:231], v[136:139]
s_or_b64 s[16:17], s[16:17], vcc
ds_read_b128 a[24:27], v145 offset:38912
v_cmp_ngt_f32 vcc, 0x4e800000, v7
v_mfma_f32_16x16x32_bf16 v[140:143], a[124:127], v[228:231], v[140:143]
L_p38:
s_waitcnt lgkmcnt(5)
v_rcp_f32 v6, v6
v_mfma_f32_16x16x32_bf16 v[152:155], a[144:147], a[0:3], 0
s_or_b64 s[16:17], s[16:17], vcc
s_cmp_eq_u32 s67, 0
s_cselect_b64 s[16:17], s[16:17], 0
v_mfma_f32_16x16x32_bf16 v[152:155], a[152:155], a[4:7], v[152:155]
s_waitcnt lgkmcnt(3)
s_cmp_lg_u64 s[16:17], 0
s_cselect_b32 s101, 1, 0
v_mfma_f32_16x16x32_bf16 v[152:155], a[160:163], a[8:11], v[152:155]
ds_read_b128 a[28:31], v145 offset:39936
v_mov_b32 v7, s101
v_mfma_f32_16x16x32_bf16 v[152:155], a[168:171], a[12:15], v[152:155]
s_lshl_b32 s101, s101, 30
s_or_b32 s64, s101, s19
s_or_b32 s65, s101, s20
v_mfma_f32_16x16x32_bf16 v[156:159], a[164:167], a[12:15], 0
s_lshl_b32 s101, s3, 2
s_add_u32 s101, s101, 65536
v_mov_b32 v11, s101
v_mfma_f32_16x16x32_bf16 v[156:159], a[156:159], a[8:11], v[156:159]
ds_write_b32 v11, v7
v_lshlrev_b32 v150, 6, v148
v_mfma_f32_16x16x32_bf16 v[156:159], a[148:151], a[4:7], v[156:159]
ds_read_b128 a[32:35], v145 offset:40960
v_mov_b32 v11, 65536
v_mfma_f32_16x16x32_bf16 v[156:159], a[140:143], a[0:3], v[156:159]
s_waitcnt lgkmcnt(3)
ds_read_b128 a[12:15], v145 offset:41984
v_lshlrev_b32 v151, 10, v148
v_mfma_f32_16x16x32_bf16 v[156:159], a[172:175], a[16:19], v[156:159]
ds_read_b128 a[8:11], v145 offset:43008
v_lshlrev_b32 v148, 2, v148
v_mfma_f32_16x16x32_bf16 v[156:159], a[180:183], a[20:23], v[156:159]
s_waitcnt vmcnt(4)
buffer_store_dword v13, v2, s[28:31], s64 offen sc1
v_mfma_f32_16x16x32_bf16 v[156:159], a[188:191], a[24:27], v[156:159]
s_waitcnt lgkmcnt(4)
ds_read_b128 a[0:3], v145 offset:44032
v_and_b32 v149, 48, v0
v_mfma_f32_16x16x32_bf16 v[156:159], a[196:199], a[28:31], v[156:159]
ds_read_b128 a[4:7], v145 offset:45056
v_add_u32 v151, v151, v149
v_mfma_f32_16x16x32_bf16 v[152:155], a[200:203], a[28:31], v[152:155]
s_waitcnt lgkmcnt(5)
ds_read_b128 a[36:39], v145 offset:46080
v_min_u32 v149, 2, v0
v_mfma_f32_16x16x32_bf16 v[152:155], a[192:195], a[24:27], v[152:155]
s_barrier
v_mfma_f32_16x16x32_bf16 v[152:155], a[184:187], a[20:23], v[152:155]
ds_read_b128 v[160:163], v11
v_lshlrev_b32 v149, 2, v149
v_mfma_f32_16x16x32_bf16 v[152:155], a[176:179], a[16:19], v[152:155]
s_waitcnt lgkmcnt(6)
ds_read_b128 a[28:31], v145 offset:47104
v_mul_f32 v80, v4, v80
v_mfma_f32_16x16x32_bf16 v[152:155], a[208:211], a[32:35], v[152:155]
s_waitcnt lgkmcnt(6)
ds_read_b128 a[24:27], v145 offset:48128
v_mul_f32 v81, v4, v81
v_mfma_f32_16x16x32_bf16 v[152:155], a[216:219], a[12:15], v[152:155]
s_waitcnt lgkmcnt(6)
ds_read_b128 a[20:23], v145 offset:49152
v_mul_f32 v82, v4, v82
v_mfma_f32_16x16x32_bf16 v[152:155], a[224:227], a[8:11], v[152:155]
ds_read_b128 a[16:19], v145 offset:50176
v_mul_f32 v83, v4, v83
v_mfma_f32_16x16x32_bf16 v[156:159], a[220:223], a[8:11], v[156:159]
ds_read_b128 a[40:43], v145 offset:51200
v_mul_f32 v84, v4, v84
v_mfma_f32_16x16x32_bf16 v[156:159], a[212:215], a[12:15], v[156:159]
ds_read_b128 a[44:47], v145 offset:52224
v_mul_f32 v85, v4, v85
v_mfma_f32_16x16x32_bf16 v[156:159], a[204:207], a[32:35], v[156:159]
s_waitcnt lgkmcnt(7)
v_mul_f32 v86, v4, v86
v_mul_f32 v87, v4, v87
v_mfma_f32_16x16x32_bf16 v[156:159], a[228:231], a[0:3], v[156:159]
s_waitcnt lgkmcnt(6)
v_or3_b32 v160, v160, v161, v162
v_or_b32 v160, v160, v163
v_mfma_f32_16x16x32_bf16 v[156:159], a[236:239], a[4:7], v[156:159]
ds_read_b128 a[8:11], v145 offset:53248
v_cvt_pk_bf16_f32 v80, v80, v81
v_mfma_f32_16x16x32_bf16 v[156:159], a[244:247], a[36:39], v[156:159]
ds_read_b128 a[12:15], v145 offset:54272
v_cvt_pk_bf16_f32 v81, v82, v83
v_mfma_f32_16x16x32_bf16 v[152:155], a[248:251], a[36:39], v[152:155]
v_cmp_ne_u32 vcc, 0, v160
s_nop 0
s_cbranch_vccnz L_redo
v_mfma_f32_16x16x32_bf16 v[152:155], a[240:243], a[4:7], v[152:155]
buffer_store_dword v13, v5, s[28:31], 0 offen sc1
ds_read_b128 a[32:35], v145 offset:55296
v_mfma_f32_16x16x32_bf16 v[152:155], a[232:235], a[0:3], v[152:155]
s_waitcnt lgkmcnt(5)
v_cvt_pk_bf16_f32 v82, v84, v85
v_cvt_pk_bf16_f32 v83, v86, v87
v_mfma_f32_16x16x32_bf16 v[16:19], a[144:147], a[28:31], 0
buffer_store_dwordx4 v[80:83], v1, s[28:31], s52 offen sc1
ds_read_b128 a[36:39], v145 offset:56320
v_mul_f32 v88, v4, v88
v_mul_f32 v89, v4, v89
v_mfma_f32_16x16x32_bf16 v[16:19], a[152:155], a[24:27], v[16:19]
v_mul_f32 v90, v4, v90
v_mul_f32 v91, v4, v91
v_mfma_f32_16x16x32_bf16 v[16:19], a[160:163], a[20:23], v[16:19]
ds_read_b128 a[0:3], v145 offset:57344
v_mul_f32 v92, v4, v92
v_mfma_f32_16x16x32_bf16 v[16:19], a[168:171], a[16:19], v[16:19]
v_mul_f32 v93, v4, v93
v_mul_f32 v94, v4, v94
v_mfma_f32_16x16x32_bf16 v[20:23], a[164:167], a[16:19], 0
ds_read_b128 a[4:7], v145 offset:58368
v_mul_f32 v95, v4, v95
v_mfma_f32_16x16x32_bf16 v[20:23], a[156:159], a[20:23], v[20:23]
v_cvt_pk_bf16_f32 v88, v88, v89
v_cvt_pk_bf16_f32 v89, v90, v91
v_mfma_f32_16x16x32_bf16 v[20:23], a[148:151], a[24:27], v[20:23]
ds_read_b128 a[48:51], v145 offset:59392
v_cvt_pk_bf16_f32 v90, v92, v93
v_mfma_f32_16x16x32_bf16 v[20:23], a[140:143], a[28:31], v[20:23]
s_waitcnt lgkmcnt(4)
v_cvt_pk_bf16_f32 v91, v94, v95
v_mul_f32 v96, v4, v96
v_mfma_f32_16x16x32_bf16 v[20:23], a[172:175], a[40:43], v[20:23]
buffer_store_dwordx4 v[88:91], v1, s[28:31], s52 offen offset:1024 sc1
ds_read_b128 a[16:19], v145 offset:60416
v_mul_f32 v97, v4, v97
v_mul_f32 v98, v4, v98
v_mfma_f32_16x16x32_bf16 v[20:23], a[180:183], a[44:47], v[20:23]
v_mul_f32 v99, v4, v99
v_mul_f32 v100, v4, v100
v_mfma_f32_16x16x32_bf16 v[20:23], a[188:191], a[8:11], v[20:23]
ds_read_b128 a[20:23], v145 offset:61440
v_mul_f32 v101, v4, v101
v_mfma_f32_16x16x32_bf16 v[20:23], a[196:199], a[12:15], v[20:23]
v_mul_f32 v102, v4, v102
v_mul_f32 v103, v4, v103
v_mfma_f32_16x16x32_bf16 v[16:19], a[200:203], a[12:15], v[16:19]
ds_read_b128 a[24:27], v145 offset:62464
v_cvt_pk_bf16_f32 v96, v96, v97
v_mfma_f32_16x16x32_bf16 v[16:19], a[192:195], a[8:11], v[16:19]
v_cvt_pk_bf16_f32 v97, v98, v99
v_cvt_pk_bf16_f32 v98, v100, v101
v_mfma_f32_16x16x32_bf16 v[16:19], a[184:187], a[44:47], v[16:19]
ds_read_b128 a[28:31], v145 offset:63488
v_cvt_pk_bf16_f32 v99, v102, v103
v_mfma_f32_16x16x32_bf16 v[16:19], a[176:179], a[40:43], v[16:19]
buffer_store_dwordx4 v[96:99], v1, s[28:31], s52 offen offset:2048 sc1
v_mul_f32 v104, v4, v104
v_mul_f32 v105, v4, v105
v_mul_f32 v106, v4, v106
v_mfma_f32_16x16x32_bf16 v[16:19], a[208:211], a[32:35], v[16:19]
s_waitcnt lgkmcnt(4)
ds_read_b128 a[8:11], v145 offset:64512
v_mul_f32 v107, v4, v107
v_mfma_f32_16x16x32_bf16 v[16:19], a[216:219], a[36:39], v[16:19]
v_mul_f32 v108, v4, v108
v_mul_f32 v109, v4, v109
v_mfma_f32_16x16x32_bf16 v[16:19], a[224:227], a[0:3], v[16:19]
ds_read_b128 a[12:15], v146 offset:0
v_mul_f32 v110, v4, v110
v_mfma_f32_16x16x32_bf16 v[20:23], a[220:223], a[0:3], v[20:23]
v_mul_f32 v111, v4, v111
v_cvt_pk_bf16_f32 v104, v104, v105
v_mfma_f32_16x16x32_bf16 v[20:23], a[212:215], a[36:39], v[20:23]
ds_read_b128 a[40:43], v146 offset:1024
v_cvt_pk_bf16_f32 v105, v106, v107
v_mfma_f32_16x16x32_bf16 v[20:23], a[204:207], a[32:35], v[20:23]
v_cvt_pk_bf16_f32 v106, v108, v109
v_cvt_pk_bf16_f32 v107, v110, v111
v_mfma_f32_16x16x32_bf16 v[20:23], a[228:231], a[4:7], v[20:23]
buffer_store_dwordx4 v[104:107], v1, s[28:31], s52 offen offset:3072 sc1
ds_read_b128 a[0:3], v146 offset:2048
v_mul_f32 v112, v6, v112
v_mul_f32 v113, v6, v113
v_mfma_f32_16x16x32_bf16 v[20:23], a[236:239], a[48:51], v[20:23]
s_waitcnt lgkmcnt(4)
v_mul_f32 v114, v6, v114
v_mul_f32 v115, v6, v115
v_mfma_f32_16x16x32_bf16 v[20:23], a[244:247], a[16:19], v[20:23]
ds_read_b128 a[32:35], v146 offset:3072
v_mul_f32 v116, v6, v116
v_mfma_f32_16x16x32_bf16 v[16:19], a[248:251], a[16:19], v[16:19]
v_mul_f32 v117, v6, v117
v_mul_f32 v118, v6, v118
v_mfma_f32_16x16x32_bf16 v[16:19], a[240:243], a[48:51], v[16:19]
ds_read_b128 a[36:39], v146 offset:4096
v_mul_f32 v119, v6, v119
v_mfma_f32_16x16x32_bf16 v[16:19], a[232:235], a[4:7], v[16:19]
v_cvt_pk_bf16_f32 v112, v112, v113
v_cvt_pk_bf16_f32 v113, v114, v115
v_mfma_f32_16x16x32_bf16 v[24:27], a[144:147], a[20:23], 0
ds_read_b128 a[44:47], v146 offset:5120
v_cvt_pk_bf16_f32 v114, v116, v117
v_mfma_f32_16x16x32_bf16 v[24:27], a[152:155], a[24:27], v[24:27]
v_cvt_pk_bf16_f32 v115, v118, v119
v_mul_f32 v120, v6, v120
v_mfma_f32_16x16x32_bf16 v[24:27], a[160:163], a[28:31], v[24:27]
s_waitcnt lgkmcnt(4)
buffer_store_dwordx4 v[112:115], v1, s[28:31], s53 offen sc1
ds_read_b128 a[4:7], v146 offset:6144
v_mul_f32 v121, v6, v121
v_mul_f32 v122, v6, v122
v_mfma_f32_16x16x32_bf16 v[24:27], a[168:171], a[8:11], v[24:27]
v_mul_f32 v123, v6, v123
v_mul_f32 v124, v6, v124
v_mfma_f32_16x16x32_bf16 v[28:31], a[164:167], a[8:11], 0
ds_read_b128 a[16:19], v146 offset:7168
v_mul_f32 v125, v6, v125
v_mfma_f32_16x16x32_bf16 v[28:31], a[156:159], a[28:31], v[28:31]
s_barrier
v_mfma_f32_16x16x32_bf16 v[28:31], a[148:151], a[24:27], v[28:31]
ds_read_b128 a[48:51], v146 offset:8192
v_mul_f32 v126, v6, v126
v_mfma_f32_16x16x32_bf16 v[28:31], a[140:143], a[20:23], v[28:31]
v_mul_f32 v127, v6, v127
v_cvt_pk_bf16_f32 v120, v120, v121
v_mfma_f32_16x16x32_bf16 v[28:31], a[172:175], a[12:15], v[28:31]
ds_read_b128 a[8:11], v146 offset:9216
v_cvt_pk_bf16_f32 v121, v122, v123
v_mfma_f32_16x16x32_bf16 v[28:31], a[180:183], a[40:43], v[28:31]
s_waitcnt lgkmcnt(4)
v_cvt_pk_bf16_f32 v122, v124, v125
v_cvt_pk_bf16_f32 v123, v126, v127
v_mfma_f32_16x16x32_bf16 v[28:31], a[188:191], a[0:3], v[28:31]
buffer_store_dwordx4 v[120:123], v1, s[28:31], s53 offen offset:1024 sc1
ds_read_b128 a[20:23], v146 offset:10240
v_mul_f32 v128, v6, v128
v_mul_f32 v129, v6, v129
v_mfma_f32_16x16x32_bf16 v[28:31], a[196:199], a[32:35], v[28:31]
v_mul_f32 v130, v6, v130
v_mul_f32 v131, v6, v131
v_mfma_f32_16x16x32_bf16 v[24:27], a[200:203], a[32:35], v[24:27]
ds_read_b128 a[24:27], v146 offset:11264
v_mul_f32 v132, v6, v132
v_mfma_f32_16x16x32_bf16 v[24:27], a[192:195], a[0:3], v[24:27]
v_mul_f32 v133, v6, v133
v_mul_f32 v134, v6, v134
v_mfma_f32_16x16x32_bf16 v[24:27], a[184:187], a[40:43], v[24:27]
ds_read_b128 a[28:31], v146 offset:12288
v_mul_f32 v135, v6, v135
v_mfma_f32_16x16x32_bf16 v[24:27], a[176:179], a[12:15], v[24:27]
v_cvt_pk_bf16_f32 v128, v128, v129
v_cvt_pk_bf16_f32 v129, v130, v131
v_mfma_f32_16x16x32_bf16 v[24:27], a[208:211], a[36:39], v[24:27]
ds_read_b128 a[32:35], v146 offset:13312
v_cvt_pk_bf16_f32 v130, v132, v133
v_mfma_f32_16x16x32_bf16 v[24:27], a[216:219], a[44:47], v[24:27]
s_waitcnt lgkmcnt(4)
v_cvt_pk_bf16_f32 v131, v134, v135
v_mul_f32 v136, v6, v136
v_mfma_f32_16x16x32_bf16 v[24:27], a[224:227], a[4:7], v[24:27]
buffer_store_dwordx4 v[128:131], v1, s[28:31], s53 offen offset:2048 sc1
ds_read_b128 a[0:3], v146 offset:14336
v_mul_f32 v137, v6, v137
v_mul_f32 v138, v6, v138
v_mfma_f32_16x16x32_bf16 v[28:31], a[220:223], a[4:7], v[28:31]
v_mul_f32 v139, v6, v139
v_mul_f32 v140, v6, v140
v_mfma_f32_16x16x32_bf16 v[28:31], a[212:215], a[44:47], v[28:31]
buffer_load_dwordx4 a[12:15], v1, s[40:43], 0 offen offset:1024 sc1
ds_read_b128 a[40:43], v146 offset:15360
v_mfma_f32_16x16x32_bf16 v[28:31], a[204:207], a[36:39], v[28:31]
v_mul_f32 v141, v6, v141
v_mul_f32 v142, v6, v142
v_mfma_f32_16x16x32_bf16 v[28:31], a[228:231], a[16:19], v[28:31]
ds_read_b128 a[52:55], v146 offset:16384
v_mul_f32 v143, v6, v143
v_mfma_f32_16x16x32_bf16 v[28:31], a[236:239], a[48:51], v[28:31]
v_cvt_pk_bf16_f32 v136, v136, v137
v_cvt_pk_bf16_f32 v137, v138, v139
v_mfma_f32_16x16x32_bf16 v[28:31], a[244:247], a[8:11], v[28:31]
ds_read_b128 a[4:7], v146 offset:17408
v_cvt_pk_bf16_f32 v138, v140, v141
v_mfma_f32_16x16x32_bf16 v[24:27], a[248:251], a[8:11], v[24:27]
buffer_load_dwordx4 a[36:39], v1, s[40:43], 0 offen offset:2048 sc1
v_cvt_pk_bf16_f32 v139, v142, v143
v_mfma_f32_16x16x32_bf16 v[24:27], a[240:243], a[48:51], v[24:27]
buffer_store_dwordx4 v[136:139], v1, s[28:31], s53 offen offset:3072 sc1
ds_read_b128 a[44:47], v146 offset:18432
v_mfma_f32_16x16x32_bf16 v[24:27], a[232:235], a[16:19], v[24:27]
s_waitcnt lgkmcnt(4)
v_mfma_f32_16x16x32_bf16 v[32:35], a[144:147], a[20:23], 0
ds_read_b128 a[56:59], v146 offset:19456
v_mfma_f32_16x16x32_bf16 v[32:35], a[152:155], a[24:27], v[32:35]
buffer_load_dwordx4 a[8:11], v1, s[40:43], 0 offen offset:3072 sc1
v_mfma_f32_16x16x32_bf16 v[32:35], a[160:163], a[28:31], v[32:35]
s_add_u32 s94, s32, 16384
ds_read_b128 a[48:51], v146 offset:20480
v_mfma_f32_16x16x32_bf16 v[32:35], a[168:171], a[32:35], v[32:35]
s_add_u32 s40, s28, s94
s_addc_u32 s41, s29, 0
v_mfma_f32_16x16x32_bf16 v[36:39], a[164:167], a[32:35], 0
ds_read_b128 a[16:19], v146 offset:21504
v_mfma_f32_16x16x32_bf16 v[36:39], a[156:159], a[28:31], v[36:39]
buffer_load_dwordx4 a[60:63], v1, s[40:43], 0 offen sc1
v_mfma_f32_16x16x32_bf16 v[36:39], a[148:151], a[24:27], v[36:39]
buffer_load_dword v8, v148, s[28:31], s90 offen sc1
v_mfma_f32_16x16x32_bf16 v[36:39], a[140:143], a[20:23], v[36:39]
ds_read_b128 a[64:67], v146 offset:22528
v_mfma_f32_16x16x32_bf16 v[36:39], a[172:175], a[0:3], v[36:39]
s_waitcnt lgkmcnt(4)
ds_read_b128 a[68:71], v146 offset:23552
v_mfma_f32_16x16x32_bf16 v[36:39], a[180:183], a[40:43], v[36:39]
v_mfma_f32_16x16x32_bf16 v[36:39], a[188:191], a[52:55], v[36:39]
buffer_load_dwordx4 a[28:31], v1, s[40:43], 0 offen offset:1024 sc1
ds_read_b128 a[32:35], v146 offset:24576
v_mfma_f32_16x16x32_bf16 v[36:39], a[196:199], a[4:7], v[36:39]
v_mfma_f32_16x16x32_bf16 v[32:35], a[200:203], a[4:7], v[32:35]
ds_read_b128 a[20:23], v146 offset:25600
v_mfma_f32_16x16x32_bf16 v[32:35], a[192:195], a[52:55], v[32:35]
v_mfma_f32_16x16x32_bf16 v[32:35], a[184:187], a[40:43], v[32:35]
buffer_load_dwordx4 a[24:27], v1, s[40:43], 0 offen offset:2048 sc1
ds_read_b128 a[72:75], v146 offset:26624
v_mfma_f32_16x16x32_bf16 v[32:35], a[176:179], a[0:3], v[32:35]
v_mfma_f32_16x16x32_bf16 v[32:35], a[208:211], a[44:47], v[32:35]
s_waitcnt lgkmcnt(4)
ds_read_b128 a[76:79], v146 offset:27648
v_mfma_f32_16x16x32_bf16 v[32:35], a[216:219], a[56:59], v[32:35]
v_mfma_f32_16x16x32_bf16 v[32:35], a[224:227], a[48:51], v[32:35]
buffer_load_dwordx4 a[4:7], v1, s[40:43], 0 offen offset:3072 sc1
ds_read_b128 a[52:55], v146 offset:28672
v_mfma_f32_16x16x32_bf16 v[36:39], a[220:223], a[48:51], v[36:39]
s_add_u32 s94, s32, 20480
s_add_u32 s40, s28, s94
s_addc_u32 s41, s29, 0
v_mfma_f32_16x16x32_bf16 v[36:39], a[212:215], a[56:59], v[36:39]
ds_read_b128 a[0:3], v146 offset:29696
v_mfma_f32_16x16x32_bf16 v[36:39], a[204:207], a[44:47], v[36:39]
v_mfma_f32_16x16x32_bf16 v[36:39], a[228:231], a[16:19], v[36:39]
ds_read_b128 a[40:43], v146 offset:30720
v_mfma_f32_16x16x32_bf16 v[36:39], a[236:239], a[64:67], v[36:39]
s_waitcnt lgkmcnt(4)
buffer_load_dwordx4 a[80:83], v1, s[40:43], 0 offen sc1
v_mfma_f32_16x16x32_bf16 v[36:39], a[244:247], a[68:71], v[36:39]
ds_read_b128 a[48:51], v146 offset:31744
v_mfma_f32_16x16x32_bf16 v[32:35], a[248:251], a[68:71], v[32:35]
s_barrier
v_mfma_f32_16x16x32_bf16 v[32:35], a[240:243], a[64:67], v[32:35]
ds_read_b128 a[44:47], v144 offset:32768
v_mfma_f32_16x16x32_bf16 v[32:35], a[232:235], a[16:19], v[32:35]
buffer_load_dwordx4 a[56:59], v1, s[40:43], 0 offen offset:1024 sc1
v_mfma_f32_16x16x32_bf16 v[40:43], a[144:147], a[32:35], 0
ds_read_b128 a[84:87], v144 offset:33792
v_mfma_f32_16x16x32_bf16 v[40:43], a[152:155], a[20:23], v[40:43]
v_mfma_f32_16x16x32_bf16 v[40:43], a[160:163], a[72:75], v[40:43]
s_waitcnt lgkmcnt(4)
ds_read_b128 a[68:71], v144 offset:34816
v_mfma_f32_16x16x32_bf16 v[40:43], a[168:171], a[76:79], v[40:43]
buffer_load_dwordx4 a[64:67], v1, s[40:43], 0 offen offset:2048 sc1
v_mfma_f32_16x16x32_bf16 v[44:47], a[164:167], a[76:79], 0
ds_read_b128 a[16:19], v144 offset:35840
v_mfma_f32_16x16x32_bf16 v[44:47], a[156:159], a[72:75], v[44:47]
v_mfma_f32_16x16x32_bf16 v[44:47], a[148:151], a[20:23], v[44:47]
ds_read_b128 a[88:91], v144 offset:36864
v_mfma_f32_16x16x32_bf16 v[44:47], a[140:143], a[32:35], v[44:47]
v_mfma_f32_16x16x32_bf16 v[44:47], a[172:175], a[52:55], v[44:47]
buffer_load_dwordx4 a[92:95], v1, s[40:43], 0 offen offset:3072 sc1
ds_read_b128 a[96:99], v144 offset:37888
v_mfma_f32_16x16x32_bf16 v[44:47], a[180:183], a[0:3], v[44:47]
s_waitcnt vmcnt(10) lgkmcnt(4)
buffer_store_dword v13, v2, s[28:31], s65 offen sc1
v_mfma_f32_16x16x32_bf16 v[44:47], a[188:191], a[40:43], v[44:47]
s_add_u32 s94, s32, 24576
ds_read_b128 a[20:23], v144 offset:38912
v_mfma_f32_16x16x32_bf16 v[44:47], a[196:199], a[48:51], v[44:47]
s_add_u32 s40, s28, s94
s_addc_u32 s41, s29, 0
v_mfma_f32_16x16x32_bf16 v[40:43], a[200:203], a[48:51], v[40:43]
buffer_load_dwordx4 a[32:35], v1, s[40:43], 0 offen sc1
ds_read_b128 a[72:75], v144 offset:39936
v_mfma_f32_16x16x32_bf16 v[40:43], a[192:195], a[40:43], v[40:43]
v_mfma_f32_16x16x32_bf16 v[40:43], a[184:187], a[0:3], v[40:43]
ds_read_b128 a[76:79], v144 offset:40960
v_mfma_f32_16x16x32_bf16 v[40:43], a[176:179], a[52:55], v[40:43]
v_mfma_f32_16x16x32_bf16 v[40:43], a[208:211], a[44:47], v[40:43]
buffer_load_dwordx4 a[100:103], v1, s[40:43], 0 offen offset:1024 sc1
ds_read_b128 a[104:107], v144 offset:41984
v_mfma_f32_16x16x32_bf16 v[40:43], a[216:219], a[84:87], v[40:43]
s_waitcnt lgkmcnt(4)
v_mfma_f32_16x16x32_bf16 v[40:43], a[224:227], a[68:71], v[40:43]
s_waitcnt vmcnt(10)
v_cmp_gt_u32 vcc, 1, v8
s_nop 0
s_cbranch_vccnz L_spin9
L_back9:
v_mfma_f32_16x16x32_bf16 v[44:47], a[220:223], a[68:71], v[44:47]
s_add_u32 s90, s90, 16384
ds_read_b128 a[0:3], v144 offset:43008
v_mfma_f32_16x16x32_bf16 v[44:47], a[212:215], a[84:87], v[44:47]
ds_read_b128 a[40:43], v144 offset:44032
v_mfma_f32_16x16x32_bf16 v[44:47], a[204:207], a[44:47], v[44:47]
buffer_load_dwordx4 v1, s[36:39], 0 offen sc1 lds
v_mfma_f32_16x16x32_bf16 v[44:47], a[228:231], a[16:19], v[44:47]
ds_read_b128 a[48:51], v144 offset:45056
v_mfma_f32_16x16x32_bf16 v[44:47], a[236:239], a[88:91], v[44:47]
v_mfma_f32_16x16x32_bf16 v[44:47], a[244:247], a[96:99], v[44:47]
ds_read_b128 a[52:55], v144 offset:46080
v_mfma_f32_16x16x32_bf16 v[40:43], a[248:251], a[96:99], v[40:43]
buffer_load_dwordx4 v1, s[36:39], 0 offen offset:1024 sc1 lds
v_mfma_f32_16x16x32_bf16 v[40:43], a[240:243], a[88:91], v[40:43]
s_add_u32 m0, s83, 8192
s_add_u32 s80, s45, 33792
ds_read_b128 a[44:47], v144 offset:47104
v_mfma_f32_16x16x32_bf16 v[40:43], a[232:235], a[16:19], v[40:43]
s_waitcnt lgkmcnt(5)
s_add_u32 s36, s28, s80
s_addc_u32 s37, s29, 0
v_mfma_f32_16x16x32_bf16 v[48:51], a[144:147], a[20:23], 0
ds_read_b128 a[68:71], v144 offset:48128
v_mfma_f32_16x16x32_bf16 v[48:51], a[152:155], a[72:75], v[48:51]
buffer_load_dwordx4 v1, s[36:39], 0 offen sc1 lds
v_mfma_f32_16x16x32_bf16 v[48:51], a[160:163], a[76:79], v[48:51]
ds_read_b128 a[84:87], v144 offset:49152
v_mfma_f32_16x16x32_bf16 v[48:51], a[168:171], a[104:107], v[48:51]
v_mfma_f32_16x16x32_bf16 v[52:55], a[164:167], a[104:107], 0
ds_read_b128 a[16:19], v144 offset:50176
v_mfma_f32_16x16x32_bf16 v[52:55], a[156:159], a[76:79], v[52:55]
v_mfma_f32_16x16x32_bf16 v[52:55], a[148:151], a[72:75], v[52:55]
buffer_load_dwordx4 v1, s[36:39], 0 offen offset:1024 sc1 lds
ds_read_b128 a[88:91], v144 offset:51200
v_mfma_f32_16x16x32_bf16 v[52:55], a[140:143], a[20:23], v[52:55]
s_waitcnt lgkmcnt(4)
s_add_u32 m0, s83, 16384
s_add_u32 s80, s45, 67584
v_mfma_f32_16x16x32_bf16 v[52:55], a[172:175], a[0:3], v[52:55]
s_add_u32 s36, s28, s80
s_addc_u32 s37, s29, 0
ds_read_b128 a[96:99], v144 offset:52224
v_mfma_f32_16x16x32_bf16 v[52:55], a[180:183], a[40:43], v[52:55]
v_mfma_f32_16x16x32_bf16 v[52:55], a[188:191], a[48:51], v[52:55]
buffer_load_dwordx4 v1, s[36:39], 0 offen sc1 lds
ds_read_b128 a[72:75], v144 offset:53248
v_mfma_f32_16x16x32_bf16 v[52:55], a[196:199], a[52:55], v[52:55]
v_mfma_f32_16x16x32_bf16 v[48:51], a[200:203], a[52:55], v[48:51]
ds_read_b128 a[20:23], v144 offset:54272
v_mfma_f32_16x16x32_bf16 v[48:51], a[192:195], a[48:51], v[48:51]
v_mfma_f32_16x16x32_bf16 v[48:51], a[184:187], a[40:43], v[48:51]
buffer_load_dwordx4 v1, s[36:39], 0 offen offset:1024 sc1 lds
ds_read_b128 a[76:79], v144 offset:55296
v_mfma_f32_16x16x32_bf16 v[48:51], a[176:179], a[0:3], v[48:51]
s_add_u32 m0, s83, 24576
s_add_u32 s80, s45, 8192
v_mfma_f32_16x16x32_bf16 v[48:51], a[208:211], a[44:47], v[48:51]
s_waitcnt lgkmcnt(4)
ds_read_b128 a[52:55], v144 offset:56320
v_mfma_f32_16x16x32_bf16 v[48:51], a[216:219], a[68:71], v[48:51]
s_barrier
v_mfma_f32_16x16x32_bf16 v[48:51], a[224:227], a[84:87], v[48:51]
s_add_u32 s36, s28, s80
s_addc_u32 s37, s29, 0
ds_read_b128 a[40:43], v144 offset:57344
v_mfma_f32_16x16x32_bf16 v[52:55], a[220:223], a[84:87], v[52:55]
buffer_load_dwordx4 v1, s[36:39], 0 offen sc1 lds
v_mfma_f32_16x16x32_bf16 v[52:55], a[212:215], a[68:71], v[52:55]
ds_read_b128 a[0:3], v144 offset:58368
v_mfma_f32_16x16x32_bf16 v[52:55], a[204:207], a[44:47], v[52:55]
v_mfma_f32_16x16x32_bf16 v[52:55], a[228:231], a[16:19], v[52:55]
ds_read_b128 a[48:51], v144 offset:59392
v_mfma_f32_16x16x32_bf16 v[52:55], a[236:239], a[88:91], v[52:55]
s_waitcnt lgkmcnt(4)
buffer_load_dwordx4 v1, s[36:39], 0 offen offset:1024 sc1 lds
v_mfma_f32_16x16x32_bf16 v[52:55], a[244:247], a[96:99], v[52:55]
s_add_u32 m0, s83, 65536
s_add_u32 s80, s45, 41984
ds_read_b128 a[68:71], v144 offset:60416
v_mfma_f32_16x16x32_bf16 v[48:51], a[248:251], a[96:99], v[48:51]
s_add_u32 s36, s28, s80
s_addc_u32 s37, s29, 0
v_mfma_f32_16x16x32_bf16 v[48:51], a[240:243], a[88:91], v[48:51]
ds_read_b128 a[44:47], v144 offset:61440
v_mfma_f32_16x16x32_bf16 v[48:51], a[232:235], a[16:19], v[48:51]
buffer_load_dwordx4 v1, s[36:39], 0 offen sc1 lds
v_mfma_f32_16x16x32_bf16 v[56:59], a[144:147], a[72:75], 0
ds_read_b128 a[84:87], v144 offset:62464
v_mfma_f32_16x16x32_bf16 v[56:59], a[152:155], a[20:23], v[56:59]
v_mfma_f32_16x16x32_bf16 v[56:59], a[160:163], a[76:79], v[56:59]
s_waitcnt lgkmcnt(4)
ds_read_b128 a[96:99], v144 offset:63488
v_mfma_f32_16x16x32_bf16 v[56:59], a[168:171], a[52:55], v[56:59]
v_mfma_f32_16x16x32_bf16 v[60:63], a[164:167], a[52:55], 0
buffer_load_dwordx4 v1, s[36:39], 0 offen offset:1024 sc1 lds
ds_read_b128 a[16:19], v144 offset:64512
v_mfma_f32_16x16x32_bf16 v[60:63], a[156:159], a[76:79], v[60:63]
s_add_u32 m0, s83, 73728
s_add_u32 s80, s45, 75776
v_mfma_f32_16x16x32_bf16 v[60:63], a[148:151], a[20:23], v[60:63]
s_add_u32 s36, s28, s80
s_addc_u32 s37, s29, 0
ds_read_b128 a[88:91], v145 offset:16384
v_mfma_f32_16x16x32_bf16 v[60:63], a[140:143], a[72:75], v[60:63]
v_mfma_f32_16x16x32_bf16 v[60:63], a[172:175], a[40:43], v[60:63]
buffer_load_dwordx4 v1, s[36:39], 0 offen sc1 lds
ds_read_b128 a[52:55], v145 offset:17408
v_mfma_f32_16x16x32_bf16 v[60:63], a[180:183], a[0:3], v[60:63]
s_waitcnt lgkmcnt(4)
v_mfma_f32_16x16x32_bf16 v[60:63], a[188:191], a[48:51], v[60:63]
ds_read_b128 a[76:79], v145 offset:18432
v_mfma_f32_16x16x32_bf16 v[60:63], a[196:199], a[68:71], v[60:63]
v_mfma_f32_16x16x32_bf16 v[56:59], a[200:203], a[68:71], v[56:59]
buffer_load_dwordx4 v1, s[36:39], 0 offen offset:1024 sc1 lds
ds_read_b128 a[20:23], v145 offset:19456
v_mfma_f32_16x16x32_bf16 v[56:59], a[192:195], a[48:51], v[56:59]
s_add_u32 m0, s83, 98304
s_add_u32 s80, s45, 135168
v_mfma_f32_16x16x32_bf16 v[56:59], a[184:187], a[0:3], v[56:59]
s_add_u32 s36, s28, s80
s_addc_u32 s37, s29, 0
ds_read_b128 a[72:75], v145 offset:20480
v_mfma_f32_16x16x32_bf16 v[56:59], a[176:179], a[40:43], v[56:59]
v_mfma_f32_16x16x32_bf16 v[56:59], a[208:211], a[44:47], v[56:59]
ds_read_b128 a[68:71], v145 offset:21504
v_mfma_f32_16x16x32_bf16 v[56:59], a[216:219], a[84:87], v[56:59]
s_waitcnt lgkmcnt(4)
buffer_load_dwordx4 a[48:51], v1, s[40:43], 0 offen offset:2048 sc1
v_mfma_f32_16x16x32_bf16 v[56:59], a[224:227], a[96:99], v[56:59]
ds_read_b128 a[104:107], v145 offset:22528
v_mfma_f32_16x16x32_bf16 v[60:63], a[220:223], a[96:99], v[60:63]
v_mfma_f32_16x16x32_bf16 v[60:63], a[212:215], a[84:87], v[60:63]
L_pad16:
s_cbranch_execz L_padret0
ds_read_b128 a[0:3], v145 offset:23552
v_mfma_f32_16x16x32_bf16 v[60:63], a[204:207], a[44:47], v[60:63]
buffer_load_dwordx4 a[40:43], v1, s[40:43], 0 offen offset:3072 sc1
v_mfma_f32_16x16x32_bf16 v[60:63], a[228:231], a[16:19], v[60:63]
s_add_u32 s94, s32, 28672
ds_read_b128 a[108:111], v145 offset:24576
v_mfma_f32_16x16x32_bf16 v[60:63], a[236:239], a[88:91], v[60:63]
s_add_u32 s40, s28, s94
s_addc_u32 s41, s29, 0
v_mfma_f32_16x16x32_bf16 v[60:63], a[244:247], a[52:55], v[60:63]
ds_read_b128 a[96:99], v145 offset:25600
v_mfma_f32_16x16x32_bf16 v[56:59], a[248:251], a[52:55], v[56:59]
buffer_load_dwordx4 a[84:87], v1, s[40:43], 0 offen sc1
v_mfma_f32_16x16x32_bf16 v[56:59], a[240:243], a[88:91], v[56:59]
ds_read_b128 a[44:47], v145 offset:26624
v_mfma_f32_16x16x32_bf16 v[56:59], a[232:235], a[16:19], v[56:59]
s_waitcnt lgkmcnt(4)
buffer_load_dword v8, v148, s[28:31], s90 offen sc1
v_mfma_f32_16x16x32_bf16 v[64:67], a[144:147], a[76:79], 0
ds_read_b128 a[112:115], v145 offset:27648
v_mfma_f32_16x16x32_bf16 v[64:67], a[152:155], a[20:23], v[64:67]
v_mfma_f32_16x16x32_bf16 v[64:67], a[160:163], a[72:75], v[64:67]
buffer_load_dwordx4 a[52:55], v1, s[40:43], 0 offen offset:1024 sc1
ds_read_b128 a[116:119], v145 offset:28672
v_mfma_f32_16x16x32_bf16 v[64:67], a[168:171], a[68:71], v[64:67]
v_mfma_f32_16x16x32_bf16 v[68:71], a[164:167], a[68:71], 0
ds_read_b128 a[16:19], v145 offset:29696
v_mfma_f32_16x16x32_bf16 v[68:71], a[156:159], a[72:75], v[68:71]
v_mfma_f32_16x16x32_bf16 v[68:71], a[148:151], a[20:23], v[68:71]
buffer_load_dwordx4 a[88:91], v1, s[40:43], 0 offen offset:2048 sc1
ds_read_b128 a[120:123], v145 offset:30720
v_mfma_f32_16x16x32_bf16 v[68:71], a[140:143], a[76:79], v[68:71]
v_mfma_f32_16x16x32_bf16 v[68:71], a[172:175], a[104:107], v[68:71]
s_waitcnt vmcnt(12) lgkmcnt(4)
ds_read_b128 a[124:127], v145 offset:31744
v_mfma_f32_16x16x32_bf16 v[68:71], a[180:183], a[0:3], v[68:71]
s_barrier
v_mfma_f32_16x16x32_bf16 v[68:71], a[188:191], a[108:111], v[68:71]
buffer_load_dwordx4 a[68:71], v1, s[40:43], 0 offen offset:3072 sc1
ds_read_b128 a[20:23], v144 offset:0
v_mfma_f32_16x16x32_bf16 v[68:71], a[196:199], a[96:99], v[68:71]
s_add_u32 s94, s89, 0
s_add_u32 s40, s28, s94
s_addc_u32 s41, s29, 0
v_mfma_f32_16x16x32_bf16 v[64:67], a[200:203], a[96:99], v[64:67]
ds_read_b128 a[72:75], v144 offset:1024
v_mfma_f32_16x16x32_bf16 v[64:67], a[192:195], a[108:111], v[64:67]
v_mfma_f32_16x16x32_bf16 v[64:67], a[184:187], a[0:3], v[64:67]
ds_read_b128 a[76:79], v144 offset:2048
v_mfma_f32_16x16x32_bf16 v[64:67], a[176:179], a[104:107], v[64:67]
buffer_load_dwordx4 v[72:75], v150, s[40:43], 0 offen offset:32 sc1
v_mfma_f32_16x16x32_bf16 v[64:67], a[208:211], a[44:47], v[64:67]
s_waitcnt lgkmcnt(4)
ds_read_b128 a[128:131], v144 offset:3072
v_mfma_f32_16x16x32_bf16 v[64:67], a[216:219], a[112:115], v[64:67]
v_mfma_f32_16x16x32_bf16 v[64:67], a[224:227], a[116:119], v[64:67]
ds_read_b128 a[96:99], v144 offset:4096
v_mfma_f32_16x16x32_bf16 v[68:71], a[220:223], a[116:119], v[68:71]
buffer_load_dwordx4 v[76:79], v150, s[40:43], 0 offen sc1
v_mfma_f32_16x16x32_bf16 v[68:71], a[212:215], a[112:115], v[68:71]
s_add_u32 s94, s32, 32768
ds_read_b128 a[0:3], v144 offset:5120
v_mfma_f32_16x16x32_bf16 v[68:71], a[204:207], a[44:47], v[68:71]
s_add_u32 s40, s28, s94
s_addc_u32 s41, s29, 0
v_mfma_f32_16x16x32_bf16 v[68:71], a[228:231], a[16:19], v[68:71]
ds_read_b128 a[104:107], v144 offset:6144
v_mfma_f32_16x16x32_bf16 v[68:71], a[236:239], a[120:123], v[68:71]
s_waitcnt lgkmcnt(4)
buffer_load_dwordx4 a[108:111], v1, s[40:43], 0 offen sc1
v_mfma_f32_16x16x32_bf16 v[68:71], a[244:247], a[124:127], v[68:71]
ds_read_b128 a[112:115], v144 offset:7168
v_mfma_f32_16x16x32_bf16 v[64:67], a[248:251], a[124:127], v[64:67]
v_mfma_f32_16x16x32_bf16 v[64:67], a[240:243], a[120:123], v[64:67]
ds_read_b128 a[44:47], v144 offset:8192
v_mfma_f32_16x16x32_bf16 v[64:67], a[232:235], a[16:19], v[64:67]
v_mfma_f32_16x16x32_bf16 v[80:83], v[172:175], a[20:23], 0
buffer_load_dwordx4 a[116:119], v1, s[40:43], 0 offen offset:1024 sc1
ds_read_b128 a[132:135], v144 offset:9216
v_mfma_f32_16x16x32_bf16 v[80:83], v[180:183], a[72:75], v[80:83]
v_mfma_f32_16x16x32_bf16 v[80:83], v[188:191], a[76:79], v[80:83]
s_waitcnt lgkmcnt(4)
ds_read_b128 a[136:139], v144 offset:10240
v_mfma_f32_16x16x32_bf16 v[80:83], v[196:199], a[128:131], v[80:83]
v_mfma_f32_16x16x32_bf16 v[84:87], v[192:195], a[128:131], 0
buffer_load_dwordx4 a[120:123], v1, s[40:43], 0 offen offset:2048 sc1
ds_read_b128 a[16:19], v144 offset:11264
v_mfma_f32_16x16x32_bf16 v[84:87], v[184:187], a[76:79], v[84:87]
v_mfma_f32_16x16x32_bf16 v[84:87], v[176:179], a[72:75], v[84:87]
ds_read_b128 a[124:127], v144 offset:12288
v_mfma_f32_16x16x32_bf16 v[84:87], v[168:171], a[20:23], v[84:87]
v_mfma_f32_16x16x32_bf16 v[84:87], v[200:203], a[96:99], v[84:87]
buffer_load_dwordx4 a[140:143], v1, s[40:43], 0 offen offset:3072 sc1
ds_read_b128 a[144:147], v144 offset:13312
v_mfma_f32_16x16x32_bf16 v[84:87], v[240:243], a[0:3], v[84:87]
s_waitcnt lgkmcnt(4)
s_add_u32 s94, s32, 36864
v_mfma_f32_16x16x32_bf16 v[84:87], v[252:255], a[104:107], v[84:87]
s_add_u32 s40, s28, s94
s_addc_u32 s41, s29, 0
ds_read_b128 a[72:75], v144 offset:14336
v_mfma_f32_16x16x32_bf16 v[84:87], a[36:39], a[112:115], v[84:87]
s_waitcnt vmcnt(9)
v_cmp_gt_u32 vcc, 1, v8
s_nop 0
s_cbranch_vccnz L_spin10
L_back10:
v_mfma_f32_16x16x32_bf16 v[80:83], a[8:11], a[112:115], v[80:83]
s_mov_b32 s6, 0x00003f80
s_mov_b32 s7, 0x3f800000
ds_read_b128 a[20:23], v144 offset:15360
v_mfma_f32_16x16x32_bf16 v[80:83], a[12:15], a[104:107], v[80:83]
buffer_load_dwordx4 v1, s[36:39], 0 offen sc1 lds
v_mfma_f32_16x16x32_bf16 v[80:83], v[248:251], a[0:3], v[80:83]
ds_read_b128 a[76:79], v144 offset:16384
v_mfma_f32_16x16x32_bf16 v[80:83], v[204:207], a[96:99], v[80:83]
v_mfma_f32_16x16x32_bf16 v[88:91], v[172:175], a[44:47], 0
ds_read_b128 a[128:131], v144 offset:17408
v_mfma_f32_16x16x32_bf16 v[88:91], v[180:183], a[132:135], v[88:91]
s_waitcnt lgkmcnt(4)
buffer_load_dwordx4 v1, s[36:39], 0 offen offset:1024 sc1 lds
v_mfma_f32_16x16x32_bf16 v[88:91], v[188:191], a[136:139], v[88:91]
s_add_u32 m0, s83, 106496
s_add_u32 s80, s45, 168960
ds_read_b128 a[0:3], v144 offset:18432
v_mfma_f32_16x16x32_bf16 v[88:91], v[196:199], a[16:19], v[88:91]
s_add_u32 s36, s28, s80
s_addc_u32 s37, s29, 0
v_mfma_f32_16x16x32_bf16 v[92:95], v[192:195], a[16:19], 0
ds_read_b128 a[96:99], v144 offset:19456
v_mfma_f32_16x16x32_bf16 v[92:95], v[184:187], a[136:139], v[92:95]
buffer_load_dwordx4 v1, s[36:39], 0 offen sc1 lds
v_mfma_f32_16x16x32_bf16 v[92:95], v[176:179], a[132:135], v[92:95]
ds_read_b128 a[104:107], v144 offset:20480
v_mfma_f32_16x16x32_bf16 v[92:95], v[168:171], a[44:47], v[92:95]
v_mfma_f32_16x16x32_bf16 v[92:95], v[200:203], a[124:127], v[92:95]
ds_read_b128 a[112:115], v144 offset:21504
v_mfma_f32_16x16x32_bf16 v[92:95], v[240:243], a[144:147], v[92:95]
s_waitcnt lgkmcnt(4)
v_mfma_f32_16x16x32_bf16 v[92:95], v[252:255], a[72:75], v[92:95]
buffer_load_dwordx4 v1, s[36:39], 0 offen offset:1024 sc1 lds
ds_read_b128 a[16:19], v144 offset:22528
v_mfma_f32_16x16x32_bf16 v[92:95], a[36:39], a[20:23], v[92:95]
s_add_u32 m0, s83, 114688
s_add_u32 s80, s45, 202752
v_mfma_f32_16x16x32_bf16 v[88:91], a[8:11], a[20:23], v[88:91]
s_add_u32 s36, s28, s80
s_addc_u32 s37, s29, 0
ds_read_b128 a[44:47], v144 offset:23552
v_mfma_f32_16x16x32_bf16 v[88:91], a[12:15], a[72:75], v[88:91]
s_barrier
v_mfma_f32_16x16x32_bf16 v[88:91], v[248:251], a[144:147], v[88:91]
buffer_load_dwordx4 v1, s[36:39], 0 offen sc1 lds
ds_read_b128 a[132:135], v144 offset:24576
v_mfma_f32_16x16x32_bf16 v[88:91], v[204:207], a[124:127], v[88:91]
s_waitcnt vmcnt(9)
v_min3_u32 v96, v72, v73, v74
v_min3_u32 v96, v96, v75, v76
v_mfma_f32_16x16x32_bf16 v[100:103], v[172:175], a[76:79], 0
ds_read_b128 a[20:23], v144 offset:25600
v_min3_u32 v96, v96, v77, v78
v_mfma_f32_16x16x32_bf16 v[100:103], v[180:183], a[128:131], v[100:103]
s_waitcnt lgkmcnt(4)
v_min3_u32 v96, v96, v79, v76
v_mfma_f32_16x16x32_bf16 v[100:103], v[188:191], a[0:3], v[100:103]
buffer_load_dwordx4 v1, s[36:39], 0 offen offset:1024 sc1 lds
ds_read_b128 a[72:75], v144 offset:26624
v_mfma_f32_16x16x32_bf16 v[100:103], v[196:199], a[96:99], v[100:103]
s_add_u32 m0, s83, 122880
s_add_u32 s80, s45, 143360
v_mfma_f32_16x16x32_bf16 v[104:107], v[192:195], a[96:99], 0
s_add_u32 s36, s28, s80
s_addc_u32 s37, s29, 0
ds_read_b128 a[124:127], v144 offset:27648
v_mfma_f32_16x16x32_bf16 v[104:107], v[184:187], a[0:3], v[104:107]
v_mfma_f32_16x16x32_bf16 v[104:107], v[176:179], a[128:131], v[104:107]
ds_read_b128 a[136:139], v144 offset:28672
v_mfma_f32_16x16x32_bf16 v[104:107], v[168:171], a[76:79], v[104:107]
buffer_load_dwordx4 v1, s[36:39], 0 offen sc1 lds
v_mfma_f32_16x16x32_bf16 v[104:107], v[200:203], a[104:107], v[104:107]
ds_read_b128 a[144:147], v144 offset:29696
v_mfma_f32_16x16x32_bf16 v[104:107], v[240:243], a[112:115], v[104:107]
s_waitcnt lgkmcnt(4)
v_mfma_f32_16x16x32_bf16 v[104:107], v[252:255], a[16:19], v[104:107]
ds_read_b128 a[96:99], v144 offset:30720
v_mfma_f32_16x16x32_bf16 v[104:107], a[36:39], a[44:47], v[104:107]
buffer_load_dwordx4 v1, s[36:39], 0 offen offset:1024 sc1 lds
v_mfma_f32_16x16x32_bf16 v[100:103], a[8:11], a[44:47], v[100:103]
s_add_u32 m0, s83, 131072
s_add_u32 s80, s45, 177152
ds_read_b128 a[0:3], v144 offset:31744
v_mfma_f32_16x16x32_bf16 v[100:103], a[12:15], a[16:19], v[100:103]
s_add_u32 s36, s28, s80
s_addc_u32 s37, s29, 0
v_mfma_f32_16x16x32_bf16 v[100:103], v[248:251], a[112:115], v[100:103]
ds_read_b128 a[76:79], v145 offset:0
v_mfma_f32_16x16x32_bf16 v[100:103], v[204:207], a[104:107], v[100:103]
buffer_load_dwordx4 v1, s[36:39], 0 offen sc1 lds
v_mfma_f32_16x16x32_bf16 v[80:83], a[28:31], a[132:135], v[80:83]
ds_read_b128 a[44:47], v145 offset:1024
v_mfma_f32_16x16x32_bf16 v[80:83], a[4:7], a[20:23], v[80:83]
s_waitcnt lgkmcnt(4)
v_mfma_f32_16x16x32_bf16 v[80:83], a[56:59], a[72:75], v[80:83]
ds_read_b128 a[16:19], v145 offset:2048
v_mfma_f32_16x16x32_bf16 v[80:83], a[92:95], a[124:127], v[80:83]
v_mfma_f32_16x16x32_bf16 v[84:87], a[64:67], a[124:127], v[84:87]
buffer_load_dwordx4 v1, s[36:39], 0 offen offset:1024 sc1 lds
ds_read_b128 a[104:107], v145 offset:3072
v_mfma_f32_16x16x32_bf16 v[84:87], a[80:83], a[72:75], v[84:87]
s_add_u32 m0, s83, 139264
s_add_u32 s80, s45, 210944
v_mfma_f32_16x16x32_bf16 v[84:87], a[24:27], a[20:23], v[84:87]
s_add_u32 s36, s28, s80
s_addc_u32 s37, s29, 0
ds_read_b128 a[112:115], v145 offset:4096
v_mfma_f32_16x16x32_bf16 v[84:87], a[60:63], a[132:135], v[84:87]
v_mfma_f32_16x16x32_bf16 v[84:87], a[32:35], a[136:139], v[84:87]
buffer_load_dwordx4 v1, s[36:39], 0 offen sc1 lds
ds_read_b128 a[124:127], v145 offset:5120
v_mfma_f32_16x16x32_bf16 v[84:87], a[48:51], a[144:147], v[84:87]
s_waitcnt lgkmcnt(4)
v_mfma_f32_16x16x32_bf16 v[84:87], a[84:87], a[96:99], v[84:87]
ds_read_b128 a[72:75], v145 offset:6144
v_mfma_f32_16x16x32_bf16 v[84:87], a[88:91], a[0:3], v[84:87]
v_mfma_f32_16x16x32_bf16 v[80:83], a[68:71], a[0:3], v[80:83]
buffer_load_dwordx4 v1, s[36:39], 0 offen offset:1024 sc1 lds
ds_read_b128 a[20:23], v145 offset:7168
v_mfma_f32_16x16x32_bf16 v[80:83], a[52:55], a[96:99], v[80:83]
s_add_u32 m0, s83, 147456
s_add_u32 s80, s45, 16384
v_mfma_f32_16x16x32_bf16 v[80:83], a[40:43], a[144:147], v[80:83]
s_add_u32 s36, s28, s80
s_addc_u32 s37, s29, 0
ds_read_b128 a[128:131], v145 offset:8192
v_mfma_f32_16x16x32_bf16 v[80:83], a[100:103], a[136:139], v[80:83]
v_mfma_f32_16x16x32_bf16 v[88:91], a[28:31], a[76:79], v[88:91]
ds_read_b128 a[0:3], v145 offset:9216
v_mfma_f32_16x16x32_bf16 v[88:91], a[4:7], a[44:47], v[88:91]
s_waitcnt lgkmcnt(4)
buffer_load_dwordx4 v1, s[36:39], 0 offen sc1 lds
v_mfma_f32_16x16x32_bf16 v[88:91], a[56:59], a[16:19], v[88:91]
ds_read_b128 a[96:99], v145 offset:10240
v_mfma_f32_16x16x32_bf16 v[88:91], a[92:95], a[104:107], v[88:91]
v_mfma_f32_16x16x32_bf16 v[92:95], a[64:67], a[104:107], v[92:95]
ds_read_b128 a[132:135], v145 offset:11264
v_mfma_f32_16x16x32_bf16 v[92:95], a[80:83], a[16:19], v[92:95]
buffer_load_dwordx4 v1, s[36:39], 0 offen offset:1024 sc1 lds
v_mfma_f32_16x16x32_bf16 v[92:95], a[24:27], a[44:47], v[92:95]
s_add_u32 m0, s83, 155648
s_add_u32 s80, s45, 50176
ds_read_b128 a[136:139], v145 offset:12288
v_mfma_f32_16x16x32_bf16 v[92:95], a[60:63], a[76:79], v[92:95]
s_add_u32 s36, s28, s80
s_addc_u32 s37, s29, 0
v_mfma_f32_16x16x32_bf16 v[92:95], a[32:35], a[112:115], v[92:95]
ds_read_b128 a[104:107], v145 offset:13312
v_mfma_f32_16x16x32_bf16 v[92:95], a[48:51], a[124:127], v[92:95]
s_waitcnt lgkmcnt(4)
buffer_load_dwordx4 v1, s[36:39], 0 offen sc1 lds
v_mfma_f32_16x16x32_bf16 v[92:95], a[84:87], a[72:75], v[92:95]
ds_read_b128 a[16:19], v145 offset:14336
v_mfma_f32_16x16x32_bf16 v[92:95], a[88:91], a[20:23], v[92:95]
v_mfma_f32_16x16x32_bf16 v[88:91], a[68:71], a[20:23], v[88:91]
s_waitcnt vmcnt(9)
ds_read_b128 a[44:47], v145 offset:15360
v_mfma_f32_16x16x32_bf16 v[88:91], a[52:55], a[72:75], v[88:91]
s_barrier
v_mfma_f32_16x16x32_bf16 v[88:91], a[40:43], a[124:127], v[88:91]
buffer_load_dwordx4 v1, s[36:39], 0 offen offset:1024 sc1 lds
ds_read_b128 a[76:79], v145 offset:32768
v_mfma_f32_16x16x32_bf16 v[88:91], a[100:103], a[112:115], v[88:91]
s_add_u32 m0, s83, 32768
s_add_u32 s80, s45, 83968
v_mfma_f32_16x16x32_bf16 v[100:103], a[28:31], a[128:131], v[100:103]
s_add_u32 s36, s28, s80
s_addc_u32 s37, s29, 0
ds_read_b128 a[20:23], v145 offset:33792
v_mfma_f32_16x16x32_bf16 v[100:103], a[4:7], a[0:3], v[100:103]
s_waitcnt lgkmcnt(4)
v_mfma_f32_16x16x32_bf16 v[100:103], a[56:59], a[96:99], v[100:103]
buffer_load_dwordx4 v1, s[36:39], 0 offen sc1 lds
ds_read_b128 a[72:75], v145 offset:34816
v_mfma_f32_16x16x32_bf16 v[100:103], a[92:95], a[132:135], v[100:103]
v_mfma_f32_16x16x32_bf16 v[104:107], a[64:67], a[132:135], v[104:107]
ds_read_b128 a[112:115], v145 offset:35840
v_mfma_f32_16x16x32_bf16 v[104:107], a[80:83], a[96:99], v[104:107]
v_mfma_f32_16x16x32_bf16 v[104:107], a[24:27], a[0:3], v[104:107]
buffer_load_dwordx4 v1, s[36:39], 0 offen offset:1024 sc1 lds
ds_read_b128 a[124:127], v145 offset:36864
v_mfma_f32_16x16x32_bf16 v[104:107], a[60:63], a[128:131], v[104:107]
s_add_u32 m0, s83, 40960
s_add_u32 s80, s45, 151552
v_mfma_f32_16x16x32_bf16 v[104:107], a[32:35], a[136:139], v[104:107]
s_add_u32 s36, s28, s80
s_addc_u32 s37, s29, 0
ds_read_b128 a[132:135], v145 offset:37888
v_mfma_f32_16x16x32_bf16 v[104:107], a[48:51], a[104:107], v[104:107]
s_waitcnt lgkmcnt(4)
v_mfma_f32_16x16x32_bf16 v[104:107], a[84:87], a[16:19], v[104:107]
ds_read_b128 a[0:3], v145 offset:38912
v_mfma_f32_16x16x32_bf16 v[104:107], a[88:91], a[44:47], v[104:107]
buffer_load_dwordx4 a[96:99], v1, s[40:43], 0 offen sc1
v_mfma_f32_16x16x32_bf16 v[100:103], a[68:71], a[44:47], v[100:103]
ds_read_b128 a[128:131], v145 offset:39936
v_mfma_f32_16x16x32_bf16 v[100:103], a[52:55], a[16:19], v[100:103]
v_mfma_f32_16x16x32_bf16 v[100:103], a[40:43], a[104:107], v[100:103]
ds_read_b128 a[144:147], v145 offset:40960
v_mfma_f32_16x16x32_bf16 v[100:103], a[100:103], a[136:139], v[100:103]
buffer_load_dwordx4 a[148:151], v1, s[40:43], 0 offen offset:1024 sc1
v_mfma_f32_16x16x32_bf16 v[108:111], v[172:175], a[76:79], 0
ds_read_b128 a[152:155], v145 offset:41984
v_mfma_f32_16x16x32_bf16 v[108:111], v[180:183], a[20:23], v[108:111]
s_waitcnt lgkmcnt(4)
v_mfma_f32_16x16x32_bf16 v[108:111], v[188:191], a[72:75], v[108:111]
ds_read_b128 a[44:47], v145 offset:43008
v_mfma_f32_16x16x32_bf16 v[108:111], v[196:199], a[112:115], v[108:111]
buffer_load_dwordx4 a[16:19], v1, s[40:43], 0 offen offset:2048 sc1
v_mfma_f32_16x16x32_bf16 v[112:115], v[192:195], a[112:115], 0
ds_read_b128 a[104:107], v145 offset:44032
v_mfma_f32_16x16x32_bf16 v[112:115], v[184:187], a[72:75], v[112:115]
v_mfma_f32_16x16x32_bf16 v[112:115], v[176:179], a[20:23], v[112:115]
ds_read_b128 a[136:139], v145 offset:45056
v_mfma_f32_16x16x32_bf16 v[112:115], v[168:171], a[76:79], v[112:115]
v_mfma_f32_16x16x32_bf16 v[112:115], v[200:203], a[124:127], v[112:115]
buffer_load_dwordx4 a[156:159], v1, s[40:43], 0 offen offset:3072 sc1
ds_read_b128 a[160:163], v145 offset:46080
v_mfma_f32_16x16x32_bf16 v[112:115], v[240:243], a[132:135], v[112:115]
s_waitcnt lgkmcnt(4)
s_add_u32 s94, s32, 40960
v_mfma_f32_16x16x32_bf16 v[112:115], v[252:255], a[0:3], v[112:115]
s_add_u32 s40, s28, s94
s_addc_u32 s41, s29, 0
ds_read_b128 a[20:23], v145 offset:47104
v_mfma_f32_16x16x32_bf16 v[112:115], a[36:39], a[128:131], v[112:115]
v_mfma_f32_16x16x32_bf16 v[108:111], a[8:11], a[128:131], v[108:111]
buffer_load_dwordx4 a[72:75], v1, s[40:43], 0 offen sc1
ds_read_b128 a[76:79], v145 offset:48128
v_mfma_f32_16x16x32_bf16 v[108:111], a[12:15], a[0:3], v[108:111]
v_mfma_f32_16x16x32_bf16 v[108:111], v[248:251], a[132:135], v[108:111]
ds_read_b128 a[112:115], v145 offset:49152
v_mfma_f32_16x16x32_bf16 v[108:111], v[204:207], a[124:127], v[108:111]
v_mfma_f32_16x16x32_bf16 v[116:119], v[172:175], a[144:147], 0
buffer_load_dwordx4 a[164:167], v1, s[40:43], 0 offen offset:1024 sc1
ds_read_b128 a[168:171], v145 offset:50176
v_mfma_f32_16x16x32_bf16 v[116:119], v[180:183], a[152:155], v[116:119]
s_waitcnt lgkmcnt(4)
v_mfma_f32_16x16x32_bf16 v[116:119], v[188:191], a[44:47], v[116:119]
ds_read_b128 a[128:131], v145 offset:51200
v_mfma_f32_16x16x32_bf16 v[116:119], v[196:199], a[104:107], v[116:119]
v_mfma_f32_16x16x32_bf16 v[120:123], v[192:195], a[104:107], 0
ds_read_b128 a[0:3], v145 offset:52224
v_mfma_f32_16x16x32_bf16 v[120:123], v[184:187], a[44:47], v[120:123]
buffer_load_dwordx4 a[124:127], v1, s[40:43], 0 offen offset:2048 sc1
v_mfma_f32_16x16x32_bf16 v[120:123], v[176:179], a[152:155], v[120:123]
ds_read_b128 a[132:135], v145 offset:53248
v_mfma_f32_16x16x32_bf16 v[120:123], v[168:171], a[144:147], v[120:123]
v_mfma_f32_16x16x32_bf16 v[120:123], v[200:203], a[136:139], v[120:123]
ds_read_b128 a[172:175], v145 offset:54272
v_mfma_f32_16x16x32_bf16 v[120:123], v[240:243], a[160:163], v[120:123]
s_waitcnt lgkmcnt(4)
buffer_load_dwordx4 a[104:107], v1, s[40:43], 0 offen offset:3072 sc1
v_mfma_f32_16x16x32_bf16 v[120:123], v[252:255], a[20:23], v[120:123]
s_add_u32 s94, s32, 45056
ds_read_b128 a[44:47], v145 offset:55296
v_mfma_f32_16x16x32_bf16 v[120:123], a[36:39], a[76:79], v[120:123]
s_add_u32 s40, s28, s94
s_addc_u32 s41, s29, 0
v_mfma_f32_16x16x32_bf16 v[116:119], a[8:11], a[76:79], v[116:119]
s_waitcnt vmcnt(14)
ds_read_b128 a[144:147], v145 offset:56320
v_mfma_f32_16x16x32_bf16 v[116:119], a[12:15], a[20:23], v[116:119]
s_barrier
v_mfma_f32_16x16x32_bf16 v[116:119], v[248:251], a[160:163], v[116:119]
buffer_load_dwordx4 a[152:155], v1, s[40:43], 0 offen sc1
ds_read_b128 a[176:179], v145 offset:57344
v_mfma_f32_16x16x32_bf16 v[116:119], v[204:207], a[136:139], v[116:119]
v_mfma_f32_16x16x32_bf16 v[124:127], v[172:175], a[112:115], 0
ds_read_b128 a[180:183], v145 offset:58368
v_mfma_f32_16x16x32_bf16 v[124:127], v[180:183], a[168:171], v[124:127]
s_waitcnt lgkmcnt(4)
v_mfma_f32_16x16x32_bf16 v[124:127], v[188:191], a[128:131], v[124:127]
ds_read_b128 a[20:23], v145 offset:59392
v_mfma_f32_16x16x32_bf16 v[124:127], v[196:199], a[0:3], v[124:127]
buffer_load_dwordx4 a[76:79], v1, s[40:43], 0 offen offset:1024 sc1
v_mfma_f32_16x16x32_bf16 v[128:131], v[192:195], a[0:3], 0
ds_read_b128 a[160:163], v145 offset:60416
v_mfma_f32_16x16x32_bf16 v[128:131], v[184:187], a[128:131], v[128:131]
v_mfma_f32_16x16x32_bf16 v[128:131], v[176:179], a[168:171], v[128:131]
ds_read_b128 a[136:139], v145 offset:61440
v_mfma_f32_16x16x32_bf16 v[128:131], v[168:171], a[112:115], v[128:131]
buffer_load_dwordx4 a[184:187], v1, s[40:43], 0 offen offset:2048 sc1
v_mfma_f32_16x16x32_bf16 v[128:131], v[200:203], a[132:135], v[128:131]
ds_read_b128 a[188:191], v145 offset:62464
v_mfma_f32_16x16x32_bf16 v[128:131], v[240:243], a[172:175], v[128:131]
s_waitcnt lgkmcnt(4)
v_mfma_f32_16x16x32_bf16 v[128:131], v[252:255], a[44:47], v[128:131]
ds_read_b128 a[0:3], v145 offset:63488
v_mfma_f32_16x16x32_bf16 v[128:131], a[36:39], a[144:147], v[128:131]
buffer_load_dwordx4 a[128:131], v1, s[40:43], 0 offen offset:3072 sc1
v_mfma_f32_16x16x32_bf16 v[124:127], a[8:11], a[144:147], v[124:127]
s_add_u32 s94, s32, 49152
ds_read_b128 a[112:115], v145 offset:64512
v_mfma_f32_16x16x32_bf16 v[124:127], a[12:15], a[44:47], v[124:127]
s_add_u32 s40, s28, s94
s_addc_u32 s41, s29, 0
v_mfma_f32_16x16x32_bf16 v[124:127], v[248:251], a[172:175], v[124:127]
ds_read_b128 a[168:171], v146 offset:0
v_mfma_f32_16x16x32_bf16 v[124:127], v[204:207], a[132:135], v[124:127]
v_mfma_f32_16x16x32_bf16 v[108:111], a[28:31], a[176:179], v[108:111]
buffer_load_dwordx4 v1, s[36:39], 0 offen sc1 lds
ds_read_b128 a[192:195], v146 offset:1024
v_mfma_f32_16x16x32_bf16 v[108:111], a[4:7], a[180:183], v[108:111]
s_waitcnt lgkmcnt(4)
v_mfma_f32_16x16x32_bf16 v[108:111], a[56:59], a[20:23], v[108:111]
ds_read_b128 a[44:47], v146 offset:2048
v_mfma_f32_16x16x32_bf16 v[108:111], a[92:95], a[160:163], v[108:111]
v_mfma_f32_16x16x32_bf16 v[112:115], a[64:67], a[160:163], v[112:115]
buffer_load_dwordx4 v1, s[36:39], 0 offen offset:1024 sc1 lds
ds_read_b128 a[132:135], v146 offset:3072
v_mfma_f32_16x16x32_bf16 v[112:115], a[80:83], a[20:23], v[112:115]
s_add_u32 m0, s83, 0
s_add_u32 s80, s45, 185344
v_mfma_f32_16x16x32_bf16 v[112:115], a[24:27], a[180:183], v[112:115]
s_add_u32 s36, s28, s80
s_addc_u32 s37, s29, 0
ds_read_b128 a[144:147], v146 offset:4096
v_mfma_f32_16x16x32_bf16 v[112:115], a[60:63], a[176:179], v[112:115]
v_mfma_f32_16x16x32_bf16 v[112:115], a[32:35], a[136:139], v[112:115]
buffer_load_dwordx4 v1, s[36:39], 0 offen sc1 lds
ds_read_b128 a[160:163], v146 offset:5120
v_mfma_f32_16x16x32_bf16 v[112:115], a[48:51], a[188:191], v[112:115]
s_waitcnt lgkmcnt(4)
v_mfma_f32_16x16x32_bf16 v[112:115], a[84:87], a[0:3], v[112:115]
ds_read_b128 a[20:23], v146 offset:6144
v_mfma_f32_16x16x32_bf16 v[112:115], a[88:91], a[112:115], v[112:115]
v_mfma_f32_16x16x32_bf16 v[108:111], a[68:71], a[112:115], v[108:111]
ds_read_b128 a[172:175], v146 offset:7168
v_mfma_f32_16x16x32_bf16 v[108:111], a[52:55], a[0:3], v[108:111]
buffer_load_dwordx4 v1, s[36:39], 0 offen offset:1024 sc1 lds
v_mfma_f32_16x16x32_bf16 v[108:111], a[40:43], a[188:191], v[108:111]
s_add_u32 m0, s83, 8192
s_add_u32 s80, s45, 219136
ds_read_b128 a[176:179], v146 offset:8192
v_mfma_f32_16x16x32_bf16 v[108:111], a[100:103], a[136:139], v[108:111]
s_add_u32 s36, s28, s80
s_addc_u32 s37, s29, 0
v_mfma_f32_16x16x32_bf16 v[116:119], a[28:31], a[168:171], v[116:119]
ds_read_b128 a[112:115], v146 offset:9216
v_mfma_f32_16x16x32_bf16 v[116:119], a[4:7], a[192:195], v[116:119]
s_waitcnt lgkmcnt(4)
buffer_load_dwordx4 v1, s[36:39], 0 offen sc1 lds
v_mfma_f32_16x16x32_bf16 v[116:119], a[56:59], a[44:47], v[116:119]
ds_read_b128 a[0:3], v146 offset:10240
v_mfma_f32_16x16x32_bf16 v[116:119], a[92:95], a[132:135], v[116:119]
v_mfma_f32_16x16x32_bf16 v[120:123], a[64:67], a[132:135], v[120:123]
ds_read_b128 a[136:139], v146 offset:11264
v_mfma_f32_16x16x32_bf16 v[120:123], a[80:83], a[44:47], v[120:123]
buffer_load_dwordx4 v1, s[36:39], 0 offen offset:1024 sc1 lds
v_mfma_f32_16x16x32_bf16 v[120:123], a[24:27], a[192:195], v[120:123]
s_add_u32 m0, s83, 16384
s_add_u32 s80, s45, 24576
ds_read_b128 a[180:183], v146 offset:12288
v_mfma_f32_16x16x32_bf16 v[120:123], a[60:63], a[168:171], v[120:123]
s_add_u32 s36, s28, s80
s_addc_u32 s37, s29, 0
v_mfma_f32_16x16x32_bf16 v[120:123], a[32:35], a[144:147], v[120:123]
ds_read_b128 a[132:135], v146 offset:13312
v_mfma_f32_16x16x32_bf16 v[120:123], a[48:51], a[160:163], v[120:123]
s_waitcnt lgkmcnt(4)
v_mfma_f32_16x16x32_bf16 v[120:123], a[84:87], a[20:23], v[120:123]
buffer_load_dwordx4 v1, s[36:39], 0 offen sc1 lds
ds_read_b128 a[44:47], v146 offset:14336
v_mfma_f32_16x16x32_bf16 v[120:123], a[88:91], a[172:175], v[120:123]
v_mfma_f32_16x16x32_bf16 v[116:119], a[68:71], a[172:175], v[116:119]
s_waitcnt vmcnt(19)
ds_read_b128 a[168:171], v146 offset:15360
v_mfma_f32_16x16x32_bf16 v[116:119], a[52:55], a[20:23], v[116:119]
s_barrier
v_mfma_f32_16x16x32_bf16 v[116:119], a[40:43], a[160:163], v[116:119]
buffer_load_dwordx4 v1, s[36:39], 0 offen offset:1024 sc1 lds
ds_read_b128 a[188:191], v146 offset:16384
v_mfma_f32_16x16x32_bf16 v[116:119], a[100:103], a[144:147], v[116:119]
s_add_u32 m0, s83, 24576
s_add_u32 s80, s45, 159744
v_mfma_f32_16x16x32_bf16 v[124:127], a[28:31], a[176:179], v[124:127]
s_add_u32 s36, s28, s80
s_addc_u32 s37, s29, 0
ds_read_b128 a[172:175], v146 offset:17408
v_mfma_f32_16x16x32_bf16 v[124:127], a[4:7], a[112:115], v[124:127]
s_waitcnt lgkmcnt(4)
v_mfma_f32_16x16x32_bf16 v[124:127], a[56:59], a[0:3], v[124:127]
buffer_load_dwordx4 v1, s[36:39], 0 offen sc1 lds
ds_read_b128 a[20:23], v146 offset:18432
v_mfma_f32_16x16x32_bf16 v[124:127], a[92:95], a[136:139], v[124:127]
v_mfma_f32_16x16x32_bf16 v[128:131], a[64:67], a[136:139], v[128:131]
ds_read_b128 a[144:147], v146 offset:19456
v_mfma_f32_16x16x32_bf16 v[128:131], a[80:83], a[0:3], v[128:131]
v_mfma_f32_16x16x32_bf16 v[128:131], a[24:27], a[112:115], v[128:131]
ds_read_b128 a[160:163], v146 offset:20480
v_mfma_f32_16x16x32_bf16 v[128:131], a[60:63], a[176:179], v[128:131]
buffer_load_dwordx4 v1, s[36:39], 0 offen offset:1024 sc1 lds
v_mfma_f32_16x16x32_bf16 v[128:131], a[32:35], a[180:183], v[128:131]
s_add_u32 m0, s83, 65536
s_add_u32 s80, s45, 58368
ds_read_b128 a[192:195], v146 offset:21504
v_mfma_f32_16x16x32_bf16 v[128:131], a[48:51], a[132:135], v[128:131]
s_waitcnt lgkmcnt(4)
s_add_u32 s36, s28, s80
s_addc_u32 s37, s29, 0
v_mfma_f32_16x16x32_bf16 v[128:131], a[84:87], a[44:47], v[128:131]
ds_read_b128 a[0:3], v146 offset:22528
v_mfma_f32_16x16x32_bf16 v[128:131], a[88:91], a[168:171], v[128:131]
buffer_load_dwordx4 v1, s[36:39], 0 offen sc1 lds
v_mfma_f32_16x16x32_bf16 v[124:127], a[68:71], a[168:171], v[124:127]
ds_read_b128 a[112:115], v146 offset:23552
v_mfma_f32_16x16x32_bf16 v[124:127], a[52:55], a[44:47], v[124:127]
v_mfma_f32_16x16x32_bf16 v[124:127], a[40:43], a[132:135], v[124:127]
ds_read_b128 a[136:139], v146 offset:24576
v_mfma_f32_16x16x32_bf16 v[124:127], a[100:103], a[180:183], v[124:127]
buffer_load_dwordx4 v1, s[36:39], 0 offen offset:1024 sc1 lds
v_mfma_f32_16x16x32_bf16 v[80:83], a[116:119], a[188:191], v[80:83]
s_add_u32 m0, s83, 73728
s_add_u32 s80, s45, 193536
ds_read_b128 a[176:179], v146 offset:25600
v_mfma_f32_16x16x32_bf16 v[80:83], a[140:143], a[172:175], v[80:83]
s_waitcnt vmcnt(22) lgkmcnt(4)
s_add_u32 s36, s28, s80
s_addc_u32 s37, s29, 0
v_mfma_f32_16x16x32_bf16 v[80:83], a[148:151], a[20:23], v[80:83]
s_waitcnt vmcnt(20)
ds_read_b128 a[44:47], v146 offset:26624
v_mfma_f32_16x16x32_bf16 v[80:83], a[156:159], a[144:147], v[80:83]
v_mfma_f32_16x16x32_bf16 v[84:87], a[16:19], a[144:147], v[84:87]
buffer_load_dwordx4 a[132:135], v1, s[40:43], 0 offen sc1
ds_read_b128 a[168:171], v146 offset:27648
v_mfma_f32_16x16x32_bf16 v[84:87], a[96:99], a[20:23], v[84:87]
v_mfma_f32_16x16x32_bf16 v[84:87], a[120:123], a[172:175], v[84:87]
ds_read_b128 a[180:183], v146 offset:28672
v_mfma_f32_16x16x32_bf16 v[84:87], a[108:111], a[188:191], v[84:87]
s_waitcnt vmcnt(20)
v_mfma_f32_16x16x32_bf16 v[84:87], a[72:75], a[160:163], v[84:87]
s_waitcnt vmcnt(18)
buffer_load_dwordx4 a[196:199], v1, s[40:43], 0 offen offset:1024 sc1
ds_read_b128 a[144:147], v146 offset:29696
v_mfma_f32_16x16x32_bf16 v[84:87], a[124:127], a[192:195], v[84:87]
s_waitcnt vmcnt(17) lgkmcnt(4)
v_mfma_f32_16x16x32_bf16 v[84:87], a[152:155], a[0:3], v[84:87]
s_waitcnt vmcnt(15)
ds_read_b128 a[20:23], v146 offset:30720
v_mfma_f32_16x16x32_bf16 v[84:87], a[184:187], a[112:115], v[84:87]
s_waitcnt vmcnt(14)
v_mfma_f32_16x16x32_bf16 v[80:83], a[128:131], a[112:115], v[80:83]
buffer_load_dwordx4 a[172:175], v1, s[40:43], 0 offen offset:2048 sc1
ds_read_b128 a[188:191], v146 offset:31744
v_mfma_f32_16x16x32_bf16 v[80:83], a[76:79], a[0:3], v[80:83]
v_mfma_f32_16x16x32_bf16 v[80:83], a[104:107], a[192:195], v[80:83]
ds_read_b128 a[200:203], v144 offset:32768
v_mfma_f32_16x16x32_bf16 v[80:83], a[164:167], a[160:163], v[80:83]
v_mfma_f32_16x16x32_bf16 v[88:91], a[116:119], a[136:139], v[88:91]
ds_read_b128 a[204:207], v144 offset:33792
v_mfma_f32_16x16x32_bf16 v[88:91], a[140:143], a[176:179], v[88:91]
L_pad17:
s_cbranch_execz L_padret0
s_waitcnt lgkmcnt(4)
buffer_load_dwordx4 a[112:115], v1, s[40:43], 0 offen offset:3072 sc1
v_mfma_f32_16x16x32_bf16 v[88:91], a[148:151], a[44:47], v[88:91]
s_add_u32 s94, s32, 53248
ds_read_b128 a[0:3], v144 offset:34816
v_mfma_f32_16x16x32_bf16 v[88:91], a[156:159], a[168:171], v[88:91]
s_add_u32 s40, s28, s94
s_addc_u32 s41, s29, 0
v_mfma_f32_16x16x32_bf16 v[92:95], a[16:19], a[168:171], v[92:95]
ds_read_b128 a[160:163], v144 offset:35840
v_mfma_f32_16x16x32_bf16 v[92:95], a[96:99], a[44:47], v[92:95]
buffer_load_dwordx4 a[192:195], v1, s[40:43], 0 offen sc1
v_mfma_f32_16x16x32_bf16 v[92:95], a[120:123], a[176:179], v[92:95]
ds_read_b128 a[208:211], v144 offset:36864
v_mfma_f32_16x16x32_bf16 v[92:95], a[108:111], a[136:139], v[92:95]
v_mfma_f32_16x16x32_bf16 v[92:95], a[72:75], a[180:183], v[92:95]
ds_read_b128 a[212:215], v144 offset:37888
v_mfma_f32_16x16x32_bf16 v[92:95], a[124:127], a[144:147], v[92:95]
s_waitcnt lgkmcnt(4)
buffer_load_dwordx4 a[168:171], v1, s[40:43], 0 offen offset:1024 sc1
v_mfma_f32_16x16x32_bf16 v[92:95], a[152:155], a[20:23], v[92:95]
ds_read_b128 a[44:47], v144 offset:38912
v_mfma_f32_16x16x32_bf16 v[92:95], a[184:187], a[188:191], v[92:95]
v_mfma_f32_16x16x32_bf16 v[88:91], a[128:131], a[188:191], v[88:91]
s_waitcnt vmcnt(12)
ds_read_b128 a[136:139], v144 offset:39936
v_mfma_f32_16x16x32_bf16 v[88:91], a[76:79], a[20:23], v[88:91]
s_barrier
v_mfma_f32_16x16x32_bf16 v[88:91], a[104:107], a[144:147], v[88:91]
buffer_load_dwordx4 a[176:179], v1, s[40:43], 0 offen offset:2048 sc1
ds_read_b128 a[216:219], v144 offset:40960
v_mfma_f32_16x16x32_bf16 v[88:91], a[164:167], a[180:183], v[88:91]
v_mfma_f32_16x16x32_bf16 v[100:103], a[116:119], a[200:203], v[100:103]
ds_read_b128 a[220:223], v144 offset:41984
v_mfma_f32_16x16x32_bf16 v[100:103], a[140:143], a[204:207], v[100:103]
s_waitcnt lgkmcnt(4)
v_mfma_f32_16x16x32_bf16 v[100:103], a[148:151], a[0:3], v[100:103]
buffer_load_dwordx4 a[20:23], v1, s[40:43], 0 offen offset:3072 sc1
ds_read_b128 a[188:191], v144 offset:43008
v_mfma_f32_16x16x32_bf16 v[100:103], a[156:159], a[160:163], v[100:103]
s_add_u32 s94, s32, 57344
s_add_u32 s40, s28, s94
s_addc_u32 s41, s29, 0
v_mfma_f32_16x16x32_bf16 v[104:107], a[16:19], a[160:163], v[104:107]
ds_read_b128 a[144:147], v144 offset:44032
v_mfma_f32_16x16x32_bf16 v[104:107], a[96:99], a[0:3], v[104:107]
v_cmp_eq_u32 vcc, 0, v96
s_nop 0
s_cbranch_vccnz L_gspin8
L_gback8:
v_mfma_f32_16x16x32_bf16 v[104:107], a[120:123], a[204:207], v[104:107]
buffer_load_dwordx4 a[180:183], v1, s[40:43], 0 offen sc1
ds_read_b128 a[224:227], v144 offset:45056
v_mfma_f32_16x16x32_bf16 v[104:107], a[108:111], a[200:203], v[104:107]
v_fma_f32 v156, v72, v156, v156
v_fma_f32 v157, v72, v157, v157
v_mfma_f32_16x16x32_bf16 v[104:107], a[72:75], a[208:211], v[104:107]
ds_read_b128 a[0:3], v144 offset:46080
v_fma_f32 v158, v72, v158, v158
v_mfma_f32_16x16x32_bf16 v[104:107], a[124:127], a[212:215], v[104:107]
s_waitcnt lgkmcnt(4)
v_fma_f32 v159, v72, v159, v159
v_fma_f32 v152, v72, v152, v152
v_mfma_f32_16x16x32_bf16 v[104:107], a[152:155], a[44:47], v[104:107]
ds_read_b128 a[160:163], v144 offset:47104
v_fma_f32 v153, v72, v153, v153
v_mfma_f32_16x16x32_bf16 v[104:107], a[184:187], a[136:139], v[104:107]
buffer_load_dwordx4 a[200:203], v1, s[40:43], 0 offen offset:1024 sc1
v_fma_f32 v154, v72, v154, v154
v_mfma_f32_16x16x32_bf16 v[100:103], a[128:131], a[136:139], v[100:103]
ds_read_b128 a[204:207], v144 offset:48128
v_fma_f32 v155, v72, v155, v155
v_mfma_f32_16x16x32_bf16 v[100:103], a[76:79], a[44:47], v[100:103]
v_fma_f32 v36, v76, v36, v36
v_fma_f32 v37, v76, v37, v37
v_mfma_f32_16x16x32_bf16 v[100:103], a[104:107], a[212:215], v[100:103]
ds_read_b128 a[228:231], v144 offset:0
v_fma_f32 v38, v76, v38, v38
v_mfma_f32_16x16x32_bf16 v[100:103], a[164:167], a[208:211], v[100:103]
buffer_load_dwordx4 a[232:235], v1, s[40:43], 0 offen offset:2048 sc1
v_fma_f32 v39, v76, v39, v39
v_mfma_f32_16x16x32_bf16 v[108:111], a[116:119], a[216:219], v[108:111]
ds_read_b128 a[136:139], v144 offset:1024
v_fma_f32 v32, v76, v32, v32
v_mfma_f32_16x16x32_bf16 v[108:111], a[140:143], a[220:223], v[108:111]
s_waitcnt lgkmcnt(4)
v_fma_f32 v33, v76, v33, v33
v_fma_f32 v34, v76, v34, v34
v_mfma_f32_16x16x32_bf16 v[108:111], a[148:151], a[188:191], v[108:111]
ds_read_b128 a[44:47], v144 offset:2048
v_fma_f32 v35, v76, v35, v35
v_mfma_f32_16x16x32_bf16 v[108:111], a[156:159], a[144:147], v[108:111]
buffer_load_dwordx4 a[208:211], v1, s[40:43], 0 offen offset:3072 sc1
v_fma_f32 v20, v73, v20, v20
v_mfma_f32_16x16x32_bf16 v[112:115], a[16:19], a[144:147], v[112:115]
s_add_u32 s94, s32, 61440
ds_read_b128 a[212:215], v144 offset:3072
v_fma_f32 v21, v73, v21, v21
v_mfma_f32_16x16x32_bf16 v[112:115], a[96:99], a[188:191], v[112:115]
s_add_u32 s40, s28, s94
s_addc_u32 s41, s29, 0
v_fma_f32 v22, v73, v22, v22
v_mfma_f32_16x16x32_bf16 v[112:115], a[120:123], a[220:223], v[112:115]
ds_read_b128 a[236:239], v144 offset:4096
v_fma_f32 v23, v73, v23, v23
v_mfma_f32_16x16x32_bf16 v[112:115], a[108:111], a[216:219], v[112:115]
v_fma_f32 v16, v73, v16, v16
v_fma_f32 v17, v73, v17, v17
v_mfma_f32_16x16x32_bf16 v[112:115], a[72:75], a[224:227], v[112:115]
buffer_load_dwordx4 a[144:147], v1, s[40:43], 0 offen sc1
ds_read_b128 a[188:191], v144 offset:5120
v_mfma_f32_16x16x32_bf16 v[112:115], a[124:127], a[0:3], v[112:115]
s_waitcnt lgkmcnt(4)
v_fma_f32 v18, v73, v18, v18
v_fma_f32 v19, v73, v19, v19
v_mfma_f32_16x16x32_bf16 v[112:115], a[152:155], a[160:163], v[112:115]
ds_read_b128 a[216:219], v144 offset:6144
v_fma_f32 v44, v77, v44, v44
v_mfma_f32_16x16x32_bf16 v[112:115], a[184:187], a[204:207], v[112:115]
v_fma_f32 v45, v77, v45, v45
v_fma_f32 v46, v77, v46, v46
v_mfma_f32_16x16x32_bf16 v[108:111], a[128:131], a[204:207], v[108:111]
buffer_load_dwordx4 a[220:223], v1, s[40:43], 0 offen offset:1024 sc1
ds_read_b128 a[240:243], v144 offset:7168
v_mfma_f32_16x16x32_bf16 v[108:111], a[76:79], a[160:163], v[108:111]
v_fma_f32 v47, v77, v47, v47
v_fma_f32 v40, v77, v40, v40
v_mfma_f32_16x16x32_bf16 v[108:111], a[104:107], a[0:3], v[108:111]
ds_read_b128 a[244:247], v144 offset:8192
v_fma_f32 v41, v77, v41, v41
v_mfma_f32_16x16x32_bf16 v[108:111], a[164:167], a[224:227], v[108:111]
v_fma_f32 v42, v77, v42, v42
v_fma_f32 v43, v77, v43, v43
v_mfma_f32_16x16x32_bf16 v[116:119], a[116:119], a[228:231], v[116:119]
buffer_load_dwordx4 a[204:207], v1, s[40:43], 0 offen offset:2048 sc1
ds_read_b128 a[160:163], v144 offset:9216
v_mfma_f32_16x16x32_bf16 v[116:119], a[140:143], a[136:139], v[116:119]
s_waitcnt lgkmcnt(4)
v_fma_f32 v28, v74, v28, v28
v_fma_f32 v29, v74, v29, v29
v_mfma_f32_16x16x32_bf16 v[116:119], a[148:151], a[44:47], v[116:119]
ds_read_b128 a[0:3], v144 offset:10240
v_fma_f32 v30, v74, v30, v30
v_mfma_f32_16x16x32_bf16 v[116:119], a[156:159], a[212:215], v[116:119]
v_fma_f32 v31, v74, v31, v31
v_fma_f32 v24, v74, v24, v24
v_mfma_f32_16x16x32_bf16 v[120:123], a[16:19], a[212:215], v[120:123]
ds_read_b128 a[224:227], v144 offset:11264
v_fma_f32 v25, v74, v25, v25
v_mfma_f32_16x16x32_bf16 v[120:123], a[96:99], a[44:47], v[120:123]
buffer_load_dwordx4 a[248:251], v1, s[40:43], 0 offen offset:3072 sc1
v_fma_f32 v26, v74, v26, v26
v_mfma_f32_16x16x32_bf16 v[120:123], a[120:123], a[136:139], v[120:123]
s_add_u32 s94, s88, 0
ds_read_b128 a[252:255], v144 offset:12288
v_fma_f32 v27, v74, v27, v27
v_mfma_f32_16x16x32_bf16 v[120:123], a[108:111], a[228:231], v[120:123]
s_add_u32 s40, s28, s94
s_addc_u32 s41, s29, 0
v_fma_f32 v52, v78, v52, v52
v_mfma_f32_16x16x32_bf16 v[120:123], a[72:75], a[236:239], v[120:123]
ds_read_b128 a[44:47], v144 offset:13312
v_fma_f32 v53, v78, v53, v53
v_mfma_f32_16x16x32_bf16 v[120:123], a[124:127], a[188:191], v[120:123]
s_waitcnt lgkmcnt(4)
buffer_load_dwordx4 v1, s[36:39], 0 offen sc1 lds
v_fma_f32 v54, v78, v54, v54
v_mfma_f32_16x16x32_bf16 v[120:123], a[152:155], a[216:219], v[120:123]
ds_read_b128 a[136:139], v144 offset:14336
v_fma_f32 v55, v78, v55, v55
v_mfma_f32_16x16x32_bf16 v[120:123], a[184:187], a[240:243], v[120:123]
v_fma_f32 v48, v78, v48, v48
v_fma_f32 v49, v78, v49, v49
v_mfma_f32_16x16x32_bf16 v[116:119], a[128:131], a[240:243], v[116:119]
s_waitcnt vmcnt(17)
ds_read_b128 a[212:215], v144 offset:15360
v_fma_f32 v50, v78, v50, v50
v_mfma_f32_16x16x32_bf16 v[116:119], a[76:79], a[216:219], v[116:119]
s_barrier
v_mfma_f32_16x16x32_bf16 v[116:119], a[104:107], a[188:191], v[116:119]
buffer_load_dwordx4 v1, s[36:39], 0 offen offset:1024 sc1 lds
ds_read_b128 a[228:231], v144 offset:16384
v_mfma_f32_16x16x32_bf16 v[116:119], a[164:167], a[236:239], v[116:119]
s_add_u32 m0, s83, 98304
v_fma_f32 v51, v78, v51, v51
v_fma_f32 v60, v75, v60, v60
v_mfma_f32_16x16x32_bf16 v[124:127], a[116:119], a[244:247], v[124:127]
s_add_u32 s80, s45, 92160
buffer_load_dword v8, v149, s[28:31], s87 offen sc1
v_mfma_f32_16x16x32_bf16 v[124:127], a[140:143], a[160:163], v[124:127]
s_waitcnt lgkmcnt(3)
ds_read_b128 a[188:191], v144 offset:17408
v_fma_f32 v61, v75, v61, v61
v_mfma_f32_16x16x32_bf16 v[124:127], a[148:151], a[0:3], v[124:127]
s_add_u32 s36, s28, s80
s_addc_u32 s37, s29, 0
ds_read_b128 a[216:219], v144 offset:18432
v_mfma_f32_16x16x32_bf16 v[124:127], a[156:159], a[224:227], v[124:127]
buffer_load_dwordx4 v1, s[36:39], 0 offen sc1 lds
v_fma_f32 v62, v75, v62, v62
v_mfma_f32_16x16x32_bf16 v[128:131], a[16:19], a[224:227], v[128:131]
ds_read_b128 a[236:239], v144 offset:19456
v_fma_f32 v63, v75, v63, v63
v_mfma_f32_16x16x32_bf16 v[128:131], a[96:99], a[0:3], v[128:131]
v_fma_f32 v56, v75, v56, v56
v_fma_f32 v57, v75, v57, v57
v_mfma_f32_16x16x32_bf16 v[128:131], a[120:123], a[160:163], v[128:131]
ds_read_b128 a[240:243], v144 offset:20480
v_fma_f32 v58, v75, v58, v58
v_mfma_f32_16x16x32_bf16 v[128:131], a[108:111], a[244:247], v[128:131]
buffer_load_dwordx4 v1, s[36:39], 0 offen offset:1024 sc1 lds
v_fma_f32 v59, v75, v59, v59
v_mfma_f32_16x16x32_bf16 v[128:131], a[72:75], a[252:255], v[128:131]
s_add_u32 m0, s83, 106496
ds_read_b128 a[0:3], v144 offset:21504
v_fma_f32 v68, v79, v68, v68
v_mfma_f32_16x16x32_bf16 v[128:131], a[124:127], a[44:47], v[128:131]
s_waitcnt lgkmcnt(5)
v_fma_f32 v69, v79, v69, v69
v_fma_f32 v70, v79, v70, v70
v_mfma_f32_16x16x32_bf16 v[128:131], a[152:155], a[136:139], v[128:131]
s_add_u32 s80, s45, 227328
ds_read_b128 a[160:163], v144 offset:22528
v_fma_f32 v71, v79, v71, v71
v_mfma_f32_16x16x32_bf16 v[128:131], a[184:187], a[212:215], v[128:131]
s_add_u32 s36, s28, s80
s_addc_u32 s37, s29, 0
buffer_load_dwordx4 v1, s[36:39], 0 offen sc1 lds
v_mfma_f32_16x16x32_bf16 v[124:127], a[128:131], a[212:215], v[124:127]
ds_read_b128 a[224:227], v144 offset:23552
v_fma_f32 v64, v79, v64, v64
v_mfma_f32_16x16x32_bf16 v[124:127], a[76:79], a[136:139], v[124:127]
v_fma_f32 v65, v79, v65, v65
v_fma_f32 v66, v79, v66, v66
v_mfma_f32_16x16x32_bf16 v[124:127], a[104:107], a[44:47], v[124:127]
ds_read_b128 a[244:247], v144 offset:24576
v_fma_f32 v67, v79, v67, v67
v_mfma_f32_16x16x32_bf16 v[124:127], a[164:167], a[252:255], v[124:127]
s_waitcnt vmcnt(20)
v_mfma_f32_16x16x32_bf16 v[80:83], a[196:199], a[228:231], v[80:83]
s_waitcnt vmcnt(18) lgkmcnt(4)
buffer_load_dwordx4 v1, s[36:39], 0 offen offset:1024 sc1 lds
ds_read_b128 a[136:139], v144 offset:25600
v_mfma_f32_16x16x32_bf16 v[80:83], a[112:115], a[188:191], v[80:83]
s_waitcnt vmcnt(17)
s_add_u32 m0, s83, 114688
s_add_u32 s80, s45, 101376
v_mfma_f32_16x16x32_bf16 v[80:83], a[168:171], a[216:219], v[80:83]
s_waitcnt vmcnt(15)
ds_read_b128 a[44:47], v144 offset:26624
v_mfma_f32_16x16x32_bf16 v[80:83], a[20:23], a[236:239], v[80:83]
s_add_u32 s36, s28, s80
s_addc_u32 s37, s29, 0
v_mfma_f32_16x16x32_bf16 v[84:87], a[176:179], a[236:239], v[84:87]
buffer_load_dwordx4 v1, s[36:39], 0 offen sc1 lds
ds_read_b128 a[212:215], v144 offset:27648
v_mfma_f32_16x16x32_bf16 v[84:87], a[192:195], a[216:219], v[84:87]
v_mfma_f32_16x16x32_bf16 v[84:87], a[172:175], a[188:191], v[84:87]
ds_read_b128 a[252:255], v144 offset:28672
v_mfma_f32_16x16x32_bf16 v[84:87], a[132:135], a[228:231], v[84:87]
s_waitcnt vmcnt(15)
v_mfma_f32_16x16x32_bf16 v[84:87], a[180:183], a[240:243], v[84:87]
s_waitcnt vmcnt(13) lgkmcnt(4)
buffer_load_dwordx4 v1, s[36:39], 0 offen offset:1024 sc1 lds
ds_read_b128 a[236:239], v144 offset:29696
v_mfma_f32_16x16x32_bf16 v[84:87], a[232:235], a[0:3], v[84:87]
s_waitcnt vmcnt(12)
s_add_u32 m0, s83, 122880
s_add_u32 s80, s45, 109568
v_mfma_f32_16x16x32_bf16 v[84:87], a[144:147], a[160:163], v[84:87]
s_waitcnt vmcnt(10)
ds_read_b128 a[188:191], v144 offset:30720
v_mfma_f32_16x16x32_bf16 v[84:87], a[204:207], a[224:227], v[84:87]
s_waitcnt vmcnt(9)
s_add_u32 s36, s28, s80
s_addc_u32 s37, s29, 0
v_mfma_f32_16x16x32_bf16 v[80:83], a[248:251], a[224:227], v[80:83]
ds_read_b128 a[216:219], v144 offset:31744
v_mfma_f32_16x16x32_bf16 v[80:83], a[220:223], a[160:163], v[80:83]
buffer_load_dwordx4 v1, s[36:39], 0 offen sc1 lds
v_mfma_f32_16x16x32_bf16 v[80:83], a[208:211], a[0:3], v[80:83]
ds_read_b128 a[228:231], v145 offset:0
v_mfma_f32_16x16x32_bf16 v[80:83], a[200:203], a[240:243], v[80:83]
v_mfma_f32_16x16x32_bf16 v[108:111], a[196:199], a[244:247], v[108:111]
s_waitcnt lgkmcnt(4)
v_fma_f32 v156, -v72, v84, v156
v_fma_f32 v157, -v72, v85, v157
v_mfma_f32_16x16x32_bf16 v[108:111], a[112:115], a[136:139], v[108:111]
buffer_load_dwordx4 v1, s[36:39], 0 offen offset:1024 sc1 lds
v_fma_f32 v158, -v72, v86, v158
v_mfma_f32_16x16x32_bf16 v[108:111], a[168:171], a[44:47], v[108:111]
s_add_u32 m0, s83, 131072
v_fma_f32 v159, -v72, v87, v159
v_cvt_pk_bf16_f32 v156, v156, v157
v_mfma_f32_16x16x32_bf16 v[108:111], a[20:23], a[212:215], v[108:111]
s_add_u32 s80, s45, 117760
ds_read_b128 a[0:3], v145 offset:1024
v_cvt_pk_bf16_f32 v157, v158, v159
v_mfma_f32_16x16x32_bf16 v[112:115], a[176:179], a[212:215], v[112:115]
s_add_u32 s36, s28, s80
s_addc_u32 s37, s29, 0
v_fma_f32 v152, -v72, v80, v152
v_mfma_f32_16x16x32_bf16 v[112:115], a[192:195], a[44:47], v[112:115]
buffer_load_dwordx4 v1, s[36:39], 0 offen sc1 lds
v_fma_f32 v153, -v72, v81, v153
v_mfma_f32_16x16x32_bf16 v[112:115], a[172:175], a[136:139], v[112:115]
v_fma_f32 v154, -v72, v82, v154
v_fma_f32 v155, -v72, v83, v155
v_mfma_f32_16x16x32_bf16 v[112:115], a[132:135], a[244:247], v[112:115]
v_cvt_pk_bf16_f32 v158, v152, v153
v_cvt_pk_bf16_f32 v159, v154, v155
v_mfma_f32_16x16x32_bf16 v[112:115], a[180:183], a[252:255], v[112:115]
s_waitcnt vmcnt(9) lgkmcnt(1)
v_cmp_gt_u32 vcc, 1, v8
s_nop 0
s_cbranch_vccnz L_spin11
L_back11:
v_mfma_f32_16x16x32_bf16 v[112:115], a[232:235], a[236:239], v[112:115]
buffer_store_dwordx4 v[156:159], v1, s[28:31], s95 offen sc1
ds_read_b128 a[44:47], v145 offset:2048
v_mfma_f32_16x16x32_bf16 v[112:115], a[144:147], a[188:191], v[112:115]
ds_read_b128 a[136:139], v145 offset:3072
v_mfma_f32_16x16x32_bf16 v[112:115], a[204:207], a[216:219], v[112:115]
buffer_load_dwordx4 v1, s[36:39], 0 offen offset:1024 sc1 lds
ds_read_b128 a[160:163], v145 offset:4096
v_mfma_f32_16x16x32_bf16 v[108:111], a[248:251], a[216:219], v[108:111]
s_waitcnt vmcnt(7)
s_add_u32 m0, s83, 139264
ds_read_b128 a[212:215], v145 offset:5120
v_mfma_f32_16x16x32_bf16 v[108:111], a[220:223], a[188:191], v[108:111]
s_barrier
v_mfma_f32_16x16x32_bf16 v[108:111], a[208:211], a[236:239], v[108:111]
s_add_u32 s80, s45, 125952
ds_read_b128 a[224:227], v145 offset:6144
v_mfma_f32_16x16x32_bf16 v[108:111], a[200:203], a[252:255], v[108:111]
s_add_u32 s36, s28, s80
s_addc_u32 s37, s29, 0
buffer_load_dwordx4 v1, s[36:39], 0 offen sc1 lds
v_mfma_f32_16x16x32_bf16 v[88:91], a[196:199], a[228:231], v[88:91]
s_waitcnt lgkmcnt(5)
ds_read_b128 a[216:219], v145 offset:7168
v_fma_f32 v36, -v76, v112, v36
v_mfma_f32_16x16x32_bf16 v[88:91], a[112:115], a[0:3], v[88:91]
s_waitcnt lgkmcnt(5)
v_fma_f32 v37, -v76, v113, v37
v_fma_f32 v38, -v76, v114, v38
v_mfma_f32_16x16x32_bf16 v[88:91], a[168:171], a[44:47], v[88:91]
s_waitcnt lgkmcnt(4)
v_fma_f32 v39, -v76, v115, v39
v_cvt_pk_bf16_f32 v36, v36, v37
v_mfma_f32_16x16x32_bf16 v[88:91], a[20:23], a[136:139], v[88:91]
buffer_load_dwordx4 v1, s[36:39], 0 offen offset:1024 sc1 lds
v_cvt_pk_bf16_f32 v37, v38, v39
v_mfma_f32_16x16x32_bf16 v[92:95], a[176:179], a[136:139], v[92:95]
s_add_u32 m0, s83, 147456
ds_read_b128 a[188:191], v145 offset:8192
v_fma_f32 v32, -v76, v108, v32
v_mfma_f32_16x16x32_bf16 v[92:95], a[192:195], a[44:47], v[92:95]
s_add_u32 s80, s45, 236544
v_fma_f32 v33, -v76, v109, v33
v_fma_f32 v34, -v76, v110, v34
v_mfma_f32_16x16x32_bf16 v[92:95], a[172:175], a[0:3], v[92:95]
s_add_u32 s36, s28, s80
s_addc_u32 s37, s29, 0
v_fma_f32 v35, -v76, v111, v35
v_mfma_f32_16x16x32_bf16 v[92:95], a[132:135], a[228:231], v[92:95]
s_waitcnt lgkmcnt(2)
ds_read_b128 a[136:139], v145 offset:9216
v_cvt_pk_bf16_f32 v38, v32, v33
v_mfma_f32_16x16x32_bf16 v[92:95], a[180:183], a[160:163], v[92:95]
buffer_load_dwordx4 v1, s[36:39], 0 offen sc1 lds
v_cvt_pk_bf16_f32 v39, v34, v35
v_mfma_f32_16x16x32_bf16 v[92:95], a[232:235], a[212:215], v[92:95]
buffer_store_dwordx4 v[36:39], v1, s[28:31], s95 offen offset:1024 sc1
ds_read_b128 a[0:3], v145 offset:10240
v_mfma_f32_16x16x32_bf16 v[92:95], a[144:147], a[224:227], v[92:95]
s_waitcnt lgkmcnt(3)
ds_read_b128 a[44:47], v145 offset:11264
v_mfma_f32_16x16x32_bf16 v[92:95], a[204:207], a[216:219], v[92:95]
ds_read_b128 a[228:231], v145 offset:12288
v_mfma_f32_16x16x32_bf16 v[88:91], a[248:251], a[216:219], v[88:91]
buffer_load_dwordx4 v1, s[36:39], 0 offen offset:1024 sc1 lds
ds_read_b128 a[236:239], v145 offset:13312
v_mfma_f32_16x16x32_bf16 v[88:91], a[220:223], a[224:227], v[88:91]
s_add_u32 m0, s83, 155648
s_add_u32 s80, s45, 244736
ds_read_b128 a[240:243], v145 offset:14336
v_mfma_f32_16x16x32_bf16 v[88:91], a[208:211], a[212:215], v[88:91]
s_add_u32 s36, s28, s80
s_addc_u32 s37, s29, 0
ds_read_b128 a[244:247], v145 offset:15360
v_mfma_f32_16x16x32_bf16 v[88:91], a[200:203], a[160:163], v[88:91]
s_waitcnt lgkmcnt(7)
ds_read_b128 a[216:219], v145 offset:32768
v_mfma_f32_16x16x32_bf16 v[116:119], a[196:199], a[188:191], v[116:119]
s_waitcnt lgkmcnt(7)
buffer_load_dwordx4 v1, s[36:39], 0 offen sc1 lds
v_fma_f32 v20, -v73, v92, v20
v_mfma_f32_16x16x32_bf16 v[116:119], a[112:115], a[136:139], v[116:119]
s_waitcnt lgkmcnt(6)
v_fma_f32 v21, -v73, v93, v21
v_fma_f32 v22, -v73, v94, v22
v_mfma_f32_16x16x32_bf16 v[116:119], a[168:171], a[0:3], v[116:119]
s_waitcnt lgkmcnt(5)
v_fma_f32 v23, -v73, v95, v23
v_cvt_pk_bf16_f32 v20, v20, v21
v_mfma_f32_16x16x32_bf16 v[116:119], a[20:23], a[44:47], v[116:119]
ds_read_b128 a[160:163], v145 offset:33792
v_cvt_pk_bf16_f32 v21, v22, v23
v_mfma_f32_16x16x32_bf16 v[120:123], a[176:179], a[44:47], v[120:123]
v_fma_f32 v16, -v73, v88, v16
v_fma_f32 v17, -v73, v89, v17
v_mfma_f32_16x16x32_bf16 v[120:123], a[192:195], a[0:3], v[120:123]
buffer_load_dwordx4 v1, s[36:39], 0 offen offset:1024 sc1 lds
v_fma_f32 v18, -v73, v90, v18
v_mfma_f32_16x16x32_bf16 v[120:123], a[172:175], a[136:139], v[120:123]
s_add_u32 m0, s83, 32768
v_fma_f32 v19, -v73, v91, v19
v_cvt_pk_bf16_f32 v22, v16, v17
v_mfma_f32_16x16x32_bf16 v[120:123], a[132:135], a[188:191], v[120:123]
s_waitcnt lgkmcnt(2)
ds_read_b128 a[44:47], v145 offset:34816
v_cvt_pk_bf16_f32 v23, v18, v19
v_mfma_f32_16x16x32_bf16 v[120:123], a[180:183], a[228:231], v[120:123]
s_add_u32 s80, s45, 252928
buffer_store_dwordx4 v[20:23], v1, s[28:31], s96 offen sc1
ds_read_b128 a[0:3], v145 offset:35840
v_mfma_f32_16x16x32_bf16 v[120:123], a[232:235], a[236:239], v[120:123]
s_add_u32 s36, s28, s80
s_addc_u32 s37, s29, 0
ds_read_b128 a[136:139], v145 offset:36864
v_mfma_f32_16x16x32_bf16 v[120:123], a[144:147], a[240:243], v[120:123]
buffer_load_dwordx4 v1, s[36:39], 0 offen sc1 lds
ds_read_b128 a[188:191], v145 offset:37888
v_mfma_f32_16x16x32_bf16 v[120:123], a[204:207], a[244:247], v[120:123]
ds_read_b128 a[212:215], v145 offset:38912
v_mfma_f32_16x16x32_bf16 v[116:119], a[248:251], a[244:247], v[116:119]
ds_read_b128 a[224:227], v145 offset:39936
v_mfma_f32_16x16x32_bf16 v[116:119], a[220:223], a[240:243], v[116:119]
v_mfma_f32_16x16x32_bf16 v[116:119], a[208:211], a[236:239], v[116:119]
buffer_load_dwordx4 v1, s[36:39], 0 offen offset:1024 sc1 lds
ds_read_b128 a[252:255], v145 offset:40960
v_mfma_f32_16x16x32_bf16 v[116:119], a[200:203], a[228:231], v[116:119]
s_waitcnt lgkmcnt(7)
s_add_u32 m0, s83, 40960
s_add_u32 s80, s45, 261120
v_mfma_f32_16x16x32_bf16 v[100:103], a[196:199], a[216:219], v[100:103]
s_add_u32 s36, s28, s80
s_addc_u32 s37, s29, 0
v_fma_f32 v44, -v77, v120, v44
v_mfma_f32_16x16x32_bf16 v[100:103], a[112:115], a[160:163], v[100:103]
s_waitcnt lgkmcnt(5)
v_fma_f32 v45, -v77, v121, v45
v_fma_f32 v46, -v77, v122, v46
v_mfma_f32_16x16x32_bf16 v[100:103], a[168:171], a[44:47], v[100:103]
v_fma_f32 v47, -v77, v123, v47
v_cvt_pk_bf16_f32 v44, v44, v45
v_mfma_f32_16x16x32_bf16 v[100:103], a[20:23], a[0:3], v[100:103]
buffer_load_dwordx4 v1, s[36:39], 0 offen sc1 lds
v_cvt_pk_bf16_f32 v45, v46, v47
v_mfma_f32_16x16x32_bf16 v[104:107], a[176:179], a[0:3], v[104:107]
v_fma_f32 v40, -v77, v116, v40
v_fma_f32 v41, -v77, v117, v41
v_mfma_f32_16x16x32_bf16 v[104:107], a[192:195], a[44:47], v[104:107]
v_fma_f32 v42, -v77, v118, v42
v_fma_f32 v43, -v77, v119, v43
v_mfma_f32_16x16x32_bf16 v[104:107], a[172:175], a[160:163], v[104:107]
ds_read_b128 a[228:231], v145 offset:41984
v_cvt_pk_bf16_f32 v46, v40, v41
v_mfma_f32_16x16x32_bf16 v[104:107], a[132:135], a[216:219], v[104:107]
s_waitcnt lgkmcnt(1)
buffer_load_dwordx4 v1, s[36:39], 0 offen offset:1024 sc1 lds
v_cvt_pk_bf16_f32 v47, v42, v43
v_mfma_f32_16x16x32_bf16 v[104:107], a[180:183], a[136:139], v[104:107]
buffer_store_dwordx4 v[44:47], v1, s[28:31], s96 offen offset:1024 sc1
ds_read_b128 a[0:3], v145 offset:43008
v_mfma_f32_16x16x32_bf16 v[104:107], a[232:235], a[188:191], v[104:107]
ds_read_b128 a[44:47], v145 offset:44032
v_mfma_f32_16x16x32_bf16 v[104:107], a[144:147], a[212:215], v[104:107]
ds_read_b128 a[160:163], v145 offset:45056
v_mfma_f32_16x16x32_bf16 v[104:107], a[204:207], a[224:227], v[104:107]
ds_read_b128 a[216:219], v145 offset:46080
v_mfma_f32_16x16x32_bf16 v[100:103], a[248:251], a[224:227], v[100:103]
s_waitcnt vmcnt(13)
ds_read_b128 a[236:239], v145 offset:47104
v_mfma_f32_16x16x32_bf16 v[100:103], a[220:223], a[212:215], v[100:103]
s_barrier
v_mfma_f32_16x16x32_bf16 v[100:103], a[208:211], a[188:191], v[100:103]
ds_read_b128 a[240:243], v145 offset:48128
v_mfma_f32_16x16x32_bf16 v[100:103], a[200:203], a[136:139], v[100:103]
ds_read_b128 a[244:247], v145 offset:49152
v_mfma_f32_16x16x32_bf16 v[124:127], a[196:199], a[252:255], v[124:127]
s_waitcnt lgkmcnt(7)
v_fma_f32 v28, -v74, v104, v28
v_fma_f32 v29, -v74, v105, v29
v_mfma_f32_16x16x32_bf16 v[124:127], a[112:115], a[228:231], v[124:127]
s_waitcnt lgkmcnt(6)
v_fma_f32 v30, -v74, v106, v30
v_fma_f32 v31, -v74, v107, v31
v_mfma_f32_16x16x32_bf16 v[124:127], a[168:171], a[0:3], v[124:127]
s_waitcnt lgkmcnt(5)
v_cvt_pk_bf16_f32 v28, v28, v29
v_cvt_pk_bf16_f32 v29, v30, v31
v_mfma_f32_16x16x32_bf16 v[124:127], a[20:23], a[44:47], v[124:127]
ds_read_b128 a[136:139], v145 offset:50176
v_mfma_f32_16x16x32_bf16 v[128:131], a[176:179], a[44:47], v[128:131]
v_fma_f32 v24, -v74, v100, v24
v_fma_f32 v25, -v74, v101, v25
v_mfma_f32_16x16x32_bf16 v[128:131], a[192:195], a[0:3], v[128:131]
v_fma_f32 v26, -v74, v102, v26
v_fma_f32 v27, -v74, v103, v27
v_mfma_f32_16x16x32_bf16 v[128:131], a[172:175], a[228:231], v[128:131]
v_cvt_pk_bf16_f32 v30, v24, v25
v_cvt_pk_bf16_f32 v31, v26, v27
v_mfma_f32_16x16x32_bf16 v[128:131], a[132:135], a[252:255], v[128:131]
s_waitcnt lgkmcnt(2)
buffer_store_dwordx4 v[28:31], v1, s[28:31], s85 offen sc1
ds_read_b128 a[44:47], v145 offset:51200
v_mfma_f32_16x16x32_bf16 v[128:131], a[180:183], a[160:163], v[128:131]
ds_read_b128 a[0:3], v145 offset:52224
v_mfma_f32_16x16x32_bf16 v[128:131], a[232:235], a[216:219], v[128:131]
ds_read_b128 a[188:191], v145 offset:53248
v_mfma_f32_16x16x32_bf16 v[128:131], a[144:147], a[236:239], v[128:131]
ds_read_b128 a[212:215], v145 offset:54272
v_mfma_f32_16x16x32_bf16 v[128:131], a[204:207], a[240:243], v[128:131]
ds_read_b128 a[224:227], v145 offset:55296
v_mfma_f32_16x16x32_bf16 v[124:127], a[248:251], a[240:243], v[124:127]
ds_read_b128 a[228:231], v145 offset:56320
v_mfma_f32_16x16x32_bf16 v[124:127], a[220:223], a[236:239], v[124:127]
v_mfma_f32_16x16x32_bf16 v[124:127], a[208:211], a[216:219], v[124:127]
ds_read_b128 a[252:255], v145 offset:57344
v_mfma_f32_16x16x32_bf16 v[124:127], a[200:203], a[160:163], v[124:127]
s_waitcnt lgkmcnt(7)
v_mfma_f32_16x16x32_bf16 v[16:19], v[172:175], a[244:247], 0
v_fma_f32 v52, -v78, v128, v52
v_fma_f32 v53, -v78, v129, v53
v_mfma_f32_16x16x32_bf16 v[16:19], v[180:183], a[136:139], v[16:19]
s_waitcnt lgkmcnt(5)
v_fma_f32 v54, -v78, v130, v54
v_fma_f32 v55, -v78, v131, v55
v_mfma_f32_16x16x32_bf16 v[16:19], v[188:191], a[44:47], v[16:19]
v_cvt_pk_bf16_f32 v52, v52, v53
v_cvt_pk_bf16_f32 v53, v54, v55
v_mfma_f32_16x16x32_bf16 v[16:19], v[196:199], a[0:3], v[16:19]
ds_read_b128 a[160:163], v145 offset:58368
v_mfma_f32_16x16x32_bf16 v[20:23], v[192:195], a[0:3], 0
v_fma_f32 v48, -v78, v124, v48
v_fma_f32 v49, -v78, v125, v49
v_mfma_f32_16x16x32_bf16 v[20:23], v[184:187], a[44:47], v[20:23]
v_fma_f32 v50, -v78, v126, v50
v_fma_f32 v51, -v78, v127, v51
v_mfma_f32_16x16x32_bf16 v[20:23], v[176:179], a[136:139], v[20:23]
v_cvt_pk_bf16_f32 v54, v48, v49
v_cvt_pk_bf16_f32 v55, v50, v51
v_mfma_f32_16x16x32_bf16 v[20:23], v[168:171], a[244:247], v[20:23]
s_waitcnt lgkmcnt(1)
buffer_store_dwordx4 v[52:55], v1, s[28:31], s85 offen offset:1024 sc1
ds_read_b128 a[0:3], v145 offset:59392
v_mfma_f32_16x16x32_bf16 v[20:23], v[200:203], a[188:191], v[20:23]
L_pad18:
s_cbranch_execz L_padret0
ds_read_b128 a[44:47], v145 offset:60416
v_mfma_f32_16x16x32_bf16 v[20:23], v[240:243], a[212:215], v[20:23]
ds_read_b128 a[216:219], v145 offset:61440
v_mfma_f32_16x16x32_bf16 v[20:23], v[252:255], a[224:227], v[20:23]
ds_read_b128 a[136:139], v145 offset:62464
v_mfma_f32_16x16x32_bf16 v[20:23], a[36:39], a[228:231], v[20:23]
ds_read_b128 a[236:239], v145 offset:63488
v_mfma_f32_16x16x32_bf16 v[16:19], a[8:11], a[228:231], v[16:19]
ds_read_b128 a[240:243], v145 offset:64512
v_mfma_f32_16x16x32_bf16 v[16:19], a[12:15], a[224:227], v[16:19]
v_mfma_f32_16x16x32_bf16 v[16:19], v[248:251], a[212:215], v[16:19]
ds_read_b128 a[244:247], v146 offset:0
v_mfma_f32_16x16x32_bf16 v[16:19], v[204:207], a[188:191], v[16:19]
v_mfma_f32_16x16x32_bf16 v[16:19], a[28:31], a[252:255], v[16:19]
s_waitcnt lgkmcnt(6)
ds_read_b128 v[24:27], v146 offset:1024
v_mfma_f32_16x16x32_bf16 v[16:19], a[4:7], a[160:163], v[16:19]
v_mfma_f32_16x16x32_bf16 v[16:19], a[56:59], a[0:3], v[16:19]
s_waitcnt lgkmcnt(5)
ds_read_b128 a[228:231], v146 offset:2048
v_mfma_f32_16x16x32_bf16 v[16:19], a[92:95], a[44:47], v[16:19]
v_mfma_f32_16x16x32_bf16 v[20:23], a[64:67], a[44:47], v[20:23]
ds_read_b128 a[212:215], v146 offset:3072
v_mfma_f32_16x16x32_bf16 v[20:23], a[80:83], a[0:3], v[20:23]
v_mfma_f32_16x16x32_bf16 v[20:23], a[24:27], a[160:163], v[20:23]
ds_read_b128 a[188:191], v146 offset:4096
v_mfma_f32_16x16x32_bf16 v[20:23], a[60:63], a[252:255], v[20:23]
v_mfma_f32_16x16x32_bf16 v[20:23], a[32:35], a[216:219], v[20:23]
s_waitcnt lgkmcnt(4)
ds_read_b128 a[224:227], v146 offset:5120
v_mfma_f32_16x16x32_bf16 v[20:23], a[48:51], a[136:139], v[20:23]
v_mfma_f32_16x16x32_bf16 v[20:23], a[84:87], a[236:239], v[20:23]
ds_read_b128 a[44:47], v146 offset:6144
v_mfma_f32_16x16x32_bf16 v[20:23], a[88:91], a[240:243], v[20:23]
v_mfma_f32_16x16x32_bf16 v[16:19], a[68:71], a[240:243], v[16:19]
s_waitcnt vmcnt(8)
ds_read_b128 a[0:3], v146 offset:7168
v_mfma_f32_16x16x32_bf16 v[16:19], a[52:55], a[236:239], v[16:19]
s_barrier
v_mfma_f32_16x16x32_bf16 v[16:19], a[40:43], a[136:139], v[16:19]
ds_read_b128 a[160:163], v146 offset:8192
v_mfma_f32_16x16x32_bf16 v[16:19], a[100:103], a[216:219], v[16:19]
v_mfma_f32_16x16x32_bf16 v[16:19], a[116:119], a[244:247], v[16:19]
s_waitcnt lgkmcnt(4)
ds_read_b128 a[252:255], v146 offset:9216
v_mfma_f32_16x16x32_bf16 v[16:19], a[140:143], v[24:27], v[16:19]
v_mfma_f32_16x16x32_bf16 v[16:19], a[148:151], a[228:231], v[16:19]
ds_read_b128 a[240:243], v146 offset:10240
v_mfma_f32_16x16x32_bf16 v[16:19], a[156:159], a[212:215], v[16:19]
v_mfma_f32_16x16x32_bf16 v[20:23], a[16:19], a[212:215], v[20:23]
ds_read_b128 a[136:139], v146 offset:11264
v_mfma_f32_16x16x32_bf16 v[20:23], a[96:99], a[228:231], v[20:23]
v_mfma_f32_16x16x32_bf16 v[20:23], a[120:123], v[24:27], v[20:23]
ds_read_b128 a[216:219], v146 offset:12288
v_mfma_f32_16x16x32_bf16 v[20:23], a[108:111], a[244:247], v[20:23]
v_mfma_f32_16x16x32_bf16 v[20:23], a[72:75], a[188:191], v[20:23]
s_waitcnt lgkmcnt(4)
ds_read_b128 a[236:239], v146 offset:13312
v_mfma_f32_16x16x32_bf16 v[20:23], a[124:127], a[224:227], v[20:23]
v_mfma_f32_16x16x32_bf16 v[20:23], a[152:155], a[44:47], v[20:23]
ds_read_b128 a[212:215], v146 offset:14336
v_mfma_f32_16x16x32_bf16 v[20:23], a[184:187], a[0:3], v[20:23]
v_mfma_f32_16x16x32_bf16 v[16:19], a[128:131], a[0:3], v[16:19]
ds_read_b128 a[228:231], v146 offset:15360
v_mfma_f32_16x16x32_bf16 v[16:19], a[76:79], a[44:47], v[16:19]
v_mfma_f32_16x16x32_bf16 v[16:19], a[104:107], a[224:227], v[16:19]
ds_read_b128 a[244:247], v146 offset:16384
v_mfma_f32_16x16x32_bf16 v[16:19], a[164:167], a[188:191], v[16:19]
v_mfma_f32_16x16x32_bf16 v[16:19], a[196:199], a[160:163], v[16:19]
s_waitcnt lgkmcnt(4)
buffer_load_dwordx4 v[24:27], v1, s[40:43], 0 offen sc1
ds_read_b128 v[28:31], v146 offset:17408
v_mfma_f32_16x16x32_bf16 v[16:19], a[112:115], a[252:255], v[16:19]
v_mfma_f32_16x16x32_bf16 v[16:19], a[168:171], a[240:243], v[16:19]
ds_read_b128 a[0:3], v146 offset:18432
v_mfma_f32_16x16x32_bf16 v[16:19], a[20:23], a[136:139], v[16:19]
v_mfma_f32_16x16x32_bf16 v[20:23], a[176:179], a[136:139], v[20:23]
ds_read_b128 a[44:47], v146 offset:19456
v_mfma_f32_16x16x32_bf16 v[20:23], a[192:195], a[240:243], v[20:23]
buffer_load_dwordx4 v[32:35], v1, s[40:43], 0 offen offset:1024 sc1
v_mfma_f32_16x16x32_bf16 v[20:23], a[172:175], a[252:255], v[20:23]
s_add_u32 s94, s88, 8192
ds_read_b128 a[188:191], v146 offset:20480
v_mfma_f32_16x16x32_bf16 v[20:23], a[132:135], a[160:163], v[20:23]
s_add_u32 s40, s28, s94
s_addc_u32 s41, s29, 0
v_mfma_f32_16x16x32_bf16 v[20:23], a[180:183], a[216:219], v[20:23]
s_waitcnt lgkmcnt(4)
ds_read_b128 a[136:139], v146 offset:21504
v_mfma_f32_16x16x32_bf16 v[20:23], a[232:235], a[236:239], v[20:23]
buffer_load_dwordx4 v[36:39], v1, s[40:43], 0 offen sc1
v_mfma_f32_16x16x32_bf16 v[20:23], a[144:147], a[212:215], v[20:23]
ds_read_b128 a[224:227], v146 offset:22528
v_mfma_f32_16x16x32_bf16 v[20:23], a[204:207], a[228:231], v[20:23]
v_mfma_f32_16x16x32_bf16 v[16:19], a[248:251], a[228:231], v[16:19]
ds_read_b128 a[160:163], v146 offset:23552
v_mfma_f32_16x16x32_bf16 v[16:19], a[220:223], a[212:215], v[16:19]
buffer_load_dwordx4 v[40:43], v1, s[40:43], 0 offen offset:1024 sc1
v_mfma_f32_16x16x32_bf16 v[16:19], a[208:211], a[236:239], v[16:19]
s_add_u32 s94, s88, 16384
ds_read_b128 a[240:243], v146 offset:24576
v_mfma_f32_16x16x32_bf16 v[16:19], a[200:203], a[216:219], v[16:19]
s_add_u32 s40, s28, s94
s_addc_u32 s41, s29, 0
v_mfma_f32_16x16x32_bf16 v[44:47], v[172:175], a[244:247], 0
s_waitcnt lgkmcnt(4)
v_fma_f32 v60, -v75, v20, v60
v_fma_f32 v61, -v75, v21, v61
v_mfma_f32_16x16x32_bf16 v[44:47], v[180:183], v[28:31], v[44:47]
v_fma_f32 v62, -v75, v22, v62
v_fma_f32 v63, -v75, v23, v63
v_mfma_f32_16x16x32_bf16 v[44:47], v[188:191], a[0:3], v[44:47]
buffer_load_dwordx4 v[48:51], v1, s[40:43], 0 offen sc1
ds_read_b128 a[212:215], v146 offset:25600
v_mfma_f32_16x16x32_bf16 v[44:47], v[196:199], a[44:47], v[44:47]
ds_read_b128 a[216:219], v146 offset:26624
v_mfma_f32_16x16x32_bf16 v[52:55], v[192:195], a[44:47], 0
v_fma_f32 v56, -v75, v16, v56
v_fma_f32 v57, -v75, v17, v57
v_mfma_f32_16x16x32_bf16 v[52:55], v[184:187], a[0:3], v[52:55]
v_fma_f32 v58, -v75, v18, v58
v_fma_f32 v59, -v75, v19, v59
v_mfma_f32_16x16x32_bf16 v[52:55], v[176:179], v[28:31], v[52:55]
buffer_load_dwordx4 v[20:23], v1, s[40:43], 0 offen offset:1024 sc1
ds_read_b128 a[228:231], v146 offset:27648
v_mfma_f32_16x16x32_bf16 v[52:55], v[168:171], a[244:247], v[52:55]
ds_read_b128 a[236:239], v146 offset:28672
v_mfma_f32_16x16x32_bf16 v[52:55], v[200:203], a[188:191], v[52:55]
s_waitcnt lgkmcnt(4)
ds_read_b128 a[44:47], v146 offset:29696
v_mfma_f32_16x16x32_bf16 v[52:55], v[240:243], a[136:139], v[52:55]
v_mfma_f32_16x16x32_bf16 v[52:55], v[252:255], a[224:227], v[52:55]
ds_read_b128 a[0:3], v146 offset:30720
v_mfma_f32_16x16x32_bf16 v[52:55], a[36:39], a[160:163], v[52:55]
v_mfma_f32_16x16x32_bf16 v[44:47], a[8:11], a[160:163], v[44:47]
s_waitcnt vmcnt(9)
ds_read_b128 a[244:247], v146 offset:31744
v_mfma_f32_16x16x32_bf16 v[44:47], a[12:15], a[224:227], v[44:47]
s_barrier
v_mfma_f32_16x16x32_bf16 v[44:47], v[248:251], a[136:139], v[44:47]
ds_read_b128 a[252:255], v144 offset:32768
v_mfma_f32_16x16x32_bf16 v[44:47], v[204:207], a[188:191], v[44:47]
v_mfma_f32_16x16x32_bf16 v[44:47], a[28:31], a[240:243], v[44:47]
s_waitcnt lgkmcnt(4)
ds_read_b128 a[36:39], v144 offset:33792
v_mfma_f32_16x16x32_bf16 v[44:47], a[4:7], a[212:215], v[44:47]
v_mfma_f32_16x16x32_bf16 v[44:47], a[56:59], a[216:219], v[44:47]
ds_read_b128 a[8:11], v144 offset:34816
v_mfma_f32_16x16x32_bf16 v[44:47], a[92:95], a[228:231], v[44:47]
v_mfma_f32_16x16x32_bf16 v[52:55], a[64:67], a[228:231], v[52:55]
ds_read_b128 a[12:15], v144 offset:35840
v_mfma_f32_16x16x32_bf16 v[52:55], a[80:83], a[216:219], v[52:55]
v_mfma_f32_16x16x32_bf16 v[52:55], a[24:27], a[212:215], v[52:55]
ds_read_b128 a[28:31], v144 offset:36864
v_mfma_f32_16x16x32_bf16 v[52:55], a[60:63], a[240:243], v[52:55]
v_mfma_f32_16x16x32_bf16 v[52:55], a[32:35], a[236:239], v[52:55]
s_waitcnt lgkmcnt(4)
ds_read_b128 a[4:7], v144 offset:37888
v_mfma_f32_16x16x32_bf16 v[52:55], a[48:51], a[44:47], v[52:55]
v_mfma_f32_16x16x32_bf16 v[52:55], a[84:87], a[0:3], v[52:55]
ds_read_b128 a[56:59], v144 offset:38912
v_mfma_f32_16x16x32_bf16 v[52:55], a[88:91], a[244:247], v[52:55]
v_mfma_f32_16x16x32_bf16 v[44:47], a[68:71], a[244:247], v[44:47]
ds_read_b128 a[24:27], v144 offset:39936
v_mfma_f32_16x16x32_bf16 v[44:47], a[52:55], a[0:3], v[44:47]
v_mfma_f32_16x16x32_bf16 v[44:47], a[40:43], a[44:47], v[44:47]
ds_read_b128 a[32:35], v144 offset:40960
v_mfma_f32_16x16x32_bf16 v[44:47], a[100:103], a[236:239], v[44:47]
v_mfma_f32_16x16x32_bf16 v[44:47], a[116:119], a[252:255], v[44:47]
s_waitcnt lgkmcnt(4)
ds_read_b128 a[48:51], v144 offset:41984
v_mfma_f32_16x16x32_bf16 v[44:47], a[140:143], a[36:39], v[44:47]
v_mfma_f32_16x16x32_bf16 v[44:47], a[148:151], a[8:11], v[44:47]
ds_read_b128 a[60:63], v144 offset:43008
v_mfma_f32_16x16x32_bf16 v[44:47], a[156:159], a[12:15], v[44:47]
v_mfma_f32_16x16x32_bf16 v[52:55], a[16:19], a[12:15], v[52:55]
ds_read_b128 a[0:3], v144 offset:44032
v_mfma_f32_16x16x32_bf16 v[52:55], a[96:99], a[8:11], v[52:55]
v_mfma_f32_16x16x32_bf16 v[52:55], a[120:123], a[36:39], v[52:55]
ds_read_b128 a[40:43], v144 offset:45056
v_mfma_f32_16x16x32_bf16 v[52:55], a[108:111], a[252:255], v[52:55]
v_mfma_f32_16x16x32_bf16 v[52:55], a[72:75], a[28:31], v[52:55]
s_waitcnt lgkmcnt(4)
ds_read_b128 a[44:47], v144 offset:46080
v_mfma_f32_16x16x32_bf16 v[52:55], a[124:127], a[4:7], v[52:55]
v_mfma_f32_16x16x32_bf16 v[52:55], a[152:155], a[56:59], v[52:55]
ds_read_b128 a[12:15], v144 offset:47104
v_mfma_f32_16x16x32_bf16 v[52:55], a[184:187], a[24:27], v[52:55]
v_mfma_f32_16x16x32_bf16 v[44:47], a[128:131], a[24:27], v[44:47]
ds_read_b128 a[8:11], v144 offset:48128
v_mfma_f32_16x16x32_bf16 v[44:47], a[76:79], a[56:59], v[44:47]
v_mfma_f32_16x16x32_bf16 v[44:47], a[104:107], a[4:7], v[44:47]
v_mfma_f32_16x16x32_bf16 v[44:47], a[164:167], a[28:31], v[44:47]
v_mfma_f32_16x16x32_bf16 v[44:47], a[196:199], a[32:35], v[44:47]
s_waitcnt lgkmcnt(3)
v_mfma_f32_16x16x32_bf16 v[44:47], a[112:115], a[48:51], v[44:47]
v_mfma_f32_16x16x32_bf16 v[44:47], a[168:171], a[60:63], v[44:47]
v_mfma_f32_16x16x32_bf16 v[44:47], a[20:23], a[0:3], v[44:47]
v_mfma_f32_16x16x32_bf16 v[52:55], a[176:179], a[0:3], v[52:55]
v_mfma_f32_16x16x32_bf16 v[52:55], a[192:195], a[60:63], v[52:55]
v_mfma_f32_16x16x32_bf16 v[52:55], a[172:175], a[48:51], v[52:55]
v_mfma_f32_16x16x32_bf16 v[52:55], a[132:135], a[32:35], v[52:55]
v_mfma_f32_16x16x32_bf16 v[52:55], a[180:183], a[40:43], v[52:55]
s_waitcnt lgkmcnt(0)
v_mfma_f32_16x16x32_bf16 v[52:55], a[232:235], a[44:47], v[52:55]
s_waitcnt vmcnt(5)
v_max_u32 v16, v24, v25
v_max3_u32 v16, v16, v26, v27
v_mfma_f32_16x16x32_bf16 v[52:55], a[144:147], a[12:15], v[52:55]
s_waitcnt vmcnt(4)
v_max3_u32 v16, v16, v32, v33
v_max3_u32 v16, v16, v34, v35
v_mfma_f32_16x16x32_bf16 v[52:55], a[204:207], a[8:11], v[52:55]
s_waitcnt vmcnt(3)
v_max3_u32 v16, v16, v36, v37
v_max3_u32 v16, v16, v38, v39
v_mfma_f32_16x16x32_bf16 v[44:47], a[248:251], a[8:11], v[44:47]
s_waitcnt vmcnt(2)
v_max3_u32 v16, v16, v40, v41
v_max3_u32 v16, v16, v42, v43
v_mfma_f32_16x16x32_bf16 v[44:47], a[220:223], a[12:15], v[44:47]
s_waitcnt vmcnt(1)
v_max3_u32 v16, v16, v48, v49
v_max3_u32 v16, v16, v50, v51
v_mfma_f32_16x16x32_bf16 v[44:47], a[208:211], a[44:47], v[44:47]
s_waitcnt vmcnt(0)
v_max3_u32 v16, v16, v20, v21
v_max3_u32 v16, v16, v22, v23
v_mfma_f32_16x16x32_bf16 v[44:47], a[200:203], a[40:43], v[44:47]
v_fma_f32 v68, -v79, v52, v68
v_fma_f32 v69, -v79, v53, v69
v_cmp_eq_u32 vcc, -1, v16
s_nop 0
s_cbranch_vccnz L_pspin8
L_pback8:
v_fma_f32 v70, -v79, v54, v70
v_fma_f32 v71, -v79, v55, v71
s_nop 0
v_fma_f32 v64, -v79, v44, v64
v_fma_f32 v65, -v79, v45, v65
v_fma_f32 v66, -v79, v46, v66
v_fma_f32 v67, -v79, v47, v67
v_dot2c_f32_bf16 v60, s6, v24
v_dot2c_f32_bf16 v61, s7, v24
v_dot2c_f32_bf16 v62, s6, v25
v_dot2c_f32_bf16 v63, s7, v25
v_dot2c_f32_bf16 v56, s6, v26
v_dot2c_f32_bf16 v57, s7, v26
v_dot2c_f32_bf16 v58, s6, v27
v_dot2c_f32_bf16 v59, s7, v27
v_dot2c_f32_bf16 v60, s6, v36
v_dot2c_f32_bf16 v61, s7, v36
v_dot2c_f32_bf16 v62, s6, v37
v_dot2c_f32_bf16 v63, s7, v37
v_dot2c_f32_bf16 v56, s6, v38
v_dot2c_f32_bf16 v57, s7, v38
v_dot2c_f32_bf16 v58, s6, v39
v_dot2c_f32_bf16 v59, s7, v39
v_dot2c_f32_bf16 v60, s6, v48
v_dot2c_f32_bf16 v61, s7, v48
v_dot2c_f32_bf16 v62, s6, v49
v_dot2c_f32_bf16 v63, s7, v49
v_dot2c_f32_bf16 v56, s6, v50
v_dot2c_f32_bf16 v57, s7, v50
v_dot2c_f32_bf16 v58, s6, v51
v_dot2c_f32_bf16 v59, s7, v51
v_cvt_pk_bf16_f32 v60, v60, v61
v_cvt_pk_bf16_f32 v61, v62, v63
v_cvt_pk_bf16_f32 v62, v56, v57
v_cvt_pk_bf16_f32 v63, v58, v59
buffer_store_dwordx4 v[60:63], v151, s[76:79], s92 offen
v_dot2c_f32_bf16 v68, s6, v32
v_dot2c_f32_bf16 v69, s7, v32
v_dot2c_f32_bf16 v70, s6, v33
v_dot2c_f32_bf16 v71, s7, v33
v_dot2c_f32_bf16 v64, s6, v34
v_dot2c_f32_bf16 v65, s7, v34
v_dot2c_f32_bf16 v66, s6, v35
v_dot2c_f32_bf16 v67, s7, v35
v_dot2c_f32_bf16 v68, s6, v40
v_dot2c_f32_bf16 v69, s7, v40
v_dot2c_f32_bf16 v70, s6, v41
v_dot2c_f32_bf16 v71, s7, v41
v_dot2c_f32_bf16 v64, s6, v42
v_dot2c_f32_bf16 v65, s7, v42
v_dot2c_f32_bf16 v66, s6, v43
v_dot2c_f32_bf16 v67, s7, v43
v_dot2c_f32_bf16 v68, s6, v20
v_dot2c_f32_bf16 v69, s7, v20
v_dot2c_f32_bf16 v70, s6, v21
v_dot2c_f32_bf16 v71, s7, v21
v_dot2c_f32_bf16 v64, s6, v22
v_dot2c_f32_bf16 v65, s7, v22
v_dot2c_f32_bf16 v66, s6, v23
v_dot2c_f32_bf16 v67, s7, v23
v_cvt_pk_bf16_f32 v68, v68, v69
v_cvt_pk_bf16_f32 v69, v70, v71
v_cvt_pk_bf16_f32 v70, v64, v65
v_cvt_pk_bf16_f32 v71, v66, v67
buffer_store_dwordx4 v[68:71], v151, s[76:79], s93 offen
L_exit:
s_endpgm
L_wb1:
s_waitcnt vmcnt(0)
buffer_wbl2 sc1
s_waitcnt vmcnt(0)
s_branch L_wb1b
L_wb2:
s_waitcnt vmcnt(0)
buffer_wbl2 sc1
s_waitcnt vmcnt(0)
s_branch L_wb2b
L_spin1:
s_mov_b32 s100, 0x80000
L_spinl1:
buffer_load_dword v8, v14, s[36:39], 0 offen sc1
s_sub_u32 s100, s100, 1
s_waitcnt vmcnt(0)
v_and_b32 v4, 0xff, v8
v_cmp_ne_u32 vcc, 0xff, v4
s_cmp_eq_u32 s100, 0
s_cbranch_scc1 L_back1
s_cbranch_vccnz L_spinl1
s_branch L_back1
L_spin2:
s_mov_b32 s100, 0x80000
L_spinl2:
buffer_load_dword v8, v14, s[28:31], s101 offen sc1
s_sub_u32 s100, s100, 1
s_waitcnt vmcnt(0)
v_cmp_gt_u32 vcc, 1, v8
s_cmp_eq_u32 s100, 0
s_cbranch_scc1 L_back2
s_cbranch_vccnz L_spinl2
s_branch L_back2
L_spin3:
s_mov_b32 s100, 0x80000
L_spinl3:
s_mov_b32 s101, 79695872
buffer_load_dword v8, v10, s[28:31], s101 offen sc1
s_sub_u32 s100, s100, 1
s_waitcnt vmcnt(0)
v_cmp_gt_u32 vcc, 1, v8
s_cmp_eq_u32 s100, 0
s_cbranch_scc1 L_back3
s_cbranch_vccnz L_spinl3
s_branch L_back3
L_DL_0r:
v_cndmask_b32 v248, v232, v12, s[8:9]
v_cndmask_b32 v249, v233, v12, s[10:11]
v_cndmask_b32 v250, v234, v12, s[12:13]
v_cndmask_b32 v251, v235, v12, s[14:15]
v_cndmask_b32 v252, v236, v12, s[8:9]
v_cndmask_b32 v253, v237, v12, s[10:11]
v_cndmask_b32 v254, v238, v12, s[12:13]
v_cndmask_b32 v255, v239, v12, s[14:15]
v_mov_b32 v244, v236
v_mov_b32 v245, v237
v_mov_b32 v246, v238
v_mov_b32 v247, v239
s_nop 1
s_branch L_DL_0b
L_spin4:
s_mov_b32 s100, 0x80000
L_spinl4:
buffer_load_dword v8, v9, s[28:31], s27 offen sc1
s_sub_u32 s100, s100, 1
s_waitcnt vmcnt(0)
v_cmp_gt_u32 vcc, 1, v8
s_cmp_eq_u32 s100, 0
s_cbranch_scc1 L_back4
s_cbranch_vccnz L_spinl4
s_branch L_back4
L_DL_1r:
v_cndmask_b32 v248, v232, v12, s[8:9]
v_cndmask_b32 v249, v233, v12, s[10:11]
v_cndmask_b32 v250, v234, v12, s[12:13]
v_cndmask_b32 v251, v235, v12, s[14:15]
v_cndmask_b32 v252, v236, v12, s[8:9]
v_cndmask_b32 v253, v237, v12, s[10:11]
v_cndmask_b32 v254, v238, v12, s[12:13]
v_cndmask_b32 v255, v239, v12, s[14:15]
v_mov_b32 v244, v236
v_mov_b32 v245, v237
v_mov_b32 v246, v238
v_mov_b32 v247, v239
s_nop 1
s_branch L_DL_1b
L_spin5:
s_mov_b32 s100, 0x80000
L_spinl5:
buffer_load_dword v8, v9, s[28:31], s27 offen sc1
s_sub_u32 s100, s100, 1
s_waitcnt vmcnt(0)
v_cmp_gt_u32 vcc, 1, v8
s_cmp_eq_u32 s100, 0
s_cbranch_scc1 L_back5
s_cbranch_vccnz L_spinl5
s_branch L_back5
L_DFLr:
v_cndmask_b32 v248, v232, v12, s[8:9]
v_cndmask_b32 v249, v233, v12, s[10:11]
v_cndmask_b32 v250, v234, v12, s[12:13]
v_cndmask_b32 v251, v235, v12, s[14:15]
v_cndmask_b32 v252, v236, v12, s[8:9]
v_cndmask_b32 v253, v237, v12, s[10:11]
v_cndmask_b32 v254, v238, v12, s[12:13]
v_cndmask_b32 v255, v239, v12, s[14:15]
v_mov_b32 v244, v236
v_mov_b32 v245, v237
v_mov_b32 v246, v238
v_mov_b32 v247, v239
s_nop 1
s_branch L_DFLb
L_spin6:
s_mov_b32 s100, 0x80000
L_spinl6:
s_mov_b32 s101, 79695872
buffer_load_dword v8, v10, s[28:31], s101 offen sc1
s_sub_u32 s100, s100, 1
s_waitcnt vmcnt(0)
v_cmp_gt_u32 vcc, 1, v8
s_cmp_eq_u32 s100, 0
s_cbranch_scc1 L_back6
s_cbranch_vccnz L_spinl6
s_branch L_back6
L_spin7:
s_mov_b32 s100, 0x80000
L_spinl7:
buffer_load_dword v8, v9, s[28:31], s27 offen sc1
s_sub_u32 s100, s100, 1
s_waitcnt vmcnt(0)
v_cmp_gt_u32 vcc, 1, v8
s_cmp_eq_u32 s100, 0
s_cbranch_scc1 L_back7
s_cbranch_vccnz L_spinl7
s_branch L_back7
L_spin8:
s_mov_b32 s100, 0x80000
L_spinl8:
buffer_load_dword v8, v9, s[28:31], s27 offen sc1
s_sub_u32 s100, s100, 1
s_waitcnt vmcnt(0)
v_cmp_gt_u32 vcc, 1, v8
s_cmp_eq_u32 s100, 0
s_cbranch_scc1 L_back8
s_cbranch_vccnz L_spinl8
s_branch L_back8
L_spin9:
s_mov_b32 s100, 0x80000
L_spinl9:
buffer_load_dword v8, v148, s[28:31], s90 offen sc1
s_sub_u32 s100, s100, 1
s_waitcnt vmcnt(0)
v_cmp_gt_u32 vcc, 1, v8
s_cmp_eq_u32 s100, 0
s_cbranch_scc1 L_back9
s_cbranch_vccnz L_spinl9
s_branch L_back9
L_spin10:
s_mov_b32 s100, 0x80000
L_spinl10:
buffer_load_dword v8, v148, s[28:31], s90 offen sc1
s_sub_u32 s100, s100, 1
s_waitcnt vmcnt(0)
v_cmp_gt_u32 vcc, 1, v8
s_cmp_eq_u32 s100, 0
s_cbranch_scc1 L_back10
s_cbranch_vccnz L_spinl10
s_branch L_back10
L_spin11:
s_mov_b32 s100, 0x80000
L_spinl11:
buffer_load_dword v8, v149, s[28:31], s87 offen sc1
s_sub_u32 s100, s100, 1
s_waitcnt vmcnt(0)
v_cmp_gt_u32 vcc, 1, v8
s_cmp_eq_u32 s100, 0
s_cbranch_scc1 L_back11
s_cbranch_vccnz L_spinl11
s_branch L_back11
L_pspin8:
s_mov_b32 s100, 0x80000
L_pspinl8:
s_add_u32 s94, s88, 0
s_add_u32 s40, s28, s94
s_addc_u32 s41, s29, 0
buffer_load_dwordx4 v[24:27], v1, s[40:43], 0 offen sc1
buffer_load_dwordx4 v[32:35], v1, s[40:43], 0 offen offset:1024 sc1
s_add_u32 s94, s88, 8192
s_add_u32 s40, s28, s94
s_addc_u32 s41, s29, 0
buffer_load_dwordx4 v[36:39], v1, s[40:43], 0 offen sc1
buffer_load_dwordx4 v[40:43], v1, s[40:43], 0 offen offset:1024 sc1
s_add_u32 s94, s88, 16384
s_add_u32 s40, s28, s94
s_addc_u32 s41, s29, 0
buffer_load_dwordx4 v[48:51], v1, s[40:43], 0 offen sc1
buffer_load_dwordx4 v[20:23], v1, s[40:43], 0 offen offset:1024 sc1
s_sub_u32 s100, s100, 1
s_waitcnt vmcnt(0)
v_max_u32 v16, v24, v25
v_max3_u32 v16, v16, v26, v27
v_max3_u32 v16, v16, v32, v33
v_max3_u32 v16, v16, v34, v35
v_max3_u32 v16, v16, v36, v37
v_max3_u32 v16, v16, v38, v39
v_max3_u32 v16, v16, v40, v41
v_max3_u32 v16, v16, v42, v43
v_max3_u32 v16, v16, v48, v49
v_max3_u32 v16, v16, v50, v51
v_max3_u32 v16, v16, v20, v21
v_max3_u32 v16, v16, v22, v23
v_cmp_eq_u32 vcc, -1, v16
s_cmp_eq_u32 s100, 0
s_cbranch_scc1 L_pback8
s_cbranch_vccnz L_pspinl8
s_branch L_pback8
L_gspin8:
s_mov_b32 s100, 0x80000
L_gspinl8:
buffer_load_dwordx4 v[72:75], v150, s[28:31], s89 offen offset:32 sc1
buffer_load_dwordx4 v[76:79], v150, s[28:31], s89 offen offset:0 sc1
s_sub_u32 s100, s100, 1
s_waitcnt vmcnt(0)
v_min3_u32 v96, v72, v73, v74
v_min3_u32 v96, v96, v75, v76
v_min3_u32 v96, v96, v77, v78
v_min3_u32 v96, v96, v79, v76
v_cmp_eq_u32 vcc, 0, v96
s_cmp_eq_u32 s100, 0
s_cbranch_scc1 L_gback8
s_cbranch_vccnz L_gspinl8
s_branch L_gback8
L_redo:
s_waitcnt vmcnt(0) lgkmcnt(0)
s_barrier
s_mov_b32 s67, 1
s_sub_u32 s7, 64, s59
s_lshl_b32 s6, s7, 5
s_sub_u32 s101, s59, 1
s_lshl_b32 s101, s101, 5
v_and_b32 v4, 15, v0
v_lshrrev_b32 v6, 4, v0
v_lshlrev_b32 v6, 2, v6
v_sub_u32 v4, v4, v6
v_add_u32 v84, s6, v4
v_add_u32 v85, 16, v84
v_add_u32 v86, s101, v4
v_add_u32 v87, 16, v86
v_mov_b32 v80, 0xff800000
v_mov_b32 v81, 0xff800000
v_mov_b32 v82, 0xff800000
v_mov_b32 v83, 0xff800000
s_sub_u32 s26, s56, s82
s_mov_b32 s58, 0
L_redo1:
s_add_u32 s101, s26, 0
buffer_load_dwordx4 a[0:3], v1, s[28:31], s101 offen offset:0 sc1
buffer_load_dwordx4 a[4:7], v1, s[28:31], s101 offen offset:1024 sc1
buffer_load_dwordx4 a[16:19], v1, s[28:31], s101 offen offset:2048 sc1
buffer_load_dwordx4 a[20:23], v1, s[28:31], s101 offen offset:3072 sc1
s_add_u32 s101, s26, 8192
buffer_load_dwordx4 a[8:11], v1, s[28:31], s101 offen offset:0 sc1
buffer_load_dwordx4 a[12:15], v1, s[28:31], s101 offen offset:1024 sc1
buffer_load_dwordx4 a[24:27], v1, s[28:31], s101 offen offset:2048 sc1
buffer_load_dwordx4 a[28:31], v1, s[28:31], s101 offen offset:3072 sc1
s_lshl_b32 s6, s58, 5
s_waitcnt vmcnt(0)
v_mfma_f32_16x16x32_bf16 v[88:91], a[0:3], v[16:19], 0
v_mfma_f32_16x16x32_bf16 v[88:91], a[4:7], v[20:23], v[88:91]
v_mfma_f32_16x16x32_bf16 v[88:91], a[8:11], v[24:27], v[88:91]
v_mfma_f32_16x16x32_bf16 v[88:91], a[12:15], v[28:31], v[88:91]
s_add_u32 s101, s6, 0
v_cmp_le_i32 vcc, s101, v84
s_nop 5
v_cndmask_b32 v7, v80, v88, vcc
v_max_f32 v80, v80, v7
s_add_u32 s101, s6, 1
v_cmp_le_i32 vcc, s101, v84
s_nop 1
v_cndmask_b32 v7, v80, v89, vcc
v_max_f32 v80, v80, v7
s_add_u32 s101, s6, 2
v_cmp_le_i32 vcc, s101, v84
s_nop 1
v_cndmask_b32 v7, v80, v90, vcc
v_max_f32 v80, v80, v7
s_add_u32 s101, s6, 3
v_cmp_le_i32 vcc, s101, v84
s_nop 1
v_cndmask_b32 v7, v80, v91, vcc
v_max_f32 v80, v80, v7
v_mfma_f32_16x16x32_bf16 v[88:91], a[16:19], v[16:19], 0
v_mfma_f32_16x16x32_bf16 v[88:91], a[20:23], v[20:23], v[88:91]
v_mfma_f32_16x16x32_bf16 v[88:91], a[24:27], v[24:27], v[88:91]
v_mfma_f32_16x16x32_bf16 v[88:91], a[28:31], v[28:31], v[88:91]
s_add_u32 s101, s6, 16
v_cmp_le_i32 vcc, s101, v84
s_nop 5
v_cndmask_b32 v7, v80, v88, vcc
v_max_f32 v80, v80, v7
s_add_u32 s101, s6, 17
v_cmp_le_i32 vcc, s101, v84
s_nop 1
v_cndmask_b32 v7, v80, v89, vcc
v_max_f32 v80, v80, v7
s_add_u32 s101, s6, 18
v_cmp_le_i32 vcc, s101, v84
s_nop 1
v_cndmask_b32 v7, v80, v90, vcc
v_max_f32 v80, v80, v7
s_add_u32 s101, s6, 19
v_cmp_le_i32 vcc, s101, v84
s_nop 1
v_cndmask_b32 v7, v80, v91, vcc
v_max_f32 v80, v80, v7
v_mfma_f32_16x16x32_bf16 v[88:91], a[0:3], v[32:35], 0
v_mfma_f32_16x16x32_bf16 v[88:91], a[4:7], v[36:39], v[88:91]
v_mfma_f32_16x16x32_bf16 v[88:91], a[8:11], v[40:43], v[88:91]
v_mfma_f32_16x16x32_bf16 v[88:91], a[12:15], v[44:47], v[88:91]
s_add_u32 s101, s6, 0
v_cmp_le_i32 vcc, s101, v85
s_nop 5
v_cndmask_b32 v7, v81, v88, vcc
v_max_f32 v81, v81, v7
s_add_u32 s101, s6, 1
v_cmp_le_i32 vcc, s101, v85
s_nop 1
v_cndmask_b32 v7, v81, v89, vcc
v_max_f32 v81, v81, v7
s_add_u32 s101, s6, 2
v_cmp_le_i32 vcc, s101, v85
s_nop 1
v_cndmask_b32 v7, v81, v90, vcc
v_max_f32 v81, v81, v7
s_add_u32 s101, s6, 3
v_cmp_le_i32 vcc, s101, v85
s_nop 1
v_cndmask_b32 v7, v81, v91, vcc
v_max_f32 v81, v81, v7
v_mfma_f32_16x16x32_bf16 v[88:91], a[16:19], v[32:35], 0
v_mfma_f32_16x16x32_bf16 v[88:91], a[20:23], v[36:39], v[88:91]
v_mfma_f32_16x16x32_bf16 v[88:91], a[24:27], v[40:43], v[88:91]
v_mfma_f32_16x16x32_bf16 v[88:91], a[28:31], v[44:47], v[88:91]
s_add_u32 s101, s6, 16
v_cmp_le_i32 vcc, s101, v85
s_nop 5
v_cndmask_b32 v7, v81, v88, vcc
v_max_f32 v81, v81, v7
s_add_u32 s101, s6, 17
v_cmp_le_i32 vcc, s101, v85
s_nop 1
v_cndmask_b32 v7, v81, v89, vcc
v_max_f32 v81, v81, v7
s_add_u32 s101, s6, 18
v_cmp_le_i32 vcc, s101, v85
s_nop 1
v_cndmask_b32 v7, v81, v90, vcc
v_max_f32 v81, v81, v7
s_add_u32 s101, s6, 19
v_cmp_le_i32 vcc, s101, v85
s_nop 1
v_cndmask_b32 v7, v81, v91, vcc
v_max_f32 v81, v81, v7
v_mfma_f32_16x16x32_bf16 v[88:91], a[0:3], v[48:51], 0
v_mfma_f32_16x16x32_bf16 v[88:91], a[4:7], v[52:55], v[88:91]
v_mfma_f32_16x16x32_bf16 v[88:91], a[8:11], v[56:59], v[88:91]
v_mfma_f32_16x16x32_bf16 v[88:91], a[12:15], v[60:63], v[88:91]
s_add_u32 s101, s6, 0
v_cmp_le_i32 vcc, s101, v86
s_nop 5
v_cndmask_b32 v7, v82, v88, vcc
v_max_f32 v82, v82, v7
s_add_u32 s101, s6, 1
v_cmp_le_i32 vcc, s101, v86
s_nop 1
v_cndmask_b32 v7, v82, v89, vcc
v_max_f32 v82, v82, v7
s_add_u32 s101, s6, 2
v_cmp_le_i32 vcc, s101, v86
s_nop 1
v_cndmask_b32 v7, v82, v90, vcc
v_max_f32 v82, v82, v7
s_add_u32 s101, s6, 3
v_cmp_le_i32 vcc, s101, v86
s_nop 1
v_cndmask_b32 v7, v82, v91, vcc
v_max_f32 v82, v82, v7
v_mfma_f32_16x16x32_bf16 v[88:91], a[16:19], v[48:51], 0
v_mfma_f32_16x16x32_bf16 v[88:91], a[20:23], v[52:55], v[88:91]
v_mfma_f32_16x16x32_bf16 v[88:91], a[24:27], v[56:59], v[88:91]
v_mfma_f32_16x16x32_bf16 v[88:91], a[28:31], v[60:63], v[88:91]
s_add_u32 s101, s6, 16
v_cmp_le_i32 vcc, s101, v86
s_nop 5
v_cndmask_b32 v7, v82, v88, vcc
v_max_f32 v82, v82, v7
s_add_u32 s101, s6, 17
v_cmp_le_i32 vcc, s101, v86
s_nop 1
v_cndmask_b32 v7, v82, v89, vcc
v_max_f32 v82, v82, v7
s_add_u32 s101, s6, 18
v_cmp_le_i32 vcc, s101, v86
s_nop 1
v_cndmask_b32 v7, v82, v90, vcc
v_max_f32 v82, v82, v7
s_add_u32 s101, s6, 19
v_cmp_le_i32 vcc, s101, v86
s_nop 1
v_cndmask_b32 v7, v82, v91, vcc
v_max_f32 v82, v82, v7
v_mfma_f32_16x16x32_bf16 v[88:91], a[0:3], v[64:67], 0
v_mfma_f32_16x16x32_bf16 v[88:91], a[4:7], v[68:71], v[88:91]
v_mfma_f32_16x16x32_bf16 v[88:91], a[8:11], v[72:75], v[88:91]
v_mfma_f32_16x16x32_bf16 v[88:91], a[12:15], v[76:79], v[88:91]
s_add_u32 s101, s6, 0
v_cmp_le_i32 vcc, s101, v87
s_nop 5
v_cndmask_b32 v7, v83, v88, vcc
v_max_f32 v83, v83, v7
s_add_u32 s101, s6, 1
v_cmp_le_i32 vcc, s101, v87
s_nop 1
v_cndmask_b32 v7, v83, v89, vcc
v_max_f32 v83, v83, v7
s_add_u32 s101, s6, 2
v_cmp_le_i32 vcc, s101, v87
s_nop 1
v_cndmask_b32 v7, v83, v90, vcc
v_max_f32 v83, v83, v7
s_add_u32 s101, s6, 3
v_cmp_le_i32 vcc, s101, v87
s_nop 1
v_cndmask_b32 v7, v83, v91, vcc
v_max_f32 v83, v83, v7
v_mfma_f32_16x16x32_bf16 v[88:91], a[16:19], v[64:67], 0
v_mfma_f32_16x16x32_bf16 v[88:91], a[20:23], v[68:71], v[88:91]
v_mfma_f32_16x16x32_bf16 v[88:91], a[24:27], v[72:75], v[88:91]
v_mfma_f32_16x16x32_bf16 v[88:91], a[28:31], v[76:79], v[88:91]
s_add_u32 s101, s6, 16
v_cmp_le_i32 vcc, s101, v87
s_nop 5
v_cndmask_b32 v7, v83, v88, vcc
v_max_f32 v83, v83, v7
s_add_u32 s101, s6, 17
v_cmp_le_i32 vcc, s101, v87
s_nop 1
v_cndmask_b32 v7, v83, v89, vcc
v_max_f32 v83, v83, v7
s_add_u32 s101, s6, 18
v_cmp_le_i32 vcc, s101, v87
s_nop 1
v_cndmask_b32 v7, v83, v90, vcc
v_max_f32 v83, v83, v7
s_add_u32 s101, s6, 19
v_cmp_le_i32 vcc, s101, v87
s_nop 1
v_cndmask_b32 v7, v83, v91, vcc
v_max_f32 v83, v83, v7
s_add_u32 s26, s26, 17408
s_add_u32 s58, s58, 1
s_cmp_le_u32 s58, s7
s_cbranch_scc1 L_redo1
v_mov_b32 v7, v80
s_nop 1
v_permlane32_swap_b32 v80, v7
v_max_f32 v80, v80, v7
v_mov_b32 v7, v80
s_nop 1
v_permlane16_swap_b32 v80, v7
v_max_f32 v80, v80, v7
v_sub_f32 v232, 0, v80
v_sub_f32 v233, 0, v80
v_sub_f32 v234, 0, v80
v_sub_f32 v235, 0, v80
v_mov_b32 v7, v81
s_nop 1
v_permlane32_swap_b32 v81, v7
v_max_f32 v81, v81, v7
v_mov_b32 v7, v81
s_nop 1
v_permlane16_swap_b32 v81, v7
v_max_f32 v81, v81, v7
v_sub_f32 v236, 0, v81
v_sub_f32 v237, 0, v81
v_sub_f32 v238, 0, v81
v_sub_f32 v239, 0, v81
v_mov_b32 v7, v82
s_nop 1
v_permlane32_swap_b32 v82, v7
v_max_f32 v82, v82, v7
v_mov_b32 v7, v82
s_nop 1
v_permlane16_swap_b32 v82, v7
v_max_f32 v82, v82, v7
v_sub_f32 v240, 0, v82
v_sub_f32 v241, 0, v82
v_sub_f32 v242, 0, v82
v_sub_f32 v243, 0, v82
v_mov_b32 v7, v83
s_nop 1
v_permlane32_swap_b32 v83, v7
v_max_f32 v83, v83, v7
v_mov_b32 v7, v83
s_nop 1
v_permlane16_swap_b32 v83, v7
v_max_f32 v83, v83, v7
v_sub_f32 v244, 0, v83
v_sub_f32 v245, 0, v83
v_sub_f32 v246, 0, v83
v_sub_f32 v247, 0, v83
v_cndmask_b32 v248, v240, v12, s[8:9]
v_cndmask_b32 v249, v241, v12, s[10:11]
v_cndmask_b32 v250, v242, v12, s[12:13]
v_cndmask_b32 v251, v243, v12, s[14:15]
v_cndmask_b32 v252, v244, v12, s[8:9]
v_cndmask_b32 v253, v245, v12, s[10:11]
v_cndmask_b32 v254, v246, v12, s[12:13]
v_cndmask_b32 v255, v247, v12, s[14:15]
v_mov_b32 v10, 0
s_mov_b32 s65, 4294949888
s_mov_b64 s[16:17], 0
s_mov_b32 s25, 1073741824
v_mov_b32 v112, 0
v_mov_b32 v113, 0
v_mov_b32 v114, 0
v_mov_b32 v115, 0
v_mov_b32 v116, 0
v_mov_b32 v117, 0
v_mov_b32 v118, 0
v_mov_b32 v119, 0
v_mov_b32 v120, 0
v_mov_b32 v121, 0
v_mov_b32 v122, 0
v_mov_b32 v123, 0
v_mov_b32 v124, 0
v_mov_b32 v125, 0
v_mov_b32 v126, 0
v_mov_b32 v127, 0
v_mov_b32 v128, 0
v_mov_b32 v129, 0
v_mov_b32 v130, 0
v_mov_b32 v131, 0
v_mov_b32 v132, 0
v_mov_b32 v133, 0
v_mov_b32 v134, 0
v_mov_b32 v135, 0
v_mov_b32 v136, 0
v_mov_b32 v137, 0
v_mov_b32 v138, 0
v_mov_b32 v139, 0
v_mov_b32 v140, 0
v_mov_b32 v141, 0
v_mov_b32 v142, 0
v_mov_b32 v143, 0
v_accvgpr_write_b32 a132, 0
v_accvgpr_write_b32 a133, 0
v_accvgpr_write_b32 a134, 0
v_accvgpr_write_b32 a135, 0
s_add_u32 m0, s63, 32768
s_add_u32 s101, s56, 0
buffer_load_dwordx4 v1, s[28:31], s101 offen sc1 lds
buffer_load_dwordx4 v1, s[28:31], s101 offen offset:1024 sc1 lds
buffer_load_dwordx4 v1, s[28:31], s101 offen offset:2048 sc1 lds
buffer_load_dwordx4 v1, s[28:31], s101 offen offset:3072 sc1 lds
s_add_u32 m0, s63, 65536
s_add_u32 s101, s56, 17408
buffer_load_dwordx4 v1, s[28:31], s101 offen sc1 lds
buffer_load_dwordx4 v1, s[28:31], s101 offen offset:1024 sc1 lds
buffer_load_dwordx4 v1, s[28:31], s101 offen offset:2048 sc1 lds
buffer_load_dwordx4 v1, s[28:31], s101 offen offset:3072 sc1 lds
s_add_u32 m0, s63, 98304
s_add_u32 s101, s56, 34816
buffer_load_dwordx4 v1, s[28:31], s101 offen sc1 lds
buffer_load_dwordx4 v1, s[28:31], s101 offen offset:1024 sc1 lds
buffer_load_dwordx4 v1, s[28:31], s101 offen offset:2048 sc1 lds
buffer_load_dwordx4 v1, s[28:31], s101 offen offset:3072 sc1 lds
s_add_u32 m0, s63, 114688
s_add_u32 s101, s56, 1096704
buffer_load_dwordx4 v1, s[28:31], s101 offen sc1 lds
buffer_load_dwordx4 v1, s[28:31], s101 offen offset:1024 sc1 lds
buffer_load_dwordx4 v1, s[28:31], s101 offen offset:2048 sc1 lds
buffer_load_dwordx4 v1, s[28:31], s101 offen offset:3072 sc1 lds
s_add_u32 m0, s63, 0
s_add_u32 s101, s56, 52224
buffer_load_dwordx4 v1, s[28:31], s101 offen sc1 lds
buffer_load_dwordx4 v1, s[28:31], s101 offen offset:1024 sc1 lds
buffer_load_dwordx4 v1, s[28:31], s101 offen offset:2048 sc1 lds
buffer_load_dwordx4 v1, s[28:31], s101 offen offset:3072 sc1 lds
s_add_u32 m0, s63, 16384
s_add_u32 s101, s56, 1079296
buffer_load_dwordx4 v1, s[28:31], s101 offen sc1 lds
buffer_load_dwordx4 v1, s[28:31], s101 offen offset:1024 sc1 lds
buffer_load_dwordx4 v1, s[28:31], s101 offen offset:2048 sc1 lds
buffer_load_dwordx4 v1, s[28:31], s101 offen offset:3072 sc1 lds
v_add_u32 v3, 65536, v1
s_waitcnt vmcnt(0)
s_barrier
ds_read_b128 a[0:3], v3 offset:0
ds_read_b128 a[4:7], v3 offset:1024
ds_read_b128 a[8:11], v3 offset:8192
ds_read_b128 a[12:15], v3 offset:9216
ds_read_b128 a[16:19], v3 offset:11264
ds_read_b128 a[20:23], v3 offset:10240
ds_read_b128 a[24:27], v3 offset:3072
ds_read_b128 a[28:31], v3 offset:2048
s_waitcnt lgkmcnt(0)
ds_read_b128 a[64:67], v3 offset:4096
ds_read_b128 a[68:71], v3 offset:5120
ds_read_b128 a[72:75], v3 offset:6144
ds_read_b128 a[76:79], v3 offset:7168
ds_read_b128 a[80:83], v3 offset:12288
ds_read_b128 a[84:87], v3 offset:13312
ds_read_b128 a[88:91], v3 offset:14336
ds_read_b128 a[92:95], v3 offset:15360
s_waitcnt lgkmcnt(0)
s_barrier
s_branch L_att
L_last:
s_endpgm
.section .rodata,"a"
.p2align 6
.amdhsa_kernel gated_mix__compressed_kv_cla__dense_activation_relu__prompt_kernel
  .amdhsa_next_free_vgpr 512
  .amdhsa_next_free_sgpr 102
  .amdhsa_accum_offset 256
  .amdhsa_group_segment_fixed_size 0
  .amdhsa_kernarg_size 104
  .amdhsa_user_sgpr_count 2
  .amdhsa_user_sgpr_kernarg_segment_ptr 1
  .amdhsa_system_sgpr_workgroup_id_x 1
.end_amdhsa_kernel
```
